```python
import torch

def _softmax(x, axis=-1):
    return torch.softmax(x, dim=axis)
def _gelu(x):
    return torch.nn.functional.gelu(x, approximate="tanh")
def _silu(x):
    return torch.nn.functional.silu(x)
def _sigmoid(x):
    return torch.sigmoid(x)
def _layernorm(x, axis=-1, eps=1e-5):
    m = x.mean(dim=axis, keepdim=True)
    v = x.var(dim=axis, keepdim=True, unbiased=False)
    return (x - m) / torch.sqrt(v + eps)
def _scatter_add(tgt, idx, src, axis=0):
    return tgt.clone().index_add_(axis, idx, src)
def _segment_sum(src, seg, n):
    out = torch.zeros((n,) + src.shape[1:], dtype=src.dtype)
    return out.index_add_(0, seg, src)
def _pad(x, pw):
    flat = tuple(v for pair in reversed(pw) for v in pair)
    return torch.nn.functional.pad(x, flat)

kernel_name = 'standalone__mha_block_cached__near_ridge'

def setup_inputs():

    _w = (lambda a: (lambda t: t.to(torch.bfloat16) if t.is_floating_point() else t)(torch.as_tensor(a)))
    B, Sq, D = 16, 192, 640
    H, Sk, Dh = 32, 512, 192
    return {
        "x": _w((lambda *s: torch.randn(*s, dtype=torch.bfloat16) * 0.8)(B, Sq, D)),
        "k_cache": _w((lambda *s: torch.randn(*s, dtype=torch.bfloat16) * 0.8)(B, H, Sk, Dh)),
        "v_cache": _w((lambda *s: torch.randn(*s, dtype=torch.bfloat16) * 0.05)(B, H, Sk, Dh)),
        "wq": _w((lambda *s: torch.randn(*s, dtype=torch.bfloat16) * 0.8)(D, H * Dh) * (D ** -0.5)),
        "wo": _w((lambda *s: torch.randn(*s, dtype=torch.bfloat16) * 0.05)(H * Dh, D) * ((H * Dh) ** -0.5)),
    }

def reference(x, k_cache, v_cache, wq, wo):
    B, Sq, D = x.shape
    H, Dh = 32, 192
    q = (lambda x, *d: x.permute(*d))((x @ wq).reshape(B, Sq, H, Dh), 0, 2, 1, 3)
    scores = torch.einsum("bhqd,bhkd->bhqk", q, k_cache) * (Dh ** -0.5)
    p = _softmax(scores, axis=-1)
    o = torch.einsum("bhqk,bhkd->bhqd", p, v_cache)
    return (lambda x, *d: x.permute(*d))(o, 0, 2, 1, 3).reshape(B, Sq, H * Dh) @ wo
```

```asm
; @launch grid=(256,1,1) block=(256,1,1) lds=163840
.amdgcn_target "amdgcn-amd-amdhsa--gfx950"
.text
.globl standalone__mha_block_cached__near_ridge_kernel
.p2align 8
.type standalone__mha_block_cached__near_ridge_kernel,@function
standalone__mha_block_cached__near_ridge_kernel:
    s_cmp_ge_u32 s2, 256
    s_cbranch_scc1 L_standalone__mha_block_cached__near_ridge_kernel_exit
    s_load_dwordx8 s[48:55], s[0:1], 0
    s_load_dwordx4 s[56:59], s[0:1], 32
    s_load_dwordx4 s[96:99], s[0:1], 48
    v_lshrrev_b32 v1, 6, v0
    v_lshlrev_b32 v110, 4, v0
    v_and_b32 v0, 63, v0
    v_readfirstlane_b32 s28, v1
    s_getpc_b64 s[24:25]
L_pc:
    s_sub_u32 s24, s24, (L_pc-standalone__mha_block_cached__near_ridge_kernel)
    s_subb_u32 s25, s25, 0
    s_mov_b32 s26, (L_standalone__mha_block_cached__near_ridge_kernel_end-standalone__mha_block_cached__near_ridge_kernel)
    s_mov_b32 s27, 0x20000
    s_lshr_b32 s43, s2, 3
    s_lshl_b32 s42, s43, 12
    buffer_load_dwordx4 v[40:43], v110, s[24:27], s42 offen
    s_and_b32 s42, s2, 7
    s_lshr_b32 s33, s42, 2
    s_lshl_b32 s33, s33, 3
    s_and_b32 s44, s43, 7
    s_add_u32 s33, s33, s44
    s_and_b32 s34, s42, 3
    s_lshl_b32 s34, s34, 3
    s_lshr_b32 s44, s43, 3
    s_add_u32 s34, s34, s44
    s_mov_b32 s44, s28
    s_mul_i32 s29, s44, 6144
    s_mul_i32 s38, s44, 6160
    s_mul_i32 s44, s44, 48
    v_lshrrev_b32 v2, 3, v0
    v_and_b32 v3, 7, v0
    v_lshrrev_b32 v4, 4, v0
    v_and_b32 v5, 15, v0
    v_add_u32 v107, s44, v2
    v_and_b32 v100, 6, v2
    v_xor_b32 v100, v100, v3
    v_mul_u32_u24 v101, 1280, v107
    v_lshl_add_u32 v8, v100, 4, v101
    v_add_u32 v108, 0, v107
    v_mul_u32_u24 v100, 171, v108
    v_lshrrev_b32 v100, 9, v100
    v_mul_u32_u24 v101, 3, v100
    v_sub_u32 v101, v108, v101
    v_lshlrev_b32 v101, 3, v101
    v_and_b32 v102, 2, v100
    v_xor_b32 v102, v102, v3
    v_and_b32 v103, 2, v100
    v_lshlrev_b32 v103, 1, v103
    v_xor_b32 v103, v103, v3
    v_add_u32 v103, v103, v101
    v_lshlrev_b32 v103, 4, v103
    v_mul_u32_u24 v101, 12288, v100
    v_add_u32 v14, v101, v103
    v_add_u32 v9, 9216, v8
    v_add_u32 v108, 8, v107
    v_mul_u32_u24 v100, 171, v108
    v_lshrrev_b32 v100, 9, v100
    v_mul_u32_u24 v101, 3, v100
    v_sub_u32 v101, v108, v101
    v_lshlrev_b32 v101, 3, v101
    v_and_b32 v102, 2, v100
    v_xor_b32 v102, v102, v3
    v_and_b32 v103, 2, v100
    v_lshlrev_b32 v103, 1, v103
    v_xor_b32 v103, v103, v3
    v_add_u32 v103, v103, v101
    v_lshlrev_b32 v103, 4, v103
    v_subrev_u32 v103, 1024, v103
    v_mul_u32_u24 v101, 12288, v100
    v_add_u32 v15, v101, v103
    v_add_u32 v10, 18432, v8
    v_add_u32 v108, 16, v107
    v_mul_u32_u24 v100, 171, v108
    v_lshrrev_b32 v100, 9, v100
    v_mul_u32_u24 v101, 3, v100
    v_sub_u32 v101, v108, v101
    v_lshlrev_b32 v101, 3, v101
    v_and_b32 v102, 2, v100
    v_xor_b32 v102, v102, v3
    v_and_b32 v103, 2, v100
    v_lshlrev_b32 v103, 1, v103
    v_xor_b32 v103, v103, v3
    v_add_u32 v103, v103, v101
    v_lshlrev_b32 v103, 4, v103
    v_subrev_u32 v103, 2048, v103
    v_mul_u32_u24 v101, 12288, v100
    v_add_u32 v16, v101, v103
    v_add_u32 v11, 27648, v8
    v_add_u32 v17, 98304, v14
    v_add_u32 v12, 40960, v8
    v_add_u32 v18, 98304, v15
    v_add_u32 v13, 50176, v8
    v_add_u32 v19, 98304, v16
    s_waitcnt lgkmcnt(0)
    s_mov_b32 s46, s58
    s_mov_b32 s39, s59
    s_mov_b32 s58, s98
    s_mov_b32 s59, s99
    s_mov_b32 s100, s96
    s_mov_b32 s101, s97
    s_mul_i32 s42, s33, 245760
    s_add_u32 s4, s48, s42
    s_addc_u32 s5, s49, 0
    s_mov_b32 s6, 245760
    s_mov_b32 s7, 0x20000
    s_mul_i32 s42, s34, 384
    s_sub_u32 s43, 7864320, s42
    s_add_u32 s8, s54, s42
    s_addc_u32 s9, s55, 0
    s_mov_b32 s10, s43
    s_mov_b32 s11, 0x20000
    s_add_u32 m0, s29, 98560
    s_mov_b32 s35, 0
    buffer_load_dwordx4 v8, s[4:7], s35 offen offset:0 lds
    buffer_load_dwordx4 v9, s[4:7], s35 offen offset:1024 lds
    buffer_load_dwordx4 v10, s[4:7], s35 offen offset:2048 lds
    buffer_load_dwordx4 v11, s[4:7], s35 offen offset:3072 lds
    s_add_u32 m0, s29, 102656
    s_nop 0
    buffer_load_dwordx4 v12, s[4:7], s35 offen offset:0 lds
    buffer_load_dwordx4 v13, s[4:7], s35 offen offset:1024 lds
    s_add_u32 m0, s38, 123200
    s_mov_b32 s36, 1536
    buffer_load_dwordx4 v14, s[8:11], s36 offen offset:0 lds
    buffer_load_dwordx4 v15, s[8:11], s36 offen offset:1024 lds
    buffer_load_dwordx4 v16, s[8:11], s36 offen offset:2048 lds
    s_add_u32 m0, s38, 126280
    s_nop 0
    buffer_load_dwordx4 v17, s[8:11], s36 offen offset:0 lds
    buffer_load_dwordx4 v18, s[8:11], s36 offen offset:1024 lds
    buffer_load_dwordx4 v19, s[8:11], s36 offen offset:2048 lds
    v_lshlrev_b32 v109, 4, v0
    s_lshr_b32 s43, s2, 3
    s_and_b32 s42, s2, 4
    s_mul_i32 s42, s42, 491520
    s_mul_i32 s44, s43, 61440
    s_add_u32 s42, s42, s44
    s_and_b32 s44, s2, 3
    s_mul_i32 s44, s44, 3072
    s_mul_i32 s45, s43, 24576
    s_add_u32 s44, s44, s45
    s_cmp_ge_u32 s28, 2
    s_cselect_b32 s60, s54, s48
    s_cselect_b32 s61, s55, s49
    s_cselect_b32 s42, s44, s42
    s_mov_b32 s45, 128
    s_cselect_b32 s47, 786432, s45
    s_mov_b32 s45, 3932160
    s_cselect_b32 s62, 7864320, s45
    s_add_u32 s60, s60, s42
    s_addc_u32 s61, s61, 0
    s_sub_u32 s62, s62, s42
    s_mov_b32 s63, 0x20000
    v_mul_u32_u24 v100, 24, v1
    v_add_u32 v100, v100, v0
    v_mul_u32_u24 v100, 1280, v100
    v_and_b32 v101, 1, v1
    v_mul_u32_u24 v101, 12288, v101
    v_lshl_add_u32 v101, v0, 7, v101
    v_cmp_lt_u32 vcc, 1, v1
    s_nop 1
    v_cndmask_b32 v100, v100, v101, vcc
    v_cmp_gt_u32 vcc, 24, v0
    v_mov_b32 v102, 0x40000000
    s_nop 0
    v_cndmask_b32 v36, v102, v100, vcc
    s_lshl_b32 s42, s33, 7
    s_add_u32 s42, s42, 62914560
    s_add_u32 s24, s58, s42
    s_addc_u32 s25, s59, 0
    s_mov_b32 s26, 64
    s_mov_b32 s27, 0x20000
    s_and_b32 s42, s2, 3
    s_lshl_b32 s42, s42, 2
    s_lshr_b32 s43, s2, 6
    s_add_u32 s42, s42, s43
    s_lshl_b32 s42, s42, 2
    v_lshl_add_u32 v100, v1, 6, v0
    v_cmp_eq_u32 vcc, 0, v100
    v_mov_b32 v101, 0x40000000
    v_mov_b32 v102, s42
    v_cndmask_b32 v33, v101, v102, vcc
    v_mov_b32 v37, 0
    buffer_store_dword v37, v33, s[24:27], 0 offen sc1
    v_add_u32 v108, 0, v107
    v_mul_u32_u24 v100, 171, v108
    v_lshrrev_b32 v100, 9, v100
    v_mul_u32_u24 v101, 3, v100
    v_sub_u32 v101, v108, v101
    v_lshlrev_b32 v101, 3, v101
    v_and_b32 v102, 2, v100
    v_xor_b32 v102, v102, v3
    v_lshrrev_b32 v103, 1, v100
    v_and_b32 v103, 4, v103
    v_xor_b32 v103, v103, v102
    v_add_u32 v103, v103, v101
    v_lshrrev_b32 v104, 2, v100
    v_and_b32 v104, 4, v104
    v_xor_b32 v104, v104, v102
    v_add_u32 v104, v104, v101
    v_lshlrev_b32 v103, 4, v103
    v_lshlrev_b32 v104, 4, v104
    v_mul_u32_u24 v101, 384, v100
    v_add_u32 v26, v101, v103
    v_add_u32 v20, v101, v104
    v_add_u32 v108, 8, v107
    v_mul_u32_u24 v100, 171, v108
    v_lshrrev_b32 v100, 9, v100
    v_mul_u32_u24 v101, 3, v100
    v_sub_u32 v101, v108, v101
    v_lshlrev_b32 v101, 3, v101
    v_and_b32 v102, 2, v100
    v_xor_b32 v102, v102, v3
    v_lshrrev_b32 v103, 1, v100
    v_and_b32 v103, 4, v103
    v_xor_b32 v103, v103, v102
    v_add_u32 v103, v103, v101
    v_lshrrev_b32 v104, 2, v100
    v_and_b32 v104, 4, v104
    v_xor_b32 v104, v104, v102
    v_add_u32 v104, v104, v101
    v_lshlrev_b32 v103, 4, v103
    v_lshlrev_b32 v104, 4, v104
    v_subrev_u32 v103, 1024, v103
    v_subrev_u32 v104, 1024, v104
    v_mul_u32_u24 v101, 384, v100
    v_add_u32 v27, v101, v103
    v_add_u32 v21, v101, v104
    v_add_u32 v108, 16, v107
    v_mul_u32_u24 v100, 171, v108
    v_lshrrev_b32 v100, 9, v100
    v_mul_u32_u24 v101, 3, v100
    v_sub_u32 v101, v108, v101
    v_lshlrev_b32 v101, 3, v101
    v_and_b32 v102, 2, v100
    v_xor_b32 v102, v102, v3
    v_lshrrev_b32 v103, 1, v100
    v_and_b32 v103, 4, v103
    v_xor_b32 v103, v103, v102
    v_add_u32 v103, v103, v101
    v_lshrrev_b32 v104, 2, v100
    v_and_b32 v104, 4, v104
    v_xor_b32 v104, v104, v102
    v_add_u32 v104, v104, v101
    v_lshlrev_b32 v103, 4, v103
    v_lshlrev_b32 v104, 4, v104
    v_subrev_u32 v103, 2048, v103
    v_subrev_u32 v104, 2048, v104
    v_mul_u32_u24 v101, 384, v100
    v_add_u32 v28, v101, v103
    v_add_u32 v22, v101, v104
    v_add_u32 v108, 24, v107
    v_mul_u32_u24 v100, 171, v108
    v_lshrrev_b32 v100, 9, v100
    v_mul_u32_u24 v101, 3, v100
    v_sub_u32 v101, v108, v101
    v_lshlrev_b32 v101, 3, v101
    v_and_b32 v102, 2, v100
    v_xor_b32 v102, v102, v3
    v_lshrrev_b32 v103, 1, v100
    v_and_b32 v103, 4, v103
    v_xor_b32 v103, v103, v102
    v_add_u32 v103, v103, v101
    v_lshrrev_b32 v104, 2, v100
    v_and_b32 v104, 4, v104
    v_xor_b32 v104, v104, v102
    v_add_u32 v104, v104, v101
    v_lshlrev_b32 v103, 4, v103
    v_lshlrev_b32 v104, 4, v104
    v_subrev_u32 v103, 3072, v103
    v_subrev_u32 v104, 3072, v104
    v_mul_u32_u24 v101, 384, v100
    v_add_u32 v29, v101, v103
    v_add_u32 v23, v101, v104
    v_add_u32 v108, 32, v107
    v_mul_u32_u24 v100, 171, v108
    v_lshrrev_b32 v100, 9, v100
    v_mul_u32_u24 v101, 3, v100
    v_sub_u32 v101, v108, v101
    v_lshlrev_b32 v101, 3, v101
    v_and_b32 v102, 2, v100
    v_xor_b32 v102, v102, v3
    v_lshrrev_b32 v103, 1, v100
    v_and_b32 v103, 4, v103
    v_xor_b32 v103, v103, v102
    v_add_u32 v103, v103, v101
    v_lshrrev_b32 v104, 2, v100
    v_and_b32 v104, 4, v104
    v_xor_b32 v104, v104, v102
    v_add_u32 v104, v104, v101
    v_lshlrev_b32 v103, 4, v103
    v_lshlrev_b32 v104, 4, v104
    v_mul_u32_u24 v101, 384, v100
    v_add_u32 v30, v101, v103
    v_add_u32 v24, v101, v104
    v_add_u32 v108, 40, v107
    v_mul_u32_u24 v100, 171, v108
    v_lshrrev_b32 v100, 9, v100
    v_mul_u32_u24 v101, 3, v100
    v_sub_u32 v101, v108, v101
    v_lshlrev_b32 v101, 3, v101
    v_and_b32 v102, 2, v100
    v_xor_b32 v102, v102, v3
    v_lshrrev_b32 v103, 1, v100
    v_and_b32 v103, 4, v103
    v_xor_b32 v103, v103, v102
    v_add_u32 v103, v103, v101
    v_lshrrev_b32 v104, 2, v100
    v_and_b32 v104, 4, v104
    v_xor_b32 v104, v104, v102
    v_add_u32 v104, v104, v101
    v_lshlrev_b32 v103, 4, v103
    v_lshlrev_b32 v104, 4, v104
    v_subrev_u32 v103, 1024, v103
    v_subrev_u32 v104, 1024, v104
    v_mul_u32_u24 v101, 384, v100
    v_add_u32 v31, v101, v103
    v_add_u32 v25, v101, v104
    s_lshl_b32 s42, s33, 5
    s_add_u32 s42, s42, s34
    s_mul_i32 s42, s42, 196608
    s_add_u32 s12, s50, s42
    s_addc_u32 s13, s51, 0
    s_mov_b32 s14, 196608
    s_mov_b32 s15, 0x20000
    s_add_u32 s16, s52, s42
    s_addc_u32 s17, s53, 0
    s_mov_b32 s18, 196608
    s_mov_b32 s19, 0x20000
    s_mov_b32 s41, 24576
    s_and_b32 s42, s2, 3
    s_lshl_b32 s42, s42, 2
    s_lshr_b32 s43, s2, 6
    s_add_u32 s42, s42, s43
    s_lshl_b32 s43, s33, 4
    s_add_u32 s42, s42, s43
    s_mul_i32 s42, s42, 245760
    s_add_u32 s20, s58, s42
    s_addc_u32 s21, s59, 0
    s_mov_b32 s22, 245760
    s_mov_b32 s23, 0x20000
    v_mul_u32_u24 v100, 3072, v1
    v_add_u32 v32, v100, v109
    v_and_b32 v100, 2, v5
    v_lshrrev_b32 v101, 1, v5
    v_and_b32 v101, 4, v101
    v_or_b32 v100, v100, v101
    v_and_b32 v105, 6, v5
    v_mul_u32_u24 v101, 48, v1
    v_add_u32 v101, v101, v5
    v_lshlrev_b32 v101, 7, v101
    v_lshrrev_b32 v102, 2, v5
    v_lshlrev_b32 v106, 3, v102
    v_and_b32 v2, 3, v5
    v_add_u32 v106, v106, v2
    v_mul_u32_u24 v106, 384, v106
    v_or_b32 v2, 0, v4
    v_xor_b32 v3, v2, v105
    v_xor_b32 v2, v2, v100
    v_lshlrev_b32 v2, 4, v2
    v_lshlrev_b32 v3, 4, v3
    v_add_u32 v34, v2, v106
    v_add_u32 v232, v3, v101
    v_add_u32 v234, v3, v101
    v_add_u32 v234, 49280, v234
    v_add_u32 v236, v3, v101
    v_add_u32 v236, 98560, v236
    v_or_b32 v2, 4, v4
    v_xor_b32 v3, v2, v105
    v_xor_b32 v2, v2, v100
    v_lshlrev_b32 v2, 4, v2
    v_lshlrev_b32 v3, 4, v3
    v_add_u32 v35, v2, v106
    v_add_u32 v233, v3, v101
    v_add_u32 v235, v3, v101
    v_add_u32 v235, 49280, v235
    v_add_u32 v237, v3, v101
    v_add_u32 v237, 98560, v237
    v_lshlrev_b32 v106, 3, v4
    v_add_u32 v106, v106, v102
    v_mul_u32_u24 v106, 384, v106
    v_lshrrev_b32 v2, 1, v4
    v_lshl_add_u32 v106, v2, 4, v106
    v_and_b32 v2, 1, v4
    v_lshl_add_u32 v106, v2, 3, v106
    v_and_b32 v2, 3, v5
    v_lshl_add_u32 v106, v2, 4, v106
    v_lshrrev_b32 v2, 1, v102
    v_and_b32 v2, 1, v2
    v_xor_b32 v3, 0, v2
    v_lshl_add_u32 v3, v3, 6, v106
    v_mov_b32 v238, v3
    v_add_u32 v240, 49280, v3
    v_add_u32 v242, 98560, v3
    v_xor_b32 v3, 1, v2
    v_lshl_add_u32 v3, v3, 6, v106
    v_mov_b32 v239, v3
    v_add_u32 v241, 49280, v3
    v_add_u32 v243, 98560, v3
    v_lshlrev_b32 v106, 3, v4
    v_add_u32 v106, v106, v102
    v_mul_u32_u24 v106, 384, v106
    v_and_b32 v2, 3, v5
    v_lshrrev_b32 v101, 1, v2
    v_lshlrev_b32 v101, 4, v101
    v_and_b32 v2, 1, v2
    v_lshlrev_b32 v2, 3, v2
    v_add3_u32 v106, v106, v101, v2
    v_and_b32 v100, 2, v102
    v_and_b32 v101, 1, v4
    v_lshlrev_b32 v101, 2, v101
    v_or_b32 v100, v100, v101
    v_xor_b32 v101, 0, v100
    v_lshl_add_u32 v101, v101, 4, v106
    v_mov_b32 v244, v101
    v_add_u32 v248, 49280, v101
    v_add_u32 v252, 98560, v101
    v_xor_b32 v101, 2, v100
    v_lshl_add_u32 v101, v101, 4, v106
    v_mov_b32 v245, v101
    v_add_u32 v249, 49280, v101
    v_add_u32 v253, 98560, v101
    v_xor_b32 v101, 4, v100
    v_lshl_add_u32 v101, v101, 4, v106
    v_mov_b32 v246, v101
    v_add_u32 v250, 49280, v101
    v_add_u32 v254, 98560, v101
    v_xor_b32 v101, 6, v100
    v_lshl_add_u32 v101, v101, 4, v106
    v_mov_b32 v247, v101
    v_add_u32 v251, 49280, v101
    v_add_u32 v255, 98560, v101
    v_mul_u32_u24 v100, 2048, v1
    v_add_u32 v101, v100, v109
    v_add_u32 v7, 147840, v101
    v_lshlrev_b32 v100, 7, v0
    v_add_u32 v100, s29, v100
    v_cmp_gt_u32 vcc, 48, v0
    v_mov_b32 v102, 0x40000000
    s_nop 0
    v_cndmask_b32 v3, v102, v100, vcc
    v_mov_b32 v4, 0x3dd53b95
    v_mov_b32 v5, 0x3dd53b95
    s_add_u32 m0, s38, 0
    s_mov_b32 s35, 0
    buffer_load_dwordx4 v14, s[8:11], s35 offen offset:0 lds
    buffer_load_dwordx4 v15, s[8:11], s35 offen offset:1024 lds
    buffer_load_dwordx4 v16, s[8:11], s35 offen offset:2048 lds
    s_add_u32 m0, s38, 3080
    s_nop 0
    buffer_load_dwordx4 v17, s[8:11], s35 offen offset:0 lds
    buffer_load_dwordx4 v18, s[8:11], s35 offen offset:1024 lds
    buffer_load_dwordx4 v19, s[8:11], s35 offen offset:2048 lds
    s_mov_b32 s40, 0x4e800000
    s_mov_b32 s32, 0
    s_waitcnt vmcnt(7)
    s_waitcnt lgkmcnt(0)
    s_barrier
    ds_read_b128 v[64:67], v236 offset:0
    ds_read_b128 v[68:71], v237 offset:0
    ds_read_b64_tr_b16 a[144:145], v242 offset:24640
    ds_read_b64_tr_b16 a[146:147], v242 offset:26176
    ds_read_b64_tr_b16 a[148:149], v242 offset:36960
    ds_read_b64_tr_b16 a[150:151], v242 offset:38496
    ds_read_b128 v[72:75], v236 offset:2048
    ds_read_b128 v[76:79], v237 offset:2048
    ds_read_b64_tr_b16 a[152:153], v242 offset:24648
    ds_read_b64_tr_b16 a[154:155], v242 offset:26184
    ds_read_b64_tr_b16 a[156:157], v242 offset:36968
    ds_read_b64_tr_b16 a[158:159], v242 offset:38504
    ds_read_b64_tr_b16 a[160:161], v243 offset:24640
    ds_read_b64_tr_b16 a[162:163], v243 offset:26176
    ds_read_b64_tr_b16 a[164:165], v243 offset:36960
    ds_read_b64_tr_b16 a[166:167], v243 offset:38496
    ds_read_b128 v[80:83], v236 offset:4096
    ds_read_b128 v[84:87], v237 offset:4096
    s_waitcnt lgkmcnt(2)
    v_mfma_f32_16x16x32_bf16 a[0:3], a[144:147], v[64:67], 0
    ds_read_b64_tr_b16 a[168:169], v243 offset:24648
    v_mfma_f32_16x16x32_bf16 a[0:3], a[148:151], v[68:71], a[0:3]
    ds_read_b64_tr_b16 a[170:171], v243 offset:26184
    s_add_u32 m0, s29, 24640
    s_mov_b32 s35, 128
    v_mfma_f32_16x16x32_bf16 a[4:7], a[152:155], v[64:67], 0
    ds_read_b64_tr_b16 a[172:173], v243 offset:36968
    v_mfma_f32_16x16x32_bf16 a[4:7], a[156:159], v[68:71], a[4:7]
    ds_read_b64_tr_b16 a[174:175], v243 offset:38504
    buffer_load_dwordx4 v8, s[4:7], s35 offen offset:0 lds
    v_mfma_f32_16x16x32_bf16 a[24:27], a[160:163], v[64:67], 0
    ds_read_b64_tr_b16 a[176:177], v242 offset:24768
    v_mfma_f32_16x16x32_bf16 a[24:27], a[164:167], v[68:71], a[24:27]
    ds_read_b64_tr_b16 a[178:179], v242 offset:26304
    buffer_load_dwordx4 v9, s[4:7], s35 offen offset:1024 lds
    v_mfma_f32_16x16x32_bf16 a[8:11], a[144:147], v[72:75], 0
    ds_read_b64_tr_b16 a[180:181], v242 offset:37088
    v_mfma_f32_16x16x32_bf16 a[8:11], a[148:151], v[76:79], a[8:11]
    ds_read_b64_tr_b16 a[182:183], v242 offset:38624
    buffer_load_dwordx4 v10, s[4:7], s35 offen offset:2048 lds
    v_mfma_f32_16x16x32_bf16 a[12:15], a[152:155], v[72:75], 0
    ds_read_b64_tr_b16 a[184:185], v242 offset:24776
    v_mfma_f32_16x16x32_bf16 a[12:15], a[156:159], v[76:79], a[12:15]
    ds_read_b64_tr_b16 a[186:187], v242 offset:26312
    buffer_load_dwordx4 v11, s[4:7], s35 offen offset:3072 lds
    v_mfma_f32_16x16x32_bf16 a[32:35], a[160:163], v[72:75], 0
    ds_read_b64_tr_b16 a[188:189], v242 offset:37096
    v_mfma_f32_16x16x32_bf16 a[32:35], a[164:167], v[76:79], a[32:35]
    ds_read_b64_tr_b16 a[190:191], v242 offset:38632
    s_add_u32 m0, s29, 28736
    s_waitcnt lgkmcnt(13)
    v_mfma_f32_16x16x32_bf16 a[16:19], a[144:147], v[80:83], 0
    s_waitcnt lgkmcnt(12)
    v_mfma_f32_16x16x32_bf16 a[16:19], a[148:151], v[84:87], a[16:19]
    buffer_load_dwordx4 v12, s[4:7], s35 offen offset:0 lds
    v_mfma_f32_16x16x32_bf16 a[20:23], a[152:155], v[80:83], 0
    v_mfma_f32_16x16x32_bf16 a[20:23], a[156:159], v[84:87], a[20:23]
    buffer_load_dwordx4 v13, s[4:7], s35 offen offset:1024 lds
    v_mfma_f32_16x16x32_bf16 a[40:43], a[160:163], v[80:83], 0
    v_mfma_f32_16x16x32_bf16 a[40:43], a[164:167], v[84:87], a[40:43]
    s_add_u32 m0, s38, 49280
    s_mov_b32 s36, 787968
    s_waitcnt lgkmcnt(0)
    v_mfma_f32_16x16x32_bf16 a[28:31], a[168:171], v[64:67], 0
    ds_read_b64_tr_b16 a[144:145], v243 offset:24768
    v_mfma_f32_16x16x32_bf16 a[28:31], a[172:175], v[68:71], a[28:31]
    ds_read_b64_tr_b16 a[146:147], v243 offset:26304
    buffer_load_dwordx4 v14, s[8:11], s36 offen offset:0 lds
    v_mfma_f32_16x16x32_bf16 a[48:51], a[176:179], v[64:67], 0
    ds_read_b64_tr_b16 a[148:149], v243 offset:37088
    v_mfma_f32_16x16x32_bf16 a[48:51], a[180:183], v[68:71], a[48:51]
    ds_read_b64_tr_b16 a[150:151], v243 offset:38624
    buffer_load_dwordx4 v15, s[8:11], s36 offen offset:1024 lds
    v_mfma_f32_16x16x32_bf16 a[52:55], a[184:187], v[64:67], 0
    ds_read_b64_tr_b16 a[152:153], v243 offset:24776
    v_mfma_f32_16x16x32_bf16 a[52:55], a[188:191], v[68:71], a[52:55]
    ds_read_b64_tr_b16 a[154:155], v243 offset:26312
    buffer_load_dwordx4 v16, s[8:11], s36 offen offset:2048 lds
    v_mfma_f32_16x16x32_bf16 a[36:39], a[168:171], v[72:75], 0
    ds_read_b64_tr_b16 a[156:157], v243 offset:37096
    v_mfma_f32_16x16x32_bf16 a[36:39], a[172:175], v[76:79], a[36:39]
    ds_read_b64_tr_b16 a[158:159], v243 offset:38632
    v_mfma_f32_16x16x32_bf16 a[56:59], a[176:179], v[72:75], 0
    ds_read_b64_tr_b16 a[160:161], v242 offset:24896
    s_add_u32 m0, s38, 52360
    v_mfma_f32_16x16x32_bf16 a[56:59], a[180:183], v[76:79], a[56:59]
    ds_read_b64_tr_b16 a[162:163], v242 offset:26432
    v_mfma_f32_16x16x32_bf16 a[60:63], a[184:187], v[72:75], 0
    ds_read_b64_tr_b16 a[164:165], v242 offset:37216
    buffer_load_dwordx4 v17, s[8:11], s36 offen offset:0 lds
    v_mfma_f32_16x16x32_bf16 a[60:63], a[188:191], v[76:79], a[60:63]
    ds_read_b64_tr_b16 a[166:167], v242 offset:38752
    v_mfma_f32_16x16x32_bf16 a[44:47], a[168:171], v[80:83], 0
    buffer_load_dwordx4 v18, s[8:11], s36 offen offset:1024 lds
    v_mfma_f32_16x16x32_bf16 a[44:47], a[172:175], v[84:87], a[44:47]
    v_mfma_f32_16x16x32_bf16 a[64:67], a[176:179], v[80:83], 0
    buffer_load_dwordx4 v19, s[8:11], s36 offen offset:2048 lds
    v_mfma_f32_16x16x32_bf16 a[64:67], a[180:183], v[84:87], a[64:67]
    v_mfma_f32_16x16x32_bf16 a[68:71], a[184:187], v[80:83], 0
    s_add_u32 m0, s38, 73920
    s_mov_b32 s35, 786432
    v_mfma_f32_16x16x32_bf16 a[68:71], a[188:191], v[84:87], a[68:71]
    s_waitcnt lgkmcnt(0)
    v_mfma_f32_16x16x32_bf16 a[72:75], a[144:147], v[64:67], 0
    ds_read_b64_tr_b16 a[168:169], v242 offset:24904
    buffer_load_dwordx4 v14, s[8:11], s35 offen offset:0 lds
    v_mfma_f32_16x16x32_bf16 a[72:75], a[148:151], v[68:71], a[72:75]
    ds_read_b64_tr_b16 a[170:171], v242 offset:26440
    v_mfma_f32_16x16x32_bf16 a[76:79], a[152:155], v[64:67], 0
    ds_read_b64_tr_b16 a[172:173], v242 offset:37224
    buffer_load_dwordx4 v15, s[8:11], s35 offen offset:1024 lds
    v_mfma_f32_16x16x32_bf16 a[76:79], a[156:159], v[68:71], a[76:79]
    ds_read_b64_tr_b16 a[174:175], v242 offset:38760
    v_mfma_f32_16x16x32_bf16 a[96:99], a[160:163], v[64:67], 0
    ds_read_b64_tr_b16 a[176:177], v243 offset:24896
    buffer_load_dwordx4 v16, s[8:11], s35 offen offset:2048 lds
    v_mfma_f32_16x16x32_bf16 a[96:99], a[164:167], v[68:71], a[96:99]
    ds_read_b64_tr_b16 a[178:179], v243 offset:26432
    v_mfma_f32_16x16x32_bf16 a[80:83], a[144:147], v[72:75], 0
    ds_read_b64_tr_b16 a[180:181], v243 offset:37216
    s_add_u32 m0, s38, 77000
    v_mfma_f32_16x16x32_bf16 a[80:83], a[148:151], v[76:79], a[80:83]
    ds_read_b64_tr_b16 a[182:183], v243 offset:38752
    v_mfma_f32_16x16x32_bf16 a[84:87], a[152:155], v[72:75], 0
    ds_read_b64_tr_b16 a[184:185], v243 offset:24904
    buffer_load_dwordx4 v17, s[8:11], s35 offen offset:0 lds
    v_mfma_f32_16x16x32_bf16 a[84:87], a[156:159], v[76:79], a[84:87]
    ds_read_b64_tr_b16 a[186:187], v243 offset:26440
    v_mfma_f32_16x16x32_bf16 a[104:107], a[160:163], v[72:75], 0
    ds_read_b64_tr_b16 a[188:189], v243 offset:37224
    buffer_load_dwordx4 v18, s[8:11], s35 offen offset:1024 lds
    v_mfma_f32_16x16x32_bf16 a[104:107], a[164:167], v[76:79], a[104:107]
    ds_read_b64_tr_b16 a[190:191], v243 offset:38760
    v_mfma_f32_16x16x32_bf16 a[88:91], a[144:147], v[80:83], 0
    buffer_load_dwordx4 v19, s[8:11], s35 offen offset:2048 lds
    v_mfma_f32_16x16x32_bf16 a[88:91], a[148:151], v[84:87], a[88:91]
    v_mfma_f32_16x16x32_bf16 a[92:95], a[152:155], v[80:83], 0
    v_mfma_f32_16x16x32_bf16 a[92:95], a[156:159], v[84:87], a[92:95]
    v_mfma_f32_16x16x32_bf16 a[112:115], a[160:163], v[80:83], 0
    v_mfma_f32_16x16x32_bf16 a[112:115], a[164:167], v[84:87], a[112:115]
    s_waitcnt vmcnt(18)
    s_waitcnt lgkmcnt(0)
    s_barrier
    v_mfma_f32_16x16x32_bf16 a[100:103], a[168:171], v[64:67], 0
    ds_read_b64_tr_b16 a[144:145], v238 offset:0
    v_mfma_f32_16x16x32_bf16 a[100:103], a[172:175], v[68:71], a[100:103]
    ds_read_b64_tr_b16 a[146:147], v238 offset:1536
    s_add_u32 m0, s29, 98560
    s_mov_b32 s35, 256
    v_mfma_f32_16x16x32_bf16 a[120:123], a[176:179], v[64:67], 0
    ds_read_b64_tr_b16 a[148:149], v238 offset:12320
    v_mfma_f32_16x16x32_bf16 a[120:123], a[180:183], v[68:71], a[120:123]
    ds_read_b64_tr_b16 a[150:151], v238 offset:13856
    v_mfma_f32_16x16x32_bf16 a[124:127], a[184:187], v[64:67], 0
    ds_read_b64_tr_b16 a[152:153], v238 offset:8
    v_mfma_f32_16x16x32_bf16 a[124:127], a[188:191], v[68:71], a[124:127]
    ds_read_b64_tr_b16 a[154:155], v238 offset:1544
    buffer_load_dwordx4 v8, s[4:7], s35 offen offset:0 lds
    v_mfma_f32_16x16x32_bf16 a[108:111], a[168:171], v[72:75], 0
    ds_read_b64_tr_b16 a[156:157], v238 offset:12328
    v_mfma_f32_16x16x32_bf16 a[108:111], a[172:175], v[76:79], a[108:111]
    ds_read_b64_tr_b16 a[158:159], v238 offset:13864
    v_mfma_f32_16x16x32_bf16 a[128:131], a[176:179], v[72:75], 0
    ds_read_b64_tr_b16 a[160:161], v239 offset:0
    v_mfma_f32_16x16x32_bf16 a[128:131], a[180:183], v[76:79], a[128:131]
    ds_read_b64_tr_b16 a[162:163], v239 offset:1536
    buffer_load_dwordx4 v9, s[4:7], s35 offen offset:1024 lds
    v_mfma_f32_16x16x32_bf16 a[132:135], a[184:187], v[72:75], 0
    ds_read_b64_tr_b16 a[164:165], v239 offset:12320
    v_mfma_f32_16x16x32_bf16 a[132:135], a[188:191], v[76:79], a[132:135]
    ds_read_b64_tr_b16 a[166:167], v239 offset:13856
    v_mfma_f32_16x16x32_bf16 a[116:119], a[168:171], v[80:83], 0
    v_mfma_f32_16x16x32_bf16 a[116:119], a[172:175], v[84:87], a[116:119]
    buffer_load_dwordx4 v10, s[4:7], s35 offen offset:2048 lds
    v_mfma_f32_16x16x32_bf16 a[136:139], a[176:179], v[80:83], 0
    v_mfma_f32_16x16x32_bf16 a[136:139], a[180:183], v[84:87], a[136:139]
    v_mfma_f32_16x16x32_bf16 a[140:143], a[184:187], v[80:83], 0
    v_mfma_f32_16x16x32_bf16 a[140:143], a[188:191], v[84:87], a[140:143]
    s_waitcnt lgkmcnt(0)
    v_mfma_f32_16x16x32_bf16 v[88:91], a[144:147], v[64:67], 0
    ds_read_b64_tr_b16 a[168:169], v239 offset:8
    buffer_load_dwordx4 v11, s[4:7], s35 offen offset:3072 lds
    v_mfma_f32_16x16x32_bf16 v[88:91], a[148:151], v[68:71], v[88:91]
    ds_read_b64_tr_b16 a[170:171], v239 offset:1544
    v_mfma_f32_16x16x32_bf16 v[92:95], a[152:155], v[64:67], 0
    ds_read_b64_tr_b16 a[172:173], v239 offset:12328
    v_mfma_f32_16x16x32_bf16 v[92:95], a[156:159], v[68:71], v[92:95]
    ds_read_b64_tr_b16 a[174:175], v239 offset:13864
    v_mfma_f32_16x16x32_bf16 v[112:115], a[160:163], v[64:67], 0
    ds_read_b64_tr_b16 a[176:177], v238 offset:128
    s_add_u32 m0, s29, 102656
    v_mfma_f32_16x16x32_bf16 v[112:115], a[164:167], v[68:71], v[112:115]
    ds_read_b64_tr_b16 a[178:179], v238 offset:1664
    v_mfma_f32_16x16x32_bf16 v[96:99], a[144:147], v[72:75], 0
    ds_read_b64_tr_b16 a[180:181], v238 offset:12448
    v_mfma_f32_16x16x32_bf16 v[96:99], a[148:151], v[76:79], v[96:99]
    ds_read_b64_tr_b16 a[182:183], v238 offset:13984
    v_mfma_f32_16x16x32_bf16 v[100:103], a[152:155], v[72:75], 0
    ds_read_b64_tr_b16 a[184:185], v238 offset:136
    buffer_load_dwordx4 v12, s[4:7], s35 offen offset:0 lds
    v_mfma_f32_16x16x32_bf16 v[100:103], a[156:159], v[76:79], v[100:103]
    ds_read_b64_tr_b16 a[186:187], v238 offset:1672
    v_mfma_f32_16x16x32_bf16 v[120:123], a[160:163], v[72:75], 0
    ds_read_b64_tr_b16 a[188:189], v238 offset:12456
    v_mfma_f32_16x16x32_bf16 v[120:123], a[164:167], v[76:79], v[120:123]
    ds_read_b64_tr_b16 a[190:191], v238 offset:13992
    v_mfma_f32_16x16x32_bf16 v[104:107], a[144:147], v[80:83], 0
    buffer_load_dwordx4 v13, s[4:7], s35 offen offset:1024 lds
    v_mfma_f32_16x16x32_bf16 v[104:107], a[148:151], v[84:87], v[104:107]
    v_mfma_f32_16x16x32_bf16 v[108:111], a[152:155], v[80:83], 0
    v_mfma_f32_16x16x32_bf16 v[108:111], a[156:159], v[84:87], v[108:111]
    v_mfma_f32_16x16x32_bf16 v[128:131], a[160:163], v[80:83], 0
    v_mfma_f32_16x16x32_bf16 v[128:131], a[164:167], v[84:87], v[128:131]
    s_add_u32 m0, s38, 123200
    s_mov_b32 s36, 1574400
    s_waitcnt lgkmcnt(0)
    v_mfma_f32_16x16x32_bf16 v[116:119], a[168:171], v[64:67], 0
    ds_read_b64_tr_b16 a[144:145], v239 offset:128
    v_mfma_f32_16x16x32_bf16 v[116:119], a[172:175], v[68:71], v[116:119]
    ds_read_b64_tr_b16 a[146:147], v239 offset:1664
    v_mfma_f32_16x16x32_bf16 v[136:139], a[176:179], v[64:67], 0
    ds_read_b64_tr_b16 a[148:149], v239 offset:12448
    v_mfma_f32_16x16x32_bf16 v[136:139], a[180:183], v[68:71], v[136:139]
    ds_read_b64_tr_b16 a[150:151], v239 offset:13984
    buffer_load_dwordx4 v14, s[8:11], s36 offen offset:0 lds
    v_mfma_f32_16x16x32_bf16 v[140:143], a[184:187], v[64:67], 0
    ds_read_b64_tr_b16 a[152:153], v239 offset:136
    v_mfma_f32_16x16x32_bf16 v[140:143], a[188:191], v[68:71], v[140:143]
    ds_read_b64_tr_b16 a[154:155], v239 offset:1672
    v_mfma_f32_16x16x32_bf16 v[124:127], a[168:171], v[72:75], 0
    ds_read_b64_tr_b16 a[156:157], v239 offset:12456
    v_mfma_f32_16x16x32_bf16 v[124:127], a[172:175], v[76:79], v[124:127]
    ds_read_b64_tr_b16 a[158:159], v239 offset:13992
    buffer_load_dwordx4 v15, s[8:11], s36 offen offset:1024 lds
    v_mfma_f32_16x16x32_bf16 v[144:147], a[176:179], v[72:75], 0
    ds_read_b64_tr_b16 a[160:161], v238 offset:256
    v_mfma_f32_16x16x32_bf16 v[144:147], a[180:183], v[76:79], v[144:147]
    ds_read_b64_tr_b16 a[162:163], v238 offset:1792
    v_mfma_f32_16x16x32_bf16 v[148:151], a[184:187], v[72:75], 0
    ds_read_b64_tr_b16 a[164:165], v238 offset:12576
    v_mfma_f32_16x16x32_bf16 v[148:151], a[188:191], v[76:79], v[148:151]
    ds_read_b64_tr_b16 a[166:167], v238 offset:14112
    buffer_load_dwordx4 v16, s[8:11], s36 offen offset:2048 lds
    v_mfma_f32_16x16x32_bf16 v[132:135], a[168:171], v[80:83], 0
    v_mfma_f32_16x16x32_bf16 v[132:135], a[172:175], v[84:87], v[132:135]
    v_mfma_f32_16x16x32_bf16 v[152:155], a[176:179], v[80:83], 0
    v_mfma_f32_16x16x32_bf16 v[152:155], a[180:183], v[84:87], v[152:155]
    v_mfma_f32_16x16x32_bf16 v[156:159], a[184:187], v[80:83], 0
    s_add_u32 m0, s38, 126280
    v_mfma_f32_16x16x32_bf16 v[156:159], a[188:191], v[84:87], v[156:159]
    s_waitcnt lgkmcnt(0)
    v_mfma_f32_16x16x32_bf16 v[160:163], a[144:147], v[64:67], 0
    ds_read_b64_tr_b16 a[168:169], v238 offset:264
    v_mfma_f32_16x16x32_bf16 v[160:163], a[148:151], v[68:71], v[160:163]
    ds_read_b64_tr_b16 a[170:171], v238 offset:1800
    v_mfma_f32_16x16x32_bf16 v[164:167], a[152:155], v[64:67], 0
    ds_read_b64_tr_b16 a[172:173], v238 offset:12584
    buffer_load_dwordx4 v17, s[8:11], s36 offen offset:0 lds
    v_mfma_f32_16x16x32_bf16 v[164:167], a[156:159], v[68:71], v[164:167]
    ds_read_b64_tr_b16 a[174:175], v238 offset:14120
    v_mfma_f32_16x16x32_bf16 v[184:187], a[160:163], v[64:67], 0
    ds_read_b64_tr_b16 a[176:177], v239 offset:256
    v_mfma_f32_16x16x32_bf16 v[184:187], a[164:167], v[68:71], v[184:187]
    ds_read_b64_tr_b16 a[178:179], v239 offset:1792
    v_mfma_f32_16x16x32_bf16 v[168:171], a[144:147], v[72:75], 0
    ds_read_b64_tr_b16 a[180:181], v239 offset:12576
    buffer_load_dwordx4 v18, s[8:11], s36 offen offset:1024 lds
    v_mfma_f32_16x16x32_bf16 v[168:171], a[148:151], v[76:79], v[168:171]
    ds_read_b64_tr_b16 a[182:183], v239 offset:14112
    v_mfma_f32_16x16x32_bf16 v[172:175], a[152:155], v[72:75], 0
    ds_read_b64_tr_b16 a[184:185], v239 offset:264
    v_mfma_f32_16x16x32_bf16 v[172:175], a[156:159], v[76:79], v[172:175]
    ds_read_b64_tr_b16 a[186:187], v239 offset:1800
    v_mfma_f32_16x16x32_bf16 v[192:195], a[160:163], v[72:75], 0
    ds_read_b64_tr_b16 a[188:189], v239 offset:12584
    buffer_load_dwordx4 v19, s[8:11], s36 offen offset:2048 lds
    v_mfma_f32_16x16x32_bf16 v[192:195], a[164:167], v[76:79], v[192:195]
    ds_read_b64_tr_b16 a[190:191], v239 offset:14120
    v_mfma_f32_16x16x32_bf16 v[176:179], a[144:147], v[80:83], 0
    v_mfma_f32_16x16x32_bf16 v[176:179], a[148:151], v[84:87], v[176:179]
    v_mfma_f32_16x16x32_bf16 v[180:183], a[152:155], v[80:83], 0
    v_mfma_f32_16x16x32_bf16 v[180:183], a[156:159], v[84:87], v[180:183]
    v_mfma_f32_16x16x32_bf16 v[200:203], a[160:163], v[80:83], 0
    v_mfma_f32_16x16x32_bf16 v[200:203], a[164:167], v[84:87], v[200:203]
    s_waitcnt vmcnt(18)
    s_waitcnt lgkmcnt(0)
    s_barrier
    v_mfma_f32_16x16x32_bf16 v[188:191], a[168:171], v[64:67], 0
    ds_read_b64_tr_b16 a[144:145], v240 offset:0
    v_mfma_f32_16x16x32_bf16 v[188:191], a[172:175], v[68:71], v[188:191]
    ds_read_b64_tr_b16 a[146:147], v240 offset:1536
    s_add_u32 m0, s38, 0
    s_mov_b32 s35, 1572864
    v_mfma_f32_16x16x32_bf16 v[208:211], a[176:179], v[64:67], 0
    ds_read_b64_tr_b16 a[148:149], v240 offset:12320
    v_mfma_f32_16x16x32_bf16 v[208:211], a[180:183], v[68:71], v[208:211]
    ds_read_b64_tr_b16 a[150:151], v240 offset:13856
    v_mfma_f32_16x16x32_bf16 v[212:215], a[184:187], v[64:67], 0
    ds_read_b64_tr_b16 a[152:153], v240 offset:8
    v_mfma_f32_16x16x32_bf16 v[212:215], a[188:191], v[68:71], v[212:215]
    ds_read_b128 v[64:67], v232 offset:24640
    ds_read_b64_tr_b16 a[154:155], v240 offset:1544
    v_mfma_f32_16x16x32_bf16 v[196:199], a[168:171], v[72:75], 0
    ds_read_b128 v[68:71], v233 offset:24640
    ds_read_b64_tr_b16 a[156:157], v240 offset:12328
    v_mfma_f32_16x16x32_bf16 v[196:199], a[172:175], v[76:79], v[196:199]
    ds_read_b64_tr_b16 a[158:159], v240 offset:13864
    v_mfma_f32_16x16x32_bf16 v[216:219], a[176:179], v[72:75], 0
    ds_read_b64_tr_b16 a[160:161], v241 offset:0
    v_mfma_f32_16x16x32_bf16 v[216:219], a[180:183], v[76:79], v[216:219]
    ds_read_b64_tr_b16 a[162:163], v241 offset:1536
    buffer_load_dwordx4 v14, s[8:11], s35 offen offset:0 lds
    v_mfma_f32_16x16x32_bf16 v[220:223], a[184:187], v[72:75], 0
    ds_read_b64_tr_b16 a[164:165], v241 offset:12320
    v_mfma_f32_16x16x32_bf16 v[220:223], a[188:191], v[76:79], v[220:223]
    ds_read_b128 v[72:75], v232 offset:26688
    ds_read_b64_tr_b16 a[166:167], v241 offset:13856
    v_mfma_f32_16x16x32_bf16 v[204:207], a[168:171], v[80:83], 0
    ds_read_b128 v[76:79], v233 offset:26688
    v_mfma_f32_16x16x32_bf16 v[204:207], a[172:175], v[84:87], v[204:207]
    v_mfma_f32_16x16x32_bf16 v[224:227], a[176:179], v[80:83], 0
    v_mfma_f32_16x16x32_bf16 v[224:227], a[180:183], v[84:87], v[224:227]
    v_mfma_f32_16x16x32_bf16 v[228:231], a[184:187], v[80:83], 0
    v_mfma_f32_16x16x32_bf16 v[228:231], a[188:191], v[84:87], v[228:231]
    ds_read_b128 v[80:83], v232 offset:28736
    ds_read_b128 v[84:87], v233 offset:28736
    s_waitcnt lgkmcnt(3)
    v_mfma_f32_16x16x32_bf16 a[0:3], a[144:147], v[64:67], a[0:3]
    ds_read_b64_tr_b16 a[168:169], v241 offset:8
    buffer_load_dwordx4 v15, s[8:11], s35 offen offset:1024 lds
    v_mfma_f32_16x16x32_bf16 a[0:3], a[148:151], v[68:71], a[0:3]
    ds_read_b64_tr_b16 a[170:171], v241 offset:1544
    v_mfma_f32_16x16x32_bf16 a[4:7], a[152:155], v[64:67], a[4:7]
    ds_read_b64_tr_b16 a[172:173], v241 offset:12328
    v_mfma_f32_16x16x32_bf16 a[4:7], a[156:159], v[68:71], a[4:7]
    ds_read_b64_tr_b16 a[174:175], v241 offset:13864
    v_mfma_f32_16x16x32_bf16 a[24:27], a[160:163], v[64:67], a[24:27]
    ds_read_b64_tr_b16 a[176:177], v240 offset:128
    v_mfma_f32_16x16x32_bf16 a[24:27], a[164:167], v[68:71], a[24:27]
    ds_read_b64_tr_b16 a[178:179], v240 offset:1664
    v_mfma_f32_16x16x32_bf16 a[8:11], a[144:147], v[72:75], a[8:11]
    ds_read_b64_tr_b16 a[180:181], v240 offset:12448
    s_waitcnt lgkmcnt(9)
    v_mfma_f32_16x16x32_bf16 a[8:11], a[148:151], v[76:79], a[8:11]
    ds_read_b64_tr_b16 a[182:183], v240 offset:13984
    v_mfma_f32_16x16x32_bf16 a[12:15], a[152:155], v[72:75], a[12:15]
    ds_read_b64_tr_b16 a[184:185], v240 offset:136
    buffer_load_dwordx4 v16, s[8:11], s35 offen offset:2048 lds
    v_mfma_f32_16x16x32_bf16 a[12:15], a[156:159], v[76:79], a[12:15]
    ds_read_b64_tr_b16 a[186:187], v240 offset:1672
    v_mfma_f32_16x16x32_bf16 a[32:35], a[160:163], v[72:75], a[32:35]
    ds_read_b64_tr_b16 a[188:189], v240 offset:12456
    v_mfma_f32_16x16x32_bf16 a[32:35], a[164:167], v[76:79], a[32:35]
    ds_read_b64_tr_b16 a[190:191], v240 offset:13992
    s_waitcnt lgkmcnt(13)
    v_mfma_f32_16x16x32_bf16 a[16:19], a[144:147], v[80:83], a[16:19]
    s_waitcnt lgkmcnt(12)
    v_mfma_f32_16x16x32_bf16 a[16:19], a[148:151], v[84:87], a[16:19]
    v_mfma_f32_16x16x32_bf16 a[20:23], a[152:155], v[80:83], a[20:23]
    v_mfma_f32_16x16x32_bf16 a[20:23], a[156:159], v[84:87], a[20:23]
    v_mfma_f32_16x16x32_bf16 a[40:43], a[160:163], v[80:83], a[40:43]
    v_mfma_f32_16x16x32_bf16 a[40:43], a[164:167], v[84:87], a[40:43]
    s_add_u32 m0, s38, 3080
    s_waitcnt lgkmcnt(0)
    v_mfma_f32_16x16x32_bf16 a[28:31], a[168:171], v[64:67], a[28:31]
    ds_read_b64_tr_b16 a[144:145], v241 offset:128
    v_mfma_f32_16x16x32_bf16 a[28:31], a[172:175], v[68:71], a[28:31]
    ds_read_b64_tr_b16 a[146:147], v241 offset:1664
    v_mfma_f32_16x16x32_bf16 a[48:51], a[176:179], v[64:67], a[48:51]
    ds_read_b64_tr_b16 a[148:149], v241 offset:12448
    v_mfma_f32_16x16x32_bf16 a[48:51], a[180:183], v[68:71], a[48:51]
    ds_read_b64_tr_b16 a[150:151], v241 offset:13984
    v_mfma_f32_16x16x32_bf16 a[52:55], a[184:187], v[64:67], a[52:55]
    ds_read_b64_tr_b16 a[152:153], v241 offset:136
    v_mfma_f32_16x16x32_bf16 a[52:55], a[188:191], v[68:71], a[52:55]
    ds_read_b64_tr_b16 a[154:155], v241 offset:1672
    v_mfma_f32_16x16x32_bf16 a[36:39], a[168:171], v[72:75], a[36:39]
    ds_read_b64_tr_b16 a[156:157], v241 offset:12456
    v_mfma_f32_16x16x32_bf16 a[36:39], a[172:175], v[76:79], a[36:39]
    ds_read_b64_tr_b16 a[158:159], v241 offset:13992
    buffer_load_dwordx4 v17, s[8:11], s35 offen offset:0 lds
    v_mfma_f32_16x16x32_bf16 a[56:59], a[176:179], v[72:75], a[56:59]
    ds_read_b64_tr_b16 a[160:161], v240 offset:256
    v_mfma_f32_16x16x32_bf16 a[56:59], a[180:183], v[76:79], a[56:59]
    ds_read_b64_tr_b16 a[162:163], v240 offset:1792
    v_mfma_f32_16x16x32_bf16 a[60:63], a[184:187], v[72:75], a[60:63]
    ds_read_b64_tr_b16 a[164:165], v240 offset:12576
    v_mfma_f32_16x16x32_bf16 a[60:63], a[188:191], v[76:79], a[60:63]
    ds_read_b64_tr_b16 a[166:167], v240 offset:14112
    v_mfma_f32_16x16x32_bf16 a[44:47], a[168:171], v[80:83], a[44:47]
    v_mfma_f32_16x16x32_bf16 a[44:47], a[172:175], v[84:87], a[44:47]
    v_mfma_f32_16x16x32_bf16 a[64:67], a[176:179], v[80:83], a[64:67]
    v_mfma_f32_16x16x32_bf16 a[64:67], a[180:183], v[84:87], a[64:67]
    v_mfma_f32_16x16x32_bf16 a[68:71], a[184:187], v[80:83], a[68:71]
    buffer_load_dwordx4 v18, s[8:11], s35 offen offset:1024 lds
    v_mfma_f32_16x16x32_bf16 a[68:71], a[188:191], v[84:87], a[68:71]
    s_waitcnt lgkmcnt(0)
    v_mfma_f32_16x16x32_bf16 a[72:75], a[144:147], v[64:67], a[72:75]
    ds_read_b64_tr_b16 a[168:169], v240 offset:264
    v_mfma_f32_16x16x32_bf16 a[72:75], a[148:151], v[68:71], a[72:75]
    ds_read_b64_tr_b16 a[170:171], v240 offset:1800
    v_mfma_f32_16x16x32_bf16 a[76:79], a[152:155], v[64:67], a[76:79]
    ds_read_b64_tr_b16 a[172:173], v240 offset:12584
    v_mfma_f32_16x16x32_bf16 a[76:79], a[156:159], v[68:71], a[76:79]
    ds_read_b64_tr_b16 a[174:175], v240 offset:14120
    v_mfma_f32_16x16x32_bf16 a[96:99], a[160:163], v[64:67], a[96:99]
    ds_read_b64_tr_b16 a[176:177], v241 offset:256
    v_mfma_f32_16x16x32_bf16 a[96:99], a[164:167], v[68:71], a[96:99]
    ds_read_b64_tr_b16 a[178:179], v241 offset:1792
    v_mfma_f32_16x16x32_bf16 a[80:83], a[144:147], v[72:75], a[80:83]
    ds_read_b64_tr_b16 a[180:181], v241 offset:12576
    buffer_load_dwordx4 v19, s[8:11], s35 offen offset:2048 lds
    v_mfma_f32_16x16x32_bf16 a[80:83], a[148:151], v[76:79], a[80:83]
    ds_read_b64_tr_b16 a[182:183], v241 offset:14112
    v_mfma_f32_16x16x32_bf16 a[84:87], a[152:155], v[72:75], a[84:87]
    ds_read_b64_tr_b16 a[184:185], v241 offset:264
    v_mfma_f32_16x16x32_bf16 a[84:87], a[156:159], v[76:79], a[84:87]
    ds_read_b64_tr_b16 a[186:187], v241 offset:1800
    v_mfma_f32_16x16x32_bf16 a[104:107], a[160:163], v[72:75], a[104:107]
    ds_read_b64_tr_b16 a[188:189], v241 offset:12584
    v_mfma_f32_16x16x32_bf16 a[104:107], a[164:167], v[76:79], a[104:107]
    ds_read_b64_tr_b16 a[190:191], v241 offset:14120
    v_mfma_f32_16x16x32_bf16 a[88:91], a[144:147], v[80:83], a[88:91]
    v_mfma_f32_16x16x32_bf16 a[88:91], a[148:151], v[84:87], a[88:91]
    v_mfma_f32_16x16x32_bf16 a[92:95], a[152:155], v[80:83], a[92:95]
    v_mfma_f32_16x16x32_bf16 a[92:95], a[156:159], v[84:87], a[92:95]
    v_mfma_f32_16x16x32_bf16 a[112:115], a[160:163], v[80:83], a[112:115]
    v_mfma_f32_16x16x32_bf16 a[112:115], a[164:167], v[84:87], a[112:115]
    s_waitcnt vmcnt(18)
    s_waitcnt lgkmcnt(0)
    s_barrier
    v_mfma_f32_16x16x32_bf16 a[100:103], a[168:171], v[64:67], a[100:103]
    ds_read_b64_tr_b16 a[144:145], v240 offset:24640
    v_mfma_f32_16x16x32_bf16 a[100:103], a[172:175], v[68:71], a[100:103]
    ds_read_b64_tr_b16 a[146:147], v240 offset:26176
    s_add_u32 m0, s29, 24640
    s_mov_b32 s35, 384
    v_mfma_f32_16x16x32_bf16 a[120:123], a[176:179], v[64:67], a[120:123]
    ds_read_b64_tr_b16 a[148:149], v240 offset:36960
    v_mfma_f32_16x16x32_bf16 a[120:123], a[180:183], v[68:71], a[120:123]
    ds_read_b64_tr_b16 a[150:151], v240 offset:38496
    v_mfma_f32_16x16x32_bf16 a[124:127], a[184:187], v[64:67], a[124:127]
    ds_read_b64_tr_b16 a[152:153], v240 offset:24648
    v_mfma_f32_16x16x32_bf16 a[124:127], a[188:191], v[68:71], a[124:127]
    ds_read_b64_tr_b16 a[154:155], v240 offset:26184
    buffer_load_dwordx4 v8, s[4:7], s35 offen offset:0 lds
    v_mfma_f32_16x16x32_bf16 a[108:111], a[168:171], v[72:75], a[108:111]
    ds_read_b64_tr_b16 a[156:157], v240 offset:36968
    v_mfma_f32_16x16x32_bf16 a[108:111], a[172:175], v[76:79], a[108:111]
    ds_read_b64_tr_b16 a[158:159], v240 offset:38504
    v_mfma_f32_16x16x32_bf16 a[128:131], a[176:179], v[72:75], a[128:131]
    ds_read_b64_tr_b16 a[160:161], v241 offset:24640
    v_mfma_f32_16x16x32_bf16 a[128:131], a[180:183], v[76:79], a[128:131]
    ds_read_b64_tr_b16 a[162:163], v241 offset:26176
    buffer_load_dwordx4 v9, s[4:7], s35 offen offset:1024 lds
    v_mfma_f32_16x16x32_bf16 a[132:135], a[184:187], v[72:75], a[132:135]
    ds_read_b64_tr_b16 a[164:165], v241 offset:36960
    v_mfma_f32_16x16x32_bf16 a[132:135], a[188:191], v[76:79], a[132:135]
    ds_read_b64_tr_b16 a[166:167], v241 offset:38496
    v_mfma_f32_16x16x32_bf16 a[116:119], a[168:171], v[80:83], a[116:119]
    v_mfma_f32_16x16x32_bf16 a[116:119], a[172:175], v[84:87], a[116:119]
    buffer_load_dwordx4 v10, s[4:7], s35 offen offset:2048 lds
    v_mfma_f32_16x16x32_bf16 a[136:139], a[176:179], v[80:83], a[136:139]
    v_mfma_f32_16x16x32_bf16 a[136:139], a[180:183], v[84:87], a[136:139]
    v_mfma_f32_16x16x32_bf16 a[140:143], a[184:187], v[80:83], a[140:143]
    v_mfma_f32_16x16x32_bf16 a[140:143], a[188:191], v[84:87], a[140:143]
    s_waitcnt lgkmcnt(0)
    v_mfma_f32_16x16x32_bf16 v[88:91], a[144:147], v[64:67], v[88:91]
    ds_read_b64_tr_b16 a[168:169], v241 offset:24648
    buffer_load_dwordx4 v11, s[4:7], s35 offen offset:3072 lds
    v_mfma_f32_16x16x32_bf16 v[88:91], a[148:151], v[68:71], v[88:91]
    ds_read_b64_tr_b16 a[170:171], v241 offset:26184
    v_mfma_f32_16x16x32_bf16 v[92:95], a[152:155], v[64:67], v[92:95]
    ds_read_b64_tr_b16 a[172:173], v241 offset:36968
    v_mfma_f32_16x16x32_bf16 v[92:95], a[156:159], v[68:71], v[92:95]
    ds_read_b64_tr_b16 a[174:175], v241 offset:38504
    v_mfma_f32_16x16x32_bf16 v[112:115], a[160:163], v[64:67], v[112:115]
    ds_read_b64_tr_b16 a[176:177], v240 offset:24768
    s_add_u32 m0, s29, 28736
    v_mfma_f32_16x16x32_bf16 v[112:115], a[164:167], v[68:71], v[112:115]
    ds_read_b64_tr_b16 a[178:179], v240 offset:26304
    v_mfma_f32_16x16x32_bf16 v[96:99], a[144:147], v[72:75], v[96:99]
    ds_read_b64_tr_b16 a[180:181], v240 offset:37088
    v_mfma_f32_16x16x32_bf16 v[96:99], a[148:151], v[76:79], v[96:99]
    ds_read_b64_tr_b16 a[182:183], v240 offset:38624
    v_mfma_f32_16x16x32_bf16 v[100:103], a[152:155], v[72:75], v[100:103]
    ds_read_b64_tr_b16 a[184:185], v240 offset:24776
    buffer_load_dwordx4 v12, s[4:7], s35 offen offset:0 lds
    v_mfma_f32_16x16x32_bf16 v[100:103], a[156:159], v[76:79], v[100:103]
    ds_read_b64_tr_b16 a[186:187], v240 offset:26312
    v_mfma_f32_16x16x32_bf16 v[120:123], a[160:163], v[72:75], v[120:123]
    ds_read_b64_tr_b16 a[188:189], v240 offset:37096
    v_mfma_f32_16x16x32_bf16 v[120:123], a[164:167], v[76:79], v[120:123]
    ds_read_b64_tr_b16 a[190:191], v240 offset:38632
    v_mfma_f32_16x16x32_bf16 v[104:107], a[144:147], v[80:83], v[104:107]
    buffer_load_dwordx4 v13, s[4:7], s35 offen offset:1024 lds
    v_mfma_f32_16x16x32_bf16 v[104:107], a[148:151], v[84:87], v[104:107]
    v_mfma_f32_16x16x32_bf16 v[108:111], a[152:155], v[80:83], v[108:111]
    v_mfma_f32_16x16x32_bf16 v[108:111], a[156:159], v[84:87], v[108:111]
    v_mfma_f32_16x16x32_bf16 v[128:131], a[160:163], v[80:83], v[128:131]
    v_mfma_f32_16x16x32_bf16 v[128:131], a[164:167], v[84:87], v[128:131]
    s_add_u32 m0, s38, 49280
    s_mov_b32 s36, 2360832
    s_waitcnt lgkmcnt(0)
    v_mfma_f32_16x16x32_bf16 v[116:119], a[168:171], v[64:67], v[116:119]
    ds_read_b64_tr_b16 a[144:145], v241 offset:24768
    v_mfma_f32_16x16x32_bf16 v[116:119], a[172:175], v[68:71], v[116:119]
    ds_read_b64_tr_b16 a[146:147], v241 offset:26304
    v_mfma_f32_16x16x32_bf16 v[136:139], a[176:179], v[64:67], v[136:139]
    ds_read_b64_tr_b16 a[148:149], v241 offset:37088
    v_mfma_f32_16x16x32_bf16 v[136:139], a[180:183], v[68:71], v[136:139]
    ds_read_b64_tr_b16 a[150:151], v241 offset:38624
    buffer_load_dwordx4 v14, s[8:11], s36 offen offset:0 lds
    v_mfma_f32_16x16x32_bf16 v[140:143], a[184:187], v[64:67], v[140:143]
    ds_read_b64_tr_b16 a[152:153], v241 offset:24776
    v_mfma_f32_16x16x32_bf16 v[140:143], a[188:191], v[68:71], v[140:143]
    ds_read_b64_tr_b16 a[154:155], v241 offset:26312
    v_mfma_f32_16x16x32_bf16 v[124:127], a[168:171], v[72:75], v[124:127]
    ds_read_b64_tr_b16 a[156:157], v241 offset:37096
    v_mfma_f32_16x16x32_bf16 v[124:127], a[172:175], v[76:79], v[124:127]
    ds_read_b64_tr_b16 a[158:159], v241 offset:38632
    buffer_load_dwordx4 v15, s[8:11], s36 offen offset:1024 lds
    v_mfma_f32_16x16x32_bf16 v[144:147], a[176:179], v[72:75], v[144:147]
    ds_read_b64_tr_b16 a[160:161], v240 offset:24896
    v_mfma_f32_16x16x32_bf16 v[144:147], a[180:183], v[76:79], v[144:147]
    ds_read_b64_tr_b16 a[162:163], v240 offset:26432
    v_mfma_f32_16x16x32_bf16 v[148:151], a[184:187], v[72:75], v[148:151]
    ds_read_b64_tr_b16 a[164:165], v240 offset:37216
    v_mfma_f32_16x16x32_bf16 v[148:151], a[188:191], v[76:79], v[148:151]
    ds_read_b64_tr_b16 a[166:167], v240 offset:38752
    buffer_load_dwordx4 v16, s[8:11], s36 offen offset:2048 lds
    v_mfma_f32_16x16x32_bf16 v[132:135], a[168:171], v[80:83], v[132:135]
    v_mfma_f32_16x16x32_bf16 v[132:135], a[172:175], v[84:87], v[132:135]
    v_mfma_f32_16x16x32_bf16 v[152:155], a[176:179], v[80:83], v[152:155]
    v_mfma_f32_16x16x32_bf16 v[152:155], a[180:183], v[84:87], v[152:155]
    v_mfma_f32_16x16x32_bf16 v[156:159], a[184:187], v[80:83], v[156:159]
    s_add_u32 m0, s38, 52360
    v_mfma_f32_16x16x32_bf16 v[156:159], a[188:191], v[84:87], v[156:159]
    s_waitcnt lgkmcnt(0)
    v_mfma_f32_16x16x32_bf16 v[160:163], a[144:147], v[64:67], v[160:163]
    ds_read_b64_tr_b16 a[168:169], v240 offset:24904
    v_mfma_f32_16x16x32_bf16 v[160:163], a[148:151], v[68:71], v[160:163]
    ds_read_b64_tr_b16 a[170:171], v240 offset:26440
    v_mfma_f32_16x16x32_bf16 v[164:167], a[152:155], v[64:67], v[164:167]
    ds_read_b64_tr_b16 a[172:173], v240 offset:37224
    buffer_load_dwordx4 v17, s[8:11], s36 offen offset:0 lds
    v_mfma_f32_16x16x32_bf16 v[164:167], a[156:159], v[68:71], v[164:167]
    ds_read_b64_tr_b16 a[174:175], v240 offset:38760
    v_mfma_f32_16x16x32_bf16 v[184:187], a[160:163], v[64:67], v[184:187]
    ds_read_b64_tr_b16 a[176:177], v241 offset:24896
    v_mfma_f32_16x16x32_bf16 v[184:187], a[164:167], v[68:71], v[184:187]
    ds_read_b64_tr_b16 a[178:179], v241 offset:26432
    v_mfma_f32_16x16x32_bf16 v[168:171], a[144:147], v[72:75], v[168:171]
    ds_read_b64_tr_b16 a[180:181], v241 offset:37216
    buffer_load_dwordx4 v18, s[8:11], s36 offen offset:1024 lds
    v_mfma_f32_16x16x32_bf16 v[168:171], a[148:151], v[76:79], v[168:171]
    ds_read_b64_tr_b16 a[182:183], v241 offset:38752
    v_mfma_f32_16x16x32_bf16 v[172:175], a[152:155], v[72:75], v[172:175]
    ds_read_b64_tr_b16 a[184:185], v241 offset:24904
    v_mfma_f32_16x16x32_bf16 v[172:175], a[156:159], v[76:79], v[172:175]
    ds_read_b64_tr_b16 a[186:187], v241 offset:26440
    v_mfma_f32_16x16x32_bf16 v[192:195], a[160:163], v[72:75], v[192:195]
    ds_read_b64_tr_b16 a[188:189], v241 offset:37224
    buffer_load_dwordx4 v19, s[8:11], s36 offen offset:2048 lds
    v_mfma_f32_16x16x32_bf16 v[192:195], a[164:167], v[76:79], v[192:195]
    ds_read_b64_tr_b16 a[190:191], v241 offset:38760
    v_mfma_f32_16x16x32_bf16 v[176:179], a[144:147], v[80:83], v[176:179]
    v_mfma_f32_16x16x32_bf16 v[176:179], a[148:151], v[84:87], v[176:179]
    v_mfma_f32_16x16x32_bf16 v[180:183], a[152:155], v[80:83], v[180:183]
    v_mfma_f32_16x16x32_bf16 v[180:183], a[156:159], v[84:87], v[180:183]
    v_mfma_f32_16x16x32_bf16 v[200:203], a[160:163], v[80:83], v[200:203]
    v_mfma_f32_16x16x32_bf16 v[200:203], a[164:167], v[84:87], v[200:203]
    s_waitcnt vmcnt(18)
    s_waitcnt lgkmcnt(0)
    s_barrier
    v_mfma_f32_16x16x32_bf16 v[188:191], a[168:171], v[64:67], v[188:191]
    ds_read_b64_tr_b16 a[144:145], v242 offset:24640
    v_mfma_f32_16x16x32_bf16 v[188:191], a[172:175], v[68:71], v[188:191]
    ds_read_b64_tr_b16 a[146:147], v242 offset:26176
    s_add_u32 m0, s38, 73920
    s_mov_b32 s35, 2359296
    v_mfma_f32_16x16x32_bf16 v[208:211], a[176:179], v[64:67], v[208:211]
    ds_read_b64_tr_b16 a[148:149], v242 offset:36960
    v_mfma_f32_16x16x32_bf16 v[208:211], a[180:183], v[68:71], v[208:211]
    ds_read_b64_tr_b16 a[150:151], v242 offset:38496
    v_mfma_f32_16x16x32_bf16 v[212:215], a[184:187], v[64:67], v[212:215]
    ds_read_b64_tr_b16 a[152:153], v242 offset:24648
    v_mfma_f32_16x16x32_bf16 v[212:215], a[188:191], v[68:71], v[212:215]
    ds_read_b128 v[64:67], v236 offset:0
    ds_read_b64_tr_b16 a[154:155], v242 offset:26184
    v_mfma_f32_16x16x32_bf16 v[196:199], a[168:171], v[72:75], v[196:199]
    ds_read_b128 v[68:71], v237 offset:0
    ds_read_b64_tr_b16 a[156:157], v242 offset:36968
    v_mfma_f32_16x16x32_bf16 v[196:199], a[172:175], v[76:79], v[196:199]
    ds_read_b64_tr_b16 a[158:159], v242 offset:38504
    v_mfma_f32_16x16x32_bf16 v[216:219], a[176:179], v[72:75], v[216:219]
    ds_read_b64_tr_b16 a[160:161], v243 offset:24640
    v_mfma_f32_16x16x32_bf16 v[216:219], a[180:183], v[76:79], v[216:219]
    ds_read_b64_tr_b16 a[162:163], v243 offset:26176
    buffer_load_dwordx4 v14, s[8:11], s35 offen offset:0 lds
    v_mfma_f32_16x16x32_bf16 v[220:223], a[184:187], v[72:75], v[220:223]
    ds_read_b64_tr_b16 a[164:165], v243 offset:36960
    v_mfma_f32_16x16x32_bf16 v[220:223], a[188:191], v[76:79], v[220:223]
    ds_read_b128 v[72:75], v236 offset:2048
    ds_read_b64_tr_b16 a[166:167], v243 offset:38496
    v_mfma_f32_16x16x32_bf16 v[204:207], a[168:171], v[80:83], v[204:207]
    ds_read_b128 v[76:79], v237 offset:2048
    v_mfma_f32_16x16x32_bf16 v[204:207], a[172:175], v[84:87], v[204:207]
    v_mfma_f32_16x16x32_bf16 v[224:227], a[176:179], v[80:83], v[224:227]
    v_mfma_f32_16x16x32_bf16 v[224:227], a[180:183], v[84:87], v[224:227]
    v_mfma_f32_16x16x32_bf16 v[228:231], a[184:187], v[80:83], v[228:231]
    v_mfma_f32_16x16x32_bf16 v[228:231], a[188:191], v[84:87], v[228:231]
    ds_read_b128 v[80:83], v236 offset:4096
    ds_read_b128 v[84:87], v237 offset:4096
    s_waitcnt lgkmcnt(3)
    v_mfma_f32_16x16x32_bf16 a[0:3], a[144:147], v[64:67], a[0:3]
    ds_read_b64_tr_b16 a[168:169], v243 offset:24648
    buffer_load_dwordx4 v15, s[8:11], s35 offen offset:1024 lds
    v_mfma_f32_16x16x32_bf16 a[0:3], a[148:151], v[68:71], a[0:3]
    ds_read_b64_tr_b16 a[170:171], v243 offset:26184
    v_mfma_f32_16x16x32_bf16 a[4:7], a[152:155], v[64:67], a[4:7]
    ds_read_b64_tr_b16 a[172:173], v243 offset:36968
    v_mfma_f32_16x16x32_bf16 a[4:7], a[156:159], v[68:71], a[4:7]
    ds_read_b64_tr_b16 a[174:175], v243 offset:38504
    v_mfma_f32_16x16x32_bf16 a[24:27], a[160:163], v[64:67], a[24:27]
    ds_read_b64_tr_b16 a[176:177], v242 offset:24768
    v_mfma_f32_16x16x32_bf16 a[24:27], a[164:167], v[68:71], a[24:27]
    ds_read_b64_tr_b16 a[178:179], v242 offset:26304
    v_mfma_f32_16x16x32_bf16 a[8:11], a[144:147], v[72:75], a[8:11]
    ds_read_b64_tr_b16 a[180:181], v242 offset:37088
    s_waitcnt lgkmcnt(9)
    v_mfma_f32_16x16x32_bf16 a[8:11], a[148:151], v[76:79], a[8:11]
    ds_read_b64_tr_b16 a[182:183], v242 offset:38624
    v_mfma_f32_16x16x32_bf16 a[12:15], a[152:155], v[72:75], a[12:15]
    ds_read_b64_tr_b16 a[184:185], v242 offset:24776
    buffer_load_dwordx4 v16, s[8:11], s35 offen offset:2048 lds
    v_mfma_f32_16x16x32_bf16 a[12:15], a[156:159], v[76:79], a[12:15]
    ds_read_b64_tr_b16 a[186:187], v242 offset:26312
    v_mfma_f32_16x16x32_bf16 a[32:35], a[160:163], v[72:75], a[32:35]
    ds_read_b64_tr_b16 a[188:189], v242 offset:37096
    v_mfma_f32_16x16x32_bf16 a[32:35], a[164:167], v[76:79], a[32:35]
    ds_read_b64_tr_b16 a[190:191], v242 offset:38632
    s_waitcnt lgkmcnt(13)
    v_mfma_f32_16x16x32_bf16 a[16:19], a[144:147], v[80:83], a[16:19]
    s_waitcnt lgkmcnt(12)
    v_mfma_f32_16x16x32_bf16 a[16:19], a[148:151], v[84:87], a[16:19]
    v_mfma_f32_16x16x32_bf16 a[20:23], a[152:155], v[80:83], a[20:23]
    v_mfma_f32_16x16x32_bf16 a[20:23], a[156:159], v[84:87], a[20:23]
    v_mfma_f32_16x16x32_bf16 a[40:43], a[160:163], v[80:83], a[40:43]
    v_mfma_f32_16x16x32_bf16 a[40:43], a[164:167], v[84:87], a[40:43]
    s_add_u32 m0, s38, 77000
    s_waitcnt lgkmcnt(0)
    v_mfma_f32_16x16x32_bf16 a[28:31], a[168:171], v[64:67], a[28:31]
    ds_read_b64_tr_b16 a[144:145], v243 offset:24768
    v_mfma_f32_16x16x32_bf16 a[28:31], a[172:175], v[68:71], a[28:31]
    ds_read_b64_tr_b16 a[146:147], v243 offset:26304
    v_mfma_f32_16x16x32_bf16 a[48:51], a[176:179], v[64:67], a[48:51]
    ds_read_b64_tr_b16 a[148:149], v243 offset:37088
    v_mfma_f32_16x16x32_bf16 a[48:51], a[180:183], v[68:71], a[48:51]
    ds_read_b64_tr_b16 a[150:151], v243 offset:38624
    v_mfma_f32_16x16x32_bf16 a[52:55], a[184:187], v[64:67], a[52:55]
    ds_read_b64_tr_b16 a[152:153], v243 offset:24776
    v_mfma_f32_16x16x32_bf16 a[52:55], a[188:191], v[68:71], a[52:55]
    ds_read_b64_tr_b16 a[154:155], v243 offset:26312
    v_mfma_f32_16x16x32_bf16 a[36:39], a[168:171], v[72:75], a[36:39]
    ds_read_b64_tr_b16 a[156:157], v243 offset:37096
    v_mfma_f32_16x16x32_bf16 a[36:39], a[172:175], v[76:79], a[36:39]
    ds_read_b64_tr_b16 a[158:159], v243 offset:38632
    buffer_load_dwordx4 v17, s[8:11], s35 offen offset:0 lds
    v_mfma_f32_16x16x32_bf16 a[56:59], a[176:179], v[72:75], a[56:59]
    ds_read_b64_tr_b16 a[160:161], v242 offset:24896
    v_mfma_f32_16x16x32_bf16 a[56:59], a[180:183], v[76:79], a[56:59]
    ds_read_b64_tr_b16 a[162:163], v242 offset:26432
    v_mfma_f32_16x16x32_bf16 a[60:63], a[184:187], v[72:75], a[60:63]
    ds_read_b64_tr_b16 a[164:165], v242 offset:37216
    v_mfma_f32_16x16x32_bf16 a[60:63], a[188:191], v[76:79], a[60:63]
    ds_read_b64_tr_b16 a[166:167], v242 offset:38752
    v_mfma_f32_16x16x32_bf16 a[44:47], a[168:171], v[80:83], a[44:47]
    v_mfma_f32_16x16x32_bf16 a[44:47], a[172:175], v[84:87], a[44:47]
    v_mfma_f32_16x16x32_bf16 a[64:67], a[176:179], v[80:83], a[64:67]
    v_mfma_f32_16x16x32_bf16 a[64:67], a[180:183], v[84:87], a[64:67]
    v_mfma_f32_16x16x32_bf16 a[68:71], a[184:187], v[80:83], a[68:71]
    buffer_load_dwordx4 v18, s[8:11], s35 offen offset:1024 lds
    v_mfma_f32_16x16x32_bf16 a[68:71], a[188:191], v[84:87], a[68:71]
    s_waitcnt lgkmcnt(0)
    v_mfma_f32_16x16x32_bf16 a[72:75], a[144:147], v[64:67], a[72:75]
    ds_read_b64_tr_b16 a[168:169], v242 offset:24904
    v_mfma_f32_16x16x32_bf16 a[72:75], a[148:151], v[68:71], a[72:75]
    ds_read_b64_tr_b16 a[170:171], v242 offset:26440
    v_mfma_f32_16x16x32_bf16 a[76:79], a[152:155], v[64:67], a[76:79]
    ds_read_b64_tr_b16 a[172:173], v242 offset:37224
    v_mfma_f32_16x16x32_bf16 a[76:79], a[156:159], v[68:71], a[76:79]
    ds_read_b64_tr_b16 a[174:175], v242 offset:38760
    v_mfma_f32_16x16x32_bf16 a[96:99], a[160:163], v[64:67], a[96:99]
    ds_read_b64_tr_b16 a[176:177], v243 offset:24896
    v_mfma_f32_16x16x32_bf16 a[96:99], a[164:167], v[68:71], a[96:99]
    ds_read_b64_tr_b16 a[178:179], v243 offset:26432
    v_mfma_f32_16x16x32_bf16 a[80:83], a[144:147], v[72:75], a[80:83]
    ds_read_b64_tr_b16 a[180:181], v243 offset:37216
    buffer_load_dwordx4 v19, s[8:11], s35 offen offset:2048 lds
    v_mfma_f32_16x16x32_bf16 a[80:83], a[148:151], v[76:79], a[80:83]
    ds_read_b64_tr_b16 a[182:183], v243 offset:38752
    v_mfma_f32_16x16x32_bf16 a[84:87], a[152:155], v[72:75], a[84:87]
    ds_read_b64_tr_b16 a[184:185], v243 offset:24904
    v_mfma_f32_16x16x32_bf16 a[84:87], a[156:159], v[76:79], a[84:87]
    ds_read_b64_tr_b16 a[186:187], v243 offset:26440
    v_mfma_f32_16x16x32_bf16 a[104:107], a[160:163], v[72:75], a[104:107]
    ds_read_b64_tr_b16 a[188:189], v243 offset:37224
    v_mfma_f32_16x16x32_bf16 a[104:107], a[164:167], v[76:79], a[104:107]
    ds_read_b64_tr_b16 a[190:191], v243 offset:38760
    v_mfma_f32_16x16x32_bf16 a[88:91], a[144:147], v[80:83], a[88:91]
    v_mfma_f32_16x16x32_bf16 a[88:91], a[148:151], v[84:87], a[88:91]
    v_mfma_f32_16x16x32_bf16 a[92:95], a[152:155], v[80:83], a[92:95]
    v_mfma_f32_16x16x32_bf16 a[92:95], a[156:159], v[84:87], a[92:95]
    v_mfma_f32_16x16x32_bf16 a[112:115], a[160:163], v[80:83], a[112:115]
    v_mfma_f32_16x16x32_bf16 a[112:115], a[164:167], v[84:87], a[112:115]
    s_waitcnt vmcnt(18)
    s_waitcnt lgkmcnt(0)
    s_barrier
    v_mfma_f32_16x16x32_bf16 a[100:103], a[168:171], v[64:67], a[100:103]
    ds_read_b64_tr_b16 a[144:145], v238 offset:0
    v_mfma_f32_16x16x32_bf16 a[100:103], a[172:175], v[68:71], a[100:103]
    ds_read_b64_tr_b16 a[146:147], v238 offset:1536
    s_add_u32 m0, s29, 98560
    s_mov_b32 s35, 512
    v_mfma_f32_16x16x32_bf16 a[120:123], a[176:179], v[64:67], a[120:123]
    ds_read_b64_tr_b16 a[148:149], v238 offset:12320
    v_mfma_f32_16x16x32_bf16 a[120:123], a[180:183], v[68:71], a[120:123]
    ds_read_b64_tr_b16 a[150:151], v238 offset:13856
    v_mfma_f32_16x16x32_bf16 a[124:127], a[184:187], v[64:67], a[124:127]
    ds_read_b64_tr_b16 a[152:153], v238 offset:8
    v_mfma_f32_16x16x32_bf16 a[124:127], a[188:191], v[68:71], a[124:127]
    ds_read_b64_tr_b16 a[154:155], v238 offset:1544
    buffer_load_dwordx4 v8, s[4:7], s35 offen offset:0 lds
    v_mfma_f32_16x16x32_bf16 a[108:111], a[168:171], v[72:75], a[108:111]
    ds_read_b64_tr_b16 a[156:157], v238 offset:12328
    v_mfma_f32_16x16x32_bf16 a[108:111], a[172:175], v[76:79], a[108:111]
    ds_read_b64_tr_b16 a[158:159], v238 offset:13864
    v_mfma_f32_16x16x32_bf16 a[128:131], a[176:179], v[72:75], a[128:131]
    ds_read_b64_tr_b16 a[160:161], v239 offset:0
    v_mfma_f32_16x16x32_bf16 a[128:131], a[180:183], v[76:79], a[128:131]
    ds_read_b64_tr_b16 a[162:163], v239 offset:1536
    buffer_load_dwordx4 v9, s[4:7], s35 offen offset:1024 lds
    v_mfma_f32_16x16x32_bf16 a[132:135], a[184:187], v[72:75], a[132:135]
    ds_read_b64_tr_b16 a[164:165], v239 offset:12320
    v_mfma_f32_16x16x32_bf16 a[132:135], a[188:191], v[76:79], a[132:135]
    ds_read_b64_tr_b16 a[166:167], v239 offset:13856
    v_mfma_f32_16x16x32_bf16 a[116:119], a[168:171], v[80:83], a[116:119]
    v_mfma_f32_16x16x32_bf16 a[116:119], a[172:175], v[84:87], a[116:119]
    buffer_load_dwordx4 v10, s[4:7], s35 offen offset:2048 lds
    v_mfma_f32_16x16x32_bf16 a[136:139], a[176:179], v[80:83], a[136:139]
    v_mfma_f32_16x16x32_bf16 a[136:139], a[180:183], v[84:87], a[136:139]
    v_mfma_f32_16x16x32_bf16 a[140:143], a[184:187], v[80:83], a[140:143]
    v_mfma_f32_16x16x32_bf16 a[140:143], a[188:191], v[84:87], a[140:143]
    s_waitcnt lgkmcnt(0)
    v_mfma_f32_16x16x32_bf16 v[88:91], a[144:147], v[64:67], v[88:91]
    ds_read_b64_tr_b16 a[168:169], v239 offset:8
    buffer_load_dwordx4 v11, s[4:7], s35 offen offset:3072 lds
    v_mfma_f32_16x16x32_bf16 v[88:91], a[148:151], v[68:71], v[88:91]
    ds_read_b64_tr_b16 a[170:171], v239 offset:1544
    v_mfma_f32_16x16x32_bf16 v[92:95], a[152:155], v[64:67], v[92:95]
    ds_read_b64_tr_b16 a[172:173], v239 offset:12328
    v_mfma_f32_16x16x32_bf16 v[92:95], a[156:159], v[68:71], v[92:95]
    ds_read_b64_tr_b16 a[174:175], v239 offset:13864
    v_mfma_f32_16x16x32_bf16 v[112:115], a[160:163], v[64:67], v[112:115]
    ds_read_b64_tr_b16 a[176:177], v238 offset:128
    s_add_u32 m0, s29, 102656
    v_mfma_f32_16x16x32_bf16 v[112:115], a[164:167], v[68:71], v[112:115]
    ds_read_b64_tr_b16 a[178:179], v238 offset:1664
    v_mfma_f32_16x16x32_bf16 v[96:99], a[144:147], v[72:75], v[96:99]
    ds_read_b64_tr_b16 a[180:181], v238 offset:12448
    v_mfma_f32_16x16x32_bf16 v[96:99], a[148:151], v[76:79], v[96:99]
    ds_read_b64_tr_b16 a[182:183], v238 offset:13984
    v_mfma_f32_16x16x32_bf16 v[100:103], a[152:155], v[72:75], v[100:103]
    ds_read_b64_tr_b16 a[184:185], v238 offset:136
    buffer_load_dwordx4 v12, s[4:7], s35 offen offset:0 lds
    v_mfma_f32_16x16x32_bf16 v[100:103], a[156:159], v[76:79], v[100:103]
    ds_read_b64_tr_b16 a[186:187], v238 offset:1672
    v_mfma_f32_16x16x32_bf16 v[120:123], a[160:163], v[72:75], v[120:123]
    ds_read_b64_tr_b16 a[188:189], v238 offset:12456
    v_mfma_f32_16x16x32_bf16 v[120:123], a[164:167], v[76:79], v[120:123]
    ds_read_b64_tr_b16 a[190:191], v238 offset:13992
    v_mfma_f32_16x16x32_bf16 v[104:107], a[144:147], v[80:83], v[104:107]
    buffer_load_dwordx4 v13, s[4:7], s35 offen offset:1024 lds
    v_mfma_f32_16x16x32_bf16 v[104:107], a[148:151], v[84:87], v[104:107]
    v_mfma_f32_16x16x32_bf16 v[108:111], a[152:155], v[80:83], v[108:111]
    v_mfma_f32_16x16x32_bf16 v[108:111], a[156:159], v[84:87], v[108:111]
    v_mfma_f32_16x16x32_bf16 v[128:131], a[160:163], v[80:83], v[128:131]
    v_mfma_f32_16x16x32_bf16 v[128:131], a[164:167], v[84:87], v[128:131]
    s_add_u32 m0, s38, 123200
    s_mov_b32 s36, 3147264
    s_waitcnt lgkmcnt(0)
    v_mfma_f32_16x16x32_bf16 v[116:119], a[168:171], v[64:67], v[116:119]
    ds_read_b64_tr_b16 a[144:145], v239 offset:128
    v_mfma_f32_16x16x32_bf16 v[116:119], a[172:175], v[68:71], v[116:119]
    ds_read_b64_tr_b16 a[146:147], v239 offset:1664
    v_mfma_f32_16x16x32_bf16 v[136:139], a[176:179], v[64:67], v[136:139]
    ds_read_b64_tr_b16 a[148:149], v239 offset:12448
    v_mfma_f32_16x16x32_bf16 v[136:139], a[180:183], v[68:71], v[136:139]
    ds_read_b64_tr_b16 a[150:151], v239 offset:13984
    buffer_load_dwordx4 v14, s[8:11], s36 offen offset:0 lds
    v_mfma_f32_16x16x32_bf16 v[140:143], a[184:187], v[64:67], v[140:143]
    ds_read_b64_tr_b16 a[152:153], v239 offset:136
    v_mfma_f32_16x16x32_bf16 v[140:143], a[188:191], v[68:71], v[140:143]
    ds_read_b64_tr_b16 a[154:155], v239 offset:1672
    v_mfma_f32_16x16x32_bf16 v[124:127], a[168:171], v[72:75], v[124:127]
    ds_read_b64_tr_b16 a[156:157], v239 offset:12456
    v_mfma_f32_16x16x32_bf16 v[124:127], a[172:175], v[76:79], v[124:127]
    ds_read_b64_tr_b16 a[158:159], v239 offset:13992
    buffer_load_dwordx4 v15, s[8:11], s36 offen offset:1024 lds
    v_mfma_f32_16x16x32_bf16 v[144:147], a[176:179], v[72:75], v[144:147]
    ds_read_b64_tr_b16 a[160:161], v238 offset:256
    v_mfma_f32_16x16x32_bf16 v[144:147], a[180:183], v[76:79], v[144:147]
    ds_read_b64_tr_b16 a[162:163], v238 offset:1792
    v_mfma_f32_16x16x32_bf16 v[148:151], a[184:187], v[72:75], v[148:151]
    ds_read_b64_tr_b16 a[164:165], v238 offset:12576
    v_mfma_f32_16x16x32_bf16 v[148:151], a[188:191], v[76:79], v[148:151]
    ds_read_b64_tr_b16 a[166:167], v238 offset:14112
    buffer_load_dwordx4 v16, s[8:11], s36 offen offset:2048 lds
    v_mfma_f32_16x16x32_bf16 v[132:135], a[168:171], v[80:83], v[132:135]
    v_mfma_f32_16x16x32_bf16 v[132:135], a[172:175], v[84:87], v[132:135]
    v_mfma_f32_16x16x32_bf16 v[152:155], a[176:179], v[80:83], v[152:155]
    v_mfma_f32_16x16x32_bf16 v[152:155], a[180:183], v[84:87], v[152:155]
    v_mfma_f32_16x16x32_bf16 v[156:159], a[184:187], v[80:83], v[156:159]
    s_add_u32 m0, s38, 126280
    v_mfma_f32_16x16x32_bf16 v[156:159], a[188:191], v[84:87], v[156:159]
    s_waitcnt lgkmcnt(0)
    v_mfma_f32_16x16x32_bf16 v[160:163], a[144:147], v[64:67], v[160:163]
    ds_read_b64_tr_b16 a[168:169], v238 offset:264
    v_mfma_f32_16x16x32_bf16 v[160:163], a[148:151], v[68:71], v[160:163]
    ds_read_b64_tr_b16 a[170:171], v238 offset:1800
    v_mfma_f32_16x16x32_bf16 v[164:167], a[152:155], v[64:67], v[164:167]
    ds_read_b64_tr_b16 a[172:173], v238 offset:12584
    buffer_load_dwordx4 v17, s[8:11], s36 offen offset:0 lds
    v_mfma_f32_16x16x32_bf16 v[164:167], a[156:159], v[68:71], v[164:167]
    ds_read_b64_tr_b16 a[174:175], v238 offset:14120
    v_mfma_f32_16x16x32_bf16 v[184:187], a[160:163], v[64:67], v[184:187]
    ds_read_b64_tr_b16 a[176:177], v239 offset:256
    v_mfma_f32_16x16x32_bf16 v[184:187], a[164:167], v[68:71], v[184:187]
    ds_read_b64_tr_b16 a[178:179], v239 offset:1792
    v_mfma_f32_16x16x32_bf16 v[168:171], a[144:147], v[72:75], v[168:171]
    ds_read_b64_tr_b16 a[180:181], v239 offset:12576
    buffer_load_dwordx4 v18, s[8:11], s36 offen offset:1024 lds
    v_mfma_f32_16x16x32_bf16 v[168:171], a[148:151], v[76:79], v[168:171]
    ds_read_b64_tr_b16 a[182:183], v239 offset:14112
    v_mfma_f32_16x16x32_bf16 v[172:175], a[152:155], v[72:75], v[172:175]
    ds_read_b64_tr_b16 a[184:185], v239 offset:264
    v_mfma_f32_16x16x32_bf16 v[172:175], a[156:159], v[76:79], v[172:175]
    ds_read_b64_tr_b16 a[186:187], v239 offset:1800
    v_mfma_f32_16x16x32_bf16 v[192:195], a[160:163], v[72:75], v[192:195]
    ds_read_b64_tr_b16 a[188:189], v239 offset:12584
    buffer_load_dwordx4 v19, s[8:11], s36 offen offset:2048 lds
    v_mfma_f32_16x16x32_bf16 v[192:195], a[164:167], v[76:79], v[192:195]
    ds_read_b64_tr_b16 a[190:191], v239 offset:14120
    v_mfma_f32_16x16x32_bf16 v[176:179], a[144:147], v[80:83], v[176:179]
    v_mfma_f32_16x16x32_bf16 v[176:179], a[148:151], v[84:87], v[176:179]
    v_mfma_f32_16x16x32_bf16 v[180:183], a[152:155], v[80:83], v[180:183]
    v_mfma_f32_16x16x32_bf16 v[180:183], a[156:159], v[84:87], v[180:183]
    v_mfma_f32_16x16x32_bf16 v[200:203], a[160:163], v[80:83], v[200:203]
    v_mfma_f32_16x16x32_bf16 v[200:203], a[164:167], v[84:87], v[200:203]
    s_waitcnt vmcnt(18)
    s_waitcnt lgkmcnt(0)
    s_barrier
    s_mov_b32 s60, s100
    s_mov_b32 s61, s101
    s_mov_b32 s62, 256
    s_lshl_b32 s42, s33, 2
    s_add_u32 s42, s42, 64
    v_cmp_eq_u32 vcc, 0x40000000, v33
    v_mov_b32 v1, 0
    v_mov_b32 v2, 0x40000000
    v_cndmask_b32 v1, v1, v2, vcc
    v_mov_b32 v2, 1
    buffer_atomic_add v2, v1, s[60:63], s42 offen
    v_mfma_f32_16x16x32_bf16 v[188:191], a[168:171], v[64:67], v[188:191]
    ds_read_b64_tr_b16 a[144:145], v240 offset:0
    v_mfma_f32_16x16x32_bf16 v[188:191], a[172:175], v[68:71], v[188:191]
    ds_read_b64_tr_b16 a[146:147], v240 offset:1536
    s_add_u32 m0, s38, 0
    s_mov_b32 s35, 3145728
    v_mfma_f32_16x16x32_bf16 v[208:211], a[176:179], v[64:67], v[208:211]
    ds_read_b64_tr_b16 a[148:149], v240 offset:12320
    v_mfma_f32_16x16x32_bf16 v[208:211], a[180:183], v[68:71], v[208:211]
    ds_read_b64_tr_b16 a[150:151], v240 offset:13856
    v_mfma_f32_16x16x32_bf16 v[212:215], a[184:187], v[64:67], v[212:215]
    ds_read_b64_tr_b16 a[152:153], v240 offset:8
    v_mfma_f32_16x16x32_bf16 v[212:215], a[188:191], v[68:71], v[212:215]
    ds_read_b128 v[64:67], v232 offset:24640
    ds_read_b64_tr_b16 a[154:155], v240 offset:1544
    v_mfma_f32_16x16x32_bf16 v[196:199], a[168:171], v[72:75], v[196:199]
    ds_read_b128 v[68:71], v233 offset:24640
    ds_read_b64_tr_b16 a[156:157], v240 offset:12328
    v_mfma_f32_16x16x32_bf16 v[196:199], a[172:175], v[76:79], v[196:199]
    ds_read_b64_tr_b16 a[158:159], v240 offset:13864
    v_mfma_f32_16x16x32_bf16 v[216:219], a[176:179], v[72:75], v[216:219]
    ds_read_b64_tr_b16 a[160:161], v241 offset:0
    v_mfma_f32_16x16x32_bf16 v[216:219], a[180:183], v[76:79], v[216:219]
    ds_read_b64_tr_b16 a[162:163], v241 offset:1536
    buffer_load_dwordx4 v14, s[8:11], s35 offen offset:0 lds
    v_mfma_f32_16x16x32_bf16 v[220:223], a[184:187], v[72:75], v[220:223]
    ds_read_b64_tr_b16 a[164:165], v241 offset:12320
    v_mfma_f32_16x16x32_bf16 v[220:223], a[188:191], v[76:79], v[220:223]
    ds_read_b128 v[72:75], v232 offset:26688
    ds_read_b64_tr_b16 a[166:167], v241 offset:13856
    v_mfma_f32_16x16x32_bf16 v[204:207], a[168:171], v[80:83], v[204:207]
    ds_read_b128 v[76:79], v233 offset:26688
    v_mfma_f32_16x16x32_bf16 v[204:207], a[172:175], v[84:87], v[204:207]
    v_mfma_f32_16x16x32_bf16 v[224:227], a[176:179], v[80:83], v[224:227]
    v_mfma_f32_16x16x32_bf16 v[224:227], a[180:183], v[84:87], v[224:227]
    v_mfma_f32_16x16x32_bf16 v[228:231], a[184:187], v[80:83], v[228:231]
    v_mfma_f32_16x16x32_bf16 v[228:231], a[188:191], v[84:87], v[228:231]
    ds_read_b128 v[80:83], v232 offset:28736
    ds_read_b128 v[84:87], v233 offset:28736
    s_waitcnt lgkmcnt(3)
    v_mfma_f32_16x16x32_bf16 a[0:3], a[144:147], v[64:67], a[0:3]
    ds_read_b64_tr_b16 a[168:169], v241 offset:8
    buffer_load_dwordx4 v15, s[8:11], s35 offen offset:1024 lds
    v_mfma_f32_16x16x32_bf16 a[0:3], a[148:151], v[68:71], a[0:3]
    ds_read_b64_tr_b16 a[170:171], v241 offset:1544
    v_mfma_f32_16x16x32_bf16 a[4:7], a[152:155], v[64:67], a[4:7]
    ds_read_b64_tr_b16 a[172:173], v241 offset:12328
    v_mfma_f32_16x16x32_bf16 a[4:7], a[156:159], v[68:71], a[4:7]
    ds_read_b64_tr_b16 a[174:175], v241 offset:13864
    v_mfma_f32_16x16x32_bf16 a[24:27], a[160:163], v[64:67], a[24:27]
    ds_read_b64_tr_b16 a[176:177], v240 offset:128
    v_mfma_f32_16x16x32_bf16 a[24:27], a[164:167], v[68:71], a[24:27]
    ds_read_b64_tr_b16 a[178:179], v240 offset:1664
    v_mfma_f32_16x16x32_bf16 a[8:11], a[144:147], v[72:75], a[8:11]
    ds_read_b64_tr_b16 a[180:181], v240 offset:12448
    s_waitcnt lgkmcnt(9)
    v_mfma_f32_16x16x32_bf16 a[8:11], a[148:151], v[76:79], a[8:11]
    ds_read_b64_tr_b16 a[182:183], v240 offset:13984
    v_mfma_f32_16x16x32_bf16 a[12:15], a[152:155], v[72:75], a[12:15]
    ds_read_b64_tr_b16 a[184:185], v240 offset:136
    buffer_load_dwordx4 v16, s[8:11], s35 offen offset:2048 lds
    v_mfma_f32_16x16x32_bf16 a[12:15], a[156:159], v[76:79], a[12:15]
    ds_read_b64_tr_b16 a[186:187], v240 offset:1672
    v_mfma_f32_16x16x32_bf16 a[32:35], a[160:163], v[72:75], a[32:35]
    ds_read_b64_tr_b16 a[188:189], v240 offset:12456
    v_mfma_f32_16x16x32_bf16 a[32:35], a[164:167], v[76:79], a[32:35]
    ds_read_b64_tr_b16 a[190:191], v240 offset:13992
    s_waitcnt lgkmcnt(13)
    v_mfma_f32_16x16x32_bf16 a[16:19], a[144:147], v[80:83], a[16:19]
    s_waitcnt lgkmcnt(12)
    v_mfma_f32_16x16x32_bf16 a[16:19], a[148:151], v[84:87], a[16:19]
    v_mfma_f32_16x16x32_bf16 a[20:23], a[152:155], v[80:83], a[20:23]
    v_mfma_f32_16x16x32_bf16 a[20:23], a[156:159], v[84:87], a[20:23]
    v_mfma_f32_16x16x32_bf16 a[40:43], a[160:163], v[80:83], a[40:43]
    v_mfma_f32_16x16x32_bf16 a[40:43], a[164:167], v[84:87], a[40:43]
    s_add_u32 m0, s38, 3080
    s_waitcnt lgkmcnt(0)
    v_mfma_f32_16x16x32_bf16 a[28:31], a[168:171], v[64:67], a[28:31]
    ds_read_b64_tr_b16 a[144:145], v241 offset:128
    v_mfma_f32_16x16x32_bf16 a[28:31], a[172:175], v[68:71], a[28:31]
    ds_read_b64_tr_b16 a[146:147], v241 offset:1664
    v_mfma_f32_16x16x32_bf16 a[48:51], a[176:179], v[64:67], a[48:51]
    ds_read_b64_tr_b16 a[148:149], v241 offset:12448
    v_mfma_f32_16x16x32_bf16 a[48:51], a[180:183], v[68:71], a[48:51]
    ds_read_b64_tr_b16 a[150:151], v241 offset:13984
    v_mfma_f32_16x16x32_bf16 a[52:55], a[184:187], v[64:67], a[52:55]
    ds_read_b64_tr_b16 a[152:153], v241 offset:136
    v_mfma_f32_16x16x32_bf16 a[52:55], a[188:191], v[68:71], a[52:55]
    ds_read_b64_tr_b16 a[154:155], v241 offset:1672
    v_mfma_f32_16x16x32_bf16 a[36:39], a[168:171], v[72:75], a[36:39]
    ds_read_b64_tr_b16 a[156:157], v241 offset:12456
    v_mfma_f32_16x16x32_bf16 a[36:39], a[172:175], v[76:79], a[36:39]
    ds_read_b64_tr_b16 a[158:159], v241 offset:13992
    buffer_load_dwordx4 v17, s[8:11], s35 offen offset:0 lds
    v_mfma_f32_16x16x32_bf16 a[56:59], a[176:179], v[72:75], a[56:59]
    ds_read_b64_tr_b16 a[160:161], v240 offset:256
    v_mfma_f32_16x16x32_bf16 a[56:59], a[180:183], v[76:79], a[56:59]
    ds_read_b64_tr_b16 a[162:163], v240 offset:1792
    v_mfma_f32_16x16x32_bf16 a[60:63], a[184:187], v[72:75], a[60:63]
    ds_read_b64_tr_b16 a[164:165], v240 offset:12576
    v_mfma_f32_16x16x32_bf16 a[60:63], a[188:191], v[76:79], a[60:63]
    ds_read_b64_tr_b16 a[166:167], v240 offset:14112
    v_mfma_f32_16x16x32_bf16 a[44:47], a[168:171], v[80:83], a[44:47]
    v_mfma_f32_16x16x32_bf16 a[44:47], a[172:175], v[84:87], a[44:47]
    v_mfma_f32_16x16x32_bf16 a[64:67], a[176:179], v[80:83], a[64:67]
    v_mfma_f32_16x16x32_bf16 a[64:67], a[180:183], v[84:87], a[64:67]
    v_mfma_f32_16x16x32_bf16 a[68:71], a[184:187], v[80:83], a[68:71]
    buffer_load_dwordx4 v18, s[8:11], s35 offen offset:1024 lds
    v_mfma_f32_16x16x32_bf16 a[68:71], a[188:191], v[84:87], a[68:71]
    s_waitcnt lgkmcnt(0)
    v_mfma_f32_16x16x32_bf16 a[72:75], a[144:147], v[64:67], a[72:75]
    ds_read_b64_tr_b16 a[168:169], v240 offset:264
    v_mfma_f32_16x16x32_bf16 a[72:75], a[148:151], v[68:71], a[72:75]
    ds_read_b64_tr_b16 a[170:171], v240 offset:1800
    v_mfma_f32_16x16x32_bf16 a[76:79], a[152:155], v[64:67], a[76:79]
    ds_read_b64_tr_b16 a[172:173], v240 offset:12584
    v_mfma_f32_16x16x32_bf16 a[76:79], a[156:159], v[68:71], a[76:79]
    ds_read_b64_tr_b16 a[174:175], v240 offset:14120
    v_mfma_f32_16x16x32_bf16 a[96:99], a[160:163], v[64:67], a[96:99]
    ds_read_b64_tr_b16 a[176:177], v241 offset:256
    v_mfma_f32_16x16x32_bf16 a[96:99], a[164:167], v[68:71], a[96:99]
    ds_read_b64_tr_b16 a[178:179], v241 offset:1792
    v_mfma_f32_16x16x32_bf16 a[80:83], a[144:147], v[72:75], a[80:83]
    ds_read_b64_tr_b16 a[180:181], v241 offset:12576
    buffer_load_dwordx4 v19, s[8:11], s35 offen offset:2048 lds
    v_mfma_f32_16x16x32_bf16 a[80:83], a[148:151], v[76:79], a[80:83]
    ds_read_b64_tr_b16 a[182:183], v241 offset:14112
    v_mfma_f32_16x16x32_bf16 a[84:87], a[152:155], v[72:75], a[84:87]
    ds_read_b64_tr_b16 a[184:185], v241 offset:264
    v_mfma_f32_16x16x32_bf16 a[84:87], a[156:159], v[76:79], a[84:87]
    ds_read_b64_tr_b16 a[186:187], v241 offset:1800
    v_mfma_f32_16x16x32_bf16 a[104:107], a[160:163], v[72:75], a[104:107]
    ds_read_b64_tr_b16 a[188:189], v241 offset:12584
    v_mfma_f32_16x16x32_bf16 a[104:107], a[164:167], v[76:79], a[104:107]
    ds_read_b64_tr_b16 a[190:191], v241 offset:14120
    v_mfma_f32_16x16x32_bf16 a[88:91], a[144:147], v[80:83], a[88:91]
    v_mfma_f32_16x16x32_bf16 a[88:91], a[148:151], v[84:87], a[88:91]
    v_mfma_f32_16x16x32_bf16 a[92:95], a[152:155], v[80:83], a[92:95]
    v_mfma_f32_16x16x32_bf16 a[92:95], a[156:159], v[84:87], a[92:95]
    v_mfma_f32_16x16x32_bf16 a[112:115], a[160:163], v[80:83], a[112:115]
    v_mfma_f32_16x16x32_bf16 a[112:115], a[164:167], v[84:87], a[112:115]
    s_waitcnt vmcnt(19)
    s_waitcnt lgkmcnt(0)
    s_barrier
    v_mfma_f32_16x16x32_bf16 a[100:103], a[168:171], v[64:67], a[100:103]
    ds_read_b64_tr_b16 a[144:145], v240 offset:24640
    v_mfma_f32_16x16x32_bf16 a[100:103], a[172:175], v[68:71], a[100:103]
    ds_read_b64_tr_b16 a[146:147], v240 offset:26176
    s_add_u32 m0, s29, 24640
    s_mov_b32 s35, 640
    v_mfma_f32_16x16x32_bf16 a[120:123], a[176:179], v[64:67], a[120:123]
    ds_read_b64_tr_b16 a[148:149], v240 offset:36960
    v_mfma_f32_16x16x32_bf16 a[120:123], a[180:183], v[68:71], a[120:123]
    ds_read_b64_tr_b16 a[150:151], v240 offset:38496
    v_mfma_f32_16x16x32_bf16 a[124:127], a[184:187], v[64:67], a[124:127]
    ds_read_b64_tr_b16 a[152:153], v240 offset:24648
    v_mfma_f32_16x16x32_bf16 a[124:127], a[188:191], v[68:71], a[124:127]
    ds_read_b64_tr_b16 a[154:155], v240 offset:26184
    buffer_load_dwordx4 v8, s[4:7], s35 offen offset:0 lds
    v_mfma_f32_16x16x32_bf16 a[108:111], a[168:171], v[72:75], a[108:111]
    ds_read_b64_tr_b16 a[156:157], v240 offset:36968
    v_mfma_f32_16x16x32_bf16 a[108:111], a[172:175], v[76:79], a[108:111]
    ds_read_b64_tr_b16 a[158:159], v240 offset:38504
    v_mfma_f32_16x16x32_bf16 a[128:131], a[176:179], v[72:75], a[128:131]
    ds_read_b64_tr_b16 a[160:161], v241 offset:24640
    v_mfma_f32_16x16x32_bf16 a[128:131], a[180:183], v[76:79], a[128:131]
    ds_read_b64_tr_b16 a[162:163], v241 offset:26176
    buffer_load_dwordx4 v9, s[4:7], s35 offen offset:1024 lds
    v_mfma_f32_16x16x32_bf16 a[132:135], a[184:187], v[72:75], a[132:135]
    ds_read_b64_tr_b16 a[164:165], v241 offset:36960
    v_mfma_f32_16x16x32_bf16 a[132:135], a[188:191], v[76:79], a[132:135]
    ds_read_b64_tr_b16 a[166:167], v241 offset:38496
    v_mfma_f32_16x16x32_bf16 a[116:119], a[168:171], v[80:83], a[116:119]
    v_mfma_f32_16x16x32_bf16 a[116:119], a[172:175], v[84:87], a[116:119]
    buffer_load_dwordx4 v10, s[4:7], s35 offen offset:2048 lds
    v_mfma_f32_16x16x32_bf16 a[136:139], a[176:179], v[80:83], a[136:139]
    v_mfma_f32_16x16x32_bf16 a[136:139], a[180:183], v[84:87], a[136:139]
    v_mfma_f32_16x16x32_bf16 a[140:143], a[184:187], v[80:83], a[140:143]
    v_mfma_f32_16x16x32_bf16 a[140:143], a[188:191], v[84:87], a[140:143]
    s_waitcnt lgkmcnt(0)
    v_mfma_f32_16x16x32_bf16 v[88:91], a[144:147], v[64:67], v[88:91]
    ds_read_b64_tr_b16 a[168:169], v241 offset:24648
    buffer_load_dwordx4 v11, s[4:7], s35 offen offset:3072 lds
    v_mfma_f32_16x16x32_bf16 v[88:91], a[148:151], v[68:71], v[88:91]
    ds_read_b64_tr_b16 a[170:171], v241 offset:26184
    v_mfma_f32_16x16x32_bf16 v[92:95], a[152:155], v[64:67], v[92:95]
    ds_read_b64_tr_b16 a[172:173], v241 offset:36968
    v_mfma_f32_16x16x32_bf16 v[92:95], a[156:159], v[68:71], v[92:95]
    ds_read_b64_tr_b16 a[174:175], v241 offset:38504
    v_mfma_f32_16x16x32_bf16 v[112:115], a[160:163], v[64:67], v[112:115]
    ds_read_b64_tr_b16 a[176:177], v240 offset:24768
    s_add_u32 m0, s29, 28736
    v_mfma_f32_16x16x32_bf16 v[112:115], a[164:167], v[68:71], v[112:115]
    ds_read_b64_tr_b16 a[178:179], v240 offset:26304
    v_mfma_f32_16x16x32_bf16 v[96:99], a[144:147], v[72:75], v[96:99]
    ds_read_b64_tr_b16 a[180:181], v240 offset:37088
    v_mfma_f32_16x16x32_bf16 v[96:99], a[148:151], v[76:79], v[96:99]
    ds_read_b64_tr_b16 a[182:183], v240 offset:38624
    v_mfma_f32_16x16x32_bf16 v[100:103], a[152:155], v[72:75], v[100:103]
    ds_read_b64_tr_b16 a[184:185], v240 offset:24776
    buffer_load_dwordx4 v12, s[4:7], s35 offen offset:0 lds
    v_mfma_f32_16x16x32_bf16 v[100:103], a[156:159], v[76:79], v[100:103]
    ds_read_b64_tr_b16 a[186:187], v240 offset:26312
    v_mfma_f32_16x16x32_bf16 v[120:123], a[160:163], v[72:75], v[120:123]
    ds_read_b64_tr_b16 a[188:189], v240 offset:37096
    v_mfma_f32_16x16x32_bf16 v[120:123], a[164:167], v[76:79], v[120:123]
    ds_read_b64_tr_b16 a[190:191], v240 offset:38632
    v_mfma_f32_16x16x32_bf16 v[104:107], a[144:147], v[80:83], v[104:107]
    buffer_load_dwordx4 v13, s[4:7], s35 offen offset:1024 lds
    v_mfma_f32_16x16x32_bf16 v[104:107], a[148:151], v[84:87], v[104:107]
    v_mfma_f32_16x16x32_bf16 v[108:111], a[152:155], v[80:83], v[108:111]
    v_mfma_f32_16x16x32_bf16 v[108:111], a[156:159], v[84:87], v[108:111]
    v_mfma_f32_16x16x32_bf16 v[128:131], a[160:163], v[80:83], v[128:131]
    v_mfma_f32_16x16x32_bf16 v[128:131], a[164:167], v[84:87], v[128:131]
    s_add_u32 m0, s38, 49280
    s_mov_b32 s36, 3933696
    s_waitcnt lgkmcnt(0)
    v_mfma_f32_16x16x32_bf16 v[116:119], a[168:171], v[64:67], v[116:119]
    ds_read_b64_tr_b16 a[144:145], v241 offset:24768
    v_mfma_f32_16x16x32_bf16 v[116:119], a[172:175], v[68:71], v[116:119]
    ds_read_b64_tr_b16 a[146:147], v241 offset:26304
    v_mfma_f32_16x16x32_bf16 v[136:139], a[176:179], v[64:67], v[136:139]
    ds_read_b64_tr_b16 a[148:149], v241 offset:37088
    v_mfma_f32_16x16x32_bf16 v[136:139], a[180:183], v[68:71], v[136:139]
    ds_read_b64_tr_b16 a[150:151], v241 offset:38624
    buffer_load_dwordx4 v14, s[8:11], s36 offen offset:0 lds
    v_mfma_f32_16x16x32_bf16 v[140:143], a[184:187], v[64:67], v[140:143]
    ds_read_b64_tr_b16 a[152:153], v241 offset:24776
    v_mfma_f32_16x16x32_bf16 v[140:143], a[188:191], v[68:71], v[140:143]
    ds_read_b64_tr_b16 a[154:155], v241 offset:26312
    v_mfma_f32_16x16x32_bf16 v[124:127], a[168:171], v[72:75], v[124:127]
    ds_read_b64_tr_b16 a[156:157], v241 offset:37096
    v_mfma_f32_16x16x32_bf16 v[124:127], a[172:175], v[76:79], v[124:127]
    ds_read_b64_tr_b16 a[158:159], v241 offset:38632
    buffer_load_dwordx4 v15, s[8:11], s36 offen offset:1024 lds
    v_mfma_f32_16x16x32_bf16 v[144:147], a[176:179], v[72:75], v[144:147]
    ds_read_b64_tr_b16 a[160:161], v240 offset:24896
    v_mfma_f32_16x16x32_bf16 v[144:147], a[180:183], v[76:79], v[144:147]
    ds_read_b64_tr_b16 a[162:163], v240 offset:26432
    v_mfma_f32_16x16x32_bf16 v[148:151], a[184:187], v[72:75], v[148:151]
    ds_read_b64_tr_b16 a[164:165], v240 offset:37216
    v_mfma_f32_16x16x32_bf16 v[148:151], a[188:191], v[76:79], v[148:151]
    ds_read_b64_tr_b16 a[166:167], v240 offset:38752
    buffer_load_dwordx4 v16, s[8:11], s36 offen offset:2048 lds
    v_mfma_f32_16x16x32_bf16 v[132:135], a[168:171], v[80:83], v[132:135]
    v_mfma_f32_16x16x32_bf16 v[132:135], a[172:175], v[84:87], v[132:135]
    v_mfma_f32_16x16x32_bf16 v[152:155], a[176:179], v[80:83], v[152:155]
    v_mfma_f32_16x16x32_bf16 v[152:155], a[180:183], v[84:87], v[152:155]
    v_mfma_f32_16x16x32_bf16 v[156:159], a[184:187], v[80:83], v[156:159]
    s_add_u32 m0, s38, 52360
    v_mfma_f32_16x16x32_bf16 v[156:159], a[188:191], v[84:87], v[156:159]
    s_waitcnt lgkmcnt(0)
    v_mfma_f32_16x16x32_bf16 v[160:163], a[144:147], v[64:67], v[160:163]
    ds_read_b64_tr_b16 a[168:169], v240 offset:24904
    v_mfma_f32_16x16x32_bf16 v[160:163], a[148:151], v[68:71], v[160:163]
    ds_read_b64_tr_b16 a[170:171], v240 offset:26440
    v_mfma_f32_16x16x32_bf16 v[164:167], a[152:155], v[64:67], v[164:167]
    ds_read_b64_tr_b16 a[172:173], v240 offset:37224
    buffer_load_dwordx4 v17, s[8:11], s36 offen offset:0 lds
    v_mfma_f32_16x16x32_bf16 v[164:167], a[156:159], v[68:71], v[164:167]
    ds_read_b64_tr_b16 a[174:175], v240 offset:38760
    v_mfma_f32_16x16x32_bf16 v[184:187], a[160:163], v[64:67], v[184:187]
    ds_read_b64_tr_b16 a[176:177], v241 offset:24896
    v_mfma_f32_16x16x32_bf16 v[184:187], a[164:167], v[68:71], v[184:187]
    ds_read_b64_tr_b16 a[178:179], v241 offset:26432
    v_mfma_f32_16x16x32_bf16 v[168:171], a[144:147], v[72:75], v[168:171]
    ds_read_b64_tr_b16 a[180:181], v241 offset:37216
    buffer_load_dwordx4 v18, s[8:11], s36 offen offset:1024 lds
    v_mfma_f32_16x16x32_bf16 v[168:171], a[148:151], v[76:79], v[168:171]
    ds_read_b64_tr_b16 a[182:183], v241 offset:38752
    v_mfma_f32_16x16x32_bf16 v[172:175], a[152:155], v[72:75], v[172:175]
    ds_read_b64_tr_b16 a[184:185], v241 offset:24904
    v_mfma_f32_16x16x32_bf16 v[172:175], a[156:159], v[76:79], v[172:175]
    ds_read_b64_tr_b16 a[186:187], v241 offset:26440
    v_mfma_f32_16x16x32_bf16 v[192:195], a[160:163], v[72:75], v[192:195]
    ds_read_b64_tr_b16 a[188:189], v241 offset:37224
    buffer_load_dwordx4 v19, s[8:11], s36 offen offset:2048 lds
    v_mfma_f32_16x16x32_bf16 v[192:195], a[164:167], v[76:79], v[192:195]
    ds_read_b64_tr_b16 a[190:191], v241 offset:38760
    v_mfma_f32_16x16x32_bf16 v[176:179], a[144:147], v[80:83], v[176:179]
    v_mfma_f32_16x16x32_bf16 v[176:179], a[148:151], v[84:87], v[176:179]
    v_mfma_f32_16x16x32_bf16 v[180:183], a[152:155], v[80:83], v[180:183]
    v_mfma_f32_16x16x32_bf16 v[180:183], a[156:159], v[84:87], v[180:183]
    v_mfma_f32_16x16x32_bf16 v[200:203], a[160:163], v[80:83], v[200:203]
    v_mfma_f32_16x16x32_bf16 v[200:203], a[164:167], v[84:87], v[200:203]
    s_waitcnt vmcnt(19)
    s_waitcnt lgkmcnt(0)
    s_barrier
    v_mfma_f32_16x16x32_bf16 v[188:191], a[168:171], v[64:67], v[188:191]
    ds_read_b64_tr_b16 a[144:145], v242 offset:24640
    v_mfma_f32_16x16x32_bf16 v[188:191], a[172:175], v[68:71], v[188:191]
    ds_read_b64_tr_b16 a[146:147], v242 offset:26176
    s_add_u32 m0, s38, 73920
    s_mov_b32 s35, 3932160
    v_mfma_f32_16x16x32_bf16 v[208:211], a[176:179], v[64:67], v[208:211]
    ds_read_b64_tr_b16 a[148:149], v242 offset:36960
    v_mfma_f32_16x16x32_bf16 v[208:211], a[180:183], v[68:71], v[208:211]
    ds_read_b64_tr_b16 a[150:151], v242 offset:38496
    v_mfma_f32_16x16x32_bf16 v[212:215], a[184:187], v[64:67], v[212:215]
    ds_read_b64_tr_b16 a[152:153], v242 offset:24648
    v_mfma_f32_16x16x32_bf16 v[212:215], a[188:191], v[68:71], v[212:215]
    ds_read_b128 v[64:67], v236 offset:0
    ds_read_b64_tr_b16 a[154:155], v242 offset:26184
    v_mfma_f32_16x16x32_bf16 v[196:199], a[168:171], v[72:75], v[196:199]
    ds_read_b128 v[68:71], v237 offset:0
    ds_read_b64_tr_b16 a[156:157], v242 offset:36968
    v_mfma_f32_16x16x32_bf16 v[196:199], a[172:175], v[76:79], v[196:199]
    ds_read_b64_tr_b16 a[158:159], v242 offset:38504
    v_mfma_f32_16x16x32_bf16 v[216:219], a[176:179], v[72:75], v[216:219]
    ds_read_b64_tr_b16 a[160:161], v243 offset:24640
    v_mfma_f32_16x16x32_bf16 v[216:219], a[180:183], v[76:79], v[216:219]
    ds_read_b64_tr_b16 a[162:163], v243 offset:26176
    buffer_load_dwordx4 v14, s[8:11], s35 offen offset:0 lds
    v_mfma_f32_16x16x32_bf16 v[220:223], a[184:187], v[72:75], v[220:223]
    ds_read_b64_tr_b16 a[164:165], v243 offset:36960
    v_mfma_f32_16x16x32_bf16 v[220:223], a[188:191], v[76:79], v[220:223]
    ds_read_b128 v[72:75], v236 offset:2048
    ds_read_b64_tr_b16 a[166:167], v243 offset:38496
    v_mfma_f32_16x16x32_bf16 v[204:207], a[168:171], v[80:83], v[204:207]
    ds_read_b128 v[76:79], v237 offset:2048
    v_mfma_f32_16x16x32_bf16 v[204:207], a[172:175], v[84:87], v[204:207]
    v_mfma_f32_16x16x32_bf16 v[224:227], a[176:179], v[80:83], v[224:227]
    v_mfma_f32_16x16x32_bf16 v[224:227], a[180:183], v[84:87], v[224:227]
    v_mfma_f32_16x16x32_bf16 v[228:231], a[184:187], v[80:83], v[228:231]
    v_mfma_f32_16x16x32_bf16 v[228:231], a[188:191], v[84:87], v[228:231]
    ds_read_b128 v[80:83], v236 offset:4096
    ds_read_b128 v[84:87], v237 offset:4096
    s_waitcnt lgkmcnt(3)
    v_mfma_f32_16x16x32_bf16 a[0:3], a[144:147], v[64:67], a[0:3]
    ds_read_b64_tr_b16 a[168:169], v243 offset:24648
    buffer_load_dwordx4 v15, s[8:11], s35 offen offset:1024 lds
    v_mfma_f32_16x16x32_bf16 a[0:3], a[148:151], v[68:71], a[0:3]
    ds_read_b64_tr_b16 a[170:171], v243 offset:26184
    v_mfma_f32_16x16x32_bf16 a[4:7], a[152:155], v[64:67], a[4:7]
    ds_read_b64_tr_b16 a[172:173], v243 offset:36968
    v_mfma_f32_16x16x32_bf16 a[4:7], a[156:159], v[68:71], a[4:7]
    ds_read_b64_tr_b16 a[174:175], v243 offset:38504
    v_mfma_f32_16x16x32_bf16 a[24:27], a[160:163], v[64:67], a[24:27]
    ds_read_b64_tr_b16 a[176:177], v242 offset:24768
    v_mfma_f32_16x16x32_bf16 a[24:27], a[164:167], v[68:71], a[24:27]
    ds_read_b64_tr_b16 a[178:179], v242 offset:26304
    v_mfma_f32_16x16x32_bf16 a[8:11], a[144:147], v[72:75], a[8:11]
    ds_read_b64_tr_b16 a[180:181], v242 offset:37088
    s_waitcnt lgkmcnt(9)
    v_mfma_f32_16x16x32_bf16 a[8:11], a[148:151], v[76:79], a[8:11]
    ds_read_b64_tr_b16 a[182:183], v242 offset:38624
    v_mfma_f32_16x16x32_bf16 a[12:15], a[152:155], v[72:75], a[12:15]
    ds_read_b64_tr_b16 a[184:185], v242 offset:24776
    buffer_load_dwordx4 v16, s[8:11], s35 offen offset:2048 lds
    v_mfma_f32_16x16x32_bf16 a[12:15], a[156:159], v[76:79], a[12:15]
    ds_read_b64_tr_b16 a[186:187], v242 offset:26312
    v_mfma_f32_16x16x32_bf16 a[32:35], a[160:163], v[72:75], a[32:35]
    ds_read_b64_tr_b16 a[188:189], v242 offset:37096
    v_mfma_f32_16x16x32_bf16 a[32:35], a[164:167], v[76:79], a[32:35]
    ds_read_b64_tr_b16 a[190:191], v242 offset:38632
    s_waitcnt lgkmcnt(13)
    v_mfma_f32_16x16x32_bf16 a[16:19], a[144:147], v[80:83], a[16:19]
    s_waitcnt lgkmcnt(12)
    v_mfma_f32_16x16x32_bf16 a[16:19], a[148:151], v[84:87], a[16:19]
    v_mfma_f32_16x16x32_bf16 a[20:23], a[152:155], v[80:83], a[20:23]
    v_mfma_f32_16x16x32_bf16 a[20:23], a[156:159], v[84:87], a[20:23]
    v_mfma_f32_16x16x32_bf16 a[40:43], a[160:163], v[80:83], a[40:43]
    v_mfma_f32_16x16x32_bf16 a[40:43], a[164:167], v[84:87], a[40:43]
    s_add_u32 m0, s38, 77000
    s_waitcnt lgkmcnt(0)
    v_mfma_f32_16x16x32_bf16 a[28:31], a[168:171], v[64:67], a[28:31]
    ds_read_b64_tr_b16 a[144:145], v243 offset:24768
    v_mfma_f32_16x16x32_bf16 a[28:31], a[172:175], v[68:71], a[28:31]
    ds_read_b64_tr_b16 a[146:147], v243 offset:26304
    v_mfma_f32_16x16x32_bf16 a[48:51], a[176:179], v[64:67], a[48:51]
    ds_read_b64_tr_b16 a[148:149], v243 offset:37088
    v_mfma_f32_16x16x32_bf16 a[48:51], a[180:183], v[68:71], a[48:51]
    ds_read_b64_tr_b16 a[150:151], v243 offset:38624
    v_mfma_f32_16x16x32_bf16 a[52:55], a[184:187], v[64:67], a[52:55]
    ds_read_b64_tr_b16 a[152:153], v243 offset:24776
    v_mfma_f32_16x16x32_bf16 a[52:55], a[188:191], v[68:71], a[52:55]
    ds_read_b64_tr_b16 a[154:155], v243 offset:26312
    v_mfma_f32_16x16x32_bf16 a[36:39], a[168:171], v[72:75], a[36:39]
    ds_read_b64_tr_b16 a[156:157], v243 offset:37096
    v_mfma_f32_16x16x32_bf16 a[36:39], a[172:175], v[76:79], a[36:39]
    ds_read_b64_tr_b16 a[158:159], v243 offset:38632
    buffer_load_dwordx4 v17, s[8:11], s35 offen offset:0 lds
    v_mfma_f32_16x16x32_bf16 a[56:59], a[176:179], v[72:75], a[56:59]
    ds_read_b64_tr_b16 a[160:161], v242 offset:24896
    v_mfma_f32_16x16x32_bf16 a[56:59], a[180:183], v[76:79], a[56:59]
    ds_read_b64_tr_b16 a[162:163], v242 offset:26432
    v_mfma_f32_16x16x32_bf16 a[60:63], a[184:187], v[72:75], a[60:63]
    ds_read_b64_tr_b16 a[164:165], v242 offset:37216
    v_mfma_f32_16x16x32_bf16 a[60:63], a[188:191], v[76:79], a[60:63]
    ds_read_b64_tr_b16 a[166:167], v242 offset:38752
    v_mfma_f32_16x16x32_bf16 a[44:47], a[168:171], v[80:83], a[44:47]
    v_mfma_f32_16x16x32_bf16 a[44:47], a[172:175], v[84:87], a[44:47]
    v_mfma_f32_16x16x32_bf16 a[64:67], a[176:179], v[80:83], a[64:67]
    v_mfma_f32_16x16x32_bf16 a[64:67], a[180:183], v[84:87], a[64:67]
    v_mfma_f32_16x16x32_bf16 a[68:71], a[184:187], v[80:83], a[68:71]
    buffer_load_dwordx4 v18, s[8:11], s35 offen offset:1024 lds
    v_mfma_f32_16x16x32_bf16 a[68:71], a[188:191], v[84:87], a[68:71]
    s_waitcnt lgkmcnt(0)
    v_mfma_f32_16x16x32_bf16 a[72:75], a[144:147], v[64:67], a[72:75]
    ds_read_b64_tr_b16 a[168:169], v242 offset:24904
    v_mfma_f32_16x16x32_bf16 a[72:75], a[148:151], v[68:71], a[72:75]
    ds_read_b64_tr_b16 a[170:171], v242 offset:26440
    v_mfma_f32_16x16x32_bf16 a[76:79], a[152:155], v[64:67], a[76:79]
    ds_read_b64_tr_b16 a[172:173], v242 offset:37224
    v_mfma_f32_16x16x32_bf16 a[76:79], a[156:159], v[68:71], a[76:79]
    ds_read_b64_tr_b16 a[174:175], v242 offset:38760
    v_mfma_f32_16x16x32_bf16 a[96:99], a[160:163], v[64:67], a[96:99]
    ds_read_b64_tr_b16 a[176:177], v243 offset:24896
    v_mfma_f32_16x16x32_bf16 a[96:99], a[164:167], v[68:71], a[96:99]
    ds_read_b64_tr_b16 a[178:179], v243 offset:26432
    v_mfma_f32_16x16x32_bf16 a[80:83], a[144:147], v[72:75], a[80:83]
    ds_read_b64_tr_b16 a[180:181], v243 offset:37216
    buffer_load_dwordx4 v19, s[8:11], s35 offen offset:2048 lds
    v_mfma_f32_16x16x32_bf16 a[80:83], a[148:151], v[76:79], a[80:83]
    ds_read_b64_tr_b16 a[182:183], v243 offset:38752
    v_mfma_f32_16x16x32_bf16 a[84:87], a[152:155], v[72:75], a[84:87]
    ds_read_b64_tr_b16 a[184:185], v243 offset:24904
    v_mfma_f32_16x16x32_bf16 a[84:87], a[156:159], v[76:79], a[84:87]
    ds_read_b64_tr_b16 a[186:187], v243 offset:26440
    v_mfma_f32_16x16x32_bf16 a[104:107], a[160:163], v[72:75], a[104:107]
    ds_read_b64_tr_b16 a[188:189], v243 offset:37224
    v_mfma_f32_16x16x32_bf16 a[104:107], a[164:167], v[76:79], a[104:107]
    ds_read_b64_tr_b16 a[190:191], v243 offset:38760
    v_mfma_f32_16x16x32_bf16 a[88:91], a[144:147], v[80:83], a[88:91]
    v_mfma_f32_16x16x32_bf16 a[88:91], a[148:151], v[84:87], a[88:91]
    v_mfma_f32_16x16x32_bf16 a[92:95], a[152:155], v[80:83], a[92:95]
    v_mfma_f32_16x16x32_bf16 a[92:95], a[156:159], v[84:87], a[92:95]
    v_mfma_f32_16x16x32_bf16 a[112:115], a[160:163], v[80:83], a[112:115]
    v_mfma_f32_16x16x32_bf16 a[112:115], a[164:167], v[84:87], a[112:115]
    s_waitcnt vmcnt(18)
    s_waitcnt lgkmcnt(0)
    s_barrier
    v_mfma_f32_16x16x32_bf16 a[100:103], a[168:171], v[64:67], a[100:103]
    ds_read_b64_tr_b16 a[144:145], v238 offset:0
    v_mfma_f32_16x16x32_bf16 a[100:103], a[172:175], v[68:71], a[100:103]
    ds_read_b64_tr_b16 a[146:147], v238 offset:1536
    s_add_u32 m0, s29, 98560
    s_mov_b32 s35, 768
    v_mfma_f32_16x16x32_bf16 a[120:123], a[176:179], v[64:67], a[120:123]
    ds_read_b64_tr_b16 a[148:149], v238 offset:12320
    v_mfma_f32_16x16x32_bf16 a[120:123], a[180:183], v[68:71], a[120:123]
    ds_read_b64_tr_b16 a[150:151], v238 offset:13856
    v_mfma_f32_16x16x32_bf16 a[124:127], a[184:187], v[64:67], a[124:127]
    ds_read_b64_tr_b16 a[152:153], v238 offset:8
    v_mfma_f32_16x16x32_bf16 a[124:127], a[188:191], v[68:71], a[124:127]
    ds_read_b64_tr_b16 a[154:155], v238 offset:1544
    buffer_load_dwordx4 v8, s[4:7], s35 offen offset:0 lds
    v_mfma_f32_16x16x32_bf16 a[108:111], a[168:171], v[72:75], a[108:111]
    ds_read_b64_tr_b16 a[156:157], v238 offset:12328
    v_mfma_f32_16x16x32_bf16 a[108:111], a[172:175], v[76:79], a[108:111]
    ds_read_b64_tr_b16 a[158:159], v238 offset:13864
    v_mfma_f32_16x16x32_bf16 a[128:131], a[176:179], v[72:75], a[128:131]
    ds_read_b64_tr_b16 a[160:161], v239 offset:0
    v_mfma_f32_16x16x32_bf16 a[128:131], a[180:183], v[76:79], a[128:131]
    ds_read_b64_tr_b16 a[162:163], v239 offset:1536
    buffer_load_dwordx4 v9, s[4:7], s35 offen offset:1024 lds
    v_mfma_f32_16x16x32_bf16 a[132:135], a[184:187], v[72:75], a[132:135]
    ds_read_b64_tr_b16 a[164:165], v239 offset:12320
    v_mfma_f32_16x16x32_bf16 a[132:135], a[188:191], v[76:79], a[132:135]
    ds_read_b64_tr_b16 a[166:167], v239 offset:13856
    v_mfma_f32_16x16x32_bf16 a[116:119], a[168:171], v[80:83], a[116:119]
    v_mfma_f32_16x16x32_bf16 a[116:119], a[172:175], v[84:87], a[116:119]
    buffer_load_dwordx4 v10, s[4:7], s35 offen offset:2048 lds
    v_mfma_f32_16x16x32_bf16 a[136:139], a[176:179], v[80:83], a[136:139]
    v_mfma_f32_16x16x32_bf16 a[136:139], a[180:183], v[84:87], a[136:139]
    v_mfma_f32_16x16x32_bf16 a[140:143], a[184:187], v[80:83], a[140:143]
    v_mfma_f32_16x16x32_bf16 a[140:143], a[188:191], v[84:87], a[140:143]
    s_waitcnt lgkmcnt(0)
    v_mfma_f32_16x16x32_bf16 v[88:91], a[144:147], v[64:67], v[88:91]
    ds_read_b64_tr_b16 a[168:169], v239 offset:8
    buffer_load_dwordx4 v11, s[4:7], s35 offen offset:3072 lds
    v_mfma_f32_16x16x32_bf16 v[88:91], a[148:151], v[68:71], v[88:91]
    ds_read_b64_tr_b16 a[170:171], v239 offset:1544
    v_mfma_f32_16x16x32_bf16 v[92:95], a[152:155], v[64:67], v[92:95]
    ds_read_b64_tr_b16 a[172:173], v239 offset:12328
    v_mfma_f32_16x16x32_bf16 v[92:95], a[156:159], v[68:71], v[92:95]
    ds_read_b64_tr_b16 a[174:175], v239 offset:13864
    v_mfma_f32_16x16x32_bf16 v[112:115], a[160:163], v[64:67], v[112:115]
    ds_read_b64_tr_b16 a[176:177], v238 offset:128
    s_add_u32 m0, s29, 102656
    v_mfma_f32_16x16x32_bf16 v[112:115], a[164:167], v[68:71], v[112:115]
    ds_read_b64_tr_b16 a[178:179], v238 offset:1664
    v_mfma_f32_16x16x32_bf16 v[96:99], a[144:147], v[72:75], v[96:99]
    ds_read_b64_tr_b16 a[180:181], v238 offset:12448
    v_mfma_f32_16x16x32_bf16 v[96:99], a[148:151], v[76:79], v[96:99]
    ds_read_b64_tr_b16 a[182:183], v238 offset:13984
    v_mfma_f32_16x16x32_bf16 v[100:103], a[152:155], v[72:75], v[100:103]
    ds_read_b64_tr_b16 a[184:185], v238 offset:136
    buffer_load_dwordx4 v12, s[4:7], s35 offen offset:0 lds
    v_mfma_f32_16x16x32_bf16 v[100:103], a[156:159], v[76:79], v[100:103]
    ds_read_b64_tr_b16 a[186:187], v238 offset:1672
    v_mfma_f32_16x16x32_bf16 v[120:123], a[160:163], v[72:75], v[120:123]
    ds_read_b64_tr_b16 a[188:189], v238 offset:12456
    v_mfma_f32_16x16x32_bf16 v[120:123], a[164:167], v[76:79], v[120:123]
    ds_read_b64_tr_b16 a[190:191], v238 offset:13992
    v_mfma_f32_16x16x32_bf16 v[104:107], a[144:147], v[80:83], v[104:107]
    buffer_load_dwordx4 v13, s[4:7], s35 offen offset:1024 lds
    v_mfma_f32_16x16x32_bf16 v[104:107], a[148:151], v[84:87], v[104:107]
    v_mfma_f32_16x16x32_bf16 v[108:111], a[152:155], v[80:83], v[108:111]
    v_mfma_f32_16x16x32_bf16 v[108:111], a[156:159], v[84:87], v[108:111]
    v_mfma_f32_16x16x32_bf16 v[128:131], a[160:163], v[80:83], v[128:131]
    v_mfma_f32_16x16x32_bf16 v[128:131], a[164:167], v[84:87], v[128:131]
    s_add_u32 m0, s38, 123200
    s_mov_b32 s36, 4720128
    s_waitcnt lgkmcnt(0)
    v_mfma_f32_16x16x32_bf16 v[116:119], a[168:171], v[64:67], v[116:119]
    ds_read_b64_tr_b16 a[144:145], v239 offset:128
    v_mfma_f32_16x16x32_bf16 v[116:119], a[172:175], v[68:71], v[116:119]
    ds_read_b64_tr_b16 a[146:147], v239 offset:1664
    v_mfma_f32_16x16x32_bf16 v[136:139], a[176:179], v[64:67], v[136:139]
    ds_read_b64_tr_b16 a[148:149], v239 offset:12448
    v_mfma_f32_16x16x32_bf16 v[136:139], a[180:183], v[68:71], v[136:139]
    ds_read_b64_tr_b16 a[150:151], v239 offset:13984
    buffer_load_dwordx4 v14, s[8:11], s36 offen offset:0 lds
    v_mfma_f32_16x16x32_bf16 v[140:143], a[184:187], v[64:67], v[140:143]
    ds_read_b64_tr_b16 a[152:153], v239 offset:136
    v_mfma_f32_16x16x32_bf16 v[140:143], a[188:191], v[68:71], v[140:143]
    ds_read_b64_tr_b16 a[154:155], v239 offset:1672
    v_mfma_f32_16x16x32_bf16 v[124:127], a[168:171], v[72:75], v[124:127]
    ds_read_b64_tr_b16 a[156:157], v239 offset:12456
    v_mfma_f32_16x16x32_bf16 v[124:127], a[172:175], v[76:79], v[124:127]
    ds_read_b64_tr_b16 a[158:159], v239 offset:13992
    buffer_load_dwordx4 v15, s[8:11], s36 offen offset:1024 lds
    v_mfma_f32_16x16x32_bf16 v[144:147], a[176:179], v[72:75], v[144:147]
    ds_read_b64_tr_b16 a[160:161], v238 offset:256
    v_mfma_f32_16x16x32_bf16 v[144:147], a[180:183], v[76:79], v[144:147]
    ds_read_b64_tr_b16 a[162:163], v238 offset:1792
    v_mfma_f32_16x16x32_bf16 v[148:151], a[184:187], v[72:75], v[148:151]
    ds_read_b64_tr_b16 a[164:165], v238 offset:12576
    v_mfma_f32_16x16x32_bf16 v[148:151], a[188:191], v[76:79], v[148:151]
    ds_read_b64_tr_b16 a[166:167], v238 offset:14112
    buffer_load_dwordx4 v16, s[8:11], s36 offen offset:2048 lds
    v_mfma_f32_16x16x32_bf16 v[132:135], a[168:171], v[80:83], v[132:135]
    v_mfma_f32_16x16x32_bf16 v[132:135], a[172:175], v[84:87], v[132:135]
    v_mfma_f32_16x16x32_bf16 v[152:155], a[176:179], v[80:83], v[152:155]
    v_mfma_f32_16x16x32_bf16 v[152:155], a[180:183], v[84:87], v[152:155]
    v_mfma_f32_16x16x32_bf16 v[156:159], a[184:187], v[80:83], v[156:159]
    s_add_u32 m0, s38, 126280
    v_mfma_f32_16x16x32_bf16 v[156:159], a[188:191], v[84:87], v[156:159]
    s_waitcnt lgkmcnt(0)
    v_mfma_f32_16x16x32_bf16 v[160:163], a[144:147], v[64:67], v[160:163]
    ds_read_b64_tr_b16 a[168:169], v238 offset:264
    v_mfma_f32_16x16x32_bf16 v[160:163], a[148:151], v[68:71], v[160:163]
    ds_read_b64_tr_b16 a[170:171], v238 offset:1800
    v_mfma_f32_16x16x32_bf16 v[164:167], a[152:155], v[64:67], v[164:167]
    ds_read_b64_tr_b16 a[172:173], v238 offset:12584
    buffer_load_dwordx4 v17, s[8:11], s36 offen offset:0 lds
    v_mfma_f32_16x16x32_bf16 v[164:167], a[156:159], v[68:71], v[164:167]
    ds_read_b64_tr_b16 a[174:175], v238 offset:14120
    v_mfma_f32_16x16x32_bf16 v[184:187], a[160:163], v[64:67], v[184:187]
    ds_read_b64_tr_b16 a[176:177], v239 offset:256
    v_mfma_f32_16x16x32_bf16 v[184:187], a[164:167], v[68:71], v[184:187]
    ds_read_b64_tr_b16 a[178:179], v239 offset:1792
    v_mfma_f32_16x16x32_bf16 v[168:171], a[144:147], v[72:75], v[168:171]
    ds_read_b64_tr_b16 a[180:181], v239 offset:12576
    buffer_load_dwordx4 v18, s[8:11], s36 offen offset:1024 lds
    v_mfma_f32_16x16x32_bf16 v[168:171], a[148:151], v[76:79], v[168:171]
    ds_read_b64_tr_b16 a[182:183], v239 offset:14112
    v_mfma_f32_16x16x32_bf16 v[172:175], a[152:155], v[72:75], v[172:175]
    ds_read_b64_tr_b16 a[184:185], v239 offset:264
    v_mfma_f32_16x16x32_bf16 v[172:175], a[156:159], v[76:79], v[172:175]
    ds_read_b64_tr_b16 a[186:187], v239 offset:1800
    v_mfma_f32_16x16x32_bf16 v[192:195], a[160:163], v[72:75], v[192:195]
    ds_read_b64_tr_b16 a[188:189], v239 offset:12584
    buffer_load_dwordx4 v19, s[8:11], s36 offen offset:2048 lds
    v_mfma_f32_16x16x32_bf16 v[192:195], a[164:167], v[76:79], v[192:195]
    ds_read_b64_tr_b16 a[190:191], v239 offset:14120
    v_mfma_f32_16x16x32_bf16 v[176:179], a[144:147], v[80:83], v[176:179]
    v_mfma_f32_16x16x32_bf16 v[176:179], a[148:151], v[84:87], v[176:179]
    v_mfma_f32_16x16x32_bf16 v[180:183], a[152:155], v[80:83], v[180:183]
    v_mfma_f32_16x16x32_bf16 v[180:183], a[156:159], v[84:87], v[180:183]
    v_mfma_f32_16x16x32_bf16 v[200:203], a[160:163], v[80:83], v[200:203]
    v_mfma_f32_16x16x32_bf16 v[200:203], a[164:167], v[84:87], v[200:203]
    s_waitcnt vmcnt(18)
    s_waitcnt lgkmcnt(0)
    s_barrier
    v_mfma_f32_16x16x32_bf16 v[188:191], a[168:171], v[64:67], v[188:191]
    ds_read_b64_tr_b16 a[144:145], v240 offset:0
    v_mfma_f32_16x16x32_bf16 v[188:191], a[172:175], v[68:71], v[188:191]
    ds_read_b64_tr_b16 a[146:147], v240 offset:1536
    s_add_u32 m0, s38, 0
    s_mov_b32 s35, 4718592
    v_mfma_f32_16x16x32_bf16 v[208:211], a[176:179], v[64:67], v[208:211]
    ds_read_b64_tr_b16 a[148:149], v240 offset:12320
    v_mfma_f32_16x16x32_bf16 v[208:211], a[180:183], v[68:71], v[208:211]
    ds_read_b64_tr_b16 a[150:151], v240 offset:13856
    v_mfma_f32_16x16x32_bf16 v[212:215], a[184:187], v[64:67], v[212:215]
    ds_read_b64_tr_b16 a[152:153], v240 offset:8
    v_mfma_f32_16x16x32_bf16 v[212:215], a[188:191], v[68:71], v[212:215]
    ds_read_b128 v[64:67], v232 offset:24640
    ds_read_b64_tr_b16 a[154:155], v240 offset:1544
    v_mfma_f32_16x16x32_bf16 v[196:199], a[168:171], v[72:75], v[196:199]
    ds_read_b128 v[68:71], v233 offset:24640
    ds_read_b64_tr_b16 a[156:157], v240 offset:12328
    v_mfma_f32_16x16x32_bf16 v[196:199], a[172:175], v[76:79], v[196:199]
    ds_read_b64_tr_b16 a[158:159], v240 offset:13864
    v_mfma_f32_16x16x32_bf16 v[216:219], a[176:179], v[72:75], v[216:219]
    ds_read_b64_tr_b16 a[160:161], v241 offset:0
    v_mfma_f32_16x16x32_bf16 v[216:219], a[180:183], v[76:79], v[216:219]
    ds_read_b64_tr_b16 a[162:163], v241 offset:1536
    buffer_load_dwordx4 v14, s[8:11], s35 offen offset:0 lds
    v_mfma_f32_16x16x32_bf16 v[220:223], a[184:187], v[72:75], v[220:223]
    ds_read_b64_tr_b16 a[164:165], v241 offset:12320
    v_mfma_f32_16x16x32_bf16 v[220:223], a[188:191], v[76:79], v[220:223]
    ds_read_b128 v[72:75], v232 offset:26688
    ds_read_b64_tr_b16 a[166:167], v241 offset:13856
    v_mfma_f32_16x16x32_bf16 v[204:207], a[168:171], v[80:83], v[204:207]
    ds_read_b128 v[76:79], v233 offset:26688
    v_mfma_f32_16x16x32_bf16 v[204:207], a[172:175], v[84:87], v[204:207]
    v_mfma_f32_16x16x32_bf16 v[224:227], a[176:179], v[80:83], v[224:227]
    v_mfma_f32_16x16x32_bf16 v[224:227], a[180:183], v[84:87], v[224:227]
    v_mfma_f32_16x16x32_bf16 v[228:231], a[184:187], v[80:83], v[228:231]
    v_mfma_f32_16x16x32_bf16 v[228:231], a[188:191], v[84:87], v[228:231]
    ds_read_b128 v[80:83], v232 offset:28736
    ds_read_b128 v[84:87], v233 offset:28736
    s_waitcnt lgkmcnt(3)
    v_mfma_f32_16x16x32_bf16 a[0:3], a[144:147], v[64:67], a[0:3]
    ds_read_b64_tr_b16 a[168:169], v241 offset:8
    buffer_load_dwordx4 v15, s[8:11], s35 offen offset:1024 lds
    v_mfma_f32_16x16x32_bf16 a[0:3], a[148:151], v[68:71], a[0:3]
    ds_read_b64_tr_b16 a[170:171], v241 offset:1544
    v_mfma_f32_16x16x32_bf16 a[4:7], a[152:155], v[64:67], a[4:7]
    ds_read_b64_tr_b16 a[172:173], v241 offset:12328
    v_mfma_f32_16x16x32_bf16 a[4:7], a[156:159], v[68:71], a[4:7]
    ds_read_b64_tr_b16 a[174:175], v241 offset:13864
    v_mfma_f32_16x16x32_bf16 a[24:27], a[160:163], v[64:67], a[24:27]
    ds_read_b64_tr_b16 a[176:177], v240 offset:128
    v_mfma_f32_16x16x32_bf16 a[24:27], a[164:167], v[68:71], a[24:27]
    ds_read_b64_tr_b16 a[178:179], v240 offset:1664
    v_mfma_f32_16x16x32_bf16 a[8:11], a[144:147], v[72:75], a[8:11]
    ds_read_b64_tr_b16 a[180:181], v240 offset:12448
    s_waitcnt lgkmcnt(9)
    v_mfma_f32_16x16x32_bf16 a[8:11], a[148:151], v[76:79], a[8:11]
    ds_read_b64_tr_b16 a[182:183], v240 offset:13984
    v_mfma_f32_16x16x32_bf16 a[12:15], a[152:155], v[72:75], a[12:15]
    ds_read_b64_tr_b16 a[184:185], v240 offset:136
    buffer_load_dwordx4 v16, s[8:11], s35 offen offset:2048 lds
    v_mfma_f32_16x16x32_bf16 a[12:15], a[156:159], v[76:79], a[12:15]
    ds_read_b64_tr_b16 a[186:187], v240 offset:1672
    v_mfma_f32_16x16x32_bf16 a[32:35], a[160:163], v[72:75], a[32:35]
    ds_read_b64_tr_b16 a[188:189], v240 offset:12456
    v_mfma_f32_16x16x32_bf16 a[32:35], a[164:167], v[76:79], a[32:35]
    ds_read_b64_tr_b16 a[190:191], v240 offset:13992
    s_waitcnt lgkmcnt(13)
    v_mfma_f32_16x16x32_bf16 a[16:19], a[144:147], v[80:83], a[16:19]
    s_waitcnt lgkmcnt(12)
    v_mfma_f32_16x16x32_bf16 a[16:19], a[148:151], v[84:87], a[16:19]
    v_mfma_f32_16x16x32_bf16 a[20:23], a[152:155], v[80:83], a[20:23]
    v_mfma_f32_16x16x32_bf16 a[20:23], a[156:159], v[84:87], a[20:23]
    v_mfma_f32_16x16x32_bf16 a[40:43], a[160:163], v[80:83], a[40:43]
    v_mfma_f32_16x16x32_bf16 a[40:43], a[164:167], v[84:87], a[40:43]
    s_add_u32 m0, s38, 3080
    s_waitcnt lgkmcnt(0)
    v_mfma_f32_16x16x32_bf16 a[28:31], a[168:171], v[64:67], a[28:31]
    ds_read_b64_tr_b16 a[144:145], v241 offset:128
    v_mfma_f32_16x16x32_bf16 a[28:31], a[172:175], v[68:71], a[28:31]
    ds_read_b64_tr_b16 a[146:147], v241 offset:1664
    v_mfma_f32_16x16x32_bf16 a[48:51], a[176:179], v[64:67], a[48:51]
    ds_read_b64_tr_b16 a[148:149], v241 offset:12448
    v_mfma_f32_16x16x32_bf16 a[48:51], a[180:183], v[68:71], a[48:51]
    ds_read_b64_tr_b16 a[150:151], v241 offset:13984
    v_mfma_f32_16x16x32_bf16 a[52:55], a[184:187], v[64:67], a[52:55]
    ds_read_b64_tr_b16 a[152:153], v241 offset:136
    v_mfma_f32_16x16x32_bf16 a[52:55], a[188:191], v[68:71], a[52:55]
    ds_read_b64_tr_b16 a[154:155], v241 offset:1672
    v_mfma_f32_16x16x32_bf16 a[36:39], a[168:171], v[72:75], a[36:39]
    ds_read_b64_tr_b16 a[156:157], v241 offset:12456
    v_mfma_f32_16x16x32_bf16 a[36:39], a[172:175], v[76:79], a[36:39]
    ds_read_b64_tr_b16 a[158:159], v241 offset:13992
    buffer_load_dwordx4 v17, s[8:11], s35 offen offset:0 lds
    v_mfma_f32_16x16x32_bf16 a[56:59], a[176:179], v[72:75], a[56:59]
    ds_read_b64_tr_b16 a[160:161], v240 offset:256
    v_mfma_f32_16x16x32_bf16 a[56:59], a[180:183], v[76:79], a[56:59]
    ds_read_b64_tr_b16 a[162:163], v240 offset:1792
    v_mfma_f32_16x16x32_bf16 a[60:63], a[184:187], v[72:75], a[60:63]
    ds_read_b64_tr_b16 a[164:165], v240 offset:12576
    v_mfma_f32_16x16x32_bf16 a[60:63], a[188:191], v[76:79], a[60:63]
    ds_read_b64_tr_b16 a[166:167], v240 offset:14112
    v_mfma_f32_16x16x32_bf16 a[44:47], a[168:171], v[80:83], a[44:47]
    v_mfma_f32_16x16x32_bf16 a[44:47], a[172:175], v[84:87], a[44:47]
    v_mfma_f32_16x16x32_bf16 a[64:67], a[176:179], v[80:83], a[64:67]
    v_mfma_f32_16x16x32_bf16 a[64:67], a[180:183], v[84:87], a[64:67]
    v_mfma_f32_16x16x32_bf16 a[68:71], a[184:187], v[80:83], a[68:71]
    buffer_load_dwordx4 v18, s[8:11], s35 offen offset:1024 lds
    v_mfma_f32_16x16x32_bf16 a[68:71], a[188:191], v[84:87], a[68:71]
    s_waitcnt lgkmcnt(0)
    v_mfma_f32_16x16x32_bf16 a[72:75], a[144:147], v[64:67], a[72:75]
    ds_read_b64_tr_b16 a[168:169], v240 offset:264
    v_mfma_f32_16x16x32_bf16 a[72:75], a[148:151], v[68:71], a[72:75]
    ds_read_b64_tr_b16 a[170:171], v240 offset:1800
    v_mfma_f32_16x16x32_bf16 a[76:79], a[152:155], v[64:67], a[76:79]
    ds_read_b64_tr_b16 a[172:173], v240 offset:12584
    v_mfma_f32_16x16x32_bf16 a[76:79], a[156:159], v[68:71], a[76:79]
    ds_read_b64_tr_b16 a[174:175], v240 offset:14120
    v_mfma_f32_16x16x32_bf16 a[96:99], a[160:163], v[64:67], a[96:99]
    ds_read_b64_tr_b16 a[176:177], v241 offset:256
    v_mfma_f32_16x16x32_bf16 a[96:99], a[164:167], v[68:71], a[96:99]
    ds_read_b64_tr_b16 a[178:179], v241 offset:1792
    v_mfma_f32_16x16x32_bf16 a[80:83], a[144:147], v[72:75], a[80:83]
    ds_read_b64_tr_b16 a[180:181], v241 offset:12576
    buffer_load_dwordx4 v19, s[8:11], s35 offen offset:2048 lds
    v_mfma_f32_16x16x32_bf16 a[80:83], a[148:151], v[76:79], a[80:83]
    ds_read_b64_tr_b16 a[182:183], v241 offset:14112
    v_mfma_f32_16x16x32_bf16 a[84:87], a[152:155], v[72:75], a[84:87]
    ds_read_b64_tr_b16 a[184:185], v241 offset:264
    v_mfma_f32_16x16x32_bf16 a[84:87], a[156:159], v[76:79], a[84:87]
    ds_read_b64_tr_b16 a[186:187], v241 offset:1800
    v_mfma_f32_16x16x32_bf16 a[104:107], a[160:163], v[72:75], a[104:107]
    ds_read_b64_tr_b16 a[188:189], v241 offset:12584
    v_mfma_f32_16x16x32_bf16 a[104:107], a[164:167], v[76:79], a[104:107]
    ds_read_b64_tr_b16 a[190:191], v241 offset:14120
    v_mfma_f32_16x16x32_bf16 a[88:91], a[144:147], v[80:83], a[88:91]
    v_mfma_f32_16x16x32_bf16 a[88:91], a[148:151], v[84:87], a[88:91]
    v_mfma_f32_16x16x32_bf16 a[92:95], a[152:155], v[80:83], a[92:95]
    v_mfma_f32_16x16x32_bf16 a[92:95], a[156:159], v[84:87], a[92:95]
    v_mfma_f32_16x16x32_bf16 a[112:115], a[160:163], v[80:83], a[112:115]
    v_mfma_f32_16x16x32_bf16 a[112:115], a[164:167], v[84:87], a[112:115]
    s_waitcnt vmcnt(18)
    s_waitcnt lgkmcnt(0)
    s_barrier
    v_mfma_f32_16x16x32_bf16 a[100:103], a[168:171], v[64:67], a[100:103]
    ds_read_b64_tr_b16 a[144:145], v240 offset:24640
    v_mfma_f32_16x16x32_bf16 a[100:103], a[172:175], v[68:71], a[100:103]
    ds_read_b64_tr_b16 a[146:147], v240 offset:26176
    s_add_u32 m0, s29, 24640
    s_mov_b32 s35, 896
    v_mfma_f32_16x16x32_bf16 a[120:123], a[176:179], v[64:67], a[120:123]
    ds_read_b64_tr_b16 a[148:149], v240 offset:36960
    v_mfma_f32_16x16x32_bf16 a[120:123], a[180:183], v[68:71], a[120:123]
    ds_read_b64_tr_b16 a[150:151], v240 offset:38496
    v_mfma_f32_16x16x32_bf16 a[124:127], a[184:187], v[64:67], a[124:127]
    ds_read_b64_tr_b16 a[152:153], v240 offset:24648
    v_mfma_f32_16x16x32_bf16 a[124:127], a[188:191], v[68:71], a[124:127]
    ds_read_b64_tr_b16 a[154:155], v240 offset:26184
    buffer_load_dwordx4 v8, s[4:7], s35 offen offset:0 lds
    v_mfma_f32_16x16x32_bf16 a[108:111], a[168:171], v[72:75], a[108:111]
    ds_read_b64_tr_b16 a[156:157], v240 offset:36968
    v_mfma_f32_16x16x32_bf16 a[108:111], a[172:175], v[76:79], a[108:111]
    ds_read_b64_tr_b16 a[158:159], v240 offset:38504
    v_mfma_f32_16x16x32_bf16 a[128:131], a[176:179], v[72:75], a[128:131]
    ds_read_b64_tr_b16 a[160:161], v241 offset:24640
    v_mfma_f32_16x16x32_bf16 a[128:131], a[180:183], v[76:79], a[128:131]
    ds_read_b64_tr_b16 a[162:163], v241 offset:26176
    buffer_load_dwordx4 v9, s[4:7], s35 offen offset:1024 lds
    v_mfma_f32_16x16x32_bf16 a[132:135], a[184:187], v[72:75], a[132:135]
    ds_read_b64_tr_b16 a[164:165], v241 offset:36960
    v_mfma_f32_16x16x32_bf16 a[132:135], a[188:191], v[76:79], a[132:135]
    ds_read_b64_tr_b16 a[166:167], v241 offset:38496
    v_mfma_f32_16x16x32_bf16 a[116:119], a[168:171], v[80:83], a[116:119]
    v_mfma_f32_16x16x32_bf16 a[116:119], a[172:175], v[84:87], a[116:119]
    buffer_load_dwordx4 v10, s[4:7], s35 offen offset:2048 lds
    v_mfma_f32_16x16x32_bf16 a[136:139], a[176:179], v[80:83], a[136:139]
    v_mfma_f32_16x16x32_bf16 a[136:139], a[180:183], v[84:87], a[136:139]
    v_mfma_f32_16x16x32_bf16 a[140:143], a[184:187], v[80:83], a[140:143]
    v_mfma_f32_16x16x32_bf16 a[140:143], a[188:191], v[84:87], a[140:143]
    s_waitcnt lgkmcnt(0)
    v_mfma_f32_16x16x32_bf16 v[88:91], a[144:147], v[64:67], v[88:91]
    ds_read_b64_tr_b16 a[168:169], v241 offset:24648
    buffer_load_dwordx4 v11, s[4:7], s35 offen offset:3072 lds
    v_mfma_f32_16x16x32_bf16 v[88:91], a[148:151], v[68:71], v[88:91]
    ds_read_b64_tr_b16 a[170:171], v241 offset:26184
    v_mfma_f32_16x16x32_bf16 v[92:95], a[152:155], v[64:67], v[92:95]
    ds_read_b64_tr_b16 a[172:173], v241 offset:36968
    v_mfma_f32_16x16x32_bf16 v[92:95], a[156:159], v[68:71], v[92:95]
    ds_read_b64_tr_b16 a[174:175], v241 offset:38504
    v_mfma_f32_16x16x32_bf16 v[112:115], a[160:163], v[64:67], v[112:115]
    ds_read_b64_tr_b16 a[176:177], v240 offset:24768
    s_add_u32 m0, s29, 28736
    v_mfma_f32_16x16x32_bf16 v[112:115], a[164:167], v[68:71], v[112:115]
    ds_read_b64_tr_b16 a[178:179], v240 offset:26304
    v_mfma_f32_16x16x32_bf16 v[96:99], a[144:147], v[72:75], v[96:99]
    ds_read_b64_tr_b16 a[180:181], v240 offset:37088
    v_mfma_f32_16x16x32_bf16 v[96:99], a[148:151], v[76:79], v[96:99]
    ds_read_b64_tr_b16 a[182:183], v240 offset:38624
    v_mfma_f32_16x16x32_bf16 v[100:103], a[152:155], v[72:75], v[100:103]
    ds_read_b64_tr_b16 a[184:185], v240 offset:24776
    buffer_load_dwordx4 v12, s[4:7], s35 offen offset:0 lds
    v_mfma_f32_16x16x32_bf16 v[100:103], a[156:159], v[76:79], v[100:103]
    ds_read_b64_tr_b16 a[186:187], v240 offset:26312
    v_mfma_f32_16x16x32_bf16 v[120:123], a[160:163], v[72:75], v[120:123]
    ds_read_b64_tr_b16 a[188:189], v240 offset:37096
    v_mfma_f32_16x16x32_bf16 v[120:123], a[164:167], v[76:79], v[120:123]
    ds_read_b64_tr_b16 a[190:191], v240 offset:38632
    v_mfma_f32_16x16x32_bf16 v[104:107], a[144:147], v[80:83], v[104:107]
    buffer_load_dwordx4 v13, s[4:7], s35 offen offset:1024 lds
    v_mfma_f32_16x16x32_bf16 v[104:107], a[148:151], v[84:87], v[104:107]
    v_mfma_f32_16x16x32_bf16 v[108:111], a[152:155], v[80:83], v[108:111]
    v_mfma_f32_16x16x32_bf16 v[108:111], a[156:159], v[84:87], v[108:111]
    v_mfma_f32_16x16x32_bf16 v[128:131], a[160:163], v[80:83], v[128:131]
    v_mfma_f32_16x16x32_bf16 v[128:131], a[164:167], v[84:87], v[128:131]
    s_add_u32 m0, s38, 49280
    s_mov_b32 s36, 5506560
    s_waitcnt lgkmcnt(0)
    v_mfma_f32_16x16x32_bf16 v[116:119], a[168:171], v[64:67], v[116:119]
    ds_read_b64_tr_b16 a[144:145], v241 offset:24768
    v_mfma_f32_16x16x32_bf16 v[116:119], a[172:175], v[68:71], v[116:119]
    ds_read_b64_tr_b16 a[146:147], v241 offset:26304
    v_mfma_f32_16x16x32_bf16 v[136:139], a[176:179], v[64:67], v[136:139]
    ds_read_b64_tr_b16 a[148:149], v241 offset:37088
    v_mfma_f32_16x16x32_bf16 v[136:139], a[180:183], v[68:71], v[136:139]
    ds_read_b64_tr_b16 a[150:151], v241 offset:38624
    buffer_load_dwordx4 v14, s[8:11], s36 offen offset:0 lds
    v_mfma_f32_16x16x32_bf16 v[140:143], a[184:187], v[64:67], v[140:143]
    ds_read_b64_tr_b16 a[152:153], v241 offset:24776
    v_mfma_f32_16x16x32_bf16 v[140:143], a[188:191], v[68:71], v[140:143]
    ds_read_b64_tr_b16 a[154:155], v241 offset:26312
    v_mfma_f32_16x16x32_bf16 v[124:127], a[168:171], v[72:75], v[124:127]
    ds_read_b64_tr_b16 a[156:157], v241 offset:37096
    v_mfma_f32_16x16x32_bf16 v[124:127], a[172:175], v[76:79], v[124:127]
    ds_read_b64_tr_b16 a[158:159], v241 offset:38632
    buffer_load_dwordx4 v15, s[8:11], s36 offen offset:1024 lds
    v_mfma_f32_16x16x32_bf16 v[144:147], a[176:179], v[72:75], v[144:147]
    ds_read_b64_tr_b16 a[160:161], v240 offset:24896
    v_mfma_f32_16x16x32_bf16 v[144:147], a[180:183], v[76:79], v[144:147]
    ds_read_b64_tr_b16 a[162:163], v240 offset:26432
    v_mfma_f32_16x16x32_bf16 v[148:151], a[184:187], v[72:75], v[148:151]
    ds_read_b64_tr_b16 a[164:165], v240 offset:37216
    v_mfma_f32_16x16x32_bf16 v[148:151], a[188:191], v[76:79], v[148:151]
    ds_read_b64_tr_b16 a[166:167], v240 offset:38752
    buffer_load_dwordx4 v16, s[8:11], s36 offen offset:2048 lds
    v_mfma_f32_16x16x32_bf16 v[132:135], a[168:171], v[80:83], v[132:135]
    v_mfma_f32_16x16x32_bf16 v[132:135], a[172:175], v[84:87], v[132:135]
    v_mfma_f32_16x16x32_bf16 v[152:155], a[176:179], v[80:83], v[152:155]
    v_mfma_f32_16x16x32_bf16 v[152:155], a[180:183], v[84:87], v[152:155]
    v_mfma_f32_16x16x32_bf16 v[156:159], a[184:187], v[80:83], v[156:159]
    s_add_u32 m0, s38, 52360
    v_mfma_f32_16x16x32_bf16 v[156:159], a[188:191], v[84:87], v[156:159]
    s_waitcnt lgkmcnt(0)
    v_mfma_f32_16x16x32_bf16 v[160:163], a[144:147], v[64:67], v[160:163]
    ds_read_b64_tr_b16 a[168:169], v240 offset:24904
    v_mfma_f32_16x16x32_bf16 v[160:163], a[148:151], v[68:71], v[160:163]
    ds_read_b64_tr_b16 a[170:171], v240 offset:26440
    v_mfma_f32_16x16x32_bf16 v[164:167], a[152:155], v[64:67], v[164:167]
    ds_read_b64_tr_b16 a[172:173], v240 offset:37224
    buffer_load_dwordx4 v17, s[8:11], s36 offen offset:0 lds
    v_mfma_f32_16x16x32_bf16 v[164:167], a[156:159], v[68:71], v[164:167]
    ds_read_b64_tr_b16 a[174:175], v240 offset:38760
    v_mfma_f32_16x16x32_bf16 v[184:187], a[160:163], v[64:67], v[184:187]
    ds_read_b64_tr_b16 a[176:177], v241 offset:24896
    v_mfma_f32_16x16x32_bf16 v[184:187], a[164:167], v[68:71], v[184:187]
    ds_read_b64_tr_b16 a[178:179], v241 offset:26432
    v_mfma_f32_16x16x32_bf16 v[168:171], a[144:147], v[72:75], v[168:171]
    ds_read_b64_tr_b16 a[180:181], v241 offset:37216
    buffer_load_dwordx4 v18, s[8:11], s36 offen offset:1024 lds
    v_mfma_f32_16x16x32_bf16 v[168:171], a[148:151], v[76:79], v[168:171]
    ds_read_b64_tr_b16 a[182:183], v241 offset:38752
    v_mfma_f32_16x16x32_bf16 v[172:175], a[152:155], v[72:75], v[172:175]
    ds_read_b64_tr_b16 a[184:185], v241 offset:24904
    v_mfma_f32_16x16x32_bf16 v[172:175], a[156:159], v[76:79], v[172:175]
    ds_read_b64_tr_b16 a[186:187], v241 offset:26440
    v_mfma_f32_16x16x32_bf16 v[192:195], a[160:163], v[72:75], v[192:195]
    ds_read_b64_tr_b16 a[188:189], v241 offset:37224
    buffer_load_dwordx4 v19, s[8:11], s36 offen offset:2048 lds
    v_mfma_f32_16x16x32_bf16 v[192:195], a[164:167], v[76:79], v[192:195]
    ds_read_b64_tr_b16 a[190:191], v241 offset:38760
    v_mfma_f32_16x16x32_bf16 v[176:179], a[144:147], v[80:83], v[176:179]
    v_mfma_f32_16x16x32_bf16 v[176:179], a[148:151], v[84:87], v[176:179]
    v_mfma_f32_16x16x32_bf16 v[180:183], a[152:155], v[80:83], v[180:183]
    v_mfma_f32_16x16x32_bf16 v[180:183], a[156:159], v[84:87], v[180:183]
    v_mfma_f32_16x16x32_bf16 v[200:203], a[160:163], v[80:83], v[200:203]
    v_mfma_f32_16x16x32_bf16 v[200:203], a[164:167], v[84:87], v[200:203]
    s_waitcnt vmcnt(18)
    s_waitcnt lgkmcnt(0)
    s_barrier
    v_mfma_f32_16x16x32_bf16 v[188:191], a[168:171], v[64:67], v[188:191]
    ds_read_b64_tr_b16 a[144:145], v242 offset:24640
    v_mfma_f32_16x16x32_bf16 v[188:191], a[172:175], v[68:71], v[188:191]
    ds_read_b64_tr_b16 a[146:147], v242 offset:26176
    s_add_u32 m0, s38, 73920
    s_mov_b32 s35, 5505024
    v_mfma_f32_16x16x32_bf16 v[208:211], a[176:179], v[64:67], v[208:211]
    ds_read_b64_tr_b16 a[148:149], v242 offset:36960
    v_mfma_f32_16x16x32_bf16 v[208:211], a[180:183], v[68:71], v[208:211]
    ds_read_b64_tr_b16 a[150:151], v242 offset:38496
    v_mfma_f32_16x16x32_bf16 v[212:215], a[184:187], v[64:67], v[212:215]
    ds_read_b64_tr_b16 a[152:153], v242 offset:24648
    v_mfma_f32_16x16x32_bf16 v[212:215], a[188:191], v[68:71], v[212:215]
    ds_read_b128 v[64:67], v236 offset:0
    ds_read_b64_tr_b16 a[154:155], v242 offset:26184
    v_mfma_f32_16x16x32_bf16 v[196:199], a[168:171], v[72:75], v[196:199]
    ds_read_b128 v[68:71], v237 offset:0
    ds_read_b64_tr_b16 a[156:157], v242 offset:36968
    v_mfma_f32_16x16x32_bf16 v[196:199], a[172:175], v[76:79], v[196:199]
    ds_read_b64_tr_b16 a[158:159], v242 offset:38504
    v_mfma_f32_16x16x32_bf16 v[216:219], a[176:179], v[72:75], v[216:219]
    ds_read_b64_tr_b16 a[160:161], v243 offset:24640
    v_mfma_f32_16x16x32_bf16 v[216:219], a[180:183], v[76:79], v[216:219]
    ds_read_b64_tr_b16 a[162:163], v243 offset:26176
    buffer_load_dwordx4 v14, s[8:11], s35 offen offset:0 lds
    v_mfma_f32_16x16x32_bf16 v[220:223], a[184:187], v[72:75], v[220:223]
    ds_read_b64_tr_b16 a[164:165], v243 offset:36960
    v_mfma_f32_16x16x32_bf16 v[220:223], a[188:191], v[76:79], v[220:223]
    ds_read_b128 v[72:75], v236 offset:2048
    ds_read_b64_tr_b16 a[166:167], v243 offset:38496
    v_mfma_f32_16x16x32_bf16 v[204:207], a[168:171], v[80:83], v[204:207]
    ds_read_b128 v[76:79], v237 offset:2048
    v_mfma_f32_16x16x32_bf16 v[204:207], a[172:175], v[84:87], v[204:207]
    v_mfma_f32_16x16x32_bf16 v[224:227], a[176:179], v[80:83], v[224:227]
    v_mfma_f32_16x16x32_bf16 v[224:227], a[180:183], v[84:87], v[224:227]
    v_mfma_f32_16x16x32_bf16 v[228:231], a[184:187], v[80:83], v[228:231]
    v_mfma_f32_16x16x32_bf16 v[228:231], a[188:191], v[84:87], v[228:231]
    ds_read_b128 v[80:83], v236 offset:4096
    ds_read_b128 v[84:87], v237 offset:4096
    s_waitcnt lgkmcnt(3)
    v_mfma_f32_16x16x32_bf16 a[0:3], a[144:147], v[64:67], a[0:3]
    ds_read_b64_tr_b16 a[168:169], v243 offset:24648
    buffer_load_dwordx4 v15, s[8:11], s35 offen offset:1024 lds
    v_mfma_f32_16x16x32_bf16 a[0:3], a[148:151], v[68:71], a[0:3]
    ds_read_b64_tr_b16 a[170:171], v243 offset:26184
    v_mfma_f32_16x16x32_bf16 a[4:7], a[152:155], v[64:67], a[4:7]
    ds_read_b64_tr_b16 a[172:173], v243 offset:36968
    v_mfma_f32_16x16x32_bf16 a[4:7], a[156:159], v[68:71], a[4:7]
    ds_read_b64_tr_b16 a[174:175], v243 offset:38504
    v_mfma_f32_16x16x32_bf16 a[24:27], a[160:163], v[64:67], a[24:27]
    ds_read_b64_tr_b16 a[176:177], v242 offset:24768
    v_mfma_f32_16x16x32_bf16 a[24:27], a[164:167], v[68:71], a[24:27]
    ds_read_b64_tr_b16 a[178:179], v242 offset:26304
    v_mfma_f32_16x16x32_bf16 a[8:11], a[144:147], v[72:75], a[8:11]
    ds_read_b64_tr_b16 a[180:181], v242 offset:37088
    s_waitcnt lgkmcnt(9)
    v_mfma_f32_16x16x32_bf16 a[8:11], a[148:151], v[76:79], a[8:11]
    ds_read_b64_tr_b16 a[182:183], v242 offset:38624
    v_mfma_f32_16x16x32_bf16 a[12:15], a[152:155], v[72:75], a[12:15]
    ds_read_b64_tr_b16 a[184:185], v242 offset:24776
    buffer_load_dwordx4 v16, s[8:11], s35 offen offset:2048 lds
    v_mfma_f32_16x16x32_bf16 a[12:15], a[156:159], v[76:79], a[12:15]
    ds_read_b64_tr_b16 a[186:187], v242 offset:26312
    v_mfma_f32_16x16x32_bf16 a[32:35], a[160:163], v[72:75], a[32:35]
    ds_read_b64_tr_b16 a[188:189], v242 offset:37096
    v_mfma_f32_16x16x32_bf16 a[32:35], a[164:167], v[76:79], a[32:35]
    ds_read_b64_tr_b16 a[190:191], v242 offset:38632
    s_waitcnt lgkmcnt(13)
    v_mfma_f32_16x16x32_bf16 a[16:19], a[144:147], v[80:83], a[16:19]
    s_waitcnt lgkmcnt(12)
    v_mfma_f32_16x16x32_bf16 a[16:19], a[148:151], v[84:87], a[16:19]
    v_mfma_f32_16x16x32_bf16 a[20:23], a[152:155], v[80:83], a[20:23]
    v_mfma_f32_16x16x32_bf16 a[20:23], a[156:159], v[84:87], a[20:23]
    v_mfma_f32_16x16x32_bf16 a[40:43], a[160:163], v[80:83], a[40:43]
    v_mfma_f32_16x16x32_bf16 a[40:43], a[164:167], v[84:87], a[40:43]
    s_add_u32 m0, s38, 77000
    s_waitcnt lgkmcnt(0)
    v_mfma_f32_16x16x32_bf16 a[28:31], a[168:171], v[64:67], a[28:31]
    ds_read_b64_tr_b16 a[144:145], v243 offset:24768
    v_mfma_f32_16x16x32_bf16 a[28:31], a[172:175], v[68:71], a[28:31]
    ds_read_b64_tr_b16 a[146:147], v243 offset:26304
    v_mfma_f32_16x16x32_bf16 a[48:51], a[176:179], v[64:67], a[48:51]
    ds_read_b64_tr_b16 a[148:149], v243 offset:37088
    v_mfma_f32_16x16x32_bf16 a[48:51], a[180:183], v[68:71], a[48:51]
    ds_read_b64_tr_b16 a[150:151], v243 offset:38624
    v_mfma_f32_16x16x32_bf16 a[52:55], a[184:187], v[64:67], a[52:55]
    ds_read_b64_tr_b16 a[152:153], v243 offset:24776
    v_mfma_f32_16x16x32_bf16 a[52:55], a[188:191], v[68:71], a[52:55]
    ds_read_b64_tr_b16 a[154:155], v243 offset:26312
    v_mfma_f32_16x16x32_bf16 a[36:39], a[168:171], v[72:75], a[36:39]
    ds_read_b64_tr_b16 a[156:157], v243 offset:37096
    v_mfma_f32_16x16x32_bf16 a[36:39], a[172:175], v[76:79], a[36:39]
    ds_read_b64_tr_b16 a[158:159], v243 offset:38632
    buffer_load_dwordx4 v17, s[8:11], s35 offen offset:0 lds
    v_mfma_f32_16x16x32_bf16 a[56:59], a[176:179], v[72:75], a[56:59]
    ds_read_b64_tr_b16 a[160:161], v242 offset:24896
    v_mfma_f32_16x16x32_bf16 a[56:59], a[180:183], v[76:79], a[56:59]
    ds_read_b64_tr_b16 a[162:163], v242 offset:26432
    v_mfma_f32_16x16x32_bf16 a[60:63], a[184:187], v[72:75], a[60:63]
    ds_read_b64_tr_b16 a[164:165], v242 offset:37216
    v_mfma_f32_16x16x32_bf16 a[60:63], a[188:191], v[76:79], a[60:63]
    ds_read_b64_tr_b16 a[166:167], v242 offset:38752
    v_mfma_f32_16x16x32_bf16 a[44:47], a[168:171], v[80:83], a[44:47]
    v_mfma_f32_16x16x32_bf16 a[44:47], a[172:175], v[84:87], a[44:47]
    v_mfma_f32_16x16x32_bf16 a[64:67], a[176:179], v[80:83], a[64:67]
    v_mfma_f32_16x16x32_bf16 a[64:67], a[180:183], v[84:87], a[64:67]
    v_mfma_f32_16x16x32_bf16 a[68:71], a[184:187], v[80:83], a[68:71]
    buffer_load_dwordx4 v18, s[8:11], s35 offen offset:1024 lds
    v_mfma_f32_16x16x32_bf16 a[68:71], a[188:191], v[84:87], a[68:71]
    s_waitcnt lgkmcnt(0)
    v_mfma_f32_16x16x32_bf16 a[72:75], a[144:147], v[64:67], a[72:75]
    ds_read_b64_tr_b16 a[168:169], v242 offset:24904
    v_mfma_f32_16x16x32_bf16 a[72:75], a[148:151], v[68:71], a[72:75]
    ds_read_b64_tr_b16 a[170:171], v242 offset:26440
    v_mfma_f32_16x16x32_bf16 a[76:79], a[152:155], v[64:67], a[76:79]
    ds_read_b64_tr_b16 a[172:173], v242 offset:37224
    v_mfma_f32_16x16x32_bf16 a[76:79], a[156:159], v[68:71], a[76:79]
    ds_read_b64_tr_b16 a[174:175], v242 offset:38760
    v_mfma_f32_16x16x32_bf16 a[96:99], a[160:163], v[64:67], a[96:99]
    ds_read_b64_tr_b16 a[176:177], v243 offset:24896
    v_mfma_f32_16x16x32_bf16 a[96:99], a[164:167], v[68:71], a[96:99]
    ds_read_b64_tr_b16 a[178:179], v243 offset:26432
    v_mfma_f32_16x16x32_bf16 a[80:83], a[144:147], v[72:75], a[80:83]
    ds_read_b64_tr_b16 a[180:181], v243 offset:37216
    buffer_load_dwordx4 v19, s[8:11], s35 offen offset:2048 lds
    v_mfma_f32_16x16x32_bf16 a[80:83], a[148:151], v[76:79], a[80:83]
    ds_read_b64_tr_b16 a[182:183], v243 offset:38752
    v_mfma_f32_16x16x32_bf16 a[84:87], a[152:155], v[72:75], a[84:87]
    ds_read_b64_tr_b16 a[184:185], v243 offset:24904
    v_mfma_f32_16x16x32_bf16 a[84:87], a[156:159], v[76:79], a[84:87]
    ds_read_b64_tr_b16 a[186:187], v243 offset:26440
    v_mfma_f32_16x16x32_bf16 a[104:107], a[160:163], v[72:75], a[104:107]
    ds_read_b64_tr_b16 a[188:189], v243 offset:37224
    v_mfma_f32_16x16x32_bf16 a[104:107], a[164:167], v[76:79], a[104:107]
    ds_read_b64_tr_b16 a[190:191], v243 offset:38760
    v_mfma_f32_16x16x32_bf16 a[88:91], a[144:147], v[80:83], a[88:91]
    v_mfma_f32_16x16x32_bf16 a[88:91], a[148:151], v[84:87], a[88:91]
    v_mfma_f32_16x16x32_bf16 a[92:95], a[152:155], v[80:83], a[92:95]
    v_mfma_f32_16x16x32_bf16 a[92:95], a[156:159], v[84:87], a[92:95]
    v_mfma_f32_16x16x32_bf16 a[112:115], a[160:163], v[80:83], a[112:115]
    v_mfma_f32_16x16x32_bf16 a[112:115], a[164:167], v[84:87], a[112:115]
    s_waitcnt vmcnt(18)
    s_waitcnt lgkmcnt(0)
    s_barrier
    v_mfma_f32_16x16x32_bf16 a[100:103], a[168:171], v[64:67], a[100:103]
    ds_read_b64_tr_b16 a[144:145], v238 offset:0
    v_mfma_f32_16x16x32_bf16 a[100:103], a[172:175], v[68:71], a[100:103]
    ds_read_b64_tr_b16 a[146:147], v238 offset:1536
    s_add_u32 m0, s29, 98560
    s_mov_b32 s35, 1024
    v_mfma_f32_16x16x32_bf16 a[120:123], a[176:179], v[64:67], a[120:123]
    ds_read_b64_tr_b16 a[148:149], v238 offset:12320
    v_mfma_f32_16x16x32_bf16 a[120:123], a[180:183], v[68:71], a[120:123]
    ds_read_b64_tr_b16 a[150:151], v238 offset:13856
    v_mfma_f32_16x16x32_bf16 a[124:127], a[184:187], v[64:67], a[124:127]
    ds_read_b64_tr_b16 a[152:153], v238 offset:8
    v_mfma_f32_16x16x32_bf16 a[124:127], a[188:191], v[68:71], a[124:127]
    ds_read_b64_tr_b16 a[154:155], v238 offset:1544
    buffer_load_dwordx4 v8, s[4:7], s35 offen offset:0 lds
    v_mfma_f32_16x16x32_bf16 a[108:111], a[168:171], v[72:75], a[108:111]
    ds_read_b64_tr_b16 a[156:157], v238 offset:12328
    v_mfma_f32_16x16x32_bf16 a[108:111], a[172:175], v[76:79], a[108:111]
    ds_read_b64_tr_b16 a[158:159], v238 offset:13864
    v_mfma_f32_16x16x32_bf16 a[128:131], a[176:179], v[72:75], a[128:131]
    ds_read_b64_tr_b16 a[160:161], v239 offset:0
    v_mfma_f32_16x16x32_bf16 a[128:131], a[180:183], v[76:79], a[128:131]
    ds_read_b64_tr_b16 a[162:163], v239 offset:1536
    buffer_load_dwordx4 v9, s[4:7], s35 offen offset:1024 lds
    v_mfma_f32_16x16x32_bf16 a[132:135], a[184:187], v[72:75], a[132:135]
    ds_read_b64_tr_b16 a[164:165], v239 offset:12320
    v_mfma_f32_16x16x32_bf16 a[132:135], a[188:191], v[76:79], a[132:135]
    ds_read_b64_tr_b16 a[166:167], v239 offset:13856
    v_mfma_f32_16x16x32_bf16 a[116:119], a[168:171], v[80:83], a[116:119]
    v_mfma_f32_16x16x32_bf16 a[116:119], a[172:175], v[84:87], a[116:119]
    buffer_load_dwordx4 v10, s[4:7], s35 offen offset:2048 lds
    v_mfma_f32_16x16x32_bf16 a[136:139], a[176:179], v[80:83], a[136:139]
    v_mfma_f32_16x16x32_bf16 a[136:139], a[180:183], v[84:87], a[136:139]
    v_mfma_f32_16x16x32_bf16 a[140:143], a[184:187], v[80:83], a[140:143]
    v_mfma_f32_16x16x32_bf16 a[140:143], a[188:191], v[84:87], a[140:143]
    s_waitcnt lgkmcnt(0)
    v_mfma_f32_16x16x32_bf16 v[88:91], a[144:147], v[64:67], v[88:91]
    ds_read_b64_tr_b16 a[168:169], v239 offset:8
    buffer_load_dwordx4 v11, s[4:7], s35 offen offset:3072 lds
    v_mfma_f32_16x16x32_bf16 v[88:91], a[148:151], v[68:71], v[88:91]
    ds_read_b64_tr_b16 a[170:171], v239 offset:1544
    v_mfma_f32_16x16x32_bf16 v[92:95], a[152:155], v[64:67], v[92:95]
    ds_read_b64_tr_b16 a[172:173], v239 offset:12328
    v_mfma_f32_16x16x32_bf16 v[92:95], a[156:159], v[68:71], v[92:95]
    ds_read_b64_tr_b16 a[174:175], v239 offset:13864
    v_mfma_f32_16x16x32_bf16 v[112:115], a[160:163], v[64:67], v[112:115]
    ds_read_b64_tr_b16 a[176:177], v238 offset:128
    s_add_u32 m0, s29, 102656
    v_mfma_f32_16x16x32_bf16 v[112:115], a[164:167], v[68:71], v[112:115]
    ds_read_b64_tr_b16 a[178:179], v238 offset:1664
    v_mfma_f32_16x16x32_bf16 v[96:99], a[144:147], v[72:75], v[96:99]
    ds_read_b64_tr_b16 a[180:181], v238 offset:12448
    v_mfma_f32_16x16x32_bf16 v[96:99], a[148:151], v[76:79], v[96:99]
    ds_read_b64_tr_b16 a[182:183], v238 offset:13984
    v_mfma_f32_16x16x32_bf16 v[100:103], a[152:155], v[72:75], v[100:103]
    ds_read_b64_tr_b16 a[184:185], v238 offset:136
    buffer_load_dwordx4 v12, s[4:7], s35 offen offset:0 lds
    v_mfma_f32_16x16x32_bf16 v[100:103], a[156:159], v[76:79], v[100:103]
    ds_read_b64_tr_b16 a[186:187], v238 offset:1672
    v_mfma_f32_16x16x32_bf16 v[120:123], a[160:163], v[72:75], v[120:123]
    ds_read_b64_tr_b16 a[188:189], v238 offset:12456
    v_mfma_f32_16x16x32_bf16 v[120:123], a[164:167], v[76:79], v[120:123]
    ds_read_b64_tr_b16 a[190:191], v238 offset:13992
    v_mfma_f32_16x16x32_bf16 v[104:107], a[144:147], v[80:83], v[104:107]
    buffer_load_dwordx4 v13, s[4:7], s35 offen offset:1024 lds
    v_mfma_f32_16x16x32_bf16 v[104:107], a[148:151], v[84:87], v[104:107]
    v_mfma_f32_16x16x32_bf16 v[108:111], a[152:155], v[80:83], v[108:111]
    v_mfma_f32_16x16x32_bf16 v[108:111], a[156:159], v[84:87], v[108:111]
    v_mfma_f32_16x16x32_bf16 v[128:131], a[160:163], v[80:83], v[128:131]
    v_mfma_f32_16x16x32_bf16 v[128:131], a[164:167], v[84:87], v[128:131]
    s_add_u32 m0, s38, 123200
    s_mov_b32 s36, 6292992
    s_waitcnt lgkmcnt(0)
    v_mfma_f32_16x16x32_bf16 v[116:119], a[168:171], v[64:67], v[116:119]
    ds_read_b64_tr_b16 a[144:145], v239 offset:128
    v_mfma_f32_16x16x32_bf16 v[116:119], a[172:175], v[68:71], v[116:119]
    ds_read_b64_tr_b16 a[146:147], v239 offset:1664
    v_mfma_f32_16x16x32_bf16 v[136:139], a[176:179], v[64:67], v[136:139]
    ds_read_b64_tr_b16 a[148:149], v239 offset:12448
    v_mfma_f32_16x16x32_bf16 v[136:139], a[180:183], v[68:71], v[136:139]
    ds_read_b64_tr_b16 a[150:151], v239 offset:13984
    buffer_load_dwordx4 v14, s[8:11], s36 offen offset:0 lds
    v_mfma_f32_16x16x32_bf16 v[140:143], a[184:187], v[64:67], v[140:143]
    ds_read_b64_tr_b16 a[152:153], v239 offset:136
    v_mfma_f32_16x16x32_bf16 v[140:143], a[188:191], v[68:71], v[140:143]
    ds_read_b64_tr_b16 a[154:155], v239 offset:1672
    v_mfma_f32_16x16x32_bf16 v[124:127], a[168:171], v[72:75], v[124:127]
    ds_read_b64_tr_b16 a[156:157], v239 offset:12456
    v_mfma_f32_16x16x32_bf16 v[124:127], a[172:175], v[76:79], v[124:127]
    ds_read_b64_tr_b16 a[158:159], v239 offset:13992
    buffer_load_dwordx4 v15, s[8:11], s36 offen offset:1024 lds
    v_mfma_f32_16x16x32_bf16 v[144:147], a[176:179], v[72:75], v[144:147]
    ds_read_b64_tr_b16 a[160:161], v238 offset:256
    v_mfma_f32_16x16x32_bf16 v[144:147], a[180:183], v[76:79], v[144:147]
    ds_read_b64_tr_b16 a[162:163], v238 offset:1792
    v_mfma_f32_16x16x32_bf16 v[148:151], a[184:187], v[72:75], v[148:151]
    ds_read_b64_tr_b16 a[164:165], v238 offset:12576
    v_mfma_f32_16x16x32_bf16 v[148:151], a[188:191], v[76:79], v[148:151]
    ds_read_b64_tr_b16 a[166:167], v238 offset:14112
    buffer_load_dwordx4 v16, s[8:11], s36 offen offset:2048 lds
    v_mfma_f32_16x16x32_bf16 v[132:135], a[168:171], v[80:83], v[132:135]
    v_mfma_f32_16x16x32_bf16 v[132:135], a[172:175], v[84:87], v[132:135]
    v_mfma_f32_16x16x32_bf16 v[152:155], a[176:179], v[80:83], v[152:155]
    v_mfma_f32_16x16x32_bf16 v[152:155], a[180:183], v[84:87], v[152:155]
    v_mfma_f32_16x16x32_bf16 v[156:159], a[184:187], v[80:83], v[156:159]
    s_add_u32 m0, s38, 126280
    v_mfma_f32_16x16x32_bf16 v[156:159], a[188:191], v[84:87], v[156:159]
    s_waitcnt lgkmcnt(0)
    v_mfma_f32_16x16x32_bf16 v[160:163], a[144:147], v[64:67], v[160:163]
    ds_read_b64_tr_b16 a[168:169], v238 offset:264
    v_mfma_f32_16x16x32_bf16 v[160:163], a[148:151], v[68:71], v[160:163]
    ds_read_b64_tr_b16 a[170:171], v238 offset:1800
    v_mfma_f32_16x16x32_bf16 v[164:167], a[152:155], v[64:67], v[164:167]
    ds_read_b64_tr_b16 a[172:173], v238 offset:12584
    buffer_load_dwordx4 v17, s[8:11], s36 offen offset:0 lds
    v_mfma_f32_16x16x32_bf16 v[164:167], a[156:159], v[68:71], v[164:167]
    ds_read_b64_tr_b16 a[174:175], v238 offset:14120
    v_mfma_f32_16x16x32_bf16 v[184:187], a[160:163], v[64:67], v[184:187]
    ds_read_b64_tr_b16 a[176:177], v239 offset:256
    v_mfma_f32_16x16x32_bf16 v[184:187], a[164:167], v[68:71], v[184:187]
    ds_read_b64_tr_b16 a[178:179], v239 offset:1792
    v_mfma_f32_16x16x32_bf16 v[168:171], a[144:147], v[72:75], v[168:171]
    ds_read_b64_tr_b16 a[180:181], v239 offset:12576
    buffer_load_dwordx4 v18, s[8:11], s36 offen offset:1024 lds
    v_mfma_f32_16x16x32_bf16 v[168:171], a[148:151], v[76:79], v[168:171]
    ds_read_b64_tr_b16 a[182:183], v239 offset:14112
    v_mfma_f32_16x16x32_bf16 v[172:175], a[152:155], v[72:75], v[172:175]
    ds_read_b64_tr_b16 a[184:185], v239 offset:264
    v_mfma_f32_16x16x32_bf16 v[172:175], a[156:159], v[76:79], v[172:175]
    ds_read_b64_tr_b16 a[186:187], v239 offset:1800
    v_mfma_f32_16x16x32_bf16 v[192:195], a[160:163], v[72:75], v[192:195]
    ds_read_b64_tr_b16 a[188:189], v239 offset:12584
    buffer_load_dwordx4 v19, s[8:11], s36 offen offset:2048 lds
    v_mfma_f32_16x16x32_bf16 v[192:195], a[164:167], v[76:79], v[192:195]
    ds_read_b64_tr_b16 a[190:191], v239 offset:14120
    v_mfma_f32_16x16x32_bf16 v[176:179], a[144:147], v[80:83], v[176:179]
    v_mfma_f32_16x16x32_bf16 v[176:179], a[148:151], v[84:87], v[176:179]
    v_mfma_f32_16x16x32_bf16 v[180:183], a[152:155], v[80:83], v[180:183]
    v_mfma_f32_16x16x32_bf16 v[180:183], a[156:159], v[84:87], v[180:183]
    v_mfma_f32_16x16x32_bf16 v[200:203], a[160:163], v[80:83], v[200:203]
    v_mfma_f32_16x16x32_bf16 v[200:203], a[164:167], v[84:87], v[200:203]
    s_waitcnt vmcnt(18)
    s_waitcnt lgkmcnt(0)
    s_barrier
    v_mfma_f32_16x16x32_bf16 v[188:191], a[168:171], v[64:67], v[188:191]
    ds_read_b64_tr_b16 a[144:145], v240 offset:0
    v_mfma_f32_16x16x32_bf16 v[188:191], a[172:175], v[68:71], v[188:191]
    ds_read_b64_tr_b16 a[146:147], v240 offset:1536
    s_add_u32 m0, s38, 0
    s_mov_b32 s35, 6291456
    v_mfma_f32_16x16x32_bf16 v[208:211], a[176:179], v[64:67], v[208:211]
    ds_read_b64_tr_b16 a[148:149], v240 offset:12320
    v_mfma_f32_16x16x32_bf16 v[208:211], a[180:183], v[68:71], v[208:211]
    ds_read_b64_tr_b16 a[150:151], v240 offset:13856
    v_mfma_f32_16x16x32_bf16 v[212:215], a[184:187], v[64:67], v[212:215]
    ds_read_b64_tr_b16 a[152:153], v240 offset:8
    v_mfma_f32_16x16x32_bf16 v[212:215], a[188:191], v[68:71], v[212:215]
    ds_read_b128 v[64:67], v232 offset:24640
    ds_read_b64_tr_b16 a[154:155], v240 offset:1544
    v_mfma_f32_16x16x32_bf16 v[196:199], a[168:171], v[72:75], v[196:199]
    ds_read_b128 v[68:71], v233 offset:24640
    ds_read_b64_tr_b16 a[156:157], v240 offset:12328
    v_mfma_f32_16x16x32_bf16 v[196:199], a[172:175], v[76:79], v[196:199]
    ds_read_b64_tr_b16 a[158:159], v240 offset:13864
    v_mfma_f32_16x16x32_bf16 v[216:219], a[176:179], v[72:75], v[216:219]
    ds_read_b64_tr_b16 a[160:161], v241 offset:0
    v_mfma_f32_16x16x32_bf16 v[216:219], a[180:183], v[76:79], v[216:219]
    ds_read_b64_tr_b16 a[162:163], v241 offset:1536
    buffer_load_dwordx4 v14, s[8:11], s35 offen offset:0 lds
    v_mfma_f32_16x16x32_bf16 v[220:223], a[184:187], v[72:75], v[220:223]
    ds_read_b64_tr_b16 a[164:165], v241 offset:12320
    v_mfma_f32_16x16x32_bf16 v[220:223], a[188:191], v[76:79], v[220:223]
    ds_read_b128 v[72:75], v232 offset:26688
    ds_read_b64_tr_b16 a[166:167], v241 offset:13856
    v_mfma_f32_16x16x32_bf16 v[204:207], a[168:171], v[80:83], v[204:207]
    ds_read_b128 v[76:79], v233 offset:26688
    v_mfma_f32_16x16x32_bf16 v[204:207], a[172:175], v[84:87], v[204:207]
    v_mfma_f32_16x16x32_bf16 v[224:227], a[176:179], v[80:83], v[224:227]
    v_mfma_f32_16x16x32_bf16 v[224:227], a[180:183], v[84:87], v[224:227]
    v_mfma_f32_16x16x32_bf16 v[228:231], a[184:187], v[80:83], v[228:231]
    v_mfma_f32_16x16x32_bf16 v[228:231], a[188:191], v[84:87], v[228:231]
    ds_read_b128 v[80:83], v232 offset:28736
    ds_read_b128 v[84:87], v233 offset:28736
    s_waitcnt lgkmcnt(3)
    v_mfma_f32_16x16x32_bf16 a[0:3], a[144:147], v[64:67], a[0:3]
    ds_read_b64_tr_b16 a[168:169], v241 offset:8
    buffer_load_dwordx4 v15, s[8:11], s35 offen offset:1024 lds
    v_mfma_f32_16x16x32_bf16 a[0:3], a[148:151], v[68:71], a[0:3]
    ds_read_b64_tr_b16 a[170:171], v241 offset:1544
    v_mfma_f32_16x16x32_bf16 a[4:7], a[152:155], v[64:67], a[4:7]
    ds_read_b64_tr_b16 a[172:173], v241 offset:12328
    v_mfma_f32_16x16x32_bf16 a[4:7], a[156:159], v[68:71], a[4:7]
    ds_read_b64_tr_b16 a[174:175], v241 offset:13864
    v_mfma_f32_16x16x32_bf16 a[24:27], a[160:163], v[64:67], a[24:27]
    ds_read_b64_tr_b16 a[176:177], v240 offset:128
    v_mfma_f32_16x16x32_bf16 a[24:27], a[164:167], v[68:71], a[24:27]
    ds_read_b64_tr_b16 a[178:179], v240 offset:1664
    v_mfma_f32_16x16x32_bf16 a[8:11], a[144:147], v[72:75], a[8:11]
    ds_read_b64_tr_b16 a[180:181], v240 offset:12448
    s_waitcnt lgkmcnt(9)
    v_mfma_f32_16x16x32_bf16 a[8:11], a[148:151], v[76:79], a[8:11]
    ds_read_b64_tr_b16 a[182:183], v240 offset:13984
    v_mfma_f32_16x16x32_bf16 a[12:15], a[152:155], v[72:75], a[12:15]
    ds_read_b64_tr_b16 a[184:185], v240 offset:136
    buffer_load_dwordx4 v16, s[8:11], s35 offen offset:2048 lds
    v_mfma_f32_16x16x32_bf16 a[12:15], a[156:159], v[76:79], a[12:15]
    ds_read_b64_tr_b16 a[186:187], v240 offset:1672
    v_mfma_f32_16x16x32_bf16 a[32:35], a[160:163], v[72:75], a[32:35]
    ds_read_b64_tr_b16 a[188:189], v240 offset:12456
    v_mfma_f32_16x16x32_bf16 a[32:35], a[164:167], v[76:79], a[32:35]
    ds_read_b64_tr_b16 a[190:191], v240 offset:13992
    s_waitcnt lgkmcnt(13)
    v_mfma_f32_16x16x32_bf16 a[16:19], a[144:147], v[80:83], a[16:19]
    s_waitcnt lgkmcnt(12)
    v_mfma_f32_16x16x32_bf16 a[16:19], a[148:151], v[84:87], a[16:19]
    v_mfma_f32_16x16x32_bf16 a[20:23], a[152:155], v[80:83], a[20:23]
    v_mfma_f32_16x16x32_bf16 a[20:23], a[156:159], v[84:87], a[20:23]
    v_mfma_f32_16x16x32_bf16 a[40:43], a[160:163], v[80:83], a[40:43]
    v_mfma_f32_16x16x32_bf16 a[40:43], a[164:167], v[84:87], a[40:43]
    s_add_u32 m0, s38, 3080
    s_waitcnt lgkmcnt(0)
    v_mfma_f32_16x16x32_bf16 a[28:31], a[168:171], v[64:67], a[28:31]
    ds_read_b64_tr_b16 a[144:145], v241 offset:128
    v_mfma_f32_16x16x32_bf16 a[28:31], a[172:175], v[68:71], a[28:31]
    ds_read_b64_tr_b16 a[146:147], v241 offset:1664
    v_mfma_f32_16x16x32_bf16 a[48:51], a[176:179], v[64:67], a[48:51]
    ds_read_b64_tr_b16 a[148:149], v241 offset:12448
    v_mfma_f32_16x16x32_bf16 a[48:51], a[180:183], v[68:71], a[48:51]
    ds_read_b64_tr_b16 a[150:151], v241 offset:13984
    v_mfma_f32_16x16x32_bf16 a[52:55], a[184:187], v[64:67], a[52:55]
    ds_read_b64_tr_b16 a[152:153], v241 offset:136
    v_mfma_f32_16x16x32_bf16 a[52:55], a[188:191], v[68:71], a[52:55]
    ds_read_b64_tr_b16 a[154:155], v241 offset:1672
    v_mfma_f32_16x16x32_bf16 a[36:39], a[168:171], v[72:75], a[36:39]
    ds_read_b64_tr_b16 a[156:157], v241 offset:12456
    v_mfma_f32_16x16x32_bf16 a[36:39], a[172:175], v[76:79], a[36:39]
    ds_read_b64_tr_b16 a[158:159], v241 offset:13992
    buffer_load_dwordx4 v17, s[8:11], s35 offen offset:0 lds
    v_mfma_f32_16x16x32_bf16 a[56:59], a[176:179], v[72:75], a[56:59]
    ds_read_b64_tr_b16 a[160:161], v240 offset:256
    v_mfma_f32_16x16x32_bf16 a[56:59], a[180:183], v[76:79], a[56:59]
    ds_read_b64_tr_b16 a[162:163], v240 offset:1792
    v_mfma_f32_16x16x32_bf16 a[60:63], a[184:187], v[72:75], a[60:63]
    ds_read_b64_tr_b16 a[164:165], v240 offset:12576
    v_mfma_f32_16x16x32_bf16 a[60:63], a[188:191], v[76:79], a[60:63]
    ds_read_b64_tr_b16 a[166:167], v240 offset:14112
    v_mfma_f32_16x16x32_bf16 a[44:47], a[168:171], v[80:83], a[44:47]
    v_mfma_f32_16x16x32_bf16 a[44:47], a[172:175], v[84:87], a[44:47]
    v_mfma_f32_16x16x32_bf16 a[64:67], a[176:179], v[80:83], a[64:67]
    v_mfma_f32_16x16x32_bf16 a[64:67], a[180:183], v[84:87], a[64:67]
    v_mfma_f32_16x16x32_bf16 a[68:71], a[184:187], v[80:83], a[68:71]
    buffer_load_dwordx4 v18, s[8:11], s35 offen offset:1024 lds
    v_mfma_f32_16x16x32_bf16 a[68:71], a[188:191], v[84:87], a[68:71]
    s_waitcnt lgkmcnt(0)
    v_mfma_f32_16x16x32_bf16 a[72:75], a[144:147], v[64:67], a[72:75]
    ds_read_b64_tr_b16 a[168:169], v240 offset:264
    v_mfma_f32_16x16x32_bf16 a[72:75], a[148:151], v[68:71], a[72:75]
    ds_read_b64_tr_b16 a[170:171], v240 offset:1800
    v_mfma_f32_16x16x32_bf16 a[76:79], a[152:155], v[64:67], a[76:79]
    ds_read_b64_tr_b16 a[172:173], v240 offset:12584
    v_mfma_f32_16x16x32_bf16 a[76:79], a[156:159], v[68:71], a[76:79]
    ds_read_b64_tr_b16 a[174:175], v240 offset:14120
    v_mfma_f32_16x16x32_bf16 a[96:99], a[160:163], v[64:67], a[96:99]
    ds_read_b64_tr_b16 a[176:177], v241 offset:256
    v_mfma_f32_16x16x32_bf16 a[96:99], a[164:167], v[68:71], a[96:99]
    ds_read_b64_tr_b16 a[178:179], v241 offset:1792
    v_mfma_f32_16x16x32_bf16 a[80:83], a[144:147], v[72:75], a[80:83]
    ds_read_b64_tr_b16 a[180:181], v241 offset:12576
    buffer_load_dwordx4 v19, s[8:11], s35 offen offset:2048 lds
    v_mfma_f32_16x16x32_bf16 a[80:83], a[148:151], v[76:79], a[80:83]
    ds_read_b64_tr_b16 a[182:183], v241 offset:14112
    v_mfma_f32_16x16x32_bf16 a[84:87], a[152:155], v[72:75], a[84:87]
    ds_read_b64_tr_b16 a[184:185], v241 offset:264
    v_mfma_f32_16x16x32_bf16 a[84:87], a[156:159], v[76:79], a[84:87]
    ds_read_b64_tr_b16 a[186:187], v241 offset:1800
    v_mfma_f32_16x16x32_bf16 a[104:107], a[160:163], v[72:75], a[104:107]
    ds_read_b64_tr_b16 a[188:189], v241 offset:12584
    v_mfma_f32_16x16x32_bf16 a[104:107], a[164:167], v[76:79], a[104:107]
    ds_read_b64_tr_b16 a[190:191], v241 offset:14120
    v_mfma_f32_16x16x32_bf16 a[88:91], a[144:147], v[80:83], a[88:91]
    v_mfma_f32_16x16x32_bf16 a[88:91], a[148:151], v[84:87], a[88:91]
    v_mfma_f32_16x16x32_bf16 a[92:95], a[152:155], v[80:83], a[92:95]
    v_mfma_f32_16x16x32_bf16 a[92:95], a[156:159], v[84:87], a[92:95]
    v_mfma_f32_16x16x32_bf16 a[112:115], a[160:163], v[80:83], a[112:115]
    v_mfma_f32_16x16x32_bf16 a[112:115], a[164:167], v[84:87], a[112:115]
    s_waitcnt vmcnt(18)
    s_waitcnt lgkmcnt(0)
    s_barrier
    v_mfma_f32_16x16x32_bf16 a[100:103], a[168:171], v[64:67], a[100:103]
    ds_read_b64_tr_b16 a[144:145], v240 offset:24640
    v_mfma_f32_16x16x32_bf16 a[100:103], a[172:175], v[68:71], a[100:103]
    ds_read_b64_tr_b16 a[146:147], v240 offset:26176
    s_add_u32 m0, s29, 24640
    s_mov_b32 s35, 1152
    v_mfma_f32_16x16x32_bf16 a[120:123], a[176:179], v[64:67], a[120:123]
    ds_read_b64_tr_b16 a[148:149], v240 offset:36960
    v_mfma_f32_16x16x32_bf16 a[120:123], a[180:183], v[68:71], a[120:123]
    ds_read_b64_tr_b16 a[150:151], v240 offset:38496
    v_mfma_f32_16x16x32_bf16 a[124:127], a[184:187], v[64:67], a[124:127]
    ds_read_b64_tr_b16 a[152:153], v240 offset:24648
    v_mfma_f32_16x16x32_bf16 a[124:127], a[188:191], v[68:71], a[124:127]
    ds_read_b64_tr_b16 a[154:155], v240 offset:26184
    buffer_load_dwordx4 v8, s[4:7], s35 offen offset:0 lds
    v_mfma_f32_16x16x32_bf16 a[108:111], a[168:171], v[72:75], a[108:111]
    ds_read_b64_tr_b16 a[156:157], v240 offset:36968
    v_mfma_f32_16x16x32_bf16 a[108:111], a[172:175], v[76:79], a[108:111]
    ds_read_b64_tr_b16 a[158:159], v240 offset:38504
    v_mfma_f32_16x16x32_bf16 a[128:131], a[176:179], v[72:75], a[128:131]
    ds_read_b64_tr_b16 a[160:161], v241 offset:24640
    v_mfma_f32_16x16x32_bf16 a[128:131], a[180:183], v[76:79], a[128:131]
    ds_read_b64_tr_b16 a[162:163], v241 offset:26176
    buffer_load_dwordx4 v9, s[4:7], s35 offen offset:1024 lds
    v_mfma_f32_16x16x32_bf16 a[132:135], a[184:187], v[72:75], a[132:135]
    ds_read_b64_tr_b16 a[164:165], v241 offset:36960
    v_mfma_f32_16x16x32_bf16 a[132:135], a[188:191], v[76:79], a[132:135]
    ds_read_b64_tr_b16 a[166:167], v241 offset:38496
    v_mfma_f32_16x16x32_bf16 a[116:119], a[168:171], v[80:83], a[116:119]
    v_mfma_f32_16x16x32_bf16 a[116:119], a[172:175], v[84:87], a[116:119]
    buffer_load_dwordx4 v10, s[4:7], s35 offen offset:2048 lds
    v_mfma_f32_16x16x32_bf16 a[136:139], a[176:179], v[80:83], a[136:139]
    v_mfma_f32_16x16x32_bf16 a[136:139], a[180:183], v[84:87], a[136:139]
    v_mfma_f32_16x16x32_bf16 a[140:143], a[184:187], v[80:83], a[140:143]
    v_mfma_f32_16x16x32_bf16 a[140:143], a[188:191], v[84:87], a[140:143]
    s_waitcnt lgkmcnt(0)
    v_mfma_f32_16x16x32_bf16 v[88:91], a[144:147], v[64:67], v[88:91]
    ds_read_b64_tr_b16 a[168:169], v241 offset:24648
    buffer_load_dwordx4 v11, s[4:7], s35 offen offset:3072 lds
    v_mfma_f32_16x16x32_bf16 v[88:91], a[148:151], v[68:71], v[88:91]
    ds_read_b64_tr_b16 a[170:171], v241 offset:26184
    v_mfma_f32_16x16x32_bf16 v[92:95], a[152:155], v[64:67], v[92:95]
    ds_read_b64_tr_b16 a[172:173], v241 offset:36968
    v_mfma_f32_16x16x32_bf16 v[92:95], a[156:159], v[68:71], v[92:95]
    ds_read_b64_tr_b16 a[174:175], v241 offset:38504
    v_mfma_f32_16x16x32_bf16 v[112:115], a[160:163], v[64:67], v[112:115]
    ds_read_b64_tr_b16 a[176:177], v240 offset:24768
    s_add_u32 m0, s29, 28736
    v_mfma_f32_16x16x32_bf16 v[112:115], a[164:167], v[68:71], v[112:115]
    ds_read_b64_tr_b16 a[178:179], v240 offset:26304
    v_mfma_f32_16x16x32_bf16 v[96:99], a[144:147], v[72:75], v[96:99]
    ds_read_b64_tr_b16 a[180:181], v240 offset:37088
    v_mfma_f32_16x16x32_bf16 v[96:99], a[148:151], v[76:79], v[96:99]
    ds_read_b64_tr_b16 a[182:183], v240 offset:38624
    v_mfma_f32_16x16x32_bf16 v[100:103], a[152:155], v[72:75], v[100:103]
    ds_read_b64_tr_b16 a[184:185], v240 offset:24776
    buffer_load_dwordx4 v12, s[4:7], s35 offen offset:0 lds
    v_mfma_f32_16x16x32_bf16 v[100:103], a[156:159], v[76:79], v[100:103]
    ds_read_b64_tr_b16 a[186:187], v240 offset:26312
    v_mfma_f32_16x16x32_bf16 v[120:123], a[160:163], v[72:75], v[120:123]
    ds_read_b64_tr_b16 a[188:189], v240 offset:37096
    v_mfma_f32_16x16x32_bf16 v[120:123], a[164:167], v[76:79], v[120:123]
    ds_read_b64_tr_b16 a[190:191], v240 offset:38632
    v_mfma_f32_16x16x32_bf16 v[104:107], a[144:147], v[80:83], v[104:107]
    buffer_load_dwordx4 v13, s[4:7], s35 offen offset:1024 lds
    v_mfma_f32_16x16x32_bf16 v[104:107], a[148:151], v[84:87], v[104:107]
    v_mfma_f32_16x16x32_bf16 v[108:111], a[152:155], v[80:83], v[108:111]
    v_mfma_f32_16x16x32_bf16 v[108:111], a[156:159], v[84:87], v[108:111]
    v_mfma_f32_16x16x32_bf16 v[128:131], a[160:163], v[80:83], v[128:131]
    v_mfma_f32_16x16x32_bf16 v[128:131], a[164:167], v[84:87], v[128:131]
    s_add_u32 m0, s38, 49280
    s_mov_b32 s36, 7079424
    s_waitcnt lgkmcnt(0)
    v_mfma_f32_16x16x32_bf16 v[116:119], a[168:171], v[64:67], v[116:119]
    ds_read_b64_tr_b16 a[144:145], v241 offset:24768
    v_mfma_f32_16x16x32_bf16 v[116:119], a[172:175], v[68:71], v[116:119]
    ds_read_b64_tr_b16 a[146:147], v241 offset:26304
    v_mfma_f32_16x16x32_bf16 v[136:139], a[176:179], v[64:67], v[136:139]
    ds_read_b64_tr_b16 a[148:149], v241 offset:37088
    v_mfma_f32_16x16x32_bf16 v[136:139], a[180:183], v[68:71], v[136:139]
    ds_read_b64_tr_b16 a[150:151], v241 offset:38624
    buffer_load_dwordx4 v14, s[8:11], s36 offen offset:0 lds
    v_mfma_f32_16x16x32_bf16 v[140:143], a[184:187], v[64:67], v[140:143]
    ds_read_b64_tr_b16 a[152:153], v241 offset:24776
    v_mfma_f32_16x16x32_bf16 v[140:143], a[188:191], v[68:71], v[140:143]
    ds_read_b64_tr_b16 a[154:155], v241 offset:26312
    v_mfma_f32_16x16x32_bf16 v[124:127], a[168:171], v[72:75], v[124:127]
    ds_read_b64_tr_b16 a[156:157], v241 offset:37096
    v_mfma_f32_16x16x32_bf16 v[124:127], a[172:175], v[76:79], v[124:127]
    ds_read_b64_tr_b16 a[158:159], v241 offset:38632
    buffer_load_dwordx4 v15, s[8:11], s36 offen offset:1024 lds
    v_mfma_f32_16x16x32_bf16 v[144:147], a[176:179], v[72:75], v[144:147]
    ds_read_b64_tr_b16 a[160:161], v240 offset:24896
    v_mfma_f32_16x16x32_bf16 v[144:147], a[180:183], v[76:79], v[144:147]
    ds_read_b64_tr_b16 a[162:163], v240 offset:26432
    v_mfma_f32_16x16x32_bf16 v[148:151], a[184:187], v[72:75], v[148:151]
    ds_read_b64_tr_b16 a[164:165], v240 offset:37216
    v_mfma_f32_16x16x32_bf16 v[148:151], a[188:191], v[76:79], v[148:151]
    ds_read_b64_tr_b16 a[166:167], v240 offset:38752
    buffer_load_dwordx4 v16, s[8:11], s36 offen offset:2048 lds
    v_mfma_f32_16x16x32_bf16 v[132:135], a[168:171], v[80:83], v[132:135]
    v_mfma_f32_16x16x32_bf16 v[132:135], a[172:175], v[84:87], v[132:135]
    v_mfma_f32_16x16x32_bf16 v[152:155], a[176:179], v[80:83], v[152:155]
    v_mfma_f32_16x16x32_bf16 v[152:155], a[180:183], v[84:87], v[152:155]
    v_mfma_f32_16x16x32_bf16 v[156:159], a[184:187], v[80:83], v[156:159]
    s_add_u32 m0, s38, 52360
    v_mfma_f32_16x16x32_bf16 v[156:159], a[188:191], v[84:87], v[156:159]
    s_waitcnt lgkmcnt(0)
    v_mfma_f32_16x16x32_bf16 v[160:163], a[144:147], v[64:67], v[160:163]
    ds_read_b64_tr_b16 a[168:169], v240 offset:24904
    v_mfma_f32_16x16x32_bf16 v[160:163], a[148:151], v[68:71], v[160:163]
    ds_read_b64_tr_b16 a[170:171], v240 offset:26440
    v_mfma_f32_16x16x32_bf16 v[164:167], a[152:155], v[64:67], v[164:167]
    ds_read_b64_tr_b16 a[172:173], v240 offset:37224
    buffer_load_dwordx4 v17, s[8:11], s36 offen offset:0 lds
    v_mfma_f32_16x16x32_bf16 v[164:167], a[156:159], v[68:71], v[164:167]
    ds_read_b64_tr_b16 a[174:175], v240 offset:38760
    v_mfma_f32_16x16x32_bf16 v[184:187], a[160:163], v[64:67], v[184:187]
    ds_read_b64_tr_b16 a[176:177], v241 offset:24896
    v_mfma_f32_16x16x32_bf16 v[184:187], a[164:167], v[68:71], v[184:187]
    ds_read_b64_tr_b16 a[178:179], v241 offset:26432
    v_mfma_f32_16x16x32_bf16 v[168:171], a[144:147], v[72:75], v[168:171]
    ds_read_b64_tr_b16 a[180:181], v241 offset:37216
    buffer_load_dwordx4 v18, s[8:11], s36 offen offset:1024 lds
    v_mfma_f32_16x16x32_bf16 v[168:171], a[148:151], v[76:79], v[168:171]
    ds_read_b64_tr_b16 a[182:183], v241 offset:38752
    v_mfma_f32_16x16x32_bf16 v[172:175], a[152:155], v[72:75], v[172:175]
    ds_read_b64_tr_b16 a[184:185], v241 offset:24904
    v_mfma_f32_16x16x32_bf16 v[172:175], a[156:159], v[76:79], v[172:175]
    ds_read_b64_tr_b16 a[186:187], v241 offset:26440
    v_mfma_f32_16x16x32_bf16 v[192:195], a[160:163], v[72:75], v[192:195]
    ds_read_b64_tr_b16 a[188:189], v241 offset:37224
    buffer_load_dwordx4 v19, s[8:11], s36 offen offset:2048 lds
    v_mfma_f32_16x16x32_bf16 v[192:195], a[164:167], v[76:79], v[192:195]
    ds_read_b64_tr_b16 a[190:191], v241 offset:38760
    v_mfma_f32_16x16x32_bf16 v[176:179], a[144:147], v[80:83], v[176:179]
    v_mfma_f32_16x16x32_bf16 v[176:179], a[148:151], v[84:87], v[176:179]
    v_mfma_f32_16x16x32_bf16 v[180:183], a[152:155], v[80:83], v[180:183]
    v_mfma_f32_16x16x32_bf16 v[180:183], a[156:159], v[84:87], v[180:183]
    v_mfma_f32_16x16x32_bf16 v[200:203], a[160:163], v[80:83], v[200:203]
    v_mfma_f32_16x16x32_bf16 v[200:203], a[164:167], v[84:87], v[200:203]
    s_waitcnt vmcnt(18)
    s_waitcnt lgkmcnt(0)
    s_barrier
    v_mfma_f32_16x16x32_bf16 v[188:191], a[168:171], v[64:67], v[188:191]
    ds_read_b64_tr_b16 a[144:145], v242 offset:24640
    v_mfma_f32_16x16x32_bf16 v[188:191], a[172:175], v[68:71], v[188:191]
    ds_read_b64_tr_b16 a[146:147], v242 offset:26176
    s_add_u32 m0, s38, 73920
    s_mov_b32 s35, 7077888
    v_mfma_f32_16x16x32_bf16 v[208:211], a[176:179], v[64:67], v[208:211]
    ds_read_b64_tr_b16 a[148:149], v242 offset:36960
    v_mfma_f32_16x16x32_bf16 v[208:211], a[180:183], v[68:71], v[208:211]
    ds_read_b64_tr_b16 a[150:151], v242 offset:38496
    v_mfma_f32_16x16x32_bf16 v[212:215], a[184:187], v[64:67], v[212:215]
    ds_read_b64_tr_b16 a[152:153], v242 offset:24648
    v_mfma_f32_16x16x32_bf16 v[212:215], a[188:191], v[68:71], v[212:215]
    ds_read_b128 v[64:67], v236 offset:0
    ds_read_b64_tr_b16 a[154:155], v242 offset:26184
    v_mfma_f32_16x16x32_bf16 v[196:199], a[168:171], v[72:75], v[196:199]
    ds_read_b128 v[68:71], v237 offset:0
    ds_read_b64_tr_b16 a[156:157], v242 offset:36968
    v_mfma_f32_16x16x32_bf16 v[196:199], a[172:175], v[76:79], v[196:199]
    ds_read_b64_tr_b16 a[158:159], v242 offset:38504
    v_mfma_f32_16x16x32_bf16 v[216:219], a[176:179], v[72:75], v[216:219]
    ds_read_b64_tr_b16 a[160:161], v243 offset:24640
    v_mfma_f32_16x16x32_bf16 v[216:219], a[180:183], v[76:79], v[216:219]
    ds_read_b64_tr_b16 a[162:163], v243 offset:26176
    buffer_load_dwordx4 v14, s[8:11], s35 offen offset:0 lds
    v_mfma_f32_16x16x32_bf16 v[220:223], a[184:187], v[72:75], v[220:223]
    ds_read_b64_tr_b16 a[164:165], v243 offset:36960
    v_mfma_f32_16x16x32_bf16 v[220:223], a[188:191], v[76:79], v[220:223]
    ds_read_b128 v[72:75], v236 offset:2048
    ds_read_b64_tr_b16 a[166:167], v243 offset:38496
    v_mfma_f32_16x16x32_bf16 v[204:207], a[168:171], v[80:83], v[204:207]
    ds_read_b128 v[76:79], v237 offset:2048
    v_mfma_f32_16x16x32_bf16 v[204:207], a[172:175], v[84:87], v[204:207]
    v_mfma_f32_16x16x32_bf16 v[224:227], a[176:179], v[80:83], v[224:227]
    v_mfma_f32_16x16x32_bf16 v[224:227], a[180:183], v[84:87], v[224:227]
    v_mfma_f32_16x16x32_bf16 v[228:231], a[184:187], v[80:83], v[228:231]
    v_mfma_f32_16x16x32_bf16 v[228:231], a[188:191], v[84:87], v[228:231]
    ds_read_b128 v[80:83], v236 offset:4096
    ds_read_b128 v[84:87], v237 offset:4096
    s_waitcnt lgkmcnt(3)
    v_mfma_f32_16x16x32_bf16 a[0:3], a[144:147], v[64:67], a[0:3]
    ds_read_b64_tr_b16 a[168:169], v243 offset:24648
    buffer_load_dwordx4 v15, s[8:11], s35 offen offset:1024 lds
    v_mfma_f32_16x16x32_bf16 a[0:3], a[148:151], v[68:71], a[0:3]
    ds_read_b64_tr_b16 a[170:171], v243 offset:26184
    v_mfma_f32_16x16x32_bf16 a[4:7], a[152:155], v[64:67], a[4:7]
    ds_read_b64_tr_b16 a[172:173], v243 offset:36968
    v_mfma_f32_16x16x32_bf16 a[4:7], a[156:159], v[68:71], a[4:7]
    ds_read_b64_tr_b16 a[174:175], v243 offset:38504
    v_mfma_f32_16x16x32_bf16 a[24:27], a[160:163], v[64:67], a[24:27]
    ds_read_b64_tr_b16 a[176:177], v242 offset:24768
    v_mfma_f32_16x16x32_bf16 a[24:27], a[164:167], v[68:71], a[24:27]
    ds_read_b64_tr_b16 a[178:179], v242 offset:26304
    v_mfma_f32_16x16x32_bf16 a[8:11], a[144:147], v[72:75], a[8:11]
    ds_read_b64_tr_b16 a[180:181], v242 offset:37088
    s_waitcnt lgkmcnt(9)
    v_mfma_f32_16x16x32_bf16 a[8:11], a[148:151], v[76:79], a[8:11]
    ds_read_b64_tr_b16 a[182:183], v242 offset:38624
    v_mfma_f32_16x16x32_bf16 a[12:15], a[152:155], v[72:75], a[12:15]
    ds_read_b64_tr_b16 a[184:185], v242 offset:24776
    buffer_load_dwordx4 v16, s[8:11], s35 offen offset:2048 lds
    v_mfma_f32_16x16x32_bf16 a[12:15], a[156:159], v[76:79], a[12:15]
    ds_read_b64_tr_b16 a[186:187], v242 offset:26312
    v_mfma_f32_16x16x32_bf16 a[32:35], a[160:163], v[72:75], a[32:35]
    ds_read_b64_tr_b16 a[188:189], v242 offset:37096
    v_mfma_f32_16x16x32_bf16 a[32:35], a[164:167], v[76:79], a[32:35]
    ds_read_b64_tr_b16 a[190:191], v242 offset:38632
    s_waitcnt lgkmcnt(13)
    v_mfma_f32_16x16x32_bf16 a[16:19], a[144:147], v[80:83], a[16:19]
    s_waitcnt lgkmcnt(12)
    v_mfma_f32_16x16x32_bf16 a[16:19], a[148:151], v[84:87], a[16:19]
    v_mfma_f32_16x16x32_bf16 a[20:23], a[152:155], v[80:83], a[20:23]
    v_mfma_f32_16x16x32_bf16 a[20:23], a[156:159], v[84:87], a[20:23]
    v_mfma_f32_16x16x32_bf16 a[40:43], a[160:163], v[80:83], a[40:43]
    v_mfma_f32_16x16x32_bf16 a[40:43], a[164:167], v[84:87], a[40:43]
    s_add_u32 m0, s38, 77000
    s_waitcnt lgkmcnt(0)
    v_mfma_f32_16x16x32_bf16 a[28:31], a[168:171], v[64:67], a[28:31]
    ds_read_b64_tr_b16 a[144:145], v243 offset:24768
    v_mfma_f32_16x16x32_bf16 a[28:31], a[172:175], v[68:71], a[28:31]
    ds_read_b64_tr_b16 a[146:147], v243 offset:26304
    v_mfma_f32_16x16x32_bf16 a[48:51], a[176:179], v[64:67], a[48:51]
    ds_read_b64_tr_b16 a[148:149], v243 offset:37088
    v_mfma_f32_16x16x32_bf16 a[48:51], a[180:183], v[68:71], a[48:51]
    ds_read_b64_tr_b16 a[150:151], v243 offset:38624
    v_mfma_f32_16x16x32_bf16 a[52:55], a[184:187], v[64:67], a[52:55]
    ds_read_b64_tr_b16 a[152:153], v243 offset:24776
    v_mfma_f32_16x16x32_bf16 a[52:55], a[188:191], v[68:71], a[52:55]
    ds_read_b64_tr_b16 a[154:155], v243 offset:26312
    v_mfma_f32_16x16x32_bf16 a[36:39], a[168:171], v[72:75], a[36:39]
    ds_read_b64_tr_b16 a[156:157], v243 offset:37096
    v_mfma_f32_16x16x32_bf16 a[36:39], a[172:175], v[76:79], a[36:39]
    ds_read_b64_tr_b16 a[158:159], v243 offset:38632
    buffer_load_dwordx4 v17, s[8:11], s35 offen offset:0 lds
    v_mfma_f32_16x16x32_bf16 a[56:59], a[176:179], v[72:75], a[56:59]
    ds_read_b64_tr_b16 a[160:161], v242 offset:24896
    v_mfma_f32_16x16x32_bf16 a[56:59], a[180:183], v[76:79], a[56:59]
    ds_read_b64_tr_b16 a[162:163], v242 offset:26432
    v_mfma_f32_16x16x32_bf16 a[60:63], a[184:187], v[72:75], a[60:63]
    ds_read_b64_tr_b16 a[164:165], v242 offset:37216
    v_mfma_f32_16x16x32_bf16 a[60:63], a[188:191], v[76:79], a[60:63]
    ds_read_b64_tr_b16 a[166:167], v242 offset:38752
    v_mfma_f32_16x16x32_bf16 a[44:47], a[168:171], v[80:83], a[44:47]
    v_mfma_f32_16x16x32_bf16 a[44:47], a[172:175], v[84:87], a[44:47]
    v_mfma_f32_16x16x32_bf16 a[64:67], a[176:179], v[80:83], a[64:67]
    v_mfma_f32_16x16x32_bf16 a[64:67], a[180:183], v[84:87], a[64:67]
    v_mfma_f32_16x16x32_bf16 a[68:71], a[184:187], v[80:83], a[68:71]
    buffer_load_dwordx4 v18, s[8:11], s35 offen offset:1024 lds
    v_mfma_f32_16x16x32_bf16 a[68:71], a[188:191], v[84:87], a[68:71]
    s_waitcnt lgkmcnt(0)
    v_mfma_f32_16x16x32_bf16 a[72:75], a[144:147], v[64:67], a[72:75]
    ds_read_b64_tr_b16 a[168:169], v242 offset:24904
    v_mfma_f32_16x16x32_bf16 a[72:75], a[148:151], v[68:71], a[72:75]
    ds_read_b64_tr_b16 a[170:171], v242 offset:26440
    v_mfma_f32_16x16x32_bf16 a[76:79], a[152:155], v[64:67], a[76:79]
    ds_read_b64_tr_b16 a[172:173], v242 offset:37224
    v_mfma_f32_16x16x32_bf16 a[76:79], a[156:159], v[68:71], a[76:79]
    ds_read_b64_tr_b16 a[174:175], v242 offset:38760
    v_mfma_f32_16x16x32_bf16 a[96:99], a[160:163], v[64:67], a[96:99]
    ds_read_b64_tr_b16 a[176:177], v243 offset:24896
    v_mfma_f32_16x16x32_bf16 a[96:99], a[164:167], v[68:71], a[96:99]
    ds_read_b64_tr_b16 a[178:179], v243 offset:26432
    v_mfma_f32_16x16x32_bf16 a[80:83], a[144:147], v[72:75], a[80:83]
    ds_read_b64_tr_b16 a[180:181], v243 offset:37216
    buffer_load_dwordx4 v19, s[8:11], s35 offen offset:2048 lds
    v_mfma_f32_16x16x32_bf16 a[80:83], a[148:151], v[76:79], a[80:83]
    ds_read_b64_tr_b16 a[182:183], v243 offset:38752
    v_mfma_f32_16x16x32_bf16 a[84:87], a[152:155], v[72:75], a[84:87]
    ds_read_b64_tr_b16 a[184:185], v243 offset:24904
    v_mfma_f32_16x16x32_bf16 a[84:87], a[156:159], v[76:79], a[84:87]
    ds_read_b64_tr_b16 a[186:187], v243 offset:26440
    v_mfma_f32_16x16x32_bf16 a[104:107], a[160:163], v[72:75], a[104:107]
    ds_read_b64_tr_b16 a[188:189], v243 offset:37224
    v_mfma_f32_16x16x32_bf16 a[104:107], a[164:167], v[76:79], a[104:107]
    ds_read_b64_tr_b16 a[190:191], v243 offset:38760
    v_mfma_f32_16x16x32_bf16 a[88:91], a[144:147], v[80:83], a[88:91]
    v_mfma_f32_16x16x32_bf16 a[88:91], a[148:151], v[84:87], a[88:91]
    v_mfma_f32_16x16x32_bf16 a[92:95], a[152:155], v[80:83], a[92:95]
    v_mfma_f32_16x16x32_bf16 a[92:95], a[156:159], v[84:87], a[92:95]
    v_mfma_f32_16x16x32_bf16 a[112:115], a[160:163], v[80:83], a[112:115]
    v_mfma_f32_16x16x32_bf16 a[112:115], a[164:167], v[84:87], a[112:115]
    s_waitcnt vmcnt(18)
    s_waitcnt lgkmcnt(0)
    s_barrier
    v_mfma_f32_16x16x32_bf16 a[100:103], a[168:171], v[64:67], a[100:103]
    ds_read_b64_tr_b16 a[144:145], v238 offset:0
    v_mfma_f32_16x16x32_bf16 a[100:103], a[172:175], v[68:71], a[100:103]
    ds_read_b64_tr_b16 a[146:147], v238 offset:1536
    s_add_u32 m0, s29, 98560
    s_mov_b32 s35, 0
    v_mfma_f32_16x16x32_bf16 a[120:123], a[176:179], v[64:67], a[120:123]
    ds_read_b64_tr_b16 a[148:149], v238 offset:12320
    v_mfma_f32_16x16x32_bf16 a[120:123], a[180:183], v[68:71], a[120:123]
    ds_read_b64_tr_b16 a[150:151], v238 offset:13856
    v_mfma_f32_16x16x32_bf16 a[124:127], a[184:187], v[64:67], a[124:127]
    ds_read_b64_tr_b16 a[152:153], v238 offset:8
    v_mfma_f32_16x16x32_bf16 a[124:127], a[188:191], v[68:71], a[124:127]
    ds_read_b64_tr_b16 a[154:155], v238 offset:1544
    buffer_load_dwordx4 v20, s[12:15], s35 offen offset:0 nt lds
    v_mfma_f32_16x16x32_bf16 a[108:111], a[168:171], v[72:75], a[108:111]
    ds_read_b64_tr_b16 a[156:157], v238 offset:12328
    v_mfma_f32_16x16x32_bf16 a[108:111], a[172:175], v[76:79], a[108:111]
    ds_read_b64_tr_b16 a[158:159], v238 offset:13864
    v_mfma_f32_16x16x32_bf16 a[128:131], a[176:179], v[72:75], a[128:131]
    ds_read_b64_tr_b16 a[160:161], v239 offset:0
    v_mfma_f32_16x16x32_bf16 a[128:131], a[180:183], v[76:79], a[128:131]
    ds_read_b64_tr_b16 a[162:163], v239 offset:1536
    buffer_load_dwordx4 v21, s[12:15], s35 offen offset:1024 nt lds
    v_mfma_f32_16x16x32_bf16 a[132:135], a[184:187], v[72:75], a[132:135]
    ds_read_b64_tr_b16 a[164:165], v239 offset:12320
    v_mfma_f32_16x16x32_bf16 a[132:135], a[188:191], v[76:79], a[132:135]
    ds_read_b64_tr_b16 a[166:167], v239 offset:13856
    v_mfma_f32_16x16x32_bf16 a[116:119], a[168:171], v[80:83], a[116:119]
    v_mfma_f32_16x16x32_bf16 a[116:119], a[172:175], v[84:87], a[116:119]
    buffer_load_dwordx4 v22, s[12:15], s35 offen offset:2048 nt lds
    v_mfma_f32_16x16x32_bf16 a[136:139], a[176:179], v[80:83], a[136:139]
    v_mfma_f32_16x16x32_bf16 a[136:139], a[180:183], v[84:87], a[136:139]
    v_mfma_f32_16x16x32_bf16 a[140:143], a[184:187], v[80:83], a[140:143]
    v_mfma_f32_16x16x32_bf16 a[140:143], a[188:191], v[84:87], a[140:143]
    s_waitcnt lgkmcnt(0)
    v_mfma_f32_16x16x32_bf16 v[88:91], a[144:147], v[64:67], v[88:91]
    ds_read_b64_tr_b16 a[168:169], v239 offset:8
    buffer_load_dwordx4 v23, s[12:15], s35 offen offset:3072 nt lds
    v_mfma_f32_16x16x32_bf16 v[88:91], a[148:151], v[68:71], v[88:91]
    ds_read_b64_tr_b16 a[170:171], v239 offset:1544
    v_mfma_f32_16x16x32_bf16 v[92:95], a[152:155], v[64:67], v[92:95]
    ds_read_b64_tr_b16 a[172:173], v239 offset:12328
    v_mfma_f32_16x16x32_bf16 v[92:95], a[156:159], v[68:71], v[92:95]
    ds_read_b64_tr_b16 a[174:175], v239 offset:13864
    v_mfma_f32_16x16x32_bf16 v[112:115], a[160:163], v[64:67], v[112:115]
    ds_read_b64_tr_b16 a[176:177], v238 offset:128
    s_add_u32 m0, s29, 102656
    v_mfma_f32_16x16x32_bf16 v[112:115], a[164:167], v[68:71], v[112:115]
    ds_read_b64_tr_b16 a[178:179], v238 offset:1664
    v_mfma_f32_16x16x32_bf16 v[96:99], a[144:147], v[72:75], v[96:99]
    ds_read_b64_tr_b16 a[180:181], v238 offset:12448
    v_mfma_f32_16x16x32_bf16 v[96:99], a[148:151], v[76:79], v[96:99]
    ds_read_b64_tr_b16 a[182:183], v238 offset:13984
    v_mfma_f32_16x16x32_bf16 v[100:103], a[152:155], v[72:75], v[100:103]
    ds_read_b64_tr_b16 a[184:185], v238 offset:136
    buffer_load_dwordx4 v24, s[12:15], s35 offen offset:0 nt lds
    v_mfma_f32_16x16x32_bf16 v[100:103], a[156:159], v[76:79], v[100:103]
    ds_read_b64_tr_b16 a[186:187], v238 offset:1672
    v_mfma_f32_16x16x32_bf16 v[120:123], a[160:163], v[72:75], v[120:123]
    ds_read_b64_tr_b16 a[188:189], v238 offset:12456
    v_mfma_f32_16x16x32_bf16 v[120:123], a[164:167], v[76:79], v[120:123]
    ds_read_b64_tr_b16 a[190:191], v238 offset:13992
    v_mfma_f32_16x16x32_bf16 v[104:107], a[144:147], v[80:83], v[104:107]
    buffer_load_dwordx4 v25, s[12:15], s35 offen offset:1024 nt lds
    v_mfma_f32_16x16x32_bf16 v[104:107], a[148:151], v[84:87], v[104:107]
    v_mfma_f32_16x16x32_bf16 v[108:111], a[152:155], v[80:83], v[108:111]
    v_mfma_f32_16x16x32_bf16 v[108:111], a[156:159], v[84:87], v[108:111]
    v_mfma_f32_16x16x32_bf16 v[128:131], a[160:163], v[80:83], v[128:131]
    v_mfma_f32_16x16x32_bf16 v[128:131], a[164:167], v[84:87], v[128:131]
    s_add_u32 m0, s29, 123200
    s_mov_b32 s36, 24576
    s_waitcnt lgkmcnt(0)
    v_mfma_f32_16x16x32_bf16 v[116:119], a[168:171], v[64:67], v[116:119]
    ds_read_b64_tr_b16 a[144:145], v239 offset:128
    v_mfma_f32_16x16x32_bf16 v[116:119], a[172:175], v[68:71], v[116:119]
    ds_read_b64_tr_b16 a[146:147], v239 offset:1664
    v_mfma_f32_16x16x32_bf16 v[136:139], a[176:179], v[64:67], v[136:139]
    ds_read_b64_tr_b16 a[148:149], v239 offset:12448
    v_mfma_f32_16x16x32_bf16 v[136:139], a[180:183], v[68:71], v[136:139]
    ds_read_b64_tr_b16 a[150:151], v239 offset:13984
    buffer_load_dwordx4 v20, s[12:15], s36 offen offset:0 nt lds
    v_mfma_f32_16x16x32_bf16 v[140:143], a[184:187], v[64:67], v[140:143]
    ds_read_b64_tr_b16 a[152:153], v239 offset:136
    v_mfma_f32_16x16x32_bf16 v[140:143], a[188:191], v[68:71], v[140:143]
    ds_read_b64_tr_b16 a[154:155], v239 offset:1672
    v_mfma_f32_16x16x32_bf16 v[124:127], a[168:171], v[72:75], v[124:127]
    ds_read_b64_tr_b16 a[156:157], v239 offset:12456
    v_mfma_f32_16x16x32_bf16 v[124:127], a[172:175], v[76:79], v[124:127]
    ds_read_b64_tr_b16 a[158:159], v239 offset:13992
    buffer_load_dwordx4 v21, s[12:15], s36 offen offset:1024 nt lds
    v_mfma_f32_16x16x32_bf16 v[144:147], a[176:179], v[72:75], v[144:147]
    ds_read_b64_tr_b16 a[160:161], v238 offset:256
    v_mfma_f32_16x16x32_bf16 v[144:147], a[180:183], v[76:79], v[144:147]
    ds_read_b64_tr_b16 a[162:163], v238 offset:1792
    v_mfma_f32_16x16x32_bf16 v[148:151], a[184:187], v[72:75], v[148:151]
    ds_read_b64_tr_b16 a[164:165], v238 offset:12576
    v_mfma_f32_16x16x32_bf16 v[148:151], a[188:191], v[76:79], v[148:151]
    ds_read_b64_tr_b16 a[166:167], v238 offset:14112
    buffer_load_dwordx4 v22, s[12:15], s36 offen offset:2048 nt lds
    v_mfma_f32_16x16x32_bf16 v[132:135], a[168:171], v[80:83], v[132:135]
    v_mfma_f32_16x16x32_bf16 v[132:135], a[172:175], v[84:87], v[132:135]
    v_mfma_f32_16x16x32_bf16 v[152:155], a[176:179], v[80:83], v[152:155]
    v_mfma_f32_16x16x32_bf16 v[152:155], a[180:183], v[84:87], v[152:155]
    v_mfma_f32_16x16x32_bf16 v[156:159], a[184:187], v[80:83], v[156:159]
    buffer_load_dwordx4 v23, s[12:15], s36 offen offset:3072 nt lds
    v_mfma_f32_16x16x32_bf16 v[156:159], a[188:191], v[84:87], v[156:159]
    s_waitcnt lgkmcnt(0)
    v_mfma_f32_16x16x32_bf16 v[160:163], a[144:147], v[64:67], v[160:163]
    ds_read_b64_tr_b16 a[168:169], v238 offset:264
    v_mfma_f32_16x16x32_bf16 v[160:163], a[148:151], v[68:71], v[160:163]
    ds_read_b64_tr_b16 a[170:171], v238 offset:1800
    v_mfma_f32_16x16x32_bf16 v[164:167], a[152:155], v[64:67], v[164:167]
    ds_read_b64_tr_b16 a[172:173], v238 offset:12584
    s_add_u32 m0, s29, 127296
    v_mfma_f32_16x16x32_bf16 v[164:167], a[156:159], v[68:71], v[164:167]
    ds_read_b64_tr_b16 a[174:175], v238 offset:14120
    v_mfma_f32_16x16x32_bf16 v[184:187], a[160:163], v[64:67], v[184:187]
    ds_read_b64_tr_b16 a[176:177], v239 offset:256
    v_mfma_f32_16x16x32_bf16 v[184:187], a[164:167], v[68:71], v[184:187]
    ds_read_b64_tr_b16 a[178:179], v239 offset:1792
    v_mfma_f32_16x16x32_bf16 v[168:171], a[144:147], v[72:75], v[168:171]
    ds_read_b64_tr_b16 a[180:181], v239 offset:12576
    buffer_load_dwordx4 v24, s[12:15], s36 offen offset:0 nt lds
    v_mfma_f32_16x16x32_bf16 v[168:171], a[148:151], v[76:79], v[168:171]
    ds_read_b64_tr_b16 a[182:183], v239 offset:14112
    v_mfma_f32_16x16x32_bf16 v[172:175], a[152:155], v[72:75], v[172:175]
    ds_read_b64_tr_b16 a[184:185], v239 offset:264
    v_mfma_f32_16x16x32_bf16 v[172:175], a[156:159], v[76:79], v[172:175]
    ds_read_b64_tr_b16 a[186:187], v239 offset:1800
    v_mfma_f32_16x16x32_bf16 v[192:195], a[160:163], v[72:75], v[192:195]
    ds_read_b64_tr_b16 a[188:189], v239 offset:12584
    buffer_load_dwordx4 v25, s[12:15], s36 offen offset:1024 nt lds
    v_mfma_f32_16x16x32_bf16 v[192:195], a[164:167], v[76:79], v[192:195]
    ds_read_b64_tr_b16 a[190:191], v239 offset:14120
    v_mfma_f32_16x16x32_bf16 v[176:179], a[144:147], v[80:83], v[176:179]
    v_mfma_f32_16x16x32_bf16 v[176:179], a[148:151], v[84:87], v[176:179]
    v_mfma_f32_16x16x32_bf16 v[180:183], a[152:155], v[80:83], v[180:183]
    v_mfma_f32_16x16x32_bf16 v[180:183], a[156:159], v[84:87], v[180:183]
    v_mfma_f32_16x16x32_bf16 v[200:203], a[160:163], v[80:83], v[200:203]
    v_mfma_f32_16x16x32_bf16 v[200:203], a[164:167], v[84:87], v[200:203]
    s_waitcnt vmcnt(18)
    s_waitcnt lgkmcnt(0)
    s_barrier
    v_mfma_f32_16x16x32_bf16 v[188:191], a[168:171], v[64:67], v[188:191]
    ds_read_b64_tr_b16 a[144:145], v240 offset:0
    v_mfma_f32_16x16x32_bf16 v[188:191], a[172:175], v[68:71], v[188:191]
    ds_read_b64_tr_b16 a[146:147], v240 offset:1536
    s_add_u32 m0, s29, 0
    s_mov_b32 s35, 0
    v_mfma_f32_16x16x32_bf16 v[208:211], a[176:179], v[64:67], v[208:211]
    ds_read_b64_tr_b16 a[148:149], v240 offset:12320
    v_mfma_f32_16x16x32_bf16 v[208:211], a[180:183], v[68:71], v[208:211]
    ds_read_b64_tr_b16 a[150:151], v240 offset:13856
    v_mfma_f32_16x16x32_bf16 v[212:215], a[184:187], v[64:67], v[212:215]
    ds_read_b64_tr_b16 a[152:153], v240 offset:8
    v_mfma_f32_16x16x32_bf16 v[212:215], a[188:191], v[68:71], v[212:215]
    ds_read_b128 v[64:67], v232 offset:24640
    ds_read_b64_tr_b16 a[154:155], v240 offset:1544
    v_mfma_f32_16x16x32_bf16 v[196:199], a[168:171], v[72:75], v[196:199]
    ds_read_b128 v[68:71], v233 offset:24640
    ds_read_b64_tr_b16 a[156:157], v240 offset:12328
    v_mfma_f32_16x16x32_bf16 v[196:199], a[172:175], v[76:79], v[196:199]
    ds_read_b64_tr_b16 a[158:159], v240 offset:13864
    v_mfma_f32_16x16x32_bf16 v[216:219], a[176:179], v[72:75], v[216:219]
    ds_read_b64_tr_b16 a[160:161], v241 offset:0
    v_mfma_f32_16x16x32_bf16 v[216:219], a[180:183], v[76:79], v[216:219]
    ds_read_b64_tr_b16 a[162:163], v241 offset:1536
    buffer_load_dwordx4 v26, s[16:19], s35 offen offset:0 nt lds
    v_mfma_f32_16x16x32_bf16 v[220:223], a[184:187], v[72:75], v[220:223]
    ds_read_b64_tr_b16 a[164:165], v241 offset:12320
    v_mfma_f32_16x16x32_bf16 v[220:223], a[188:191], v[76:79], v[220:223]
    ds_read_b128 v[72:75], v232 offset:26688
    ds_read_b64_tr_b16 a[166:167], v241 offset:13856
    v_mfma_f32_16x16x32_bf16 v[204:207], a[168:171], v[80:83], v[204:207]
    ds_read_b128 v[76:79], v233 offset:26688
    v_mfma_f32_16x16x32_bf16 v[204:207], a[172:175], v[84:87], v[204:207]
    v_mfma_f32_16x16x32_bf16 v[224:227], a[176:179], v[80:83], v[224:227]
    v_mfma_f32_16x16x32_bf16 v[224:227], a[180:183], v[84:87], v[224:227]
    v_mfma_f32_16x16x32_bf16 v[228:231], a[184:187], v[80:83], v[228:231]
    v_mfma_f32_16x16x32_bf16 v[228:231], a[188:191], v[84:87], v[228:231]
    ds_read_b128 v[80:83], v232 offset:28736
    ds_read_b128 v[84:87], v233 offset:28736
    s_waitcnt lgkmcnt(3)
    v_mfma_f32_16x16x32_bf16 a[0:3], a[144:147], v[64:67], a[0:3]
    ds_read_b64_tr_b16 a[168:169], v241 offset:8
    buffer_load_dwordx4 v27, s[16:19], s35 offen offset:1024 nt lds
    v_mfma_f32_16x16x32_bf16 a[0:3], a[148:151], v[68:71], a[0:3]
    ds_read_b64_tr_b16 a[170:171], v241 offset:1544
    v_mfma_f32_16x16x32_bf16 a[4:7], a[152:155], v[64:67], a[4:7]
    ds_read_b64_tr_b16 a[172:173], v241 offset:12328
    v_mfma_f32_16x16x32_bf16 a[4:7], a[156:159], v[68:71], a[4:7]
    ds_read_b64_tr_b16 a[174:175], v241 offset:13864
    v_mfma_f32_16x16x32_bf16 a[24:27], a[160:163], v[64:67], a[24:27]
    ds_read_b64_tr_b16 a[176:177], v240 offset:128
    v_mfma_f32_16x16x32_bf16 a[24:27], a[164:167], v[68:71], a[24:27]
    ds_read_b64_tr_b16 a[178:179], v240 offset:1664
    v_mfma_f32_16x16x32_bf16 a[8:11], a[144:147], v[72:75], a[8:11]
    ds_read_b64_tr_b16 a[180:181], v240 offset:12448
    s_waitcnt lgkmcnt(9)
    v_mfma_f32_16x16x32_bf16 a[8:11], a[148:151], v[76:79], a[8:11]
    ds_read_b64_tr_b16 a[182:183], v240 offset:13984
    v_mfma_f32_16x16x32_bf16 a[12:15], a[152:155], v[72:75], a[12:15]
    ds_read_b64_tr_b16 a[184:185], v240 offset:136
    buffer_load_dwordx4 v28, s[16:19], s35 offen offset:2048 nt lds
    v_mfma_f32_16x16x32_bf16 a[12:15], a[156:159], v[76:79], a[12:15]
    ds_read_b64_tr_b16 a[186:187], v240 offset:1672
    v_mfma_f32_16x16x32_bf16 a[32:35], a[160:163], v[72:75], a[32:35]
    ds_read_b64_tr_b16 a[188:189], v240 offset:12456
    v_mfma_f32_16x16x32_bf16 a[32:35], a[164:167], v[76:79], a[32:35]
    ds_read_b64_tr_b16 a[190:191], v240 offset:13992
    s_waitcnt lgkmcnt(13)
    v_mfma_f32_16x16x32_bf16 a[16:19], a[144:147], v[80:83], a[16:19]
    s_waitcnt lgkmcnt(12)
    v_mfma_f32_16x16x32_bf16 a[16:19], a[148:151], v[84:87], a[16:19]
    v_mfma_f32_16x16x32_bf16 a[20:23], a[152:155], v[80:83], a[20:23]
    v_mfma_f32_16x16x32_bf16 a[20:23], a[156:159], v[84:87], a[20:23]
    v_mfma_f32_16x16x32_bf16 a[40:43], a[160:163], v[80:83], a[40:43]
    v_mfma_f32_16x16x32_bf16 a[40:43], a[164:167], v[84:87], a[40:43]
    buffer_load_dwordx4 v29, s[16:19], s35 offen offset:3072 nt lds
    s_waitcnt lgkmcnt(0)
    v_mfma_f32_16x16x32_bf16 a[28:31], a[168:171], v[64:67], a[28:31]
    ds_read_b64_tr_b16 a[144:145], v241 offset:128
    v_mfma_f32_16x16x32_bf16 a[28:31], a[172:175], v[68:71], a[28:31]
    ds_read_b64_tr_b16 a[146:147], v241 offset:1664
    v_mfma_f32_16x16x32_bf16 a[48:51], a[176:179], v[64:67], a[48:51]
    ds_read_b64_tr_b16 a[148:149], v241 offset:12448
    v_mfma_f32_16x16x32_bf16 a[48:51], a[180:183], v[68:71], a[48:51]
    ds_read_b64_tr_b16 a[150:151], v241 offset:13984
    v_mfma_f32_16x16x32_bf16 a[52:55], a[184:187], v[64:67], a[52:55]
    ds_read_b64_tr_b16 a[152:153], v241 offset:136
    v_mfma_f32_16x16x32_bf16 a[52:55], a[188:191], v[68:71], a[52:55]
    ds_read_b64_tr_b16 a[154:155], v241 offset:1672
    v_mfma_f32_16x16x32_bf16 a[36:39], a[168:171], v[72:75], a[36:39]
    ds_read_b64_tr_b16 a[156:157], v241 offset:12456
    v_mfma_f32_16x16x32_bf16 a[36:39], a[172:175], v[76:79], a[36:39]
    ds_read_b64_tr_b16 a[158:159], v241 offset:13992
    s_add_u32 m0, s29, 4096
    v_mfma_f32_16x16x32_bf16 a[56:59], a[176:179], v[72:75], a[56:59]
    ds_read_b64_tr_b16 a[160:161], v240 offset:256
    v_mfma_f32_16x16x32_bf16 a[56:59], a[180:183], v[76:79], a[56:59]
    ds_read_b64_tr_b16 a[162:163], v240 offset:1792
    v_mfma_f32_16x16x32_bf16 a[60:63], a[184:187], v[72:75], a[60:63]
    ds_read_b64_tr_b16 a[164:165], v240 offset:12576
    v_mfma_f32_16x16x32_bf16 a[60:63], a[188:191], v[76:79], a[60:63]
    ds_read_b64_tr_b16 a[166:167], v240 offset:14112
    v_mfma_f32_16x16x32_bf16 a[44:47], a[168:171], v[80:83], a[44:47]
    v_mfma_f32_16x16x32_bf16 a[44:47], a[172:175], v[84:87], a[44:47]
    v_mfma_f32_16x16x32_bf16 a[64:67], a[176:179], v[80:83], a[64:67]
    v_mfma_f32_16x16x32_bf16 a[64:67], a[180:183], v[84:87], a[64:67]
    v_mfma_f32_16x16x32_bf16 a[68:71], a[184:187], v[80:83], a[68:71]
    buffer_load_dwordx4 v30, s[16:19], s35 offen offset:0 nt lds
    v_mfma_f32_16x16x32_bf16 a[68:71], a[188:191], v[84:87], a[68:71]
    s_waitcnt lgkmcnt(0)
    v_mfma_f32_16x16x32_bf16 a[72:75], a[144:147], v[64:67], a[72:75]
    ds_read_b64_tr_b16 a[168:169], v240 offset:264
    v_mfma_f32_16x16x32_bf16 a[72:75], a[148:151], v[68:71], a[72:75]
    ds_read_b64_tr_b16 a[170:171], v240 offset:1800
    v_mfma_f32_16x16x32_bf16 a[76:79], a[152:155], v[64:67], a[76:79]
    ds_read_b64_tr_b16 a[172:173], v240 offset:12584
    v_mfma_f32_16x16x32_bf16 a[76:79], a[156:159], v[68:71], a[76:79]
    ds_read_b64_tr_b16 a[174:175], v240 offset:14120
    v_mfma_f32_16x16x32_bf16 a[96:99], a[160:163], v[64:67], a[96:99]
    ds_read_b64_tr_b16 a[176:177], v241 offset:256
    v_mfma_f32_16x16x32_bf16 a[96:99], a[164:167], v[68:71], a[96:99]
    ds_read_b64_tr_b16 a[178:179], v241 offset:1792
    v_mfma_f32_16x16x32_bf16 a[80:83], a[144:147], v[72:75], a[80:83]
    ds_read_b64_tr_b16 a[180:181], v241 offset:12576
    buffer_load_dwordx4 v31, s[16:19], s35 offen offset:1024 nt lds
    v_mfma_f32_16x16x32_bf16 a[80:83], a[148:151], v[76:79], a[80:83]
    ds_read_b64_tr_b16 a[182:183], v241 offset:14112
    v_mfma_f32_16x16x32_bf16 a[84:87], a[152:155], v[72:75], a[84:87]
    ds_read_b64_tr_b16 a[184:185], v241 offset:264
    v_mfma_f32_16x16x32_bf16 a[84:87], a[156:159], v[76:79], a[84:87]
    ds_read_b64_tr_b16 a[186:187], v241 offset:1800
    v_mfma_f32_16x16x32_bf16 a[104:107], a[160:163], v[72:75], a[104:107]
    ds_read_b64_tr_b16 a[188:189], v241 offset:12584
    v_mfma_f32_16x16x32_bf16 a[104:107], a[164:167], v[76:79], a[104:107]
    ds_read_b64_tr_b16 a[190:191], v241 offset:14120
    v_mfma_f32_16x16x32_bf16 a[88:91], a[144:147], v[80:83], a[88:91]
    v_mfma_f32_16x16x32_bf16 a[88:91], a[148:151], v[84:87], a[88:91]
    v_mfma_f32_16x16x32_bf16 a[92:95], a[152:155], v[80:83], a[92:95]
    v_mfma_f32_16x16x32_bf16 a[92:95], a[156:159], v[84:87], a[92:95]
    v_mfma_f32_16x16x32_bf16 a[112:115], a[160:163], v[80:83], a[112:115]
    v_mfma_f32_16x16x32_bf16 a[112:115], a[164:167], v[84:87], a[112:115]
    s_waitcnt vmcnt(18)
    s_waitcnt lgkmcnt(0)
    s_barrier
    v_mfma_f32_16x16x32_bf16 a[100:103], a[168:171], v[64:67], a[100:103]
    ds_read_b64_tr_b16 a[144:145], v240 offset:24640
    v_mfma_f32_16x16x32_bf16 a[100:103], a[172:175], v[68:71], a[100:103]
    ds_read_b64_tr_b16 a[146:147], v240 offset:26176
    s_add_u32 m0, s29, 49280
    s_mov_b32 s35, 24576
    v_mfma_f32_16x16x32_bf16 a[120:123], a[176:179], v[64:67], a[120:123]
    ds_read_b64_tr_b16 a[148:149], v240 offset:36960
    v_accvgpr_read_b32 v40, a0
    v_accvgpr_read_b32 v41, a1
    v_accvgpr_read_b32 v42, a2
    v_accvgpr_read_b32 v43, a3
    v_accvgpr_read_b32 v44, a4
    v_accvgpr_read_b32 v45, a5
    v_mfma_f32_16x16x32_bf16 a[120:123], a[180:183], v[68:71], a[120:123]
    ds_read_b64_tr_b16 a[150:151], v240 offset:38496
    v_accvgpr_read_b32 v46, a6
    v_accvgpr_read_b32 v47, a7
    v_mul_f32 v40, v4, v40
    v_mul_f32 v41, v4, v41
    v_mul_f32 v42, v4, v42
    v_mul_f32 v43, v4, v43
    v_mfma_f32_16x16x32_bf16 a[124:127], a[184:187], v[64:67], a[124:127]
    ds_read_b64_tr_b16 a[152:153], v240 offset:24648
    v_mul_f32 v44, v4, v44
    v_mul_f32 v45, v4, v45
    v_mul_f32 v46, v4, v46
    v_mul_f32 v47, v4, v47
    v_cvt_pk_bf16_f32 v40, v40, v41
    v_cvt_pk_bf16_f32 v41, v42, v43
    v_mfma_f32_16x16x32_bf16 a[124:127], a[188:191], v[68:71], a[124:127]
    ds_read_b64_tr_b16 a[154:155], v240 offset:26184
    v_cvt_pk_bf16_f32 v42, v44, v45
    v_cvt_pk_bf16_f32 v43, v46, v47
    v_accvgpr_write_b32 a192, v40
    v_accvgpr_write_b32 a193, v41
    v_accvgpr_write_b32 a194, v42
    v_accvgpr_write_b32 a195, v43
    v_mfma_f32_16x16x32_bf16 a[108:111], a[168:171], v[72:75], a[108:111]
    ds_read_b64_tr_b16 a[156:157], v240 offset:36968
    v_accvgpr_read_b32 v48, a8
    v_accvgpr_read_b32 v49, a9
    v_accvgpr_read_b32 v50, a10
    v_accvgpr_read_b32 v51, a11
    v_accvgpr_read_b32 v52, a12
    v_accvgpr_read_b32 v53, a13
    v_mfma_f32_16x16x32_bf16 a[108:111], a[172:175], v[76:79], a[108:111]
    ds_read_b64_tr_b16 a[158:159], v240 offset:38504
    v_accvgpr_read_b32 v54, a14
    v_accvgpr_read_b32 v55, a15
    v_mul_f32 v48, v4, v48
    v_mul_f32 v49, v4, v49
    v_mul_f32 v50, v4, v50
    v_mul_f32 v51, v4, v51
    v_mfma_f32_16x16x32_bf16 a[128:131], a[176:179], v[72:75], a[128:131]
    ds_read_b64_tr_b16 a[160:161], v241 offset:24640
    v_mul_f32 v52, v4, v52
    v_mul_f32 v53, v4, v53
    v_mul_f32 v54, v4, v54
    v_mul_f32 v55, v4, v55
    v_cvt_pk_bf16_f32 v48, v48, v49
    v_cvt_pk_bf16_f32 v49, v50, v51
    v_mfma_f32_16x16x32_bf16 a[128:131], a[180:183], v[76:79], a[128:131]
    ds_read_b64_tr_b16 a[162:163], v241 offset:26176
    buffer_load_dwordx4 v26, s[16:19], s35 offen offset:0 nt lds
    v_cvt_pk_bf16_f32 v50, v52, v53
    v_cvt_pk_bf16_f32 v51, v54, v55
    v_accvgpr_write_b32 a196, v48
    v_accvgpr_write_b32 a197, v49
    v_accvgpr_write_b32 a198, v50
    v_mfma_f32_16x16x32_bf16 a[132:135], a[184:187], v[72:75], a[132:135]
    ds_read_b64_tr_b16 a[164:165], v241 offset:36960
    v_accvgpr_write_b32 a199, v51
    v_accvgpr_read_b32 v56, a16
    v_accvgpr_read_b32 v57, a17
    v_accvgpr_read_b32 v58, a18
    v_accvgpr_read_b32 v59, a19
    v_accvgpr_read_b32 v60, a20
    v_mfma_f32_16x16x32_bf16 a[132:135], a[188:191], v[76:79], a[132:135]
    ds_read_b64_tr_b16 a[166:167], v241 offset:38496
    v_accvgpr_read_b32 v61, a21
    v_accvgpr_read_b32 v62, a22
    v_accvgpr_read_b32 v63, a23
    v_mul_f32 v56, v4, v56
    v_mul_f32 v57, v4, v57
    v_mul_f32 v58, v4, v58
    v_mfma_f32_16x16x32_bf16 a[116:119], a[168:171], v[80:83], a[116:119]
    v_mul_f32 v59, v4, v59
    v_mul_f32 v60, v4, v60
    v_mul_f32 v61, v4, v61
    v_mul_f32 v62, v4, v62
    v_mul_f32 v63, v4, v63
    v_cvt_pk_bf16_f32 v56, v56, v57
    v_cvt_pk_bf16_f32 v57, v58, v59
    v_mfma_f32_16x16x32_bf16 a[116:119], a[172:175], v[84:87], a[116:119]
    v_cvt_pk_bf16_f32 v58, v60, v61
    v_cvt_pk_bf16_f32 v59, v62, v63
    v_accvgpr_write_b32 a200, v56
    v_accvgpr_write_b32 a201, v57
    v_accvgpr_write_b32 a202, v58
    v_accvgpr_write_b32 a203, v59
    v_accvgpr_read_b32 v40, a24
    v_mfma_f32_16x16x32_bf16 a[136:139], a[176:179], v[80:83], a[136:139]
    v_accvgpr_read_b32 v41, a25
    v_accvgpr_read_b32 v42, a26
    v_accvgpr_read_b32 v43, a27
    v_accvgpr_read_b32 v44, a28
    v_accvgpr_read_b32 v45, a29
    v_accvgpr_read_b32 v46, a30
    v_accvgpr_read_b32 v47, a31
    v_mfma_f32_16x16x32_bf16 a[136:139], a[180:183], v[84:87], a[136:139]
    v_mul_f32 v40, v4, v40
    v_mul_f32 v41, v4, v41
    v_mul_f32 v42, v4, v42
    v_mul_f32 v43, v4, v43
    v_mul_f32 v44, v4, v44
    v_mul_f32 v45, v4, v45
    v_mul_f32 v46, v4, v46
    v_mfma_f32_16x16x32_bf16 a[140:143], a[184:187], v[80:83], a[140:143]
    v_mul_f32 v47, v4, v47
    v_cvt_pk_bf16_f32 v40, v40, v41
    v_cvt_pk_bf16_f32 v41, v42, v43
    v_cvt_pk_bf16_f32 v42, v44, v45
    v_cvt_pk_bf16_f32 v43, v46, v47
    v_accvgpr_write_b32 a204, v40
    v_accvgpr_write_b32 a205, v41
    v_mfma_f32_16x16x32_bf16 a[140:143], a[188:191], v[84:87], a[140:143]
    v_accvgpr_write_b32 a206, v42
    v_accvgpr_write_b32 a207, v43
    v_accvgpr_read_b32 v48, a32
    v_accvgpr_read_b32 v49, a33
    v_accvgpr_read_b32 v50, a34
    v_accvgpr_read_b32 v51, a35
    v_accvgpr_read_b32 v52, a36
    s_waitcnt lgkmcnt(0)
    v_mfma_f32_16x16x32_bf16 v[88:91], a[144:147], v[64:67], v[88:91]
    ds_read_b64_tr_b16 a[168:169], v241 offset:24648
    buffer_load_dwordx4 v27, s[16:19], s35 offen offset:1024 nt lds
    v_accvgpr_read_b32 v53, a37
    v_accvgpr_read_b32 v54, a38
    v_accvgpr_read_b32 v55, a39
    v_mul_f32 v48, v4, v48
    v_mul_f32 v49, v4, v49
    v_mfma_f32_16x16x32_bf16 v[88:91], a[148:151], v[68:71], v[88:91]
    ds_read_b64_tr_b16 a[170:171], v241 offset:26184
    v_mul_f32 v50, v4, v50
    v_mul_f32 v51, v4, v51
    v_mul_f32 v52, v4, v52
    v_mul_f32 v53, v4, v53
    v_mul_f32 v54, v4, v54
    v_mul_f32 v55, v4, v55
    v_mfma_f32_16x16x32_bf16 v[92:95], a[152:155], v[64:67], v[92:95]
    ds_read_b64_tr_b16 a[172:173], v241 offset:36968
    v_cvt_pk_bf16_f32 v48, v48, v49
    v_cvt_pk_bf16_f32 v49, v50, v51
    v_cvt_pk_bf16_f32 v50, v52, v53
    v_cvt_pk_bf16_f32 v51, v54, v55
    v_accvgpr_write_b32 a208, v48
    v_accvgpr_write_b32 a209, v49
    v_mfma_f32_16x16x32_bf16 v[92:95], a[156:159], v[68:71], v[92:95]
    ds_read_b64_tr_b16 a[174:175], v241 offset:38504
    v_accvgpr_write_b32 a210, v50
    v_accvgpr_write_b32 a211, v51
    v_accvgpr_read_b32 v56, a40
    v_accvgpr_read_b32 v57, a41
    v_accvgpr_read_b32 v58, a42
    v_accvgpr_read_b32 v59, a43
    v_mfma_f32_16x16x32_bf16 v[112:115], a[160:163], v[64:67], v[112:115]
    ds_read_b64_tr_b16 a[176:177], v240 offset:24768
    v_accvgpr_read_b32 v60, a44
    v_accvgpr_read_b32 v61, a45
    v_accvgpr_read_b32 v62, a46
    v_accvgpr_read_b32 v63, a47
    v_mul_f32 v56, v4, v56
    v_mul_f32 v57, v4, v57
    v_mfma_f32_16x16x32_bf16 v[112:115], a[164:167], v[68:71], v[112:115]
    ds_read_b64_tr_b16 a[178:179], v240 offset:26304
    v_mul_f32 v58, v4, v58
    v_mul_f32 v59, v4, v59
    v_mul_f32 v60, v4, v60
    v_mul_f32 v61, v4, v61
    v_mul_f32 v62, v4, v62
    v_mul_f32 v63, v4, v63
    v_mfma_f32_16x16x32_bf16 v[96:99], a[144:147], v[72:75], v[96:99]
    ds_read_b64_tr_b16 a[180:181], v240 offset:37088
    v_cvt_pk_bf16_f32 v56, v56, v57
    v_cvt_pk_bf16_f32 v57, v58, v59
    v_cvt_pk_bf16_f32 v58, v60, v61
    v_cvt_pk_bf16_f32 v59, v62, v63
    v_accvgpr_write_b32 a212, v56
    v_accvgpr_write_b32 a213, v57
    v_mfma_f32_16x16x32_bf16 v[96:99], a[148:151], v[76:79], v[96:99]
    ds_read_b64_tr_b16 a[182:183], v240 offset:38624
    v_accvgpr_write_b32 a214, v58
    v_accvgpr_write_b32 a215, v59
    v_accvgpr_read_b32 v40, a48
    v_accvgpr_read_b32 v41, a49
    v_accvgpr_read_b32 v42, a50
    v_accvgpr_read_b32 v43, a51
    v_mfma_f32_16x16x32_bf16 v[100:103], a[152:155], v[72:75], v[100:103]
    ds_read_b64_tr_b16 a[184:185], v240 offset:24776
    buffer_load_dwordx4 v28, s[16:19], s35 offen offset:2048 nt lds
    v_accvgpr_read_b32 v44, a52
    v_accvgpr_read_b32 v45, a53
    v_accvgpr_read_b32 v46, a54
    v_accvgpr_read_b32 v47, a55
    v_mul_f32 v40, v4, v40
    v_mfma_f32_16x16x32_bf16 v[100:103], a[156:159], v[76:79], v[100:103]
    ds_read_b64_tr_b16 a[186:187], v240 offset:26312
    v_mul_f32 v41, v4, v41
    v_mul_f32 v42, v4, v42
    v_mul_f32 v43, v4, v43
    v_mul_f32 v44, v4, v44
    v_mul_f32 v45, v4, v45
    v_mul_f32 v46, v4, v46
    v_mfma_f32_16x16x32_bf16 v[120:123], a[160:163], v[72:75], v[120:123]
    ds_read_b64_tr_b16 a[188:189], v240 offset:37096
    v_mul_f32 v47, v4, v47
    v_cvt_pk_bf16_f32 v40, v40, v41
    v_cvt_pk_bf16_f32 v41, v42, v43
    v_cvt_pk_bf16_f32 v42, v44, v45
    v_cvt_pk_bf16_f32 v43, v46, v47
    v_accvgpr_write_b32 a216, v40
    v_mfma_f32_16x16x32_bf16 v[120:123], a[164:167], v[76:79], v[120:123]
    ds_read_b64_tr_b16 a[190:191], v240 offset:38632
    v_accvgpr_write_b32 a217, v41
    v_accvgpr_write_b32 a218, v42
    v_accvgpr_write_b32 a219, v43
    v_accvgpr_read_b32 v48, a56
    v_accvgpr_read_b32 v49, a57
    v_accvgpr_read_b32 v50, a58
    v_mfma_f32_16x16x32_bf16 v[104:107], a[144:147], v[80:83], v[104:107]
    v_accvgpr_read_b32 v51, a59
    v_accvgpr_read_b32 v52, a60
    v_accvgpr_read_b32 v53, a61
    v_accvgpr_read_b32 v54, a62
    v_accvgpr_read_b32 v55, a63
    v_mul_f32 v48, v4, v48
    v_mul_f32 v49, v4, v49
    v_mfma_f32_16x16x32_bf16 v[104:107], a[148:151], v[84:87], v[104:107]
    v_mul_f32 v50, v4, v50
    v_mul_f32 v51, v4, v51
    v_mul_f32 v52, v4, v52
    v_mul_f32 v53, v4, v53
    v_mul_f32 v54, v4, v54
    v_mul_f32 v55, v4, v55
    v_cvt_pk_bf16_f32 v48, v48, v49
    v_mfma_f32_16x16x32_bf16 v[108:111], a[152:155], v[80:83], v[108:111]
    v_cvt_pk_bf16_f32 v49, v50, v51
    v_cvt_pk_bf16_f32 v50, v52, v53
    v_cvt_pk_bf16_f32 v51, v54, v55
    v_accvgpr_write_b32 a220, v48
    v_accvgpr_write_b32 a221, v49
    v_accvgpr_write_b32 a222, v50
    v_accvgpr_write_b32 a223, v51
    v_mfma_f32_16x16x32_bf16 v[108:111], a[156:159], v[84:87], v[108:111]
    v_accvgpr_read_b32 v56, a64
    v_accvgpr_read_b32 v57, a65
    v_accvgpr_read_b32 v58, a66
    v_accvgpr_read_b32 v59, a67
    v_accvgpr_read_b32 v60, a68
    v_accvgpr_read_b32 v61, a69
    v_accvgpr_read_b32 v62, a70
    v_mfma_f32_16x16x32_bf16 v[128:131], a[160:163], v[80:83], v[128:131]
    v_accvgpr_read_b32 v63, a71
    v_mul_f32 v56, v4, v56
    v_mul_f32 v57, v4, v57
    v_mul_f32 v58, v4, v58
    v_mul_f32 v59, v4, v59
    v_mul_f32 v60, v4, v60
    v_mul_f32 v61, v4, v61
    v_mfma_f32_16x16x32_bf16 v[128:131], a[164:167], v[84:87], v[128:131]
    buffer_load_dwordx4 v29, s[16:19], s35 offen offset:3072 nt lds
    v_mul_f32 v62, v4, v62
    v_mul_f32 v63, v4, v63
    v_cvt_pk_bf16_f32 v56, v56, v57
    v_cvt_pk_bf16_f32 v57, v58, v59
    v_cvt_pk_bf16_f32 v58, v60, v61
    v_cvt_pk_bf16_f32 v59, v62, v63
    s_waitcnt lgkmcnt(0)
    v_mfma_f32_16x16x32_bf16 v[116:119], a[168:171], v[64:67], v[116:119]
    ds_read_b64_tr_b16 a[144:145], v241 offset:24768
    v_accvgpr_write_b32 a224, v56
    v_accvgpr_write_b32 a225, v57
    v_accvgpr_write_b32 a226, v58
    v_accvgpr_write_b32 a227, v59
    v_accvgpr_read_b32 v40, a72
    v_accvgpr_read_b32 v41, a73
    v_mfma_f32_16x16x32_bf16 v[116:119], a[172:175], v[68:71], v[116:119]
    ds_read_b64_tr_b16 a[146:147], v241 offset:26304
    v_accvgpr_read_b32 v42, a74
    v_accvgpr_read_b32 v43, a75
    v_accvgpr_read_b32 v44, a76
    v_accvgpr_read_b32 v45, a77
    v_accvgpr_read_b32 v46, a78
    v_accvgpr_read_b32 v47, a79
    v_mfma_f32_16x16x32_bf16 v[136:139], a[176:179], v[64:67], v[136:139]
    ds_read_b64_tr_b16 a[148:149], v241 offset:37088
    v_mul_f32 v40, v4, v40
    v_mul_f32 v41, v4, v41
    v_mul_f32 v42, v4, v42
    v_mul_f32 v43, v4, v43
    v_mul_f32 v44, v4, v44
    v_mul_f32 v45, v4, v45
    v_mfma_f32_16x16x32_bf16 v[136:139], a[180:183], v[68:71], v[136:139]
    ds_read_b64_tr_b16 a[150:151], v241 offset:38624
    v_mul_f32 v46, v4, v46
    v_mul_f32 v47, v4, v47
    v_cvt_pk_bf16_f32 v40, v40, v41
    v_cvt_pk_bf16_f32 v41, v42, v43
    v_cvt_pk_bf16_f32 v42, v44, v45
    v_cvt_pk_bf16_f32 v43, v46, v47
    v_mfma_f32_16x16x32_bf16 v[140:143], a[184:187], v[64:67], v[140:143]
    ds_read_b64_tr_b16 a[152:153], v241 offset:24776
    v_accvgpr_write_b32 a228, v40
    v_accvgpr_write_b32 a229, v41
    v_accvgpr_write_b32 a230, v42
    v_accvgpr_write_b32 a231, v43
    v_accvgpr_read_b32 v48, a80
    v_accvgpr_read_b32 v49, a81
    v_mfma_f32_16x16x32_bf16 v[140:143], a[188:191], v[68:71], v[140:143]
    ds_read_b64_tr_b16 a[154:155], v241 offset:26312
    v_accvgpr_read_b32 v50, a82
    v_accvgpr_read_b32 v51, a83
    v_accvgpr_read_b32 v52, a84
    v_accvgpr_read_b32 v53, a85
    v_accvgpr_read_b32 v54, a86
    v_accvgpr_read_b32 v55, a87
    v_mfma_f32_16x16x32_bf16 v[124:127], a[168:171], v[72:75], v[124:127]
    ds_read_b64_tr_b16 a[156:157], v241 offset:37096
    v_mul_f32 v48, v4, v48
    v_mul_f32 v49, v4, v49
    v_mul_f32 v50, v4, v50
    v_mul_f32 v51, v4, v51
    v_mul_f32 v52, v4, v52
    v_mul_f32 v53, v4, v53
    v_mfma_f32_16x16x32_bf16 v[124:127], a[172:175], v[76:79], v[124:127]
    ds_read_b64_tr_b16 a[158:159], v241 offset:38632
    s_add_u32 m0, s29, 53376
    v_mul_f32 v54, v4, v54
    v_mul_f32 v55, v4, v55
    v_cvt_pk_bf16_f32 v48, v48, v49
    v_cvt_pk_bf16_f32 v49, v50, v51
    v_cvt_pk_bf16_f32 v50, v52, v53
    v_mfma_f32_16x16x32_bf16 v[144:147], a[176:179], v[72:75], v[144:147]
    ds_read_b64_tr_b16 a[160:161], v240 offset:24896
    v_cvt_pk_bf16_f32 v51, v54, v55
    v_accvgpr_write_b32 a232, v48
    v_accvgpr_write_b32 a233, v49
    v_accvgpr_write_b32 a234, v50
    v_accvgpr_write_b32 a235, v51
    v_accvgpr_read_b32 v56, a88
    v_mfma_f32_16x16x32_bf16 v[144:147], a[180:183], v[76:79], v[144:147]
    ds_read_b64_tr_b16 a[162:163], v240 offset:26432
    v_accvgpr_read_b32 v57, a89
    v_accvgpr_read_b32 v58, a90
    v_accvgpr_read_b32 v59, a91
    v_accvgpr_read_b32 v60, a92
    v_accvgpr_read_b32 v61, a93
    v_accvgpr_read_b32 v62, a94
    v_mfma_f32_16x16x32_bf16 v[148:151], a[184:187], v[72:75], v[148:151]
    ds_read_b64_tr_b16 a[164:165], v240 offset:37216
    v_accvgpr_read_b32 v63, a95
    v_mul_f32 v56, v4, v56
    v_mul_f32 v57, v4, v57
    v_mul_f32 v58, v4, v58
    v_mul_f32 v59, v4, v59
    v_mul_f32 v60, v4, v60
    v_mfma_f32_16x16x32_bf16 v[148:151], a[188:191], v[76:79], v[148:151]
    ds_read_b64_tr_b16 a[166:167], v240 offset:38752
    v_mul_f32 v61, v4, v61
    v_mul_f32 v62, v4, v62
    v_mul_f32 v63, v4, v63
    v_cvt_pk_bf16_f32 v56, v56, v57
    v_cvt_pk_bf16_f32 v57, v58, v59
    v_cvt_pk_bf16_f32 v58, v60, v61
    v_mfma_f32_16x16x32_bf16 v[132:135], a[168:171], v[80:83], v[132:135]
    v_cvt_pk_bf16_f32 v59, v62, v63
    v_accvgpr_write_b32 a236, v56
    v_accvgpr_write_b32 a237, v57
    v_accvgpr_write_b32 a238, v58
    v_accvgpr_write_b32 a239, v59
    v_accvgpr_read_b32 v40, a96
    v_accvgpr_read_b32 v41, a97
    v_mfma_f32_16x16x32_bf16 v[132:135], a[172:175], v[84:87], v[132:135]
    v_accvgpr_read_b32 v42, a98
    v_accvgpr_read_b32 v43, a99
    v_accvgpr_read_b32 v44, a100
    v_accvgpr_read_b32 v45, a101
    v_accvgpr_read_b32 v46, a102
    v_accvgpr_read_b32 v47, a103
    v_mul_f32 v40, v4, v40
    v_mfma_f32_16x16x32_bf16 v[152:155], a[176:179], v[80:83], v[152:155]
    v_mul_f32 v41, v4, v41
    v_mul_f32 v42, v4, v42
    v_mul_f32 v43, v4, v43
    v_mul_f32 v44, v4, v44
    v_mul_f32 v45, v4, v45
    v_mul_f32 v46, v4, v46
    v_mul_f32 v47, v4, v47
    v_mfma_f32_16x16x32_bf16 v[152:155], a[180:183], v[84:87], v[152:155]
    v_cvt_pk_bf16_f32 v40, v40, v41
    v_cvt_pk_bf16_f32 v41, v42, v43
    v_cvt_pk_bf16_f32 v42, v44, v45
    v_cvt_pk_bf16_f32 v43, v46, v47
    v_accvgpr_write_b32 a240, v40
    v_accvgpr_write_b32 a241, v41
    v_accvgpr_write_b32 a242, v42
    v_mfma_f32_16x16x32_bf16 v[156:159], a[184:187], v[80:83], v[156:159]
    buffer_load_dwordx4 v30, s[16:19], s35 offen offset:0 nt lds
    v_accvgpr_write_b32 a243, v43
    v_accvgpr_read_b32 v48, a104
    v_accvgpr_read_b32 v49, a105
    v_accvgpr_read_b32 v50, a106
    v_accvgpr_read_b32 v51, a107
    v_accvgpr_read_b32 v52, a108
    v_mfma_f32_16x16x32_bf16 v[156:159], a[188:191], v[84:87], v[156:159]
    v_accvgpr_read_b32 v53, a109
    v_accvgpr_read_b32 v54, a110
    v_accvgpr_read_b32 v55, a111
    v_mul_f32 v48, v4, v48
    v_mul_f32 v49, v4, v49
    v_mul_f32 v50, v4, v50
    v_mul_f32 v51, v4, v51
    s_waitcnt lgkmcnt(0)
    v_mfma_f32_16x16x32_bf16 v[160:163], a[144:147], v[64:67], v[160:163]
    ds_read_b64_tr_b16 a[168:169], v240 offset:24904
    v_mul_f32 v52, v4, v52
    v_mul_f32 v53, v4, v53
    v_mul_f32 v54, v4, v54
    v_mul_f32 v55, v4, v55
    v_cvt_pk_bf16_f32 v48, v48, v49
    v_cvt_pk_bf16_f32 v49, v50, v51
    v_mfma_f32_16x16x32_bf16 v[160:163], a[148:151], v[68:71], v[160:163]
    ds_read_b64_tr_b16 a[170:171], v240 offset:26440
    v_cvt_pk_bf16_f32 v50, v52, v53
    v_cvt_pk_bf16_f32 v51, v54, v55
    v_accvgpr_write_b32 a244, v48
    v_accvgpr_write_b32 a245, v49
    v_accvgpr_write_b32 a246, v50
    v_accvgpr_write_b32 a247, v51
    v_mfma_f32_16x16x32_bf16 v[164:167], a[152:155], v[64:67], v[164:167]
    ds_read_b64_tr_b16 a[172:173], v240 offset:37224
    v_accvgpr_read_b32 v56, a112
    v_accvgpr_read_b32 v57, a113
    v_accvgpr_read_b32 v58, a114
    v_accvgpr_read_b32 v59, a115
    v_accvgpr_read_b32 v60, a116
    v_accvgpr_read_b32 v61, a117
    v_mfma_f32_16x16x32_bf16 v[164:167], a[156:159], v[68:71], v[164:167]
    ds_read_b64_tr_b16 a[174:175], v240 offset:38760
    v_accvgpr_read_b32 v62, a118
    v_accvgpr_read_b32 v63, a119
    v_mul_f32 v56, v4, v56
    v_mul_f32 v57, v4, v57
    v_mul_f32 v58, v4, v58
    v_mul_f32 v59, v4, v59
    v_mfma_f32_16x16x32_bf16 v[184:187], a[160:163], v[64:67], v[184:187]
    ds_read_b64_tr_b16 a[176:177], v241 offset:24896
    v_mul_f32 v60, v4, v60
    v_mul_f32 v61, v4, v61
    v_mul_f32 v62, v4, v62
    v_mul_f32 v63, v4, v63
    v_cvt_pk_bf16_f32 v56, v56, v57
    v_cvt_pk_bf16_f32 v57, v58, v59
    v_mfma_f32_16x16x32_bf16 v[184:187], a[164:167], v[68:71], v[184:187]
    ds_read_b64_tr_b16 a[178:179], v241 offset:26432
    v_cvt_pk_bf16_f32 v58, v60, v61
    v_cvt_pk_bf16_f32 v59, v62, v63
    v_accvgpr_write_b32 a248, v56
    v_accvgpr_write_b32 a249, v57
    v_accvgpr_write_b32 a250, v58
    v_accvgpr_write_b32 a251, v59
    v_mfma_f32_16x16x32_bf16 v[168:171], a[144:147], v[72:75], v[168:171]
    ds_read_b64_tr_b16 a[180:181], v241 offset:37216
    buffer_load_dwordx4 v31, s[16:19], s35 offen offset:1024 nt lds
    v_accvgpr_read_b32 v40, a120
    v_accvgpr_read_b32 v41, a121
    v_accvgpr_read_b32 v42, a122
    v_accvgpr_read_b32 v43, a123
    v_accvgpr_read_b32 v44, a124
    v_mfma_f32_16x16x32_bf16 v[168:171], a[148:151], v[76:79], v[168:171]
    ds_read_b64_tr_b16 a[182:183], v241 offset:38752
    v_accvgpr_read_b32 v45, a125
    v_accvgpr_read_b32 v46, a126
    v_accvgpr_read_b32 v47, a127
    v_mul_f32 v40, v4, v40
    v_mul_f32 v41, v4, v41
    v_mfma_f32_16x16x32_bf16 v[172:175], a[152:155], v[72:75], v[172:175]
    ds_read_b64_tr_b16 a[184:185], v241 offset:24904
    v_mul_f32 v42, v4, v42
    v_mul_f32 v43, v4, v43
    v_mul_f32 v44, v4, v44
    v_mul_f32 v45, v4, v45
    v_mul_f32 v46, v4, v46
    v_mfma_f32_16x16x32_bf16 v[172:175], a[156:159], v[76:79], v[172:175]
    ds_read_b64_tr_b16 a[186:187], v241 offset:26440
    v_mul_f32 v47, v4, v47
    v_cvt_pk_bf16_f32 v40, v40, v41
    v_cvt_pk_bf16_f32 v41, v42, v43
    v_cvt_pk_bf16_f32 v42, v44, v45
    v_cvt_pk_bf16_f32 v43, v46, v47
    v_mfma_f32_16x16x32_bf16 v[192:195], a[160:163], v[72:75], v[192:195]
    ds_read_b64_tr_b16 a[188:189], v241 offset:37224
    v_accvgpr_write_b32 a252, v40
    v_accvgpr_write_b32 a253, v41
    v_accvgpr_write_b32 a254, v42
    v_accvgpr_write_b32 a255, v43
    v_accvgpr_read_b32 v48, a128
    v_mfma_f32_16x16x32_bf16 v[192:195], a[164:167], v[76:79], v[192:195]
    ds_read_b64_tr_b16 a[190:191], v241 offset:38760
    v_accvgpr_read_b32 v49, a129
    v_accvgpr_read_b32 v50, a130
    v_accvgpr_read_b32 v51, a131
    v_accvgpr_read_b32 v52, a132
    v_accvgpr_read_b32 v53, a133
    v_mfma_f32_16x16x32_bf16 v[176:179], a[144:147], v[80:83], v[176:179]
    v_accvgpr_read_b32 v54, a134
    v_accvgpr_read_b32 v55, a135
    v_mul_f32 v48, v4, v48
    v_mul_f32 v49, v4, v49
    v_mul_f32 v50, v4, v50
    v_mul_f32 v51, v4, v51
    v_mfma_f32_16x16x32_bf16 v[176:179], a[148:151], v[84:87], v[176:179]
    v_mul_f32 v52, v4, v52
    v_mul_f32 v53, v4, v53
    v_mul_f32 v54, v4, v54
    v_mul_f32 v55, v4, v55
    v_cvt_pk_bf16_f32 v48, v48, v49
    v_cvt_pk_bf16_f32 v49, v50, v51
    v_mfma_f32_16x16x32_bf16 v[180:183], a[152:155], v[80:83], v[180:183]
    v_cvt_pk_bf16_f32 v50, v52, v53
    v_cvt_pk_bf16_f32 v51, v54, v55
    ds_write_b128 v7, v[48:51] offset:0
    v_accvgpr_read_b32 v56, a136
    v_accvgpr_read_b32 v57, a137
    v_accvgpr_read_b32 v58, a138
    v_mfma_f32_16x16x32_bf16 v[180:183], a[156:159], v[84:87], v[180:183]
    v_accvgpr_read_b32 v59, a139
    v_accvgpr_read_b32 v60, a140
    v_accvgpr_read_b32 v61, a141
    v_accvgpr_read_b32 v62, a142
    v_accvgpr_read_b32 v63, a143
    v_mul_f32 v56, v4, v56
    v_mfma_f32_16x16x32_bf16 v[200:203], a[160:163], v[80:83], v[200:203]
    v_mul_f32 v57, v4, v57
    v_mul_f32 v58, v4, v58
    v_mul_f32 v59, v4, v59
    v_mul_f32 v60, v4, v60
    v_mul_f32 v61, v4, v61
    v_mul_f32 v62, v4, v62
    v_mfma_f32_16x16x32_bf16 v[200:203], a[164:167], v[84:87], v[200:203]
    v_mul_f32 v63, v4, v63
    v_cvt_pk_bf16_f32 v56, v56, v57
    v_cvt_pk_bf16_f32 v57, v58, v59
    v_cvt_pk_bf16_f32 v58, v60, v61
    v_cvt_pk_bf16_f32 v59, v62, v63
    ds_write_b128 v7, v[56:59] offset:1024
    s_waitcnt lgkmcnt(0)
    v_mfma_f32_16x16x32_bf16 v[188:191], a[168:171], v[64:67], v[188:191]
    v_mfma_f32_16x16x32_bf16 v[188:191], a[172:175], v[68:71], v[188:191]
    v_mul_f32 v88, v4, v88
    v_mul_f32 v89, v4, v89
    v_mul_f32 v90, v4, v90
    v_mfma_f32_16x16x32_bf16 v[208:211], a[176:179], v[64:67], v[208:211]
    v_mul_f32 v91, v4, v91
    v_mul_f32 v92, v4, v92
    v_mul_f32 v93, v4, v93
    v_mfma_f32_16x16x32_bf16 v[208:211], a[180:183], v[68:71], v[208:211]
    v_mul_f32 v94, v4, v94
    v_mul_f32 v95, v4, v95
    v_mfma_f32_16x16x32_bf16 v[212:215], a[184:187], v[64:67], v[212:215]
    v_cvt_pk_bf16_f32 v88, v88, v89
    v_cvt_pk_bf16_f32 v89, v90, v91
    v_cvt_pk_bf16_f32 v90, v92, v93
    v_mfma_f32_16x16x32_bf16 v[212:215], a[188:191], v[68:71], v[212:215]
    v_cvt_pk_bf16_f32 v91, v94, v95
    v_mul_f32 v96, v4, v96
    v_mul_f32 v97, v4, v97
    v_mfma_f32_16x16x32_bf16 v[196:199], a[168:171], v[72:75], v[196:199]
    v_mul_f32 v98, v4, v98
    v_mul_f32 v99, v4, v99
    v_mul_f32 v100, v4, v100
    v_mfma_f32_16x16x32_bf16 v[196:199], a[172:175], v[76:79], v[196:199]
    v_mul_f32 v101, v4, v101
    v_mul_f32 v102, v4, v102
    v_mul_f32 v103, v4, v103
    v_mfma_f32_16x16x32_bf16 v[216:219], a[176:179], v[72:75], v[216:219]
    v_cvt_pk_bf16_f32 v92, v96, v97
    v_cvt_pk_bf16_f32 v93, v98, v99
    v_cvt_pk_bf16_f32 v94, v100, v101
    v_mfma_f32_16x16x32_bf16 v[216:219], a[180:183], v[76:79], v[216:219]
    v_cvt_pk_bf16_f32 v95, v102, v103
    v_mul_f32 v104, v4, v104
    v_mfma_f32_16x16x32_bf16 v[220:223], a[184:187], v[72:75], v[220:223]
    v_mul_f32 v105, v4, v105
    v_mul_f32 v106, v4, v106
    v_mul_f32 v107, v4, v107
    v_mfma_f32_16x16x32_bf16 v[220:223], a[188:191], v[76:79], v[220:223]
    v_mul_f32 v108, v4, v108
    v_mul_f32 v109, v4, v109
    v_mul_f32 v110, v4, v110
    v_mfma_f32_16x16x32_bf16 v[204:207], a[168:171], v[80:83], v[204:207]
    v_mul_f32 v111, v4, v111
    v_cvt_pk_bf16_f32 v96, v104, v105
    v_cvt_pk_bf16_f32 v97, v106, v107
    v_mfma_f32_16x16x32_bf16 v[204:207], a[172:175], v[84:87], v[204:207]
    v_cvt_pk_bf16_f32 v98, v108, v109
    v_cvt_pk_bf16_f32 v99, v110, v111
    v_mul_f32 v112, v4, v112
    v_mfma_f32_16x16x32_bf16 v[224:227], a[176:179], v[80:83], v[224:227]
    v_mul_f32 v113, v4, v113
    v_mul_f32 v114, v4, v114
    v_mul_f32 v115, v4, v115
    v_mfma_f32_16x16x32_bf16 v[224:227], a[180:183], v[84:87], v[224:227]
    v_mul_f32 v116, v4, v116
    v_mul_f32 v117, v4, v117
    v_mfma_f32_16x16x32_bf16 v[228:231], a[184:187], v[80:83], v[228:231]
    v_mul_f32 v118, v4, v118
    v_mul_f32 v119, v4, v119
    v_cvt_pk_bf16_f32 v100, v112, v113
    v_mfma_f32_16x16x32_bf16 v[228:231], a[188:191], v[84:87], v[228:231]
    v_cvt_pk_bf16_f32 v101, v114, v115
    v_cvt_pk_bf16_f32 v102, v116, v117
    v_cvt_pk_bf16_f32 v103, v118, v119
    v_pk_mul_f32 v[120:121], v[120:121], v[4:5]
    v_pk_mul_f32 v[122:123], v[122:123], v[4:5]
    v_pk_mul_f32 v[124:125], v[124:125], v[4:5]
    v_pk_mul_f32 v[126:127], v[126:127], v[4:5]
    v_cvt_pk_bf16_f32 v104, v120, v121
    v_cvt_pk_bf16_f32 v105, v122, v123
    v_cvt_pk_bf16_f32 v106, v124, v125
    v_cvt_pk_bf16_f32 v107, v126, v127
    v_pk_mul_f32 v[128:129], v[128:129], v[4:5]
    v_pk_mul_f32 v[130:131], v[130:131], v[4:5]
    v_pk_mul_f32 v[132:133], v[132:133], v[4:5]
    v_pk_mul_f32 v[134:135], v[134:135], v[4:5]
    v_cvt_pk_bf16_f32 v108, v128, v129
    v_cvt_pk_bf16_f32 v109, v130, v131
    v_cvt_pk_bf16_f32 v110, v132, v133
    v_cvt_pk_bf16_f32 v111, v134, v135
    v_pk_mul_f32 v[136:137], v[136:137], v[4:5]
    v_pk_mul_f32 v[138:139], v[138:139], v[4:5]
    v_pk_mul_f32 v[140:141], v[140:141], v[4:5]
    v_pk_mul_f32 v[142:143], v[142:143], v[4:5]
    v_cvt_pk_bf16_f32 v112, v136, v137
    v_cvt_pk_bf16_f32 v113, v138, v139
    v_cvt_pk_bf16_f32 v114, v140, v141
    v_cvt_pk_bf16_f32 v115, v142, v143
    v_pk_mul_f32 v[144:145], v[144:145], v[4:5]
    v_pk_mul_f32 v[146:147], v[146:147], v[4:5]
    v_pk_mul_f32 v[148:149], v[148:149], v[4:5]
    v_pk_mul_f32 v[150:151], v[150:151], v[4:5]
    v_cvt_pk_bf16_f32 v116, v144, v145
    v_cvt_pk_bf16_f32 v117, v146, v147
    v_cvt_pk_bf16_f32 v118, v148, v149
    v_cvt_pk_bf16_f32 v119, v150, v151
    v_pk_mul_f32 v[152:153], v[152:153], v[4:5]
    v_pk_mul_f32 v[154:155], v[154:155], v[4:5]
    v_pk_mul_f32 v[156:157], v[156:157], v[4:5]
    v_pk_mul_f32 v[158:159], v[158:159], v[4:5]
    v_cvt_pk_bf16_f32 v120, v152, v153
    v_cvt_pk_bf16_f32 v121, v154, v155
    v_cvt_pk_bf16_f32 v122, v156, v157
    v_cvt_pk_bf16_f32 v123, v158, v159
    v_pk_mul_f32 v[160:161], v[160:161], v[4:5]
    v_pk_mul_f32 v[162:163], v[162:163], v[4:5]
    v_pk_mul_f32 v[164:165], v[164:165], v[4:5]
    v_pk_mul_f32 v[166:167], v[166:167], v[4:5]
    v_cvt_pk_bf16_f32 v124, v160, v161
    v_cvt_pk_bf16_f32 v125, v162, v163
    v_cvt_pk_bf16_f32 v126, v164, v165
    v_cvt_pk_bf16_f32 v127, v166, v167
    v_pk_mul_f32 v[168:169], v[168:169], v[4:5]
    v_pk_mul_f32 v[170:171], v[170:171], v[4:5]
    v_pk_mul_f32 v[172:173], v[172:173], v[4:5]
    v_pk_mul_f32 v[174:175], v[174:175], v[4:5]
    v_cvt_pk_bf16_f32 v128, v168, v169
    v_cvt_pk_bf16_f32 v129, v170, v171
    v_cvt_pk_bf16_f32 v130, v172, v173
    v_cvt_pk_bf16_f32 v131, v174, v175
    v_pk_mul_f32 v[176:177], v[176:177], v[4:5]
    v_pk_mul_f32 v[178:179], v[178:179], v[4:5]
    v_pk_mul_f32 v[180:181], v[180:181], v[4:5]
    v_pk_mul_f32 v[182:183], v[182:183], v[4:5]
    v_cvt_pk_bf16_f32 v132, v176, v177
    v_cvt_pk_bf16_f32 v133, v178, v179
    v_cvt_pk_bf16_f32 v134, v180, v181
    v_cvt_pk_bf16_f32 v135, v182, v183
    v_pk_mul_f32 v[184:185], v[184:185], v[4:5]
    v_pk_mul_f32 v[186:187], v[186:187], v[4:5]
    v_pk_mul_f32 v[188:189], v[188:189], v[4:5]
    v_pk_mul_f32 v[190:191], v[190:191], v[4:5]
    v_cvt_pk_bf16_f32 v136, v184, v185
    v_cvt_pk_bf16_f32 v137, v186, v187
    v_cvt_pk_bf16_f32 v138, v188, v189
    v_cvt_pk_bf16_f32 v139, v190, v191
    v_pk_mul_f32 v[192:193], v[192:193], v[4:5]
    v_pk_mul_f32 v[194:195], v[194:195], v[4:5]
    v_pk_mul_f32 v[196:197], v[196:197], v[4:5]
    v_pk_mul_f32 v[198:199], v[198:199], v[4:5]
    v_cvt_pk_bf16_f32 v140, v192, v193
    v_cvt_pk_bf16_f32 v141, v194, v195
    v_cvt_pk_bf16_f32 v142, v196, v197
    v_cvt_pk_bf16_f32 v143, v198, v199
    v_pk_mul_f32 v[200:201], v[200:201], v[4:5]
    v_pk_mul_f32 v[202:203], v[202:203], v[4:5]
    v_pk_mul_f32 v[204:205], v[204:205], v[4:5]
    v_pk_mul_f32 v[206:207], v[206:207], v[4:5]
    v_cvt_pk_bf16_f32 v144, v200, v201
    v_cvt_pk_bf16_f32 v145, v202, v203
    v_cvt_pk_bf16_f32 v146, v204, v205
    v_cvt_pk_bf16_f32 v147, v206, v207
    v_pk_mul_f32 v[208:209], v[208:209], v[4:5]
    v_pk_mul_f32 v[210:211], v[210:211], v[4:5]
    v_pk_mul_f32 v[212:213], v[212:213], v[4:5]
    v_pk_mul_f32 v[214:215], v[214:215], v[4:5]
    v_cvt_pk_bf16_f32 v148, v208, v209
    v_cvt_pk_bf16_f32 v149, v210, v211
    v_cvt_pk_bf16_f32 v150, v212, v213
    v_cvt_pk_bf16_f32 v151, v214, v215
    v_pk_mul_f32 v[216:217], v[216:217], v[4:5]
    v_pk_mul_f32 v[218:219], v[218:219], v[4:5]
    v_pk_mul_f32 v[220:221], v[220:221], v[4:5]
    v_pk_mul_f32 v[222:223], v[222:223], v[4:5]
    v_cvt_pk_bf16_f32 v152, v216, v217
    v_cvt_pk_bf16_f32 v153, v218, v219
    v_cvt_pk_bf16_f32 v154, v220, v221
    v_cvt_pk_bf16_f32 v155, v222, v223
    v_pk_mul_f32 v[224:225], v[224:225], v[4:5]
    v_pk_mul_f32 v[226:227], v[226:227], v[4:5]
    v_pk_mul_f32 v[228:229], v[228:229], v[4:5]
    v_pk_mul_f32 v[230:231], v[230:231], v[4:5]
    v_cvt_pk_bf16_f32 v156, v224, v225
    v_cvt_pk_bf16_f32 v157, v226, v227
    v_cvt_pk_bf16_f32 v158, v228, v229
    v_cvt_pk_bf16_f32 v159, v230, v231
    v_mov_b32 v238, v34
    v_add_u32 v240, 49280, v34
    v_add_u32 v242, 98560, v34
    v_mov_b32 v239, v35
    v_add_u32 v241, 49280, v35
    v_add_u32 v243, 98560, v35
    s_waitcnt lgkmcnt(0)
L_head:
    s_waitcnt vmcnt(18)
    s_waitcnt lgkmcnt(0)
    s_barrier
    ds_read_b128 a[144:147], v242 offset:0
    ds_read_b128 a[148:151], v243 offset:0
    ds_read_b128 a[152:155], v242 offset:128
    ds_read_b128 a[156:159], v243 offset:128
    ds_read_b128 a[160:163], v242 offset:256
    ds_read_b128 a[164:167], v243 offset:256
    s_add_u32 m0, s29, 24640
    s_mov_b32 s35, 49152
    buffer_load_dwordx4 v20, s[12:15], s35 offen offset:0 nt lds
    buffer_load_dwordx4 v21, s[12:15], s35 offen offset:1024 nt lds
    buffer_load_dwordx4 v22, s[12:15], s35 offen offset:2048 nt lds
    buffer_load_dwordx4 v23, s[12:15], s35 offen offset:3072 nt lds
    s_add_u32 m0, s29, 28736
    s_nop 0
    buffer_load_dwordx4 v24, s[12:15], s35 offen offset:0 nt lds
    buffer_load_dwordx4 v25, s[12:15], s35 offen offset:1024 nt lds
    s_waitcnt lgkmcnt(0)
    v_mfma_f32_16x16x32_bf16 v[160:163], a[144:147], v[88:91], 0
    ds_read_b128 a[168:171], v242 offset:1536
    s_add_u32 m0, s29, 73920
    s_mov_b32 s36, 73728
    v_mfma_f32_16x16x32_bf16 v[160:163], a[148:151], v[100:103], v[160:163]
    ds_read_b128 a[172:175], v243 offset:1536
    v_mfma_f32_16x16x32_bf16 v[160:163], a[152:155], v[112:115], v[160:163]
    buffer_load_dwordx4 v20, s[12:15], s36 offen offset:0 nt lds
    v_mfma_f32_16x16x32_bf16 v[160:163], a[156:159], v[124:127], v[160:163]
    ds_read_b128 a[176:179], v242 offset:1664
    v_mfma_f32_16x16x32_bf16 v[160:163], a[160:163], v[136:139], v[160:163]
    buffer_load_dwordx4 v21, s[12:15], s36 offen offset:1024 nt lds
    v_mfma_f32_16x16x32_bf16 v[160:163], a[164:167], v[148:151], v[160:163]
    ds_read_b128 a[180:183], v243 offset:1664
    v_mfma_f32_16x16x32_bf16 v[164:167], a[144:147], v[92:95], 0
    buffer_load_dwordx4 v22, s[12:15], s36 offen offset:2048 nt lds
    v_mfma_f32_16x16x32_bf16 v[164:167], a[148:151], v[104:107], v[164:167]
    ds_read_b128 a[184:187], v242 offset:1792
    v_mfma_f32_16x16x32_bf16 v[164:167], a[152:155], v[116:119], v[164:167]
    v_mfma_f32_16x16x32_bf16 v[164:167], a[156:159], v[128:131], v[164:167]
    ds_read_b128 a[188:191], v243 offset:1792
    buffer_load_dwordx4 v23, s[12:15], s36 offen offset:3072 nt lds
    v_mfma_f32_16x16x32_bf16 v[164:167], a[160:163], v[140:143], v[164:167]
    v_max3_f32 v58, v160, v161, v162
    v_max_f32 v58, v58, v163
    v_mfma_f32_16x16x32_bf16 v[164:167], a[164:167], v[152:155], v[164:167]
    s_add_u32 m0, s29, 78016
    v_mov_b32 v59, v58
    v_mfma_f32_16x16x32_bf16 v[168:171], a[144:147], v[96:99], 0
    s_nop 0
    v_permlane32_swap_b32 v59, v58
    v_max_f32 v58, v58, v59
    v_mfma_f32_16x16x32_bf16 v[168:171], a[148:151], v[108:111], v[168:171]
    buffer_load_dwordx4 v24, s[12:15], s36 offen offset:0 nt lds
    v_mov_b32 v59, v58
    v_mfma_f32_16x16x32_bf16 v[168:171], a[152:155], v[120:123], v[168:171]
    s_nop 0
    v_permlane16_swap_b32 v59, v58
    v_max_f32 v58, v58, v59
    v_mfma_f32_16x16x32_bf16 v[168:171], a[156:159], v[132:135], v[168:171]
    buffer_load_dwordx4 v25, s[12:15], s36 offen offset:1024 nt lds
    v_sub_f32 v40, 0, v58
    v_mfma_f32_16x16x32_bf16 v[168:171], a[160:163], v[144:147], v[168:171]
    v_sub_f32 v41, 0, v58
    v_sub_f32 v42, 0, v58
    v_mfma_f32_16x16x32_bf16 v[168:171], a[164:167], v[156:159], v[168:171]
    v_sub_f32 v43, 0, v58
    v_max3_f32 v60, v164, v165, v166
    s_waitcnt lgkmcnt(0)
    v_mfma_f32_16x16x32_bf16 v[172:175], a[168:171], v[88:91], 0
    ds_read_b128 a[144:147], v242 offset:12288
    v_max_f32 v60, v60, v167
    v_mfma_f32_16x16x32_bf16 v[172:175], a[172:175], v[100:103], v[172:175]
    ds_read_b128 a[148:151], v243 offset:12288
    v_mov_b32 v61, v60
    v_mfma_f32_16x16x32_bf16 v[172:175], a[176:179], v[112:115], v[172:175]
    s_nop 0
    v_permlane32_swap_b32 v61, v60
    v_max_f32 v60, v60, v61
    v_mfma_f32_16x16x32_bf16 v[172:175], a[180:183], v[124:127], v[172:175]
    ds_read_b128 a[152:155], v242 offset:12416
    v_mov_b32 v61, v60
    v_mfma_f32_16x16x32_bf16 v[172:175], a[184:187], v[136:139], v[172:175]
    s_nop 0
    v_permlane16_swap_b32 v61, v60
    v_max_f32 v60, v60, v61
    v_mfma_f32_16x16x32_bf16 v[172:175], a[188:191], v[148:151], v[172:175]
    ds_read_b128 a[156:159], v243 offset:12416
    v_sub_f32 v44, 0, v60
    v_mfma_f32_16x16x32_bf16 v[176:179], a[168:171], v[92:95], 0
    v_sub_f32 v45, 0, v60
    v_sub_f32 v46, 0, v60
    v_mfma_f32_16x16x32_bf16 v[176:179], a[172:175], v[104:107], v[176:179]
    ds_read_b128 a[160:163], v242 offset:12544
    v_sub_f32 v47, 0, v60
    v_mfma_f32_16x16x32_bf16 v[176:179], a[176:179], v[116:119], v[176:179]
    v_max3_f32 v62, v168, v169, v170
    v_max_f32 v62, v62, v171
    v_mfma_f32_16x16x32_bf16 v[176:179], a[180:183], v[128:131], v[176:179]
    ds_read_b128 a[164:167], v243 offset:12544
    v_mov_b32 v63, v62
    v_mfma_f32_16x16x32_bf16 v[176:179], a[184:187], v[140:143], v[176:179]
    s_nop 0
    v_permlane32_swap_b32 v63, v62
    v_max_f32 v62, v62, v63
    v_mfma_f32_16x16x32_bf16 v[176:179], a[188:191], v[152:155], v[176:179]
    v_mov_b32 v63, v62
    s_nop 1
    v_permlane16_swap_b32 v63, v62
    v_mfma_f32_16x16x32_bf16 v[180:183], a[168:171], v[96:99], 0
    v_max_f32 v62, v62, v63
    v_sub_f32 v48, 0, v62
    v_mfma_f32_16x16x32_bf16 v[180:183], a[172:175], v[108:111], v[180:183]
    v_sub_f32 v49, 0, v62
    v_sub_f32 v50, 0, v62
    v_mfma_f32_16x16x32_bf16 v[180:183], a[176:179], v[120:123], v[180:183]
    v_sub_f32 v51, 0, v62
    v_mfma_f32_16x16x32_bf16 v[180:183], a[180:183], v[132:135], v[180:183]
    v_mfma_f32_16x16x32_bf16 v[180:183], a[184:187], v[144:147], v[180:183]
    v_add_f32 v160, v160, v40
    v_add_f32 v161, v161, v40
    v_add_f32 v162, v162, v40
    v_add_f32 v163, v163, v40
    v_exp_f32 v58, v160
    v_exp_f32 v59, v161
    v_exp_f32 v60, v162
    v_exp_f32 v61, v163
    v_add_f32 v55, v58, v59
    v_cvt_pk_bf16_f32 v208, v58, v59
    v_mfma_f32_16x16x32_bf16 v[180:183], a[188:191], v[156:159], v[180:183]
    v_add_f32 v55, v55, v60
    v_add_f32 v55, v55, v61
    v_cvt_pk_bf16_f32 v209, v60, v61
    v_add_f32 v164, v164, v44
    v_add_f32 v165, v165, v44
    v_add_f32 v166, v166, v44
    v_add_f32 v167, v167, v44
    v_exp_f32 v62, v164
    v_exp_f32 v63, v165
    v_exp_f32 v38, v166
    s_waitcnt lgkmcnt(0)
    v_mfma_f32_16x16x32_bf16 v[184:187], a[144:147], v[88:91], v[40:43]
    ds_read_b128 a[168:171], v242 offset:13824
    v_exp_f32 v39, v167
    v_add_f32 v56, v62, v63
    v_cvt_pk_bf16_f32 v212, v62, v63
    v_add_f32 v56, v56, v38
    v_add_f32 v56, v56, v39
    v_cvt_pk_bf16_f32 v213, v38, v39
    v_add_f32 v168, v168, v48
    v_add_f32 v169, v169, v48
    v_add_f32 v170, v170, v48
    v_add_f32 v171, v171, v48
    v_exp_f32 v58, v168
    v_mfma_f32_16x16x32_bf16 v[184:187], a[148:151], v[100:103], v[184:187]
    ds_read_b128 a[172:175], v243 offset:13824
    v_exp_f32 v59, v169
    v_exp_f32 v60, v170
    v_exp_f32 v61, v171
    v_add_f32 v57, v58, v59
    v_cvt_pk_bf16_f32 v216, v58, v59
    v_add_f32 v57, v57, v60
    v_add_f32 v57, v57, v61
    v_cvt_pk_bf16_f32 v217, v60, v61
    v_add_f32 v172, v172, v40
    v_add_f32 v173, v173, v40
    v_mfma_f32_16x16x32_bf16 v[184:187], a[152:155], v[112:115], v[184:187]
    v_add_f32 v174, v174, v40
    v_add_f32 v175, v175, v40
    v_exp_f32 v62, v172
    v_exp_f32 v63, v173
    v_exp_f32 v38, v174
    v_exp_f32 v39, v175
    v_add_f32 v55, v55, v62
    v_add_f32 v55, v55, v63
    v_cvt_pk_bf16_f32 v210, v62, v63
    v_add_f32 v55, v55, v38
    v_mfma_f32_16x16x32_bf16 v[184:187], a[156:159], v[124:127], v[184:187]
    ds_read_b128 a[176:179], v242 offset:13952
    v_add_f32 v55, v55, v39
    v_cvt_pk_bf16_f32 v211, v38, v39
    v_add_f32 v176, v176, v44
    v_add_f32 v177, v177, v44
    v_add_f32 v178, v178, v44
    v_add_f32 v179, v179, v44
    v_exp_f32 v58, v176
    v_exp_f32 v59, v177
    v_exp_f32 v60, v178
    v_mfma_f32_16x16x32_bf16 v[184:187], a[160:163], v[136:139], v[184:187]
    v_exp_f32 v61, v179
    v_add_f32 v56, v56, v58
    v_add_f32 v56, v56, v59
    v_cvt_pk_bf16_f32 v214, v58, v59
    v_add_f32 v56, v56, v60
    v_add_f32 v56, v56, v61
    v_cvt_pk_bf16_f32 v215, v60, v61
    v_add_f32 v180, v180, v48
    v_add_f32 v181, v181, v48
    v_add_f32 v182, v182, v48
    v_add_f32 v183, v183, v48
    v_exp_f32 v62, v180
    v_mfma_f32_16x16x32_bf16 v[184:187], a[164:167], v[148:151], v[184:187]
    ds_read_b128 a[180:183], v243 offset:13952
    v_exp_f32 v63, v181
    v_exp_f32 v38, v182
    v_exp_f32 v39, v183
    v_add_f32 v57, v57, v62
    v_add_f32 v57, v57, v63
    v_cvt_pk_bf16_f32 v218, v62, v63
    v_add_f32 v57, v57, v38
    v_add_f32 v57, v57, v39
    v_cvt_pk_bf16_f32 v219, v38, v39
    v_mfma_f32_16x16x32_bf16 v[188:191], a[144:147], v[92:95], v[44:47]
    v_mfma_f32_16x16x32_bf16 v[188:191], a[148:151], v[104:107], v[188:191]
    ds_read_b128 a[184:187], v242 offset:14080
    v_mfma_f32_16x16x32_bf16 v[188:191], a[152:155], v[116:119], v[188:191]
    v_mfma_f32_16x16x32_bf16 v[188:191], a[156:159], v[128:131], v[188:191]
    ds_read_b128 a[188:191], v243 offset:14080
    v_exp_f32 v58, v184
    v_exp_f32 v59, v185
    v_exp_f32 v60, v186
    v_exp_f32 v61, v187
    v_add_f32 v55, v55, v58
    v_add_f32 v55, v55, v59
    v_cvt_pk_bf16_f32 v220, v58, v59
    v_add_f32 v55, v55, v60
    v_add_f32 v55, v55, v61
    v_mfma_f32_16x16x32_bf16 v[188:191], a[160:163], v[140:143], v[188:191]
    v_cvt_pk_bf16_f32 v221, v60, v61
    v_mfma_f32_16x16x32_bf16 v[188:191], a[164:167], v[152:155], v[188:191]
    v_mfma_f32_16x16x32_bf16 v[192:195], a[144:147], v[96:99], v[48:51]
    v_mfma_f32_16x16x32_bf16 v[192:195], a[148:151], v[108:111], v[192:195]
    v_mfma_f32_16x16x32_bf16 v[192:195], a[152:155], v[120:123], v[192:195]
    v_mfma_f32_16x16x32_bf16 v[192:195], a[156:159], v[132:135], v[192:195]
    s_nop 3
    v_exp_f32 v62, v188
    v_exp_f32 v63, v189
    v_exp_f32 v38, v190
    v_exp_f32 v39, v191
    v_add_f32 v56, v56, v62
    v_add_f32 v56, v56, v63
    v_cvt_pk_bf16_f32 v224, v62, v63
    v_add_f32 v56, v56, v38
    v_add_f32 v56, v56, v39
    v_cvt_pk_bf16_f32 v225, v38, v39
    v_mfma_f32_16x16x32_bf16 v[192:195], a[160:163], v[144:147], v[192:195]
    v_mfma_f32_16x16x32_bf16 v[192:195], a[164:167], v[156:159], v[192:195]
    s_waitcnt lgkmcnt(0)
    v_mfma_f32_16x16x32_bf16 v[196:199], a[168:171], v[88:91], v[40:43]
    v_mfma_f32_16x16x32_bf16 v[196:199], a[172:175], v[100:103], v[196:199]
    v_mfma_f32_16x16x32_bf16 v[196:199], a[176:179], v[112:115], v[196:199]
    v_mfma_f32_16x16x32_bf16 v[196:199], a[180:183], v[124:127], v[196:199]
    s_nop 2
    v_exp_f32 v58, v192
    v_exp_f32 v59, v193
    v_exp_f32 v60, v194
    v_exp_f32 v61, v195
    v_add_f32 v57, v57, v58
    v_add_f32 v57, v57, v59
    v_cvt_pk_bf16_f32 v228, v58, v59
    v_add_f32 v57, v57, v60
    v_add_f32 v57, v57, v61
    v_cvt_pk_bf16_f32 v229, v60, v61
    v_mfma_f32_16x16x32_bf16 v[196:199], a[184:187], v[136:139], v[196:199]
    v_mfma_f32_16x16x32_bf16 v[196:199], a[188:191], v[148:151], v[196:199]
    v_mfma_f32_16x16x32_bf16 v[200:203], a[168:171], v[92:95], v[44:47]
    v_mfma_f32_16x16x32_bf16 v[200:203], a[172:175], v[104:107], v[200:203]
    v_mfma_f32_16x16x32_bf16 v[200:203], a[176:179], v[116:119], v[200:203]
    v_mfma_f32_16x16x32_bf16 v[200:203], a[180:183], v[128:131], v[200:203]
    s_nop 3
    v_exp_f32 v62, v196
    v_exp_f32 v63, v197
    v_exp_f32 v38, v198
    v_exp_f32 v39, v199
    v_add_f32 v55, v55, v62
    v_add_f32 v55, v55, v63
    v_cvt_pk_bf16_f32 v222, v62, v63
    v_add_f32 v55, v55, v38
    v_add_f32 v55, v55, v39
    v_cvt_pk_bf16_f32 v223, v38, v39
    v_mfma_f32_16x16x32_bf16 v[200:203], a[184:187], v[140:143], v[200:203]
    v_mfma_f32_16x16x32_bf16 v[200:203], a[188:191], v[152:155], v[200:203]
    v_mfma_f32_16x16x32_bf16 v[204:207], a[168:171], v[96:99], v[48:51]
    v_mfma_f32_16x16x32_bf16 v[204:207], a[172:175], v[108:111], v[204:207]
    v_mfma_f32_16x16x32_bf16 v[204:207], a[176:179], v[120:123], v[204:207]
    v_mfma_f32_16x16x32_bf16 v[204:207], a[180:183], v[132:135], v[204:207]
    s_nop 3
    v_exp_f32 v58, v200
    v_exp_f32 v59, v201
    v_exp_f32 v60, v202
    v_exp_f32 v61, v203
    v_add_f32 v56, v56, v58
    v_add_f32 v56, v56, v59
    v_cvt_pk_bf16_f32 v226, v58, v59
    v_add_f32 v56, v56, v60
    v_add_f32 v56, v56, v61
    v_cvt_pk_bf16_f32 v227, v60, v61
    v_mfma_f32_16x16x32_bf16 v[204:207], a[184:187], v[144:147], v[204:207]
    v_mfma_f32_16x16x32_bf16 v[204:207], a[188:191], v[156:159], v[204:207]
    s_nop 7
    v_exp_f32 v62, v204
    v_exp_f32 v63, v205
    v_exp_f32 v38, v206
    v_exp_f32 v39, v207
    v_add_f32 v57, v57, v62
    v_add_f32 v57, v57, v63
    v_cvt_pk_bf16_f32 v230, v62, v63
    v_add_f32 v57, v57, v38
    v_add_f32 v57, v57, v39
    v_cvt_pk_bf16_f32 v231, v38, v39
    s_waitcnt vmcnt(12)
    s_waitcnt lgkmcnt(0)
    s_barrier
    ds_read_b128 a[144:147], v242 offset:24640
    ds_read_b128 a[148:151], v243 offset:24640
    ds_read_b128 a[152:155], v242 offset:24768
    ds_read_b128 a[156:159], v243 offset:24768
    ds_read_b128 a[160:163], v242 offset:24896
    ds_read_b128 a[164:167], v243 offset:24896
    v_max3_f32 v1, v55, v56, v57
    v_cmp_lt_f32 vcc, s40, v1
    s_cbranch_vccnz L_stub_0
L_ret_0:
    v_mov_b32 v52, v55
    v_mov_b32 v53, v56
    v_mov_b32 v54, v57
    s_waitcnt lgkmcnt(0)
    v_mfma_f32_16x16x32_bf16 v[160:163], a[144:147], v[88:91], v[40:43]
    ds_read_b128 a[168:171], v242 offset:26176
    s_add_u32 m0, s29, 98560
    s_mov_b32 s35, 49152
    v_mfma_f32_16x16x32_bf16 v[160:163], a[148:151], v[100:103], v[160:163]
    ds_read_b128 a[172:175], v243 offset:26176
    v_mfma_f32_16x16x32_bf16 v[160:163], a[152:155], v[112:115], v[160:163]
    buffer_load_dwordx4 v26, s[16:19], s35 offen offset:0 nt lds
    v_mfma_f32_16x16x32_bf16 v[160:163], a[156:159], v[124:127], v[160:163]
    ds_read_b128 a[176:179], v242 offset:26304
    v_mfma_f32_16x16x32_bf16 v[160:163], a[160:163], v[136:139], v[160:163]
    buffer_load_dwordx4 v27, s[16:19], s35 offen offset:1024 nt lds
    v_mfma_f32_16x16x32_bf16 v[160:163], a[164:167], v[148:151], v[160:163]
    ds_read_b128 a[180:183], v243 offset:26304
    v_mfma_f32_16x16x32_bf16 v[164:167], a[144:147], v[92:95], v[44:47]
    buffer_load_dwordx4 v28, s[16:19], s35 offen offset:2048 nt lds
    v_mfma_f32_16x16x32_bf16 v[164:167], a[148:151], v[104:107], v[164:167]
    ds_read_b128 a[184:187], v242 offset:26432
    v_mfma_f32_16x16x32_bf16 v[164:167], a[152:155], v[116:119], v[164:167]
    v_mfma_f32_16x16x32_bf16 v[164:167], a[156:159], v[128:131], v[164:167]
    ds_read_b128 a[188:191], v243 offset:26432
    buffer_load_dwordx4 v29, s[16:19], s35 offen offset:3072 nt lds
    v_mfma_f32_16x16x32_bf16 v[164:167], a[160:163], v[140:143], v[164:167]
    v_exp_f32 v58, v160
    v_mfma_f32_16x16x32_bf16 v[164:167], a[164:167], v[152:155], v[164:167]
    s_add_u32 m0, s29, 102656
    v_mfma_f32_16x16x32_bf16 v[168:171], a[144:147], v[96:99], v[48:51]
    v_exp_f32 v59, v161
    v_mfma_f32_16x16x32_bf16 v[168:171], a[148:151], v[108:111], v[168:171]
    buffer_load_dwordx4 v30, s[16:19], s35 offen offset:0 nt lds
    v_exp_f32 v60, v162
    v_mfma_f32_16x16x32_bf16 v[168:171], a[152:155], v[120:123], v[168:171]
    v_exp_f32 v61, v163
    v_mfma_f32_16x16x32_bf16 v[168:171], a[156:159], v[132:135], v[168:171]
    buffer_load_dwordx4 v31, s[16:19], s35 offen offset:1024 nt lds
    v_add_f32 v55, v58, v59
    v_mfma_f32_16x16x32_bf16 v[168:171], a[160:163], v[144:147], v[168:171]
    v_cvt_pk_bf16_f32 v64, v58, v59
    v_add_f32 v55, v55, v60
    v_mfma_f32_16x16x32_bf16 v[168:171], a[164:167], v[156:159], v[168:171]
    v_add_f32 v55, v55, v61
    v_cvt_pk_bf16_f32 v65, v60, v61
    s_waitcnt lgkmcnt(0)
    v_mfma_f32_16x16x32_bf16 v[172:175], a[168:171], v[88:91], v[40:43]
    ds_read_b128 a[144:147], v242 offset:36928
    v_mfma_f32_16x16x32_bf16 v[172:175], a[172:175], v[100:103], v[172:175]
    ds_read_b128 a[148:151], v243 offset:36928
    v_mfma_f32_16x16x32_bf16 v[172:175], a[176:179], v[112:115], v[172:175]
    v_exp_f32 v62, v164
    v_mfma_f32_16x16x32_bf16 v[172:175], a[180:183], v[124:127], v[172:175]
    ds_read_b128 a[152:155], v242 offset:37056
    v_mfma_f32_16x16x32_bf16 v[172:175], a[184:187], v[136:139], v[172:175]
    v_exp_f32 v63, v165
    v_mfma_f32_16x16x32_bf16 v[172:175], a[188:191], v[148:151], v[172:175]
    ds_read_b128 a[156:159], v243 offset:37056
    v_exp_f32 v38, v166
    v_mfma_f32_16x16x32_bf16 v[176:179], a[168:171], v[92:95], v[44:47]
    v_exp_f32 v39, v167
    v_mfma_f32_16x16x32_bf16 v[176:179], a[172:175], v[104:107], v[176:179]
    ds_read_b128 a[160:163], v242 offset:37184
    v_add_f32 v56, v62, v63
    v_mfma_f32_16x16x32_bf16 v[176:179], a[176:179], v[116:119], v[176:179]
    v_cvt_pk_bf16_f32 v68, v62, v63
    v_add_f32 v56, v56, v38
    v_add_f32 v56, v56, v39
    v_mfma_f32_16x16x32_bf16 v[176:179], a[180:183], v[128:131], v[176:179]
    ds_read_b128 a[164:167], v243 offset:37184
    v_cvt_pk_bf16_f32 v69, v38, v39
    v_mfma_f32_16x16x32_bf16 v[176:179], a[184:187], v[140:143], v[176:179]
    v_exp_f32 v58, v168
    v_mfma_f32_16x16x32_bf16 v[176:179], a[188:191], v[152:155], v[176:179]
    v_exp_f32 v59, v169
    v_mfma_f32_16x16x32_bf16 v[180:183], a[168:171], v[96:99], v[48:51]
    v_exp_f32 v60, v170
    v_mfma_f32_16x16x32_bf16 v[180:183], a[172:175], v[108:111], v[180:183]
    v_exp_f32 v61, v171
    v_mfma_f32_16x16x32_bf16 v[180:183], a[176:179], v[120:123], v[180:183]
    v_add_f32 v57, v58, v59
    v_cvt_pk_bf16_f32 v72, v58, v59
    v_mfma_f32_16x16x32_bf16 v[180:183], a[180:183], v[132:135], v[180:183]
    v_add_f32 v57, v57, v60
    v_add_f32 v57, v57, v61
    v_cvt_pk_bf16_f32 v73, v60, v61
    v_mfma_f32_16x16x32_bf16 v[180:183], a[184:187], v[144:147], v[180:183]
    v_exp_f32 v62, v172
    v_mfma_f32_16x16x32_bf16 v[180:183], a[188:191], v[156:159], v[180:183]
    v_exp_f32 v63, v173
    s_waitcnt lgkmcnt(0)
    v_mfma_f32_16x16x32_bf16 v[184:187], a[144:147], v[88:91], v[40:43]
    ds_read_b128 a[168:171], v242 offset:38464
    v_exp_f32 v38, v174
    v_mfma_f32_16x16x32_bf16 v[184:187], a[148:151], v[100:103], v[184:187]
    ds_read_b128 a[172:175], v243 offset:38464
    v_mfma_f32_16x16x32_bf16 v[184:187], a[152:155], v[112:115], v[184:187]
    v_exp_f32 v39, v175
    v_mfma_f32_16x16x32_bf16 v[184:187], a[156:159], v[124:127], v[184:187]
    ds_read_b128 a[176:179], v242 offset:38592
    v_add_f32 v55, v55, v62
    v_add_f32 v55, v55, v63
    v_mfma_f32_16x16x32_bf16 v[184:187], a[160:163], v[136:139], v[184:187]
    v_cvt_pk_bf16_f32 v66, v62, v63
    v_add_f32 v55, v55, v38
    v_mfma_f32_16x16x32_bf16 v[184:187], a[164:167], v[148:151], v[184:187]
    ds_read_b128 a[180:183], v243 offset:38592
    v_add_f32 v55, v55, v39
    v_mfma_f32_16x16x32_bf16 v[188:191], a[144:147], v[92:95], v[44:47]
    v_cvt_pk_bf16_f32 v67, v38, v39
    v_mfma_f32_16x16x32_bf16 v[188:191], a[148:151], v[104:107], v[188:191]
    ds_read_b128 a[184:187], v242 offset:38720
    v_exp_f32 v58, v176
    v_mfma_f32_16x16x32_bf16 v[188:191], a[152:155], v[116:119], v[188:191]
    v_exp_f32 v59, v177
    v_mfma_f32_16x16x32_bf16 v[188:191], a[156:159], v[128:131], v[188:191]
    ds_read_b128 a[188:191], v243 offset:38720
    v_mfma_f32_16x16x32_bf16 v[188:191], a[160:163], v[140:143], v[188:191]
    v_exp_f32 v60, v178
    v_mfma_f32_16x16x32_bf16 v[188:191], a[164:167], v[152:155], v[188:191]
    v_exp_f32 v61, v179
    v_mfma_f32_16x16x32_bf16 v[192:195], a[144:147], v[96:99], v[48:51]
    v_add_f32 v56, v56, v58
    v_add_f32 v56, v56, v59
    v_mfma_f32_16x16x32_bf16 v[192:195], a[148:151], v[108:111], v[192:195]
    v_cvt_pk_bf16_f32 v70, v58, v59
    v_add_f32 v56, v56, v60
    v_add_f32 v56, v56, v61
    v_mfma_f32_16x16x32_bf16 v[192:195], a[152:155], v[120:123], v[192:195]
    v_cvt_pk_bf16_f32 v71, v60, v61
    v_mfma_f32_16x16x32_bf16 v[192:195], a[156:159], v[132:135], v[192:195]
    v_exp_f32 v62, v180
    v_mfma_f32_16x16x32_bf16 v[192:195], a[160:163], v[144:147], v[192:195]
    v_exp_f32 v63, v181
    v_mfma_f32_16x16x32_bf16 v[192:195], a[164:167], v[156:159], v[192:195]
    v_exp_f32 v38, v182
    s_waitcnt lgkmcnt(0)
    v_mfma_f32_16x16x32_bf16 v[196:199], a[168:171], v[88:91], v[40:43]
    ds_read_b64_tr_b16 a[144:145], v244 offset:0
    v_mfma_f32_16x16x32_bf16 v[196:199], a[172:175], v[100:103], v[196:199]
    ds_read_b64_tr_b16 a[146:147], v244 offset:1536
    v_mfma_f32_16x16x32_bf16 v[196:199], a[176:179], v[112:115], v[196:199]
    ds_read_b64_tr_b16 a[148:149], v244 offset:12288
    v_exp_f32 v39, v183
    v_mfma_f32_16x16x32_bf16 v[196:199], a[180:183], v[124:127], v[196:199]
    ds_read_b64_tr_b16 a[150:151], v244 offset:13824
    v_add_f32 v57, v57, v62
    v_mfma_f32_16x16x32_bf16 v[196:199], a[184:187], v[136:139], v[196:199]
    ds_read_b64_tr_b16 a[152:153], v245 offset:0
    v_add_f32 v57, v57, v63
    v_mfma_f32_16x16x32_bf16 v[196:199], a[188:191], v[148:151], v[196:199]
    ds_read_b64_tr_b16 a[154:155], v245 offset:1536
    v_cvt_pk_bf16_f32 v74, v62, v63
    v_add_f32 v57, v57, v38
    v_mfma_f32_16x16x32_bf16 v[200:203], a[168:171], v[92:95], v[44:47]
    ds_read_b64_tr_b16 a[156:157], v245 offset:12288
    v_add_f32 v57, v57, v39
    v_mfma_f32_16x16x32_bf16 v[200:203], a[172:175], v[104:107], v[200:203]
    ds_read_b64_tr_b16 a[158:159], v245 offset:13824
    v_cvt_pk_bf16_f32 v75, v38, v39
    v_mfma_f32_16x16x32_bf16 v[200:203], a[176:179], v[116:119], v[200:203]
    ds_read_b64_tr_b16 a[160:161], v246 offset:0
    v_exp_f32 v58, v184
    v_mfma_f32_16x16x32_bf16 v[200:203], a[180:183], v[128:131], v[200:203]
    ds_read_b64_tr_b16 a[162:163], v246 offset:1536
    v_mfma_f32_16x16x32_bf16 v[200:203], a[184:187], v[140:143], v[200:203]
    ds_read_b64_tr_b16 a[164:165], v246 offset:12288
    v_mfma_f32_16x16x32_bf16 v[200:203], a[188:191], v[152:155], v[200:203]
    ds_read_b64_tr_b16 a[166:167], v246 offset:13824
    v_exp_f32 v59, v185
    v_mfma_f32_16x16x32_bf16 v[204:207], a[168:171], v[96:99], v[48:51]
    v_exp_f32 v60, v186
    v_mfma_f32_16x16x32_bf16 v[204:207], a[172:175], v[108:111], v[204:207]
    v_exp_f32 v61, v187
    v_mfma_f32_16x16x32_bf16 v[204:207], a[176:179], v[120:123], v[204:207]
    v_add_f32 v55, v55, v58
    v_add_f32 v55, v55, v59
    v_mfma_f32_16x16x32_bf16 v[204:207], a[180:183], v[132:135], v[204:207]
    v_cvt_pk_bf16_f32 v76, v58, v59
    v_add_f32 v55, v55, v60
    v_add_f32 v55, v55, v61
    v_mfma_f32_16x16x32_bf16 v[204:207], a[184:187], v[144:147], v[204:207]
    v_cvt_pk_bf16_f32 v77, v60, v61
    v_mfma_f32_16x16x32_bf16 v[204:207], a[188:191], v[156:159], v[204:207]
    v_exp_f32 v62, v188
    s_waitcnt lgkmcnt(0)
    v_mfma_f32_16x16x32_bf16 a[0:3], a[144:147], v[208:211], 0
    ds_read_b64_tr_b16 a[168:169], v247 offset:0
    v_exp_f32 v63, v189
    v_mfma_f32_16x16x32_bf16 a[0:3], a[148:151], v[220:223], a[0:3]
    ds_read_b64_tr_b16 a[170:171], v247 offset:1536
    v_mfma_f32_16x16x32_bf16 a[4:7], a[144:147], v[212:215], 0
    ds_read_b64_tr_b16 a[172:173], v247 offset:12288
    v_mfma_f32_16x16x32_bf16 a[4:7], a[148:151], v[224:227], a[4:7]
    ds_read_b64_tr_b16 a[174:175], v247 offset:13824
    v_exp_f32 v38, v190
    v_mfma_f32_16x16x32_bf16 a[8:11], a[144:147], v[216:219], 0
    ds_read_b64_tr_b16 a[176:177], v244 offset:128
    v_mfma_f32_16x16x32_bf16 a[8:11], a[148:151], v[228:231], a[8:11]
    ds_read_b64_tr_b16 a[178:179], v244 offset:1664
    v_mfma_f32_16x16x32_bf16 a[12:15], a[152:155], v[208:211], 0
    ds_read_b64_tr_b16 a[180:181], v244 offset:12416
    v_exp_f32 v39, v191
    v_mfma_f32_16x16x32_bf16 a[12:15], a[156:159], v[220:223], a[12:15]
    ds_read_b64_tr_b16 a[182:183], v244 offset:13952
    v_add_f32 v56, v56, v62
    v_mfma_f32_16x16x32_bf16 a[16:19], a[152:155], v[212:215], 0
    ds_read_b64_tr_b16 a[184:185], v245 offset:128
    v_add_f32 v56, v56, v63
    v_mfma_f32_16x16x32_bf16 a[16:19], a[156:159], v[224:227], a[16:19]
    ds_read_b64_tr_b16 a[186:187], v245 offset:1664
    v_cvt_pk_bf16_f32 v80, v62, v63
    v_mfma_f32_16x16x32_bf16 a[20:23], a[152:155], v[216:219], 0
    ds_read_b64_tr_b16 a[188:189], v245 offset:12416
    v_add_f32 v56, v56, v38
    v_add_f32 v56, v56, v39
    v_mfma_f32_16x16x32_bf16 a[20:23], a[156:159], v[228:231], a[20:23]
    ds_read_b64_tr_b16 a[190:191], v245 offset:13952
    v_cvt_pk_bf16_f32 v81, v38, v39
    v_mfma_f32_16x16x32_bf16 a[24:27], a[160:163], v[208:211], 0
    v_exp_f32 v58, v192
    v_mfma_f32_16x16x32_bf16 a[24:27], a[164:167], v[220:223], a[24:27]
    v_exp_f32 v59, v193
    v_mfma_f32_16x16x32_bf16 a[28:31], a[160:163], v[212:215], 0
    v_exp_f32 v60, v194
    v_mfma_f32_16x16x32_bf16 a[28:31], a[164:167], v[224:227], a[28:31]
    v_exp_f32 v61, v195
    v_mfma_f32_16x16x32_bf16 a[32:35], a[160:163], v[216:219], 0
    v_add_f32 v57, v57, v58
    v_add_f32 v57, v57, v59
    v_cvt_pk_bf16_f32 v84, v58, v59
    v_mfma_f32_16x16x32_bf16 a[32:35], a[164:167], v[228:231], a[32:35]
    v_add_f32 v57, v57, v60
    v_add_f32 v57, v57, v61
    s_waitcnt lgkmcnt(0)
    v_mfma_f32_16x16x32_bf16 a[36:39], a[168:171], v[208:211], 0
    ds_read_b64_tr_b16 a[144:145], v246 offset:128
    v_cvt_pk_bf16_f32 v85, v60, v61
    v_mfma_f32_16x16x32_bf16 a[36:39], a[172:175], v[220:223], a[36:39]
    ds_read_b64_tr_b16 a[146:147], v246 offset:1664
    v_exp_f32 v62, v196
    v_mfma_f32_16x16x32_bf16 a[40:43], a[168:171], v[212:215], 0
    ds_read_b64_tr_b16 a[148:149], v246 offset:12416
    v_mfma_f32_16x16x32_bf16 a[40:43], a[172:175], v[224:227], a[40:43]
    ds_read_b64_tr_b16 a[150:151], v246 offset:13952
    v_mfma_f32_16x16x32_bf16 a[44:47], a[168:171], v[216:219], 0
    ds_read_b64_tr_b16 a[152:153], v247 offset:128
    v_mfma_f32_16x16x32_bf16 a[44:47], a[172:175], v[228:231], a[44:47]
    ds_read_b64_tr_b16 a[154:155], v247 offset:1664
    v_exp_f32 v63, v197
    v_mfma_f32_16x16x32_bf16 a[48:51], a[176:179], v[208:211], 0
    ds_read_b64_tr_b16 a[156:157], v247 offset:12416
    v_mfma_f32_16x16x32_bf16 a[48:51], a[180:183], v[220:223], a[48:51]
    ds_read_b64_tr_b16 a[158:159], v247 offset:13952
    v_mfma_f32_16x16x32_bf16 a[52:55], a[176:179], v[212:215], 0
    ds_read_b64_tr_b16 a[160:161], v244 offset:256
    v_exp_f32 v38, v198
    v_mfma_f32_16x16x32_bf16 a[52:55], a[180:183], v[224:227], a[52:55]
    ds_read_b64_tr_b16 a[162:163], v244 offset:1792
    v_mfma_f32_16x16x32_bf16 a[56:59], a[176:179], v[216:219], 0
    ds_read_b64_tr_b16 a[164:165], v244 offset:12544
    v_mfma_f32_16x16x32_bf16 a[56:59], a[180:183], v[228:231], a[56:59]
    ds_read_b64_tr_b16 a[166:167], v244 offset:14080
    v_exp_f32 v39, v199
    v_mfma_f32_16x16x32_bf16 a[60:63], a[184:187], v[208:211], 0
    v_add_f32 v55, v55, v62
    v_add_f32 v55, v55, v63
    v_mfma_f32_16x16x32_bf16 a[60:63], a[188:191], v[220:223], a[60:63]
    v_cvt_pk_bf16_f32 v78, v62, v63
    v_add_f32 v55, v55, v38
    v_mfma_f32_16x16x32_bf16 a[64:67], a[184:187], v[212:215], 0
    v_add_f32 v55, v55, v39
    v_cvt_pk_bf16_f32 v79, v38, v39
    v_mfma_f32_16x16x32_bf16 a[64:67], a[188:191], v[224:227], a[64:67]
    v_exp_f32 v58, v200
    v_mfma_f32_16x16x32_bf16 a[68:71], a[184:187], v[216:219], 0
    v_exp_f32 v59, v201
    v_mfma_f32_16x16x32_bf16 a[68:71], a[188:191], v[228:231], a[68:71]
    v_exp_f32 v60, v202
    s_waitcnt lgkmcnt(0)
    v_mfma_f32_16x16x32_bf16 a[72:75], a[144:147], v[208:211], 0
    ds_read_b64_tr_b16 a[168:169], v245 offset:256
    v_exp_f32 v61, v203
    v_mfma_f32_16x16x32_bf16 a[72:75], a[148:151], v[220:223], a[72:75]
    ds_read_b64_tr_b16 a[170:171], v245 offset:1792
    v_add_f32 v56, v56, v58
    v_mfma_f32_16x16x32_bf16 a[76:79], a[144:147], v[212:215], 0
    ds_read_b64_tr_b16 a[172:173], v245 offset:12544
    v_add_f32 v56, v56, v59
    v_mfma_f32_16x16x32_bf16 a[76:79], a[148:151], v[224:227], a[76:79]
    ds_read_b64_tr_b16 a[174:175], v245 offset:14080
    v_cvt_pk_bf16_f32 v82, v58, v59
    v_add_f32 v56, v56, v60
    v_mfma_f32_16x16x32_bf16 a[80:83], a[144:147], v[216:219], 0
    ds_read_b64_tr_b16 a[176:177], v246 offset:256
    v_add_f32 v56, v56, v61
    v_mfma_f32_16x16x32_bf16 a[80:83], a[148:151], v[228:231], a[80:83]
    ds_read_b64_tr_b16 a[178:179], v246 offset:1792
    v_cvt_pk_bf16_f32 v83, v60, v61
    v_mfma_f32_16x16x32_bf16 a[84:87], a[152:155], v[208:211], 0
    ds_read_b64_tr_b16 a[180:181], v246 offset:12544
    v_exp_f32 v62, v204
    v_mfma_f32_16x16x32_bf16 a[84:87], a[156:159], v[220:223], a[84:87]
    ds_read_b64_tr_b16 a[182:183], v246 offset:14080
    v_mfma_f32_16x16x32_bf16 a[88:91], a[152:155], v[212:215], 0
    ds_read_b64_tr_b16 a[184:185], v247 offset:256
    v_mfma_f32_16x16x32_bf16 a[88:91], a[156:159], v[224:227], a[88:91]
    ds_read_b64_tr_b16 a[186:187], v247 offset:1792
    v_exp_f32 v63, v205
    v_mfma_f32_16x16x32_bf16 a[92:95], a[152:155], v[216:219], 0
    ds_read_b64_tr_b16 a[188:189], v247 offset:12544
    v_mfma_f32_16x16x32_bf16 a[92:95], a[156:159], v[228:231], a[92:95]
    ds_read_b64_tr_b16 a[190:191], v247 offset:14080
    v_mfma_f32_16x16x32_bf16 a[96:99], a[160:163], v[208:211], 0
    v_exp_f32 v38, v206
    v_mfma_f32_16x16x32_bf16 a[96:99], a[164:167], v[220:223], a[96:99]
    v_exp_f32 v39, v207
    v_add_f32 v57, v57, v62
    v_mfma_f32_16x16x32_bf16 a[100:103], a[160:163], v[212:215], 0
    v_add_f32 v57, v57, v63
    v_cvt_pk_bf16_f32 v86, v62, v63
    v_mfma_f32_16x16x32_bf16 a[100:103], a[164:167], v[224:227], a[100:103]
    v_add_f32 v57, v57, v38
    v_add_f32 v57, v57, v39
    v_mfma_f32_16x16x32_bf16 a[104:107], a[160:163], v[216:219], 0
    v_cvt_pk_bf16_f32 v87, v38, v39
    v_mfma_f32_16x16x32_bf16 a[104:107], a[164:167], v[228:231], a[104:107]
    s_waitcnt vmcnt(12)
    s_waitcnt lgkmcnt(0)
    s_barrier
    v_mfma_f32_16x16x32_bf16 a[108:111], a[168:171], v[208:211], 0
    ds_read_b128 a[144:147], v238 offset:24640
    v_mfma_f32_16x16x32_bf16 a[108:111], a[172:175], v[220:223], a[108:111]
    s_add_u32 m0, s29, 123200
    s_mov_b32 s35, 98304
    v_mfma_f32_16x16x32_bf16 a[112:115], a[168:171], v[212:215], 0
    ds_read_b128 a[148:151], v239 offset:24640
    v_mfma_f32_16x16x32_bf16 a[112:115], a[172:175], v[224:227], a[112:115]
    buffer_load_dwordx4 v20, s[12:15], s35 offen offset:0 nt lds
    v_mfma_f32_16x16x32_bf16 a[116:119], a[168:171], v[216:219], 0
    ds_read_b128 a[152:155], v238 offset:24768
    v_mfma_f32_16x16x32_bf16 a[116:119], a[172:175], v[228:231], a[116:119]
    buffer_load_dwordx4 v21, s[12:15], s35 offen offset:1024 nt lds
    v_mfma_f32_16x16x32_bf16 a[120:123], a[176:179], v[208:211], 0
    ds_read_b128 a[156:159], v239 offset:24768
    v_mfma_f32_16x16x32_bf16 a[120:123], a[180:183], v[220:223], a[120:123]
    buffer_load_dwordx4 v22, s[12:15], s35 offen offset:2048 nt lds
    v_mfma_f32_16x16x32_bf16 a[124:127], a[176:179], v[212:215], 0
    ds_read_b128 a[160:163], v238 offset:24896
    v_mfma_f32_16x16x32_bf16 a[124:127], a[180:183], v[224:227], a[124:127]
    buffer_load_dwordx4 v23, s[12:15], s35 offen offset:3072 nt lds
    v_mfma_f32_16x16x32_bf16 a[128:131], a[176:179], v[216:219], 0
    ds_read_b128 a[164:167], v239 offset:24896
    v_mfma_f32_16x16x32_bf16 a[128:131], a[180:183], v[228:231], a[128:131]
    s_add_u32 m0, s29, 127296
    v_mfma_f32_16x16x32_bf16 a[132:135], a[184:187], v[208:211], 0
    v_mfma_f32_16x16x32_bf16 a[132:135], a[188:191], v[220:223], a[132:135]
    buffer_load_dwordx4 v24, s[12:15], s35 offen offset:0 nt lds
    v_mfma_f32_16x16x32_bf16 a[136:139], a[184:187], v[212:215], 0
    v_mfma_f32_16x16x32_bf16 a[136:139], a[188:191], v[224:227], a[136:139]
    buffer_load_dwordx4 v25, s[12:15], s35 offen offset:1024 nt lds
    v_mfma_f32_16x16x32_bf16 a[140:143], a[184:187], v[216:219], 0
    v_mfma_f32_16x16x32_bf16 a[140:143], a[188:191], v[228:231], a[140:143]
    v_max3_f32 v1, v55, v56, v57
    v_cmp_lt_f32 vcc, s40, v1
    s_cbranch_vccnz L_stub_1
L_ret_1:
    v_add_f32 v52, v52, v55
    v_add_f32 v53, v53, v56
    v_add_f32 v54, v54, v57
    s_waitcnt lgkmcnt(0)
    v_mfma_f32_16x16x32_bf16 v[160:163], a[144:147], v[88:91], v[40:43]
    ds_read_b128 a[168:171], v238 offset:26176
    s_add_u32 m0, s29, 0
    s_mov_b32 s36, 73728
    v_mfma_f32_16x16x32_bf16 v[160:163], a[148:151], v[100:103], v[160:163]
    ds_read_b128 a[172:175], v239 offset:26176
    v_mfma_f32_16x16x32_bf16 v[160:163], a[152:155], v[112:115], v[160:163]
    buffer_load_dwordx4 v26, s[16:19], s36 offen offset:0 nt lds
    v_mfma_f32_16x16x32_bf16 v[160:163], a[156:159], v[124:127], v[160:163]
    ds_read_b128 a[176:179], v238 offset:26304
    v_mfma_f32_16x16x32_bf16 v[160:163], a[160:163], v[136:139], v[160:163]
    buffer_load_dwordx4 v27, s[16:19], s36 offen offset:1024 nt lds
    v_mfma_f32_16x16x32_bf16 v[160:163], a[164:167], v[148:151], v[160:163]
    ds_read_b128 a[180:183], v239 offset:26304
    v_mfma_f32_16x16x32_bf16 v[164:167], a[144:147], v[92:95], v[44:47]
    buffer_load_dwordx4 v28, s[16:19], s36 offen offset:2048 nt lds
    v_mfma_f32_16x16x32_bf16 v[164:167], a[148:151], v[104:107], v[164:167]
    ds_read_b128 a[184:187], v238 offset:26432
    v_mfma_f32_16x16x32_bf16 v[164:167], a[152:155], v[116:119], v[164:167]
    v_mfma_f32_16x16x32_bf16 v[164:167], a[156:159], v[128:131], v[164:167]
    ds_read_b128 a[188:191], v239 offset:26432
    buffer_load_dwordx4 v29, s[16:19], s36 offen offset:3072 nt lds
    v_mfma_f32_16x16x32_bf16 v[164:167], a[160:163], v[140:143], v[164:167]
    v_exp_f32 v58, v160
    v_mfma_f32_16x16x32_bf16 v[164:167], a[164:167], v[152:155], v[164:167]
    s_add_u32 m0, s29, 4096
    v_mfma_f32_16x16x32_bf16 v[168:171], a[144:147], v[96:99], v[48:51]
    v_exp_f32 v59, v161
    v_mfma_f32_16x16x32_bf16 v[168:171], a[148:151], v[108:111], v[168:171]
    buffer_load_dwordx4 v30, s[16:19], s36 offen offset:0 nt lds
    v_exp_f32 v60, v162
    v_mfma_f32_16x16x32_bf16 v[168:171], a[152:155], v[120:123], v[168:171]
    v_exp_f32 v61, v163
    v_mfma_f32_16x16x32_bf16 v[168:171], a[156:159], v[132:135], v[168:171]
    buffer_load_dwordx4 v31, s[16:19], s36 offen offset:1024 nt lds
    v_add_f32 v55, v58, v59
    v_mfma_f32_16x16x32_bf16 v[168:171], a[160:163], v[144:147], v[168:171]
    v_cvt_pk_bf16_f32 v208, v58, v59
    v_add_f32 v55, v55, v60
    v_mfma_f32_16x16x32_bf16 v[168:171], a[164:167], v[156:159], v[168:171]
    v_add_f32 v55, v55, v61
    v_cvt_pk_bf16_f32 v209, v60, v61
    s_waitcnt lgkmcnt(0)
    v_mfma_f32_16x16x32_bf16 v[172:175], a[168:171], v[88:91], v[40:43]
    ds_read_b128 a[144:147], v238 offset:36928
    v_mfma_f32_16x16x32_bf16 v[172:175], a[172:175], v[100:103], v[172:175]
    ds_read_b128 a[148:151], v239 offset:36928
    v_mfma_f32_16x16x32_bf16 v[172:175], a[176:179], v[112:115], v[172:175]
    v_exp_f32 v62, v164
    v_mfma_f32_16x16x32_bf16 v[172:175], a[180:183], v[124:127], v[172:175]
    ds_read_b128 a[152:155], v238 offset:37056
    v_mfma_f32_16x16x32_bf16 v[172:175], a[184:187], v[136:139], v[172:175]
    v_exp_f32 v63, v165
    v_mfma_f32_16x16x32_bf16 v[172:175], a[188:191], v[148:151], v[172:175]
    ds_read_b128 a[156:159], v239 offset:37056
    v_exp_f32 v38, v166
    v_mfma_f32_16x16x32_bf16 v[176:179], a[168:171], v[92:95], v[44:47]
    v_exp_f32 v39, v167
    v_mfma_f32_16x16x32_bf16 v[176:179], a[172:175], v[104:107], v[176:179]
    ds_read_b128 a[160:163], v238 offset:37184
    v_add_f32 v56, v62, v63
    v_mfma_f32_16x16x32_bf16 v[176:179], a[176:179], v[116:119], v[176:179]
    v_cvt_pk_bf16_f32 v212, v62, v63
    v_add_f32 v56, v56, v38
    v_add_f32 v56, v56, v39
    v_mfma_f32_16x16x32_bf16 v[176:179], a[180:183], v[128:131], v[176:179]
    ds_read_b128 a[164:167], v239 offset:37184
    v_cvt_pk_bf16_f32 v213, v38, v39
    v_mfma_f32_16x16x32_bf16 v[176:179], a[184:187], v[140:143], v[176:179]
    v_exp_f32 v58, v168
    v_mfma_f32_16x16x32_bf16 v[176:179], a[188:191], v[152:155], v[176:179]
    v_exp_f32 v59, v169
    v_mfma_f32_16x16x32_bf16 v[180:183], a[168:171], v[96:99], v[48:51]
    v_exp_f32 v60, v170
    v_mfma_f32_16x16x32_bf16 v[180:183], a[172:175], v[108:111], v[180:183]
    v_exp_f32 v61, v171
    v_mfma_f32_16x16x32_bf16 v[180:183], a[176:179], v[120:123], v[180:183]
    v_add_f32 v57, v58, v59
    v_cvt_pk_bf16_f32 v216, v58, v59
    v_mfma_f32_16x16x32_bf16 v[180:183], a[180:183], v[132:135], v[180:183]
    v_add_f32 v57, v57, v60
    v_add_f32 v57, v57, v61
    v_cvt_pk_bf16_f32 v217, v60, v61
    v_mfma_f32_16x16x32_bf16 v[180:183], a[184:187], v[144:147], v[180:183]
    v_exp_f32 v62, v172
    v_mfma_f32_16x16x32_bf16 v[180:183], a[188:191], v[156:159], v[180:183]
    v_exp_f32 v63, v173
    s_waitcnt lgkmcnt(0)
    v_mfma_f32_16x16x32_bf16 v[184:187], a[144:147], v[88:91], v[40:43]
    ds_read_b128 a[168:171], v238 offset:38464
    v_exp_f32 v38, v174
    v_mfma_f32_16x16x32_bf16 v[184:187], a[148:151], v[100:103], v[184:187]
    ds_read_b128 a[172:175], v239 offset:38464
    v_mfma_f32_16x16x32_bf16 v[184:187], a[152:155], v[112:115], v[184:187]
    v_exp_f32 v39, v175
    v_mfma_f32_16x16x32_bf16 v[184:187], a[156:159], v[124:127], v[184:187]
    ds_read_b128 a[176:179], v238 offset:38592
    v_add_f32 v55, v55, v62
    v_add_f32 v55, v55, v63
    v_mfma_f32_16x16x32_bf16 v[184:187], a[160:163], v[136:139], v[184:187]
    v_cvt_pk_bf16_f32 v210, v62, v63
    v_add_f32 v55, v55, v38
    v_mfma_f32_16x16x32_bf16 v[184:187], a[164:167], v[148:151], v[184:187]
    ds_read_b128 a[180:183], v239 offset:38592
    v_add_f32 v55, v55, v39
    v_mfma_f32_16x16x32_bf16 v[188:191], a[144:147], v[92:95], v[44:47]
    v_cvt_pk_bf16_f32 v211, v38, v39
    v_mfma_f32_16x16x32_bf16 v[188:191], a[148:151], v[104:107], v[188:191]
    ds_read_b128 a[184:187], v238 offset:38720
    v_exp_f32 v58, v176
    v_mfma_f32_16x16x32_bf16 v[188:191], a[152:155], v[116:119], v[188:191]
    v_exp_f32 v59, v177
    v_mfma_f32_16x16x32_bf16 v[188:191], a[156:159], v[128:131], v[188:191]
    ds_read_b128 a[188:191], v239 offset:38720
    v_mfma_f32_16x16x32_bf16 v[188:191], a[160:163], v[140:143], v[188:191]
    v_exp_f32 v60, v178
    v_mfma_f32_16x16x32_bf16 v[188:191], a[164:167], v[152:155], v[188:191]
    v_exp_f32 v61, v179
    v_mfma_f32_16x16x32_bf16 v[192:195], a[144:147], v[96:99], v[48:51]
    v_add_f32 v56, v56, v58
    v_add_f32 v56, v56, v59
    v_mfma_f32_16x16x32_bf16 v[192:195], a[148:151], v[108:111], v[192:195]
    v_cvt_pk_bf16_f32 v214, v58, v59
    v_add_f32 v56, v56, v60
    v_add_f32 v56, v56, v61
    v_mfma_f32_16x16x32_bf16 v[192:195], a[152:155], v[120:123], v[192:195]
    v_cvt_pk_bf16_f32 v215, v60, v61
    v_mfma_f32_16x16x32_bf16 v[192:195], a[156:159], v[132:135], v[192:195]
    v_exp_f32 v62, v180
    v_mfma_f32_16x16x32_bf16 v[192:195], a[160:163], v[144:147], v[192:195]
    v_exp_f32 v63, v181
    v_mfma_f32_16x16x32_bf16 v[192:195], a[164:167], v[156:159], v[192:195]
    v_exp_f32 v38, v182
    s_waitcnt lgkmcnt(0)
    v_mfma_f32_16x16x32_bf16 v[196:199], a[168:171], v[88:91], v[40:43]
    ds_read_b64_tr_b16 a[144:145], v248 offset:0
    v_mfma_f32_16x16x32_bf16 v[196:199], a[172:175], v[100:103], v[196:199]
    ds_read_b64_tr_b16 a[146:147], v248 offset:1536
    v_mfma_f32_16x16x32_bf16 v[196:199], a[176:179], v[112:115], v[196:199]
    ds_read_b64_tr_b16 a[148:149], v248 offset:12288
    v_exp_f32 v39, v183
    v_mfma_f32_16x16x32_bf16 v[196:199], a[180:183], v[124:127], v[196:199]
    ds_read_b64_tr_b16 a[150:151], v248 offset:13824
    v_add_f32 v57, v57, v62
    v_mfma_f32_16x16x32_bf16 v[196:199], a[184:187], v[136:139], v[196:199]
    ds_read_b64_tr_b16 a[152:153], v249 offset:0
    v_add_f32 v57, v57, v63
    v_mfma_f32_16x16x32_bf16 v[196:199], a[188:191], v[148:151], v[196:199]
    ds_read_b64_tr_b16 a[154:155], v249 offset:1536
    v_cvt_pk_bf16_f32 v218, v62, v63
    v_add_f32 v57, v57, v38
    v_mfma_f32_16x16x32_bf16 v[200:203], a[168:171], v[92:95], v[44:47]
    ds_read_b64_tr_b16 a[156:157], v249 offset:12288
    v_add_f32 v57, v57, v39
    v_mfma_f32_16x16x32_bf16 v[200:203], a[172:175], v[104:107], v[200:203]
    ds_read_b64_tr_b16 a[158:159], v249 offset:13824
    v_cvt_pk_bf16_f32 v219, v38, v39
    v_mfma_f32_16x16x32_bf16 v[200:203], a[176:179], v[116:119], v[200:203]
    ds_read_b64_tr_b16 a[160:161], v250 offset:0
    v_exp_f32 v58, v184
    v_mfma_f32_16x16x32_bf16 v[200:203], a[180:183], v[128:131], v[200:203]
    ds_read_b64_tr_b16 a[162:163], v250 offset:1536
    v_mfma_f32_16x16x32_bf16 v[200:203], a[184:187], v[140:143], v[200:203]
    ds_read_b64_tr_b16 a[164:165], v250 offset:12288
    v_mfma_f32_16x16x32_bf16 v[200:203], a[188:191], v[152:155], v[200:203]
    ds_read_b64_tr_b16 a[166:167], v250 offset:13824
    v_exp_f32 v59, v185
    v_mfma_f32_16x16x32_bf16 v[204:207], a[168:171], v[96:99], v[48:51]
    v_exp_f32 v60, v186
    v_mfma_f32_16x16x32_bf16 v[204:207], a[172:175], v[108:111], v[204:207]
    v_exp_f32 v61, v187
    v_mfma_f32_16x16x32_bf16 v[204:207], a[176:179], v[120:123], v[204:207]
    v_add_f32 v55, v55, v58
    v_add_f32 v55, v55, v59
    v_mfma_f32_16x16x32_bf16 v[204:207], a[180:183], v[132:135], v[204:207]
    v_cvt_pk_bf16_f32 v220, v58, v59
    v_add_f32 v55, v55, v60
    v_add_f32 v55, v55, v61
    v_mfma_f32_16x16x32_bf16 v[204:207], a[184:187], v[144:147], v[204:207]
    v_cvt_pk_bf16_f32 v221, v60, v61
    v_mfma_f32_16x16x32_bf16 v[204:207], a[188:191], v[156:159], v[204:207]
    v_exp_f32 v62, v188
    s_waitcnt lgkmcnt(0)
    v_mfma_f32_16x16x32_bf16 a[0:3], a[144:147], v[64:67], a[0:3]
    ds_read_b64_tr_b16 a[168:169], v251 offset:0
    v_exp_f32 v63, v189
    v_mfma_f32_16x16x32_bf16 a[0:3], a[148:151], v[76:79], a[0:3]
    ds_read_b64_tr_b16 a[170:171], v251 offset:1536
    v_mfma_f32_16x16x32_bf16 a[4:7], a[144:147], v[68:71], a[4:7]
    ds_read_b64_tr_b16 a[172:173], v251 offset:12288
    v_mfma_f32_16x16x32_bf16 a[4:7], a[148:151], v[80:83], a[4:7]
    ds_read_b64_tr_b16 a[174:175], v251 offset:13824
    v_exp_f32 v38, v190
    v_mfma_f32_16x16x32_bf16 a[8:11], a[144:147], v[72:75], a[8:11]
    ds_read_b64_tr_b16 a[176:177], v248 offset:128
    v_mfma_f32_16x16x32_bf16 a[8:11], a[148:151], v[84:87], a[8:11]
    ds_read_b64_tr_b16 a[178:179], v248 offset:1664
    v_mfma_f32_16x16x32_bf16 a[12:15], a[152:155], v[64:67], a[12:15]
    ds_read_b64_tr_b16 a[180:181], v248 offset:12416
    v_exp_f32 v39, v191
    v_mfma_f32_16x16x32_bf16 a[12:15], a[156:159], v[76:79], a[12:15]
    ds_read_b64_tr_b16 a[182:183], v248 offset:13952
    v_add_f32 v56, v56, v62
    v_mfma_f32_16x16x32_bf16 a[16:19], a[152:155], v[68:71], a[16:19]
    ds_read_b64_tr_b16 a[184:185], v249 offset:128
    v_add_f32 v56, v56, v63
    v_mfma_f32_16x16x32_bf16 a[16:19], a[156:159], v[80:83], a[16:19]
    ds_read_b64_tr_b16 a[186:187], v249 offset:1664
    v_cvt_pk_bf16_f32 v224, v62, v63
    v_mfma_f32_16x16x32_bf16 a[20:23], a[152:155], v[72:75], a[20:23]
    ds_read_b64_tr_b16 a[188:189], v249 offset:12416
    v_add_f32 v56, v56, v38
    v_add_f32 v56, v56, v39
    v_mfma_f32_16x16x32_bf16 a[20:23], a[156:159], v[84:87], a[20:23]
    ds_read_b64_tr_b16 a[190:191], v249 offset:13952
    v_cvt_pk_bf16_f32 v225, v38, v39
    v_mfma_f32_16x16x32_bf16 a[24:27], a[160:163], v[64:67], a[24:27]
    v_exp_f32 v58, v192
    v_mfma_f32_16x16x32_bf16 a[24:27], a[164:167], v[76:79], a[24:27]
    v_exp_f32 v59, v193
    v_mfma_f32_16x16x32_bf16 a[28:31], a[160:163], v[68:71], a[28:31]
    v_exp_f32 v60, v194
    v_mfma_f32_16x16x32_bf16 a[28:31], a[164:167], v[80:83], a[28:31]
    v_exp_f32 v61, v195
    v_mfma_f32_16x16x32_bf16 a[32:35], a[160:163], v[72:75], a[32:35]
    v_add_f32 v57, v57, v58
    v_add_f32 v57, v57, v59
    v_cvt_pk_bf16_f32 v228, v58, v59
    v_mfma_f32_16x16x32_bf16 a[32:35], a[164:167], v[84:87], a[32:35]
    v_add_f32 v57, v57, v60
    v_add_f32 v57, v57, v61
    s_waitcnt lgkmcnt(0)
    v_mfma_f32_16x16x32_bf16 a[36:39], a[168:171], v[64:67], a[36:39]
    ds_read_b64_tr_b16 a[144:145], v250 offset:128
    v_cvt_pk_bf16_f32 v229, v60, v61
    v_mfma_f32_16x16x32_bf16 a[36:39], a[172:175], v[76:79], a[36:39]
    ds_read_b64_tr_b16 a[146:147], v250 offset:1664
    v_exp_f32 v62, v196
    v_mfma_f32_16x16x32_bf16 a[40:43], a[168:171], v[68:71], a[40:43]
    ds_read_b64_tr_b16 a[148:149], v250 offset:12416
    v_mfma_f32_16x16x32_bf16 a[40:43], a[172:175], v[80:83], a[40:43]
    ds_read_b64_tr_b16 a[150:151], v250 offset:13952
    v_mfma_f32_16x16x32_bf16 a[44:47], a[168:171], v[72:75], a[44:47]
    ds_read_b64_tr_b16 a[152:153], v251 offset:128
    v_mfma_f32_16x16x32_bf16 a[44:47], a[172:175], v[84:87], a[44:47]
    ds_read_b64_tr_b16 a[154:155], v251 offset:1664
    v_exp_f32 v63, v197
    v_mfma_f32_16x16x32_bf16 a[48:51], a[176:179], v[64:67], a[48:51]
    ds_read_b64_tr_b16 a[156:157], v251 offset:12416
    v_mfma_f32_16x16x32_bf16 a[48:51], a[180:183], v[76:79], a[48:51]
    ds_read_b64_tr_b16 a[158:159], v251 offset:13952
    v_mfma_f32_16x16x32_bf16 a[52:55], a[176:179], v[68:71], a[52:55]
    ds_read_b64_tr_b16 a[160:161], v248 offset:256
    v_exp_f32 v38, v198
    v_mfma_f32_16x16x32_bf16 a[52:55], a[180:183], v[80:83], a[52:55]
    ds_read_b64_tr_b16 a[162:163], v248 offset:1792
    v_mfma_f32_16x16x32_bf16 a[56:59], a[176:179], v[72:75], a[56:59]
    ds_read_b64_tr_b16 a[164:165], v248 offset:12544
    v_mfma_f32_16x16x32_bf16 a[56:59], a[180:183], v[84:87], a[56:59]
    ds_read_b64_tr_b16 a[166:167], v248 offset:14080
    v_exp_f32 v39, v199
    v_mfma_f32_16x16x32_bf16 a[60:63], a[184:187], v[64:67], a[60:63]
    v_add_f32 v55, v55, v62
    v_add_f32 v55, v55, v63
    v_mfma_f32_16x16x32_bf16 a[60:63], a[188:191], v[76:79], a[60:63]
    v_cvt_pk_bf16_f32 v222, v62, v63
    v_add_f32 v55, v55, v38
    v_mfma_f32_16x16x32_bf16 a[64:67], a[184:187], v[68:71], a[64:67]
    v_add_f32 v55, v55, v39
    v_cvt_pk_bf16_f32 v223, v38, v39
    v_mfma_f32_16x16x32_bf16 a[64:67], a[188:191], v[80:83], a[64:67]
    v_exp_f32 v58, v200
    v_mfma_f32_16x16x32_bf16 a[68:71], a[184:187], v[72:75], a[68:71]
    v_exp_f32 v59, v201
    v_mfma_f32_16x16x32_bf16 a[68:71], a[188:191], v[84:87], a[68:71]
    v_exp_f32 v60, v202
    s_waitcnt lgkmcnt(0)
    v_mfma_f32_16x16x32_bf16 a[72:75], a[144:147], v[64:67], a[72:75]
    ds_read_b64_tr_b16 a[168:169], v249 offset:256
    v_exp_f32 v61, v203
    v_mfma_f32_16x16x32_bf16 a[72:75], a[148:151], v[76:79], a[72:75]
    ds_read_b64_tr_b16 a[170:171], v249 offset:1792
    v_add_f32 v56, v56, v58
    v_mfma_f32_16x16x32_bf16 a[76:79], a[144:147], v[68:71], a[76:79]
    ds_read_b64_tr_b16 a[172:173], v249 offset:12544
    v_add_f32 v56, v56, v59
    v_mfma_f32_16x16x32_bf16 a[76:79], a[148:151], v[80:83], a[76:79]
    ds_read_b64_tr_b16 a[174:175], v249 offset:14080
    v_cvt_pk_bf16_f32 v226, v58, v59
    v_add_f32 v56, v56, v60
    v_mfma_f32_16x16x32_bf16 a[80:83], a[144:147], v[72:75], a[80:83]
    ds_read_b64_tr_b16 a[176:177], v250 offset:256
    v_add_f32 v56, v56, v61
    v_mfma_f32_16x16x32_bf16 a[80:83], a[148:151], v[84:87], a[80:83]
    ds_read_b64_tr_b16 a[178:179], v250 offset:1792
    v_cvt_pk_bf16_f32 v227, v60, v61
    v_mfma_f32_16x16x32_bf16 a[84:87], a[152:155], v[64:67], a[84:87]
    ds_read_b64_tr_b16 a[180:181], v250 offset:12544
    v_exp_f32 v62, v204
    v_mfma_f32_16x16x32_bf16 a[84:87], a[156:159], v[76:79], a[84:87]
    ds_read_b64_tr_b16 a[182:183], v250 offset:14080
    v_mfma_f32_16x16x32_bf16 a[88:91], a[152:155], v[68:71], a[88:91]
    ds_read_b64_tr_b16 a[184:185], v251 offset:256
    v_mfma_f32_16x16x32_bf16 a[88:91], a[156:159], v[80:83], a[88:91]
    ds_read_b64_tr_b16 a[186:187], v251 offset:1792
    v_exp_f32 v63, v205
    v_mfma_f32_16x16x32_bf16 a[92:95], a[152:155], v[72:75], a[92:95]
    ds_read_b64_tr_b16 a[188:189], v251 offset:12544
    v_mfma_f32_16x16x32_bf16 a[92:95], a[156:159], v[84:87], a[92:95]
    ds_read_b64_tr_b16 a[190:191], v251 offset:14080
    v_mfma_f32_16x16x32_bf16 a[96:99], a[160:163], v[64:67], a[96:99]
    v_exp_f32 v38, v206
    v_mfma_f32_16x16x32_bf16 a[96:99], a[164:167], v[76:79], a[96:99]
    v_exp_f32 v39, v207
    v_add_f32 v57, v57, v62
    v_mfma_f32_16x16x32_bf16 a[100:103], a[160:163], v[68:71], a[100:103]
    v_add_f32 v57, v57, v63
    v_cvt_pk_bf16_f32 v230, v62, v63
    v_mfma_f32_16x16x32_bf16 a[100:103], a[164:167], v[80:83], a[100:103]
    v_add_f32 v57, v57, v38
    v_add_f32 v57, v57, v39
    v_mfma_f32_16x16x32_bf16 a[104:107], a[160:163], v[72:75], a[104:107]
    v_cvt_pk_bf16_f32 v231, v38, v39
    v_mfma_f32_16x16x32_bf16 a[104:107], a[164:167], v[84:87], a[104:107]
    s_waitcnt vmcnt(12)
    s_waitcnt lgkmcnt(0)
    s_barrier
    v_mfma_f32_16x16x32_bf16 a[108:111], a[168:171], v[64:67], a[108:111]
    ds_read_b128 a[144:147], v240 offset:24640
    v_mfma_f32_16x16x32_bf16 a[108:111], a[172:175], v[76:79], a[108:111]
    s_add_u32 m0, s29, 24640
    s_mov_b32 s35, 122880
    v_mfma_f32_16x16x32_bf16 a[112:115], a[168:171], v[68:71], a[112:115]
    ds_read_b128 a[148:151], v241 offset:24640
    v_mfma_f32_16x16x32_bf16 a[112:115], a[172:175], v[80:83], a[112:115]
    buffer_load_dwordx4 v20, s[12:15], s35 offen offset:0 nt lds
    v_mfma_f32_16x16x32_bf16 a[116:119], a[168:171], v[72:75], a[116:119]
    ds_read_b128 a[152:155], v240 offset:24768
    v_mfma_f32_16x16x32_bf16 a[116:119], a[172:175], v[84:87], a[116:119]
    buffer_load_dwordx4 v21, s[12:15], s35 offen offset:1024 nt lds
    v_mfma_f32_16x16x32_bf16 a[120:123], a[176:179], v[64:67], a[120:123]
    ds_read_b128 a[156:159], v241 offset:24768
    v_mfma_f32_16x16x32_bf16 a[120:123], a[180:183], v[76:79], a[120:123]
    buffer_load_dwordx4 v22, s[12:15], s35 offen offset:2048 nt lds
    v_mfma_f32_16x16x32_bf16 a[124:127], a[176:179], v[68:71], a[124:127]
    ds_read_b128 a[160:163], v240 offset:24896
    v_mfma_f32_16x16x32_bf16 a[124:127], a[180:183], v[80:83], a[124:127]
    buffer_load_dwordx4 v23, s[12:15], s35 offen offset:3072 nt lds
    v_mfma_f32_16x16x32_bf16 a[128:131], a[176:179], v[72:75], a[128:131]
    ds_read_b128 a[164:167], v241 offset:24896
    v_mfma_f32_16x16x32_bf16 a[128:131], a[180:183], v[84:87], a[128:131]
    s_add_u32 m0, s29, 28736
    v_mfma_f32_16x16x32_bf16 a[132:135], a[184:187], v[64:67], a[132:135]
    v_mfma_f32_16x16x32_bf16 a[132:135], a[188:191], v[76:79], a[132:135]
    buffer_load_dwordx4 v24, s[12:15], s35 offen offset:0 nt lds
    v_mfma_f32_16x16x32_bf16 a[136:139], a[184:187], v[68:71], a[136:139]
    v_mfma_f32_16x16x32_bf16 a[136:139], a[188:191], v[80:83], a[136:139]
    buffer_load_dwordx4 v25, s[12:15], s35 offen offset:1024 nt lds
    v_mfma_f32_16x16x32_bf16 a[140:143], a[184:187], v[72:75], a[140:143]
    v_mfma_f32_16x16x32_bf16 a[140:143], a[188:191], v[84:87], a[140:143]
    v_max3_f32 v1, v55, v56, v57
    v_cmp_lt_f32 vcc, s40, v1
    s_cbranch_vccnz L_stub_2
L_ret_2:
    v_add_f32 v52, v52, v55
    v_add_f32 v53, v53, v56
    v_add_f32 v54, v54, v57
    s_waitcnt lgkmcnt(0)
    v_mfma_f32_16x16x32_bf16 v[160:163], a[144:147], v[88:91], v[40:43]
    ds_read_b128 a[168:171], v240 offset:26176
    s_add_u32 m0, s29, 49280
    s_mov_b32 s36, 98304
    v_mfma_f32_16x16x32_bf16 v[160:163], a[148:151], v[100:103], v[160:163]
    ds_read_b128 a[172:175], v241 offset:26176
    v_mfma_f32_16x16x32_bf16 v[160:163], a[152:155], v[112:115], v[160:163]
    buffer_load_dwordx4 v26, s[16:19], s36 offen offset:0 nt lds
    v_mfma_f32_16x16x32_bf16 v[160:163], a[156:159], v[124:127], v[160:163]
    ds_read_b128 a[176:179], v240 offset:26304
    v_mfma_f32_16x16x32_bf16 v[160:163], a[160:163], v[136:139], v[160:163]
    buffer_load_dwordx4 v27, s[16:19], s36 offen offset:1024 nt lds
    v_mfma_f32_16x16x32_bf16 v[160:163], a[164:167], v[148:151], v[160:163]
    ds_read_b128 a[180:183], v241 offset:26304
    v_mfma_f32_16x16x32_bf16 v[164:167], a[144:147], v[92:95], v[44:47]
    buffer_load_dwordx4 v28, s[16:19], s36 offen offset:2048 nt lds
    v_mfma_f32_16x16x32_bf16 v[164:167], a[148:151], v[104:107], v[164:167]
    ds_read_b128 a[184:187], v240 offset:26432
    v_mfma_f32_16x16x32_bf16 v[164:167], a[152:155], v[116:119], v[164:167]
    v_mfma_f32_16x16x32_bf16 v[164:167], a[156:159], v[128:131], v[164:167]
    ds_read_b128 a[188:191], v241 offset:26432
    buffer_load_dwordx4 v29, s[16:19], s36 offen offset:3072 nt lds
    v_mfma_f32_16x16x32_bf16 v[164:167], a[160:163], v[140:143], v[164:167]
    v_exp_f32 v58, v160
    v_mfma_f32_16x16x32_bf16 v[164:167], a[164:167], v[152:155], v[164:167]
    s_add_u32 m0, s29, 53376
    v_mfma_f32_16x16x32_bf16 v[168:171], a[144:147], v[96:99], v[48:51]
    v_exp_f32 v59, v161
    v_mfma_f32_16x16x32_bf16 v[168:171], a[148:151], v[108:111], v[168:171]
    buffer_load_dwordx4 v30, s[16:19], s36 offen offset:0 nt lds
    v_exp_f32 v60, v162
    v_mfma_f32_16x16x32_bf16 v[168:171], a[152:155], v[120:123], v[168:171]
    v_exp_f32 v61, v163
    v_mfma_f32_16x16x32_bf16 v[168:171], a[156:159], v[132:135], v[168:171]
    buffer_load_dwordx4 v31, s[16:19], s36 offen offset:1024 nt lds
    v_add_f32 v55, v58, v59
    v_mfma_f32_16x16x32_bf16 v[168:171], a[160:163], v[144:147], v[168:171]
    v_cvt_pk_bf16_f32 v64, v58, v59
    v_add_f32 v55, v55, v60
    v_mfma_f32_16x16x32_bf16 v[168:171], a[164:167], v[156:159], v[168:171]
    v_add_f32 v55, v55, v61
    v_cvt_pk_bf16_f32 v65, v60, v61
    s_waitcnt lgkmcnt(0)
    v_mfma_f32_16x16x32_bf16 v[172:175], a[168:171], v[88:91], v[40:43]
    ds_read_b128 a[144:147], v240 offset:36928
    v_mfma_f32_16x16x32_bf16 v[172:175], a[172:175], v[100:103], v[172:175]
    ds_read_b128 a[148:151], v241 offset:36928
    v_mfma_f32_16x16x32_bf16 v[172:175], a[176:179], v[112:115], v[172:175]
    v_exp_f32 v62, v164
    v_mfma_f32_16x16x32_bf16 v[172:175], a[180:183], v[124:127], v[172:175]
    ds_read_b128 a[152:155], v240 offset:37056
    v_mfma_f32_16x16x32_bf16 v[172:175], a[184:187], v[136:139], v[172:175]
    v_exp_f32 v63, v165
    v_mfma_f32_16x16x32_bf16 v[172:175], a[188:191], v[148:151], v[172:175]
    ds_read_b128 a[156:159], v241 offset:37056
    v_exp_f32 v38, v166
    v_mfma_f32_16x16x32_bf16 v[176:179], a[168:171], v[92:95], v[44:47]
    v_exp_f32 v39, v167
    v_mfma_f32_16x16x32_bf16 v[176:179], a[172:175], v[104:107], v[176:179]
    ds_read_b128 a[160:163], v240 offset:37184
    v_add_f32 v56, v62, v63
    v_mfma_f32_16x16x32_bf16 v[176:179], a[176:179], v[116:119], v[176:179]
    v_cvt_pk_bf16_f32 v68, v62, v63
    v_add_f32 v56, v56, v38
    v_add_f32 v56, v56, v39
    v_mfma_f32_16x16x32_bf16 v[176:179], a[180:183], v[128:131], v[176:179]
    ds_read_b128 a[164:167], v241 offset:37184
    v_cvt_pk_bf16_f32 v69, v38, v39
    v_mfma_f32_16x16x32_bf16 v[176:179], a[184:187], v[140:143], v[176:179]
    v_exp_f32 v58, v168
    v_mfma_f32_16x16x32_bf16 v[176:179], a[188:191], v[152:155], v[176:179]
    v_exp_f32 v59, v169
    v_mfma_f32_16x16x32_bf16 v[180:183], a[168:171], v[96:99], v[48:51]
    v_exp_f32 v60, v170
    v_mfma_f32_16x16x32_bf16 v[180:183], a[172:175], v[108:111], v[180:183]
    v_exp_f32 v61, v171
    v_mfma_f32_16x16x32_bf16 v[180:183], a[176:179], v[120:123], v[180:183]
    v_add_f32 v57, v58, v59
    v_cvt_pk_bf16_f32 v72, v58, v59
    v_mfma_f32_16x16x32_bf16 v[180:183], a[180:183], v[132:135], v[180:183]
    v_add_f32 v57, v57, v60
    v_add_f32 v57, v57, v61
    v_cvt_pk_bf16_f32 v73, v60, v61
    v_mfma_f32_16x16x32_bf16 v[180:183], a[184:187], v[144:147], v[180:183]
    v_exp_f32 v62, v172
    v_mfma_f32_16x16x32_bf16 v[180:183], a[188:191], v[156:159], v[180:183]
    v_exp_f32 v63, v173
    s_waitcnt lgkmcnt(0)
    v_mfma_f32_16x16x32_bf16 v[184:187], a[144:147], v[88:91], v[40:43]
    ds_read_b128 a[168:171], v240 offset:38464
    v_exp_f32 v38, v174
    v_mfma_f32_16x16x32_bf16 v[184:187], a[148:151], v[100:103], v[184:187]
    ds_read_b128 a[172:175], v241 offset:38464
    v_mfma_f32_16x16x32_bf16 v[184:187], a[152:155], v[112:115], v[184:187]
    v_exp_f32 v39, v175
    v_mfma_f32_16x16x32_bf16 v[184:187], a[156:159], v[124:127], v[184:187]
    ds_read_b128 a[176:179], v240 offset:38592
    v_add_f32 v55, v55, v62
    v_add_f32 v55, v55, v63
    v_mfma_f32_16x16x32_bf16 v[184:187], a[160:163], v[136:139], v[184:187]
    v_cvt_pk_bf16_f32 v66, v62, v63
    v_add_f32 v55, v55, v38
    v_mfma_f32_16x16x32_bf16 v[184:187], a[164:167], v[148:151], v[184:187]
    ds_read_b128 a[180:183], v241 offset:38592
    v_add_f32 v55, v55, v39
    v_mfma_f32_16x16x32_bf16 v[188:191], a[144:147], v[92:95], v[44:47]
    v_cvt_pk_bf16_f32 v67, v38, v39
    v_mfma_f32_16x16x32_bf16 v[188:191], a[148:151], v[104:107], v[188:191]
    ds_read_b128 a[184:187], v240 offset:38720
    v_exp_f32 v58, v176
    v_mfma_f32_16x16x32_bf16 v[188:191], a[152:155], v[116:119], v[188:191]
    v_exp_f32 v59, v177
    v_mfma_f32_16x16x32_bf16 v[188:191], a[156:159], v[128:131], v[188:191]
    ds_read_b128 a[188:191], v241 offset:38720
    v_mfma_f32_16x16x32_bf16 v[188:191], a[160:163], v[140:143], v[188:191]
    v_exp_f32 v60, v178
    v_mfma_f32_16x16x32_bf16 v[188:191], a[164:167], v[152:155], v[188:191]
    v_exp_f32 v61, v179
    v_mfma_f32_16x16x32_bf16 v[192:195], a[144:147], v[96:99], v[48:51]
    v_add_f32 v56, v56, v58
    v_add_f32 v56, v56, v59
    v_mfma_f32_16x16x32_bf16 v[192:195], a[148:151], v[108:111], v[192:195]
    v_cvt_pk_bf16_f32 v70, v58, v59
    v_add_f32 v56, v56, v60
    v_add_f32 v56, v56, v61
    v_mfma_f32_16x16x32_bf16 v[192:195], a[152:155], v[120:123], v[192:195]
    v_cvt_pk_bf16_f32 v71, v60, v61
    v_mfma_f32_16x16x32_bf16 v[192:195], a[156:159], v[132:135], v[192:195]
    v_exp_f32 v62, v180
    v_mfma_f32_16x16x32_bf16 v[192:195], a[160:163], v[144:147], v[192:195]
    v_exp_f32 v63, v181
    v_mfma_f32_16x16x32_bf16 v[192:195], a[164:167], v[156:159], v[192:195]
    v_exp_f32 v38, v182
    s_waitcnt lgkmcnt(0)
    v_mfma_f32_16x16x32_bf16 v[196:199], a[168:171], v[88:91], v[40:43]
    ds_read_b64_tr_b16 a[144:145], v252 offset:0
    v_mfma_f32_16x16x32_bf16 v[196:199], a[172:175], v[100:103], v[196:199]
    ds_read_b64_tr_b16 a[146:147], v252 offset:1536
    v_mfma_f32_16x16x32_bf16 v[196:199], a[176:179], v[112:115], v[196:199]
    ds_read_b64_tr_b16 a[148:149], v252 offset:12288
    v_exp_f32 v39, v183
    v_mfma_f32_16x16x32_bf16 v[196:199], a[180:183], v[124:127], v[196:199]
    ds_read_b64_tr_b16 a[150:151], v252 offset:13824
    v_add_f32 v57, v57, v62
    v_mfma_f32_16x16x32_bf16 v[196:199], a[184:187], v[136:139], v[196:199]
    ds_read_b64_tr_b16 a[152:153], v253 offset:0
    v_add_f32 v57, v57, v63
    v_mfma_f32_16x16x32_bf16 v[196:199], a[188:191], v[148:151], v[196:199]
    ds_read_b64_tr_b16 a[154:155], v253 offset:1536
    v_cvt_pk_bf16_f32 v74, v62, v63
    v_add_f32 v57, v57, v38
    v_mfma_f32_16x16x32_bf16 v[200:203], a[168:171], v[92:95], v[44:47]
    ds_read_b64_tr_b16 a[156:157], v253 offset:12288
    v_add_f32 v57, v57, v39
    v_mfma_f32_16x16x32_bf16 v[200:203], a[172:175], v[104:107], v[200:203]
    ds_read_b64_tr_b16 a[158:159], v253 offset:13824
    v_cvt_pk_bf16_f32 v75, v38, v39
    v_mfma_f32_16x16x32_bf16 v[200:203], a[176:179], v[116:119], v[200:203]
    ds_read_b64_tr_b16 a[160:161], v254 offset:0
    v_exp_f32 v58, v184
    v_mfma_f32_16x16x32_bf16 v[200:203], a[180:183], v[128:131], v[200:203]
    ds_read_b64_tr_b16 a[162:163], v254 offset:1536
    v_mfma_f32_16x16x32_bf16 v[200:203], a[184:187], v[140:143], v[200:203]
    ds_read_b64_tr_b16 a[164:165], v254 offset:12288
    v_mfma_f32_16x16x32_bf16 v[200:203], a[188:191], v[152:155], v[200:203]
    ds_read_b64_tr_b16 a[166:167], v254 offset:13824
    v_exp_f32 v59, v185
    v_mfma_f32_16x16x32_bf16 v[204:207], a[168:171], v[96:99], v[48:51]
    v_exp_f32 v60, v186
    v_mfma_f32_16x16x32_bf16 v[204:207], a[172:175], v[108:111], v[204:207]
    v_exp_f32 v61, v187
    v_mfma_f32_16x16x32_bf16 v[204:207], a[176:179], v[120:123], v[204:207]
    v_add_f32 v55, v55, v58
    v_add_f32 v55, v55, v59
    v_mfma_f32_16x16x32_bf16 v[204:207], a[180:183], v[132:135], v[204:207]
    v_cvt_pk_bf16_f32 v76, v58, v59
    v_add_f32 v55, v55, v60
    v_add_f32 v55, v55, v61
    v_mfma_f32_16x16x32_bf16 v[204:207], a[184:187], v[144:147], v[204:207]
    v_cvt_pk_bf16_f32 v77, v60, v61
    v_mfma_f32_16x16x32_bf16 v[204:207], a[188:191], v[156:159], v[204:207]
    v_exp_f32 v62, v188
    s_waitcnt lgkmcnt(0)
    v_mfma_f32_16x16x32_bf16 a[0:3], a[144:147], v[208:211], a[0:3]
    ds_read_b64_tr_b16 a[168:169], v255 offset:0
    v_exp_f32 v63, v189
    v_mfma_f32_16x16x32_bf16 a[0:3], a[148:151], v[220:223], a[0:3]
    ds_read_b64_tr_b16 a[170:171], v255 offset:1536
    v_mfma_f32_16x16x32_bf16 a[4:7], a[144:147], v[212:215], a[4:7]
    ds_read_b64_tr_b16 a[172:173], v255 offset:12288
    v_mfma_f32_16x16x32_bf16 a[4:7], a[148:151], v[224:227], a[4:7]
    ds_read_b64_tr_b16 a[174:175], v255 offset:13824
    v_exp_f32 v38, v190
    v_mfma_f32_16x16x32_bf16 a[8:11], a[144:147], v[216:219], a[8:11]
    ds_read_b64_tr_b16 a[176:177], v252 offset:128
    v_mfma_f32_16x16x32_bf16 a[8:11], a[148:151], v[228:231], a[8:11]
    ds_read_b64_tr_b16 a[178:179], v252 offset:1664
    v_mfma_f32_16x16x32_bf16 a[12:15], a[152:155], v[208:211], a[12:15]
    ds_read_b64_tr_b16 a[180:181], v252 offset:12416
    v_exp_f32 v39, v191
    v_mfma_f32_16x16x32_bf16 a[12:15], a[156:159], v[220:223], a[12:15]
    ds_read_b64_tr_b16 a[182:183], v252 offset:13952
    v_add_f32 v56, v56, v62
    v_mfma_f32_16x16x32_bf16 a[16:19], a[152:155], v[212:215], a[16:19]
    ds_read_b64_tr_b16 a[184:185], v253 offset:128
    v_add_f32 v56, v56, v63
    v_mfma_f32_16x16x32_bf16 a[16:19], a[156:159], v[224:227], a[16:19]
    ds_read_b64_tr_b16 a[186:187], v253 offset:1664
    v_cvt_pk_bf16_f32 v80, v62, v63
    v_mfma_f32_16x16x32_bf16 a[20:23], a[152:155], v[216:219], a[20:23]
    ds_read_b64_tr_b16 a[188:189], v253 offset:12416
    v_add_f32 v56, v56, v38
    v_add_f32 v56, v56, v39
    v_mfma_f32_16x16x32_bf16 a[20:23], a[156:159], v[228:231], a[20:23]
    ds_read_b64_tr_b16 a[190:191], v253 offset:13952
    v_cvt_pk_bf16_f32 v81, v38, v39
    v_mfma_f32_16x16x32_bf16 a[24:27], a[160:163], v[208:211], a[24:27]
    v_exp_f32 v58, v192
    v_mfma_f32_16x16x32_bf16 a[24:27], a[164:167], v[220:223], a[24:27]
    v_exp_f32 v59, v193
    v_mfma_f32_16x16x32_bf16 a[28:31], a[160:163], v[212:215], a[28:31]
    v_exp_f32 v60, v194
    v_mfma_f32_16x16x32_bf16 a[28:31], a[164:167], v[224:227], a[28:31]
    v_exp_f32 v61, v195
    v_mfma_f32_16x16x32_bf16 a[32:35], a[160:163], v[216:219], a[32:35]
    v_add_f32 v57, v57, v58
    v_add_f32 v57, v57, v59
    v_cvt_pk_bf16_f32 v84, v58, v59
    v_mfma_f32_16x16x32_bf16 a[32:35], a[164:167], v[228:231], a[32:35]
    v_add_f32 v57, v57, v60
    v_add_f32 v57, v57, v61
    s_waitcnt lgkmcnt(0)
    v_mfma_f32_16x16x32_bf16 a[36:39], a[168:171], v[208:211], a[36:39]
    ds_read_b64_tr_b16 a[144:145], v254 offset:128
    v_cvt_pk_bf16_f32 v85, v60, v61
    v_mfma_f32_16x16x32_bf16 a[36:39], a[172:175], v[220:223], a[36:39]
    ds_read_b64_tr_b16 a[146:147], v254 offset:1664
    v_exp_f32 v62, v196
    v_mfma_f32_16x16x32_bf16 a[40:43], a[168:171], v[212:215], a[40:43]
    ds_read_b64_tr_b16 a[148:149], v254 offset:12416
    v_mfma_f32_16x16x32_bf16 a[40:43], a[172:175], v[224:227], a[40:43]
    ds_read_b64_tr_b16 a[150:151], v254 offset:13952
    v_mfma_f32_16x16x32_bf16 a[44:47], a[168:171], v[216:219], a[44:47]
    ds_read_b64_tr_b16 a[152:153], v255 offset:128
    v_mfma_f32_16x16x32_bf16 a[44:47], a[172:175], v[228:231], a[44:47]
    ds_read_b64_tr_b16 a[154:155], v255 offset:1664
    v_exp_f32 v63, v197
    v_mfma_f32_16x16x32_bf16 a[48:51], a[176:179], v[208:211], a[48:51]
    ds_read_b64_tr_b16 a[156:157], v255 offset:12416
    v_mfma_f32_16x16x32_bf16 a[48:51], a[180:183], v[220:223], a[48:51]
    ds_read_b64_tr_b16 a[158:159], v255 offset:13952
    v_mfma_f32_16x16x32_bf16 a[52:55], a[176:179], v[212:215], a[52:55]
    ds_read_b64_tr_b16 a[160:161], v252 offset:256
    v_exp_f32 v38, v198
    v_mfma_f32_16x16x32_bf16 a[52:55], a[180:183], v[224:227], a[52:55]
    ds_read_b64_tr_b16 a[162:163], v252 offset:1792
    v_mfma_f32_16x16x32_bf16 a[56:59], a[176:179], v[216:219], a[56:59]
    ds_read_b64_tr_b16 a[164:165], v252 offset:12544
    v_mfma_f32_16x16x32_bf16 a[56:59], a[180:183], v[228:231], a[56:59]
    ds_read_b64_tr_b16 a[166:167], v252 offset:14080
    v_exp_f32 v39, v199
    v_mfma_f32_16x16x32_bf16 a[60:63], a[184:187], v[208:211], a[60:63]
    v_add_f32 v55, v55, v62
    v_add_f32 v55, v55, v63
    v_mfma_f32_16x16x32_bf16 a[60:63], a[188:191], v[220:223], a[60:63]
    v_cvt_pk_bf16_f32 v78, v62, v63
    v_add_f32 v55, v55, v38
    v_mfma_f32_16x16x32_bf16 a[64:67], a[184:187], v[212:215], a[64:67]
    v_add_f32 v55, v55, v39
    v_cvt_pk_bf16_f32 v79, v38, v39
    v_mfma_f32_16x16x32_bf16 a[64:67], a[188:191], v[224:227], a[64:67]
    v_exp_f32 v58, v200
    v_mfma_f32_16x16x32_bf16 a[68:71], a[184:187], v[216:219], a[68:71]
    v_exp_f32 v59, v201
    v_mfma_f32_16x16x32_bf16 a[68:71], a[188:191], v[228:231], a[68:71]
    v_exp_f32 v60, v202
    s_waitcnt lgkmcnt(0)
    v_mfma_f32_16x16x32_bf16 a[72:75], a[144:147], v[208:211], a[72:75]
    ds_read_b64_tr_b16 a[168:169], v253 offset:256
    v_exp_f32 v61, v203
    v_mfma_f32_16x16x32_bf16 a[72:75], a[148:151], v[220:223], a[72:75]
    ds_read_b64_tr_b16 a[170:171], v253 offset:1792
    v_add_f32 v56, v56, v58
    v_mfma_f32_16x16x32_bf16 a[76:79], a[144:147], v[212:215], a[76:79]
    ds_read_b64_tr_b16 a[172:173], v253 offset:12544
    v_add_f32 v56, v56, v59
    v_mfma_f32_16x16x32_bf16 a[76:79], a[148:151], v[224:227], a[76:79]
    ds_read_b64_tr_b16 a[174:175], v253 offset:14080
    v_cvt_pk_bf16_f32 v82, v58, v59
    v_add_f32 v56, v56, v60
    v_mfma_f32_16x16x32_bf16 a[80:83], a[144:147], v[216:219], a[80:83]
    ds_read_b64_tr_b16 a[176:177], v254 offset:256
    v_add_f32 v56, v56, v61
    v_mfma_f32_16x16x32_bf16 a[80:83], a[148:151], v[228:231], a[80:83]
    ds_read_b64_tr_b16 a[178:179], v254 offset:1792
    v_cvt_pk_bf16_f32 v83, v60, v61
    v_mfma_f32_16x16x32_bf16 a[84:87], a[152:155], v[208:211], a[84:87]
    ds_read_b64_tr_b16 a[180:181], v254 offset:12544
    v_exp_f32 v62, v204
    v_mfma_f32_16x16x32_bf16 a[84:87], a[156:159], v[220:223], a[84:87]
    ds_read_b64_tr_b16 a[182:183], v254 offset:14080
    v_mfma_f32_16x16x32_bf16 a[88:91], a[152:155], v[212:215], a[88:91]
    ds_read_b64_tr_b16 a[184:185], v255 offset:256
    v_mfma_f32_16x16x32_bf16 a[88:91], a[156:159], v[224:227], a[88:91]
    ds_read_b64_tr_b16 a[186:187], v255 offset:1792
    v_exp_f32 v63, v205
    v_mfma_f32_16x16x32_bf16 a[92:95], a[152:155], v[216:219], a[92:95]
    ds_read_b64_tr_b16 a[188:189], v255 offset:12544
    v_mfma_f32_16x16x32_bf16 a[92:95], a[156:159], v[228:231], a[92:95]
    ds_read_b64_tr_b16 a[190:191], v255 offset:14080
    v_mfma_f32_16x16x32_bf16 a[96:99], a[160:163], v[208:211], a[96:99]
    v_exp_f32 v38, v206
    v_mfma_f32_16x16x32_bf16 a[96:99], a[164:167], v[220:223], a[96:99]
    v_exp_f32 v39, v207
    v_add_f32 v57, v57, v62
    v_mfma_f32_16x16x32_bf16 a[100:103], a[160:163], v[212:215], a[100:103]
    v_add_f32 v57, v57, v63
    v_cvt_pk_bf16_f32 v86, v62, v63
    v_mfma_f32_16x16x32_bf16 a[100:103], a[164:167], v[224:227], a[100:103]
    v_add_f32 v57, v57, v38
    v_add_f32 v57, v57, v39
    v_mfma_f32_16x16x32_bf16 a[104:107], a[160:163], v[216:219], a[104:107]
    v_cvt_pk_bf16_f32 v87, v38, v39
    v_mfma_f32_16x16x32_bf16 a[104:107], a[164:167], v[228:231], a[104:107]
    s_waitcnt vmcnt(12)
    s_waitcnt lgkmcnt(0)
    s_barrier
    v_mfma_f32_16x16x32_bf16 a[108:111], a[168:171], v[208:211], a[108:111]
    ds_read_b128 a[144:147], v242 offset:24640
    v_mfma_f32_16x16x32_bf16 a[108:111], a[172:175], v[220:223], a[108:111]
    s_add_u32 m0, s29, 73920
    s_mov_b32 s35, 147456
    v_mfma_f32_16x16x32_bf16 a[112:115], a[168:171], v[212:215], a[112:115]
    ds_read_b128 a[148:151], v243 offset:24640
    v_mfma_f32_16x16x32_bf16 a[112:115], a[172:175], v[224:227], a[112:115]
    buffer_load_dwordx4 v20, s[12:15], s35 offen offset:0 nt lds
    v_mfma_f32_16x16x32_bf16 a[116:119], a[168:171], v[216:219], a[116:119]
    ds_read_b128 a[152:155], v242 offset:24768
    v_mfma_f32_16x16x32_bf16 a[116:119], a[172:175], v[228:231], a[116:119]
    buffer_load_dwordx4 v21, s[12:15], s35 offen offset:1024 nt lds
    v_mfma_f32_16x16x32_bf16 a[120:123], a[176:179], v[208:211], a[120:123]
    ds_read_b128 a[156:159], v243 offset:24768
    v_mfma_f32_16x16x32_bf16 a[120:123], a[180:183], v[220:223], a[120:123]
    buffer_load_dwordx4 v22, s[12:15], s35 offen offset:2048 nt lds
    v_mfma_f32_16x16x32_bf16 a[124:127], a[176:179], v[212:215], a[124:127]
    ds_read_b128 a[160:163], v242 offset:24896
    v_mfma_f32_16x16x32_bf16 a[124:127], a[180:183], v[224:227], a[124:127]
    buffer_load_dwordx4 v23, s[12:15], s35 offen offset:3072 nt lds
    v_mfma_f32_16x16x32_bf16 a[128:131], a[176:179], v[216:219], a[128:131]
    ds_read_b128 a[164:167], v243 offset:24896
    v_mfma_f32_16x16x32_bf16 a[128:131], a[180:183], v[228:231], a[128:131]
    s_add_u32 m0, s29, 78016
    v_mfma_f32_16x16x32_bf16 a[132:135], a[184:187], v[208:211], a[132:135]
    v_mfma_f32_16x16x32_bf16 a[132:135], a[188:191], v[220:223], a[132:135]
    buffer_load_dwordx4 v24, s[12:15], s35 offen offset:0 nt lds
    v_mfma_f32_16x16x32_bf16 a[136:139], a[184:187], v[212:215], a[136:139]
    v_mfma_f32_16x16x32_bf16 a[136:139], a[188:191], v[224:227], a[136:139]
    buffer_load_dwordx4 v25, s[12:15], s35 offen offset:1024 nt lds
    v_mfma_f32_16x16x32_bf16 a[140:143], a[184:187], v[216:219], a[140:143]
    v_mfma_f32_16x16x32_bf16 a[140:143], a[188:191], v[228:231], a[140:143]
    v_max3_f32 v1, v55, v56, v57
    v_cmp_lt_f32 vcc, s40, v1
    s_cbranch_vccnz L_stub_3
L_ret_3:
    v_add_f32 v52, v52, v55
    v_add_f32 v53, v53, v56
    v_add_f32 v54, v54, v57
    s_waitcnt lgkmcnt(0)
    v_mfma_f32_16x16x32_bf16 v[160:163], a[144:147], v[88:91], v[40:43]
    ds_read_b128 a[168:171], v242 offset:26176
    s_add_u32 m0, s29, 98560
    s_mov_b32 s36, 122880
    v_mfma_f32_16x16x32_bf16 v[160:163], a[148:151], v[100:103], v[160:163]
    ds_read_b128 a[172:175], v243 offset:26176
    v_mfma_f32_16x16x32_bf16 v[160:163], a[152:155], v[112:115], v[160:163]
    buffer_load_dwordx4 v26, s[16:19], s36 offen offset:0 nt lds
    v_mfma_f32_16x16x32_bf16 v[160:163], a[156:159], v[124:127], v[160:163]
    ds_read_b128 a[176:179], v242 offset:26304
    v_mfma_f32_16x16x32_bf16 v[160:163], a[160:163], v[136:139], v[160:163]
    buffer_load_dwordx4 v27, s[16:19], s36 offen offset:1024 nt lds
    v_mfma_f32_16x16x32_bf16 v[160:163], a[164:167], v[148:151], v[160:163]
    ds_read_b128 a[180:183], v243 offset:26304
    v_mfma_f32_16x16x32_bf16 v[164:167], a[144:147], v[92:95], v[44:47]
    buffer_load_dwordx4 v28, s[16:19], s36 offen offset:2048 nt lds
    v_mfma_f32_16x16x32_bf16 v[164:167], a[148:151], v[104:107], v[164:167]
    ds_read_b128 a[184:187], v242 offset:26432
    v_mfma_f32_16x16x32_bf16 v[164:167], a[152:155], v[116:119], v[164:167]
    v_mfma_f32_16x16x32_bf16 v[164:167], a[156:159], v[128:131], v[164:167]
    ds_read_b128 a[188:191], v243 offset:26432
    buffer_load_dwordx4 v29, s[16:19], s36 offen offset:3072 nt lds
    v_mfma_f32_16x16x32_bf16 v[164:167], a[160:163], v[140:143], v[164:167]
    v_exp_f32 v58, v160
    v_mfma_f32_16x16x32_bf16 v[164:167], a[164:167], v[152:155], v[164:167]
    s_add_u32 m0, s29, 102656
    v_mfma_f32_16x16x32_bf16 v[168:171], a[144:147], v[96:99], v[48:51]
    v_exp_f32 v59, v161
    v_mfma_f32_16x16x32_bf16 v[168:171], a[148:151], v[108:111], v[168:171]
    buffer_load_dwordx4 v30, s[16:19], s36 offen offset:0 nt lds
    v_exp_f32 v60, v162
    v_mfma_f32_16x16x32_bf16 v[168:171], a[152:155], v[120:123], v[168:171]
    v_exp_f32 v61, v163
    v_mfma_f32_16x16x32_bf16 v[168:171], a[156:159], v[132:135], v[168:171]
    buffer_load_dwordx4 v31, s[16:19], s36 offen offset:1024 nt lds
    v_add_f32 v55, v58, v59
    v_mfma_f32_16x16x32_bf16 v[168:171], a[160:163], v[144:147], v[168:171]
    v_cvt_pk_bf16_f32 v208, v58, v59
    v_add_f32 v55, v55, v60
    v_mfma_f32_16x16x32_bf16 v[168:171], a[164:167], v[156:159], v[168:171]
    v_add_f32 v55, v55, v61
    v_cvt_pk_bf16_f32 v209, v60, v61
    s_waitcnt lgkmcnt(0)
    v_mfma_f32_16x16x32_bf16 v[172:175], a[168:171], v[88:91], v[40:43]
    ds_read_b128 a[144:147], v242 offset:36928
    v_mfma_f32_16x16x32_bf16 v[172:175], a[172:175], v[100:103], v[172:175]
    ds_read_b128 a[148:151], v243 offset:36928
    v_mfma_f32_16x16x32_bf16 v[172:175], a[176:179], v[112:115], v[172:175]
    v_exp_f32 v62, v164
    v_mfma_f32_16x16x32_bf16 v[172:175], a[180:183], v[124:127], v[172:175]
    ds_read_b128 a[152:155], v242 offset:37056
    v_mfma_f32_16x16x32_bf16 v[172:175], a[184:187], v[136:139], v[172:175]
    v_exp_f32 v63, v165
    v_mfma_f32_16x16x32_bf16 v[172:175], a[188:191], v[148:151], v[172:175]
    ds_read_b128 a[156:159], v243 offset:37056
    v_exp_f32 v38, v166
    v_mfma_f32_16x16x32_bf16 v[176:179], a[168:171], v[92:95], v[44:47]
    v_exp_f32 v39, v167
    v_mfma_f32_16x16x32_bf16 v[176:179], a[172:175], v[104:107], v[176:179]
    ds_read_b128 a[160:163], v242 offset:37184
    v_add_f32 v56, v62, v63
    v_mfma_f32_16x16x32_bf16 v[176:179], a[176:179], v[116:119], v[176:179]
    v_cvt_pk_bf16_f32 v212, v62, v63
    v_add_f32 v56, v56, v38
    v_add_f32 v56, v56, v39
    v_mfma_f32_16x16x32_bf16 v[176:179], a[180:183], v[128:131], v[176:179]
    ds_read_b128 a[164:167], v243 offset:37184
    v_cvt_pk_bf16_f32 v213, v38, v39
    v_mfma_f32_16x16x32_bf16 v[176:179], a[184:187], v[140:143], v[176:179]
    v_exp_f32 v58, v168
    v_mfma_f32_16x16x32_bf16 v[176:179], a[188:191], v[152:155], v[176:179]
    v_exp_f32 v59, v169
    v_mfma_f32_16x16x32_bf16 v[180:183], a[168:171], v[96:99], v[48:51]
    v_exp_f32 v60, v170
    v_mfma_f32_16x16x32_bf16 v[180:183], a[172:175], v[108:111], v[180:183]
    v_exp_f32 v61, v171
    v_mfma_f32_16x16x32_bf16 v[180:183], a[176:179], v[120:123], v[180:183]
    v_add_f32 v57, v58, v59
    v_cvt_pk_bf16_f32 v216, v58, v59
    v_mfma_f32_16x16x32_bf16 v[180:183], a[180:183], v[132:135], v[180:183]
    v_add_f32 v57, v57, v60
    v_add_f32 v57, v57, v61
    v_cvt_pk_bf16_f32 v217, v60, v61
    v_mfma_f32_16x16x32_bf16 v[180:183], a[184:187], v[144:147], v[180:183]
    v_exp_f32 v62, v172
    v_mfma_f32_16x16x32_bf16 v[180:183], a[188:191], v[156:159], v[180:183]
    v_exp_f32 v63, v173
    s_waitcnt lgkmcnt(0)
    v_mfma_f32_16x16x32_bf16 v[184:187], a[144:147], v[88:91], v[40:43]
    ds_read_b128 a[168:171], v242 offset:38464
    v_exp_f32 v38, v174
    v_mfma_f32_16x16x32_bf16 v[184:187], a[148:151], v[100:103], v[184:187]
    ds_read_b128 a[172:175], v243 offset:38464
    v_mfma_f32_16x16x32_bf16 v[184:187], a[152:155], v[112:115], v[184:187]
    v_exp_f32 v39, v175
    v_mfma_f32_16x16x32_bf16 v[184:187], a[156:159], v[124:127], v[184:187]
    ds_read_b128 a[176:179], v242 offset:38592
    v_add_f32 v55, v55, v62
    v_add_f32 v55, v55, v63
    v_mfma_f32_16x16x32_bf16 v[184:187], a[160:163], v[136:139], v[184:187]
    v_cvt_pk_bf16_f32 v210, v62, v63
    v_add_f32 v55, v55, v38
    v_mfma_f32_16x16x32_bf16 v[184:187], a[164:167], v[148:151], v[184:187]
    ds_read_b128 a[180:183], v243 offset:38592
    v_add_f32 v55, v55, v39
    v_mfma_f32_16x16x32_bf16 v[188:191], a[144:147], v[92:95], v[44:47]
    v_cvt_pk_bf16_f32 v211, v38, v39
    v_mfma_f32_16x16x32_bf16 v[188:191], a[148:151], v[104:107], v[188:191]
    ds_read_b128 a[184:187], v242 offset:38720
    v_exp_f32 v58, v176
    v_mfma_f32_16x16x32_bf16 v[188:191], a[152:155], v[116:119], v[188:191]
    v_exp_f32 v59, v177
    v_mfma_f32_16x16x32_bf16 v[188:191], a[156:159], v[128:131], v[188:191]
    ds_read_b128 a[188:191], v243 offset:38720
    v_mfma_f32_16x16x32_bf16 v[188:191], a[160:163], v[140:143], v[188:191]
    v_exp_f32 v60, v178
    v_mfma_f32_16x16x32_bf16 v[188:191], a[164:167], v[152:155], v[188:191]
    v_exp_f32 v61, v179
    v_mfma_f32_16x16x32_bf16 v[192:195], a[144:147], v[96:99], v[48:51]
    v_add_f32 v56, v56, v58
    v_add_f32 v56, v56, v59
    v_mfma_f32_16x16x32_bf16 v[192:195], a[148:151], v[108:111], v[192:195]
    v_cvt_pk_bf16_f32 v214, v58, v59
    v_add_f32 v56, v56, v60
    v_add_f32 v56, v56, v61
    v_mfma_f32_16x16x32_bf16 v[192:195], a[152:155], v[120:123], v[192:195]
    v_cvt_pk_bf16_f32 v215, v60, v61
    v_mfma_f32_16x16x32_bf16 v[192:195], a[156:159], v[132:135], v[192:195]
    v_exp_f32 v62, v180
    v_mfma_f32_16x16x32_bf16 v[192:195], a[160:163], v[144:147], v[192:195]
    v_exp_f32 v63, v181
    v_mfma_f32_16x16x32_bf16 v[192:195], a[164:167], v[156:159], v[192:195]
    v_exp_f32 v38, v182
    s_waitcnt lgkmcnt(0)
    v_mfma_f32_16x16x32_bf16 v[196:199], a[168:171], v[88:91], v[40:43]
    ds_read_b64_tr_b16 a[144:145], v244 offset:0
    v_mfma_f32_16x16x32_bf16 v[196:199], a[172:175], v[100:103], v[196:199]
    ds_read_b64_tr_b16 a[146:147], v244 offset:1536
    v_mfma_f32_16x16x32_bf16 v[196:199], a[176:179], v[112:115], v[196:199]
    ds_read_b64_tr_b16 a[148:149], v244 offset:12288
    v_exp_f32 v39, v183
    v_mfma_f32_16x16x32_bf16 v[196:199], a[180:183], v[124:127], v[196:199]
    ds_read_b64_tr_b16 a[150:151], v244 offset:13824
    v_add_f32 v57, v57, v62
    v_mfma_f32_16x16x32_bf16 v[196:199], a[184:187], v[136:139], v[196:199]
    ds_read_b64_tr_b16 a[152:153], v245 offset:0
    v_add_f32 v57, v57, v63
    v_mfma_f32_16x16x32_bf16 v[196:199], a[188:191], v[148:151], v[196:199]
    ds_read_b64_tr_b16 a[154:155], v245 offset:1536
    v_cvt_pk_bf16_f32 v218, v62, v63
    v_add_f32 v57, v57, v38
    v_mfma_f32_16x16x32_bf16 v[200:203], a[168:171], v[92:95], v[44:47]
    ds_read_b64_tr_b16 a[156:157], v245 offset:12288
    v_add_f32 v57, v57, v39
    v_mfma_f32_16x16x32_bf16 v[200:203], a[172:175], v[104:107], v[200:203]
    ds_read_b64_tr_b16 a[158:159], v245 offset:13824
    v_cvt_pk_bf16_f32 v219, v38, v39
    v_mfma_f32_16x16x32_bf16 v[200:203], a[176:179], v[116:119], v[200:203]
    ds_read_b64_tr_b16 a[160:161], v246 offset:0
    v_exp_f32 v58, v184
    v_mfma_f32_16x16x32_bf16 v[200:203], a[180:183], v[128:131], v[200:203]
    ds_read_b64_tr_b16 a[162:163], v246 offset:1536
    v_mfma_f32_16x16x32_bf16 v[200:203], a[184:187], v[140:143], v[200:203]
    ds_read_b64_tr_b16 a[164:165], v246 offset:12288
    v_mfma_f32_16x16x32_bf16 v[200:203], a[188:191], v[152:155], v[200:203]
    ds_read_b64_tr_b16 a[166:167], v246 offset:13824
    v_exp_f32 v59, v185
    v_mfma_f32_16x16x32_bf16 v[204:207], a[168:171], v[96:99], v[48:51]
    v_exp_f32 v60, v186
    v_mfma_f32_16x16x32_bf16 v[204:207], a[172:175], v[108:111], v[204:207]
    v_exp_f32 v61, v187
    v_mfma_f32_16x16x32_bf16 v[204:207], a[176:179], v[120:123], v[204:207]
    v_add_f32 v55, v55, v58
    v_add_f32 v55, v55, v59
    v_mfma_f32_16x16x32_bf16 v[204:207], a[180:183], v[132:135], v[204:207]
    v_cvt_pk_bf16_f32 v220, v58, v59
    v_add_f32 v55, v55, v60
    v_add_f32 v55, v55, v61
    v_mfma_f32_16x16x32_bf16 v[204:207], a[184:187], v[144:147], v[204:207]
    v_cvt_pk_bf16_f32 v221, v60, v61
    v_mfma_f32_16x16x32_bf16 v[204:207], a[188:191], v[156:159], v[204:207]
    v_exp_f32 v62, v188
    s_waitcnt lgkmcnt(0)
    v_mfma_f32_16x16x32_bf16 a[0:3], a[144:147], v[64:67], a[0:3]
    ds_read_b64_tr_b16 a[168:169], v247 offset:0
    v_exp_f32 v63, v189
    v_mfma_f32_16x16x32_bf16 a[0:3], a[148:151], v[76:79], a[0:3]
    ds_read_b64_tr_b16 a[170:171], v247 offset:1536
    v_mfma_f32_16x16x32_bf16 a[4:7], a[144:147], v[68:71], a[4:7]
    ds_read_b64_tr_b16 a[172:173], v247 offset:12288
    v_mfma_f32_16x16x32_bf16 a[4:7], a[148:151], v[80:83], a[4:7]
    ds_read_b64_tr_b16 a[174:175], v247 offset:13824
    v_exp_f32 v38, v190
    v_mfma_f32_16x16x32_bf16 a[8:11], a[144:147], v[72:75], a[8:11]
    ds_read_b64_tr_b16 a[176:177], v244 offset:128
    v_mfma_f32_16x16x32_bf16 a[8:11], a[148:151], v[84:87], a[8:11]
    ds_read_b64_tr_b16 a[178:179], v244 offset:1664
    v_mfma_f32_16x16x32_bf16 a[12:15], a[152:155], v[64:67], a[12:15]
    ds_read_b64_tr_b16 a[180:181], v244 offset:12416
    v_exp_f32 v39, v191
    v_mfma_f32_16x16x32_bf16 a[12:15], a[156:159], v[76:79], a[12:15]
    ds_read_b64_tr_b16 a[182:183], v244 offset:13952
    v_add_f32 v56, v56, v62
    v_mfma_f32_16x16x32_bf16 a[16:19], a[152:155], v[68:71], a[16:19]
    ds_read_b64_tr_b16 a[184:185], v245 offset:128
    v_add_f32 v56, v56, v63
    v_mfma_f32_16x16x32_bf16 a[16:19], a[156:159], v[80:83], a[16:19]
    ds_read_b64_tr_b16 a[186:187], v245 offset:1664
    v_cvt_pk_bf16_f32 v224, v62, v63
    v_mfma_f32_16x16x32_bf16 a[20:23], a[152:155], v[72:75], a[20:23]
    ds_read_b64_tr_b16 a[188:189], v245 offset:12416
    v_add_f32 v56, v56, v38
    v_add_f32 v56, v56, v39
    v_mfma_f32_16x16x32_bf16 a[20:23], a[156:159], v[84:87], a[20:23]
    ds_read_b64_tr_b16 a[190:191], v245 offset:13952
    v_cvt_pk_bf16_f32 v225, v38, v39
    v_mfma_f32_16x16x32_bf16 a[24:27], a[160:163], v[64:67], a[24:27]
    v_exp_f32 v58, v192
    v_mfma_f32_16x16x32_bf16 a[24:27], a[164:167], v[76:79], a[24:27]
    v_exp_f32 v59, v193
    v_mfma_f32_16x16x32_bf16 a[28:31], a[160:163], v[68:71], a[28:31]
    v_exp_f32 v60, v194
    v_mfma_f32_16x16x32_bf16 a[28:31], a[164:167], v[80:83], a[28:31]
    v_exp_f32 v61, v195
    v_mfma_f32_16x16x32_bf16 a[32:35], a[160:163], v[72:75], a[32:35]
    v_add_f32 v57, v57, v58
    v_add_f32 v57, v57, v59
    v_cvt_pk_bf16_f32 v228, v58, v59
    v_mfma_f32_16x16x32_bf16 a[32:35], a[164:167], v[84:87], a[32:35]
    v_add_f32 v57, v57, v60
    v_add_f32 v57, v57, v61
    s_waitcnt lgkmcnt(0)
    v_mfma_f32_16x16x32_bf16 a[36:39], a[168:171], v[64:67], a[36:39]
    ds_read_b64_tr_b16 a[144:145], v246 offset:128
    v_cvt_pk_bf16_f32 v229, v60, v61
    v_mfma_f32_16x16x32_bf16 a[36:39], a[172:175], v[76:79], a[36:39]
    ds_read_b64_tr_b16 a[146:147], v246 offset:1664
    v_exp_f32 v62, v196
    v_mfma_f32_16x16x32_bf16 a[40:43], a[168:171], v[68:71], a[40:43]
    ds_read_b64_tr_b16 a[148:149], v246 offset:12416
    v_mfma_f32_16x16x32_bf16 a[40:43], a[172:175], v[80:83], a[40:43]
    ds_read_b64_tr_b16 a[150:151], v246 offset:13952
    v_mfma_f32_16x16x32_bf16 a[44:47], a[168:171], v[72:75], a[44:47]
    ds_read_b64_tr_b16 a[152:153], v247 offset:128
    v_mfma_f32_16x16x32_bf16 a[44:47], a[172:175], v[84:87], a[44:47]
    ds_read_b64_tr_b16 a[154:155], v247 offset:1664
    v_exp_f32 v63, v197
    v_mfma_f32_16x16x32_bf16 a[48:51], a[176:179], v[64:67], a[48:51]
    ds_read_b64_tr_b16 a[156:157], v247 offset:12416
    v_mfma_f32_16x16x32_bf16 a[48:51], a[180:183], v[76:79], a[48:51]
    ds_read_b64_tr_b16 a[158:159], v247 offset:13952
    v_mfma_f32_16x16x32_bf16 a[52:55], a[176:179], v[68:71], a[52:55]
    ds_read_b64_tr_b16 a[160:161], v244 offset:256
    v_exp_f32 v38, v198
    v_mfma_f32_16x16x32_bf16 a[52:55], a[180:183], v[80:83], a[52:55]
    ds_read_b64_tr_b16 a[162:163], v244 offset:1792
    v_mfma_f32_16x16x32_bf16 a[56:59], a[176:179], v[72:75], a[56:59]
    ds_read_b64_tr_b16 a[164:165], v244 offset:12544
    v_mfma_f32_16x16x32_bf16 a[56:59], a[180:183], v[84:87], a[56:59]
    ds_read_b64_tr_b16 a[166:167], v244 offset:14080
    v_exp_f32 v39, v199
    v_mfma_f32_16x16x32_bf16 a[60:63], a[184:187], v[64:67], a[60:63]
    v_add_f32 v55, v55, v62
    v_add_f32 v55, v55, v63
    v_mfma_f32_16x16x32_bf16 a[60:63], a[188:191], v[76:79], a[60:63]
    v_cvt_pk_bf16_f32 v222, v62, v63
    v_add_f32 v55, v55, v38
    v_mfma_f32_16x16x32_bf16 a[64:67], a[184:187], v[68:71], a[64:67]
    v_add_f32 v55, v55, v39
    v_cvt_pk_bf16_f32 v223, v38, v39
    v_mfma_f32_16x16x32_bf16 a[64:67], a[188:191], v[80:83], a[64:67]
    v_exp_f32 v58, v200
    v_mfma_f32_16x16x32_bf16 a[68:71], a[184:187], v[72:75], a[68:71]
    v_exp_f32 v59, v201
    v_mfma_f32_16x16x32_bf16 a[68:71], a[188:191], v[84:87], a[68:71]
    v_exp_f32 v60, v202
    s_waitcnt lgkmcnt(0)
    v_mfma_f32_16x16x32_bf16 a[72:75], a[144:147], v[64:67], a[72:75]
    ds_read_b64_tr_b16 a[168:169], v245 offset:256
    v_exp_f32 v61, v203
    v_mfma_f32_16x16x32_bf16 a[72:75], a[148:151], v[76:79], a[72:75]
    ds_read_b64_tr_b16 a[170:171], v245 offset:1792
    v_add_f32 v56, v56, v58
    v_mfma_f32_16x16x32_bf16 a[76:79], a[144:147], v[68:71], a[76:79]
    ds_read_b64_tr_b16 a[172:173], v245 offset:12544
    v_add_f32 v56, v56, v59
    v_mfma_f32_16x16x32_bf16 a[76:79], a[148:151], v[80:83], a[76:79]
    ds_read_b64_tr_b16 a[174:175], v245 offset:14080
    v_cvt_pk_bf16_f32 v226, v58, v59
    v_add_f32 v56, v56, v60
    v_mfma_f32_16x16x32_bf16 a[80:83], a[144:147], v[72:75], a[80:83]
    ds_read_b64_tr_b16 a[176:177], v246 offset:256
    v_add_f32 v56, v56, v61
    v_mfma_f32_16x16x32_bf16 a[80:83], a[148:151], v[84:87], a[80:83]
    ds_read_b64_tr_b16 a[178:179], v246 offset:1792
    v_cvt_pk_bf16_f32 v227, v60, v61
    v_mfma_f32_16x16x32_bf16 a[84:87], a[152:155], v[64:67], a[84:87]
    ds_read_b64_tr_b16 a[180:181], v246 offset:12544
    v_exp_f32 v62, v204
    v_mfma_f32_16x16x32_bf16 a[84:87], a[156:159], v[76:79], a[84:87]
    ds_read_b64_tr_b16 a[182:183], v246 offset:14080
    v_mfma_f32_16x16x32_bf16 a[88:91], a[152:155], v[68:71], a[88:91]
    ds_read_b64_tr_b16 a[184:185], v247 offset:256
    v_mfma_f32_16x16x32_bf16 a[88:91], a[156:159], v[80:83], a[88:91]
    ds_read_b64_tr_b16 a[186:187], v247 offset:1792
    v_exp_f32 v63, v205
    v_mfma_f32_16x16x32_bf16 a[92:95], a[152:155], v[72:75], a[92:95]
    ds_read_b64_tr_b16 a[188:189], v247 offset:12544
    v_mfma_f32_16x16x32_bf16 a[92:95], a[156:159], v[84:87], a[92:95]
    ds_read_b64_tr_b16 a[190:191], v247 offset:14080
    v_mfma_f32_16x16x32_bf16 a[96:99], a[160:163], v[64:67], a[96:99]
    v_exp_f32 v38, v206
    v_mfma_f32_16x16x32_bf16 a[96:99], a[164:167], v[76:79], a[96:99]
    v_exp_f32 v39, v207
    v_add_f32 v57, v57, v62
    v_mfma_f32_16x16x32_bf16 a[100:103], a[160:163], v[68:71], a[100:103]
    v_add_f32 v57, v57, v63
    v_cvt_pk_bf16_f32 v230, v62, v63
    v_mfma_f32_16x16x32_bf16 a[100:103], a[164:167], v[80:83], a[100:103]
    v_add_f32 v57, v57, v38
    v_add_f32 v57, v57, v39
    v_mfma_f32_16x16x32_bf16 a[104:107], a[160:163], v[72:75], a[104:107]
    v_cvt_pk_bf16_f32 v231, v38, v39
    v_mfma_f32_16x16x32_bf16 a[104:107], a[164:167], v[84:87], a[104:107]
    s_waitcnt vmcnt(12)
    s_waitcnt lgkmcnt(0)
    s_barrier
    v_mfma_f32_16x16x32_bf16 a[108:111], a[168:171], v[64:67], a[108:111]
    ds_read_b128 a[144:147], v238 offset:24640
    v_mfma_f32_16x16x32_bf16 a[108:111], a[172:175], v[76:79], a[108:111]
    s_add_u32 m0, s29, 123200
    s_mov_b32 s35, 172032
    v_mfma_f32_16x16x32_bf16 a[112:115], a[168:171], v[68:71], a[112:115]
    ds_read_b128 a[148:151], v239 offset:24640
    v_mfma_f32_16x16x32_bf16 a[112:115], a[172:175], v[80:83], a[112:115]
    buffer_load_dwordx4 v20, s[12:15], s35 offen offset:0 nt lds
    v_mfma_f32_16x16x32_bf16 a[116:119], a[168:171], v[72:75], a[116:119]
    ds_read_b128 a[152:155], v238 offset:24768
    v_mfma_f32_16x16x32_bf16 a[116:119], a[172:175], v[84:87], a[116:119]
    buffer_load_dwordx4 v21, s[12:15], s35 offen offset:1024 nt lds
    v_mfma_f32_16x16x32_bf16 a[120:123], a[176:179], v[64:67], a[120:123]
    ds_read_b128 a[156:159], v239 offset:24768
    v_mfma_f32_16x16x32_bf16 a[120:123], a[180:183], v[76:79], a[120:123]
    buffer_load_dwordx4 v22, s[12:15], s35 offen offset:2048 nt lds
    v_mfma_f32_16x16x32_bf16 a[124:127], a[176:179], v[68:71], a[124:127]
    ds_read_b128 a[160:163], v238 offset:24896
    v_mfma_f32_16x16x32_bf16 a[124:127], a[180:183], v[80:83], a[124:127]
    buffer_load_dwordx4 v23, s[12:15], s35 offen offset:3072 nt lds
    v_mfma_f32_16x16x32_bf16 a[128:131], a[176:179], v[72:75], a[128:131]
    ds_read_b128 a[164:167], v239 offset:24896
    v_mfma_f32_16x16x32_bf16 a[128:131], a[180:183], v[84:87], a[128:131]
    s_add_u32 m0, s29, 127296
    v_mfma_f32_16x16x32_bf16 a[132:135], a[184:187], v[64:67], a[132:135]
    v_mfma_f32_16x16x32_bf16 a[132:135], a[188:191], v[76:79], a[132:135]
    buffer_load_dwordx4 v24, s[12:15], s35 offen offset:0 nt lds
    v_mfma_f32_16x16x32_bf16 a[136:139], a[184:187], v[68:71], a[136:139]
    v_mfma_f32_16x16x32_bf16 a[136:139], a[188:191], v[80:83], a[136:139]
    buffer_load_dwordx4 v25, s[12:15], s35 offen offset:1024 nt lds
    v_mfma_f32_16x16x32_bf16 a[140:143], a[184:187], v[72:75], a[140:143]
    v_mfma_f32_16x16x32_bf16 a[140:143], a[188:191], v[84:87], a[140:143]
    v_max3_f32 v1, v55, v56, v57
    v_cmp_lt_f32 vcc, s40, v1
    s_cbranch_vccnz L_stub_4
L_ret_4:
    v_add_f32 v52, v52, v55
    v_add_f32 v53, v53, v56
    v_add_f32 v54, v54, v57
    s_waitcnt lgkmcnt(0)
    v_mfma_f32_16x16x32_bf16 v[160:163], a[144:147], v[88:91], v[40:43]
    ds_read_b128 a[168:171], v238 offset:26176
    s_add_u32 m0, s29, 0
    s_mov_b32 s36, 147456
    v_mfma_f32_16x16x32_bf16 v[160:163], a[148:151], v[100:103], v[160:163]
    ds_read_b128 a[172:175], v239 offset:26176
    v_mfma_f32_16x16x32_bf16 v[160:163], a[152:155], v[112:115], v[160:163]
    buffer_load_dwordx4 v26, s[16:19], s36 offen offset:0 nt lds
    v_mfma_f32_16x16x32_bf16 v[160:163], a[156:159], v[124:127], v[160:163]
    ds_read_b128 a[176:179], v238 offset:26304
    v_mfma_f32_16x16x32_bf16 v[160:163], a[160:163], v[136:139], v[160:163]
    buffer_load_dwordx4 v27, s[16:19], s36 offen offset:1024 nt lds
    v_mfma_f32_16x16x32_bf16 v[160:163], a[164:167], v[148:151], v[160:163]
    ds_read_b128 a[180:183], v239 offset:26304
    v_mfma_f32_16x16x32_bf16 v[164:167], a[144:147], v[92:95], v[44:47]
    buffer_load_dwordx4 v28, s[16:19], s36 offen offset:2048 nt lds
    v_mfma_f32_16x16x32_bf16 v[164:167], a[148:151], v[104:107], v[164:167]
    ds_read_b128 a[184:187], v238 offset:26432
    v_mfma_f32_16x16x32_bf16 v[164:167], a[152:155], v[116:119], v[164:167]
    v_mfma_f32_16x16x32_bf16 v[164:167], a[156:159], v[128:131], v[164:167]
    ds_read_b128 a[188:191], v239 offset:26432
    buffer_load_dwordx4 v29, s[16:19], s36 offen offset:3072 nt lds
    v_mfma_f32_16x16x32_bf16 v[164:167], a[160:163], v[140:143], v[164:167]
    v_exp_f32 v58, v160
    v_mfma_f32_16x16x32_bf16 v[164:167], a[164:167], v[152:155], v[164:167]
    s_add_u32 m0, s29, 4096
    v_mfma_f32_16x16x32_bf16 v[168:171], a[144:147], v[96:99], v[48:51]
    v_exp_f32 v59, v161
    v_mfma_f32_16x16x32_bf16 v[168:171], a[148:151], v[108:111], v[168:171]
    buffer_load_dwordx4 v30, s[16:19], s36 offen offset:0 nt lds
    v_exp_f32 v60, v162
    v_mfma_f32_16x16x32_bf16 v[168:171], a[152:155], v[120:123], v[168:171]
    v_exp_f32 v61, v163
    v_mfma_f32_16x16x32_bf16 v[168:171], a[156:159], v[132:135], v[168:171]
    buffer_load_dwordx4 v31, s[16:19], s36 offen offset:1024 nt lds
    v_add_f32 v55, v58, v59
    v_mfma_f32_16x16x32_bf16 v[168:171], a[160:163], v[144:147], v[168:171]
    v_cvt_pk_bf16_f32 v64, v58, v59
    v_add_f32 v55, v55, v60
    v_mfma_f32_16x16x32_bf16 v[168:171], a[164:167], v[156:159], v[168:171]
    v_add_f32 v55, v55, v61
    v_cvt_pk_bf16_f32 v65, v60, v61
    s_waitcnt lgkmcnt(0)
    v_mfma_f32_16x16x32_bf16 v[172:175], a[168:171], v[88:91], v[40:43]
    ds_read_b128 a[144:147], v238 offset:36928
    v_mfma_f32_16x16x32_bf16 v[172:175], a[172:175], v[100:103], v[172:175]
    ds_read_b128 a[148:151], v239 offset:36928
    v_mfma_f32_16x16x32_bf16 v[172:175], a[176:179], v[112:115], v[172:175]
    v_exp_f32 v62, v164
    v_mfma_f32_16x16x32_bf16 v[172:175], a[180:183], v[124:127], v[172:175]
    ds_read_b128 a[152:155], v238 offset:37056
    v_mfma_f32_16x16x32_bf16 v[172:175], a[184:187], v[136:139], v[172:175]
    v_exp_f32 v63, v165
    v_mfma_f32_16x16x32_bf16 v[172:175], a[188:191], v[148:151], v[172:175]
    ds_read_b128 a[156:159], v239 offset:37056
    v_exp_f32 v38, v166
    v_mfma_f32_16x16x32_bf16 v[176:179], a[168:171], v[92:95], v[44:47]
    v_exp_f32 v39, v167
    v_mfma_f32_16x16x32_bf16 v[176:179], a[172:175], v[104:107], v[176:179]
    ds_read_b128 a[160:163], v238 offset:37184
    v_add_f32 v56, v62, v63
    v_mfma_f32_16x16x32_bf16 v[176:179], a[176:179], v[116:119], v[176:179]
    v_cvt_pk_bf16_f32 v68, v62, v63
    v_add_f32 v56, v56, v38
    v_add_f32 v56, v56, v39
    v_mfma_f32_16x16x32_bf16 v[176:179], a[180:183], v[128:131], v[176:179]
    ds_read_b128 a[164:167], v239 offset:37184
    v_cvt_pk_bf16_f32 v69, v38, v39
    v_mfma_f32_16x16x32_bf16 v[176:179], a[184:187], v[140:143], v[176:179]
    v_exp_f32 v58, v168
    v_mfma_f32_16x16x32_bf16 v[176:179], a[188:191], v[152:155], v[176:179]
    v_exp_f32 v59, v169
    v_mfma_f32_16x16x32_bf16 v[180:183], a[168:171], v[96:99], v[48:51]
    v_exp_f32 v60, v170
    v_mfma_f32_16x16x32_bf16 v[180:183], a[172:175], v[108:111], v[180:183]
    v_exp_f32 v61, v171
    v_mfma_f32_16x16x32_bf16 v[180:183], a[176:179], v[120:123], v[180:183]
    v_add_f32 v57, v58, v59
    v_cvt_pk_bf16_f32 v72, v58, v59
    v_mfma_f32_16x16x32_bf16 v[180:183], a[180:183], v[132:135], v[180:183]
    v_add_f32 v57, v57, v60
    v_add_f32 v57, v57, v61
    v_cvt_pk_bf16_f32 v73, v60, v61
    v_mfma_f32_16x16x32_bf16 v[180:183], a[184:187], v[144:147], v[180:183]
    v_exp_f32 v62, v172
    v_mfma_f32_16x16x32_bf16 v[180:183], a[188:191], v[156:159], v[180:183]
    v_exp_f32 v63, v173
    s_waitcnt lgkmcnt(0)
    v_mfma_f32_16x16x32_bf16 v[184:187], a[144:147], v[88:91], v[40:43]
    ds_read_b128 a[168:171], v238 offset:38464
    v_exp_f32 v38, v174
    v_mfma_f32_16x16x32_bf16 v[184:187], a[148:151], v[100:103], v[184:187]
    ds_read_b128 a[172:175], v239 offset:38464
    v_mfma_f32_16x16x32_bf16 v[184:187], a[152:155], v[112:115], v[184:187]
    v_exp_f32 v39, v175
    v_mfma_f32_16x16x32_bf16 v[184:187], a[156:159], v[124:127], v[184:187]
    ds_read_b128 a[176:179], v238 offset:38592
    v_add_f32 v55, v55, v62
    v_add_f32 v55, v55, v63
    v_mfma_f32_16x16x32_bf16 v[184:187], a[160:163], v[136:139], v[184:187]
    v_cvt_pk_bf16_f32 v66, v62, v63
    v_add_f32 v55, v55, v38
    v_mfma_f32_16x16x32_bf16 v[184:187], a[164:167], v[148:151], v[184:187]
    ds_read_b128 a[180:183], v239 offset:38592
    v_add_f32 v55, v55, v39
    v_mfma_f32_16x16x32_bf16 v[188:191], a[144:147], v[92:95], v[44:47]
    v_cvt_pk_bf16_f32 v67, v38, v39
    v_mfma_f32_16x16x32_bf16 v[188:191], a[148:151], v[104:107], v[188:191]
    ds_read_b128 a[184:187], v238 offset:38720
    v_exp_f32 v58, v176
    v_mfma_f32_16x16x32_bf16 v[188:191], a[152:155], v[116:119], v[188:191]
    v_exp_f32 v59, v177
    v_mfma_f32_16x16x32_bf16 v[188:191], a[156:159], v[128:131], v[188:191]
    ds_read_b128 a[188:191], v239 offset:38720
    v_mfma_f32_16x16x32_bf16 v[188:191], a[160:163], v[140:143], v[188:191]
    v_exp_f32 v60, v178
    v_mfma_f32_16x16x32_bf16 v[188:191], a[164:167], v[152:155], v[188:191]
    v_exp_f32 v61, v179
    v_mfma_f32_16x16x32_bf16 v[192:195], a[144:147], v[96:99], v[48:51]
    v_add_f32 v56, v56, v58
    v_add_f32 v56, v56, v59
    v_mfma_f32_16x16x32_bf16 v[192:195], a[148:151], v[108:111], v[192:195]
    v_cvt_pk_bf16_f32 v70, v58, v59
    v_add_f32 v56, v56, v60
    v_add_f32 v56, v56, v61
    v_mfma_f32_16x16x32_bf16 v[192:195], a[152:155], v[120:123], v[192:195]
    v_cvt_pk_bf16_f32 v71, v60, v61
    v_mfma_f32_16x16x32_bf16 v[192:195], a[156:159], v[132:135], v[192:195]
    v_exp_f32 v62, v180
    v_mfma_f32_16x16x32_bf16 v[192:195], a[160:163], v[144:147], v[192:195]
    v_exp_f32 v63, v181
    v_mfma_f32_16x16x32_bf16 v[192:195], a[164:167], v[156:159], v[192:195]
    v_exp_f32 v38, v182
    s_waitcnt lgkmcnt(0)
    v_mfma_f32_16x16x32_bf16 v[196:199], a[168:171], v[88:91], v[40:43]
    ds_read_b64_tr_b16 a[144:145], v248 offset:0
    v_mfma_f32_16x16x32_bf16 v[196:199], a[172:175], v[100:103], v[196:199]
    ds_read_b64_tr_b16 a[146:147], v248 offset:1536
    v_mfma_f32_16x16x32_bf16 v[196:199], a[176:179], v[112:115], v[196:199]
    ds_read_b64_tr_b16 a[148:149], v248 offset:12288
    v_exp_f32 v39, v183
    v_mfma_f32_16x16x32_bf16 v[196:199], a[180:183], v[124:127], v[196:199]
    ds_read_b64_tr_b16 a[150:151], v248 offset:13824
    v_add_f32 v57, v57, v62
    v_mfma_f32_16x16x32_bf16 v[196:199], a[184:187], v[136:139], v[196:199]
    ds_read_b64_tr_b16 a[152:153], v249 offset:0
    v_add_f32 v57, v57, v63
    v_mfma_f32_16x16x32_bf16 v[196:199], a[188:191], v[148:151], v[196:199]
    ds_read_b64_tr_b16 a[154:155], v249 offset:1536
    v_cvt_pk_bf16_f32 v74, v62, v63
    v_add_f32 v57, v57, v38
    v_mfma_f32_16x16x32_bf16 v[200:203], a[168:171], v[92:95], v[44:47]
    ds_read_b64_tr_b16 a[156:157], v249 offset:12288
    v_add_f32 v57, v57, v39
    v_mfma_f32_16x16x32_bf16 v[200:203], a[172:175], v[104:107], v[200:203]
    ds_read_b64_tr_b16 a[158:159], v249 offset:13824
    v_cvt_pk_bf16_f32 v75, v38, v39
    v_mfma_f32_16x16x32_bf16 v[200:203], a[176:179], v[116:119], v[200:203]
    ds_read_b64_tr_b16 a[160:161], v250 offset:0
    v_exp_f32 v58, v184
    v_mfma_f32_16x16x32_bf16 v[200:203], a[180:183], v[128:131], v[200:203]
    ds_read_b64_tr_b16 a[162:163], v250 offset:1536
    v_mfma_f32_16x16x32_bf16 v[200:203], a[184:187], v[140:143], v[200:203]
    ds_read_b64_tr_b16 a[164:165], v250 offset:12288
    v_mfma_f32_16x16x32_bf16 v[200:203], a[188:191], v[152:155], v[200:203]
    ds_read_b64_tr_b16 a[166:167], v250 offset:13824
    v_exp_f32 v59, v185
    v_mfma_f32_16x16x32_bf16 v[204:207], a[168:171], v[96:99], v[48:51]
    v_exp_f32 v60, v186
    v_mfma_f32_16x16x32_bf16 v[204:207], a[172:175], v[108:111], v[204:207]
    v_exp_f32 v61, v187
    v_mfma_f32_16x16x32_bf16 v[204:207], a[176:179], v[120:123], v[204:207]
    v_add_f32 v55, v55, v58
    v_add_f32 v55, v55, v59
    v_mfma_f32_16x16x32_bf16 v[204:207], a[180:183], v[132:135], v[204:207]
    v_cvt_pk_bf16_f32 v76, v58, v59
    v_add_f32 v55, v55, v60
    v_add_f32 v55, v55, v61
    v_mfma_f32_16x16x32_bf16 v[204:207], a[184:187], v[144:147], v[204:207]
    v_cvt_pk_bf16_f32 v77, v60, v61
    v_mfma_f32_16x16x32_bf16 v[204:207], a[188:191], v[156:159], v[204:207]
    v_exp_f32 v62, v188
    s_waitcnt lgkmcnt(0)
    v_mfma_f32_16x16x32_bf16 a[0:3], a[144:147], v[208:211], a[0:3]
    ds_read_b64_tr_b16 a[168:169], v251 offset:0
    v_exp_f32 v63, v189
    v_mfma_f32_16x16x32_bf16 a[0:3], a[148:151], v[220:223], a[0:3]
    ds_read_b64_tr_b16 a[170:171], v251 offset:1536
    v_mfma_f32_16x16x32_bf16 a[4:7], a[144:147], v[212:215], a[4:7]
    ds_read_b64_tr_b16 a[172:173], v251 offset:12288
    v_mfma_f32_16x16x32_bf16 a[4:7], a[148:151], v[224:227], a[4:7]
    ds_read_b64_tr_b16 a[174:175], v251 offset:13824
    v_exp_f32 v38, v190
    v_mfma_f32_16x16x32_bf16 a[8:11], a[144:147], v[216:219], a[8:11]
    ds_read_b64_tr_b16 a[176:177], v248 offset:128
    v_mfma_f32_16x16x32_bf16 a[8:11], a[148:151], v[228:231], a[8:11]
    ds_read_b64_tr_b16 a[178:179], v248 offset:1664
    v_mfma_f32_16x16x32_bf16 a[12:15], a[152:155], v[208:211], a[12:15]
    ds_read_b64_tr_b16 a[180:181], v248 offset:12416
    v_exp_f32 v39, v191
    v_mfma_f32_16x16x32_bf16 a[12:15], a[156:159], v[220:223], a[12:15]
    ds_read_b64_tr_b16 a[182:183], v248 offset:13952
    v_add_f32 v56, v56, v62
    v_mfma_f32_16x16x32_bf16 a[16:19], a[152:155], v[212:215], a[16:19]
    ds_read_b64_tr_b16 a[184:185], v249 offset:128
    v_add_f32 v56, v56, v63
    v_mfma_f32_16x16x32_bf16 a[16:19], a[156:159], v[224:227], a[16:19]
    ds_read_b64_tr_b16 a[186:187], v249 offset:1664
    v_cvt_pk_bf16_f32 v80, v62, v63
    v_mfma_f32_16x16x32_bf16 a[20:23], a[152:155], v[216:219], a[20:23]
    ds_read_b64_tr_b16 a[188:189], v249 offset:12416
    v_add_f32 v56, v56, v38
    v_add_f32 v56, v56, v39
    v_mfma_f32_16x16x32_bf16 a[20:23], a[156:159], v[228:231], a[20:23]
    ds_read_b64_tr_b16 a[190:191], v249 offset:13952
    v_cvt_pk_bf16_f32 v81, v38, v39
    v_mfma_f32_16x16x32_bf16 a[24:27], a[160:163], v[208:211], a[24:27]
    v_exp_f32 v58, v192
    v_mfma_f32_16x16x32_bf16 a[24:27], a[164:167], v[220:223], a[24:27]
    v_exp_f32 v59, v193
    v_mfma_f32_16x16x32_bf16 a[28:31], a[160:163], v[212:215], a[28:31]
    v_exp_f32 v60, v194
    v_mfma_f32_16x16x32_bf16 a[28:31], a[164:167], v[224:227], a[28:31]
    v_exp_f32 v61, v195
    v_mfma_f32_16x16x32_bf16 a[32:35], a[160:163], v[216:219], a[32:35]
    v_add_f32 v57, v57, v58
    v_add_f32 v57, v57, v59
    v_cvt_pk_bf16_f32 v84, v58, v59
    v_mfma_f32_16x16x32_bf16 a[32:35], a[164:167], v[228:231], a[32:35]
    v_add_f32 v57, v57, v60
    v_add_f32 v57, v57, v61
    s_waitcnt lgkmcnt(0)
    v_mfma_f32_16x16x32_bf16 a[36:39], a[168:171], v[208:211], a[36:39]
    ds_read_b64_tr_b16 a[144:145], v250 offset:128
    v_cvt_pk_bf16_f32 v85, v60, v61
    v_mfma_f32_16x16x32_bf16 a[36:39], a[172:175], v[220:223], a[36:39]
    ds_read_b64_tr_b16 a[146:147], v250 offset:1664
    v_exp_f32 v62, v196
    v_mfma_f32_16x16x32_bf16 a[40:43], a[168:171], v[212:215], a[40:43]
    ds_read_b64_tr_b16 a[148:149], v250 offset:12416
    v_mfma_f32_16x16x32_bf16 a[40:43], a[172:175], v[224:227], a[40:43]
    ds_read_b64_tr_b16 a[150:151], v250 offset:13952
    v_mfma_f32_16x16x32_bf16 a[44:47], a[168:171], v[216:219], a[44:47]
    ds_read_b64_tr_b16 a[152:153], v251 offset:128
    v_mfma_f32_16x16x32_bf16 a[44:47], a[172:175], v[228:231], a[44:47]
    ds_read_b64_tr_b16 a[154:155], v251 offset:1664
    v_exp_f32 v63, v197
    v_mfma_f32_16x16x32_bf16 a[48:51], a[176:179], v[208:211], a[48:51]
    ds_read_b64_tr_b16 a[156:157], v251 offset:12416
    v_mfma_f32_16x16x32_bf16 a[48:51], a[180:183], v[220:223], a[48:51]
    ds_read_b64_tr_b16 a[158:159], v251 offset:13952
    v_mfma_f32_16x16x32_bf16 a[52:55], a[176:179], v[212:215], a[52:55]
    ds_read_b64_tr_b16 a[160:161], v248 offset:256
    v_exp_f32 v38, v198
    v_mfma_f32_16x16x32_bf16 a[52:55], a[180:183], v[224:227], a[52:55]
    ds_read_b64_tr_b16 a[162:163], v248 offset:1792
    v_mfma_f32_16x16x32_bf16 a[56:59], a[176:179], v[216:219], a[56:59]
    ds_read_b64_tr_b16 a[164:165], v248 offset:12544
    v_mfma_f32_16x16x32_bf16 a[56:59], a[180:183], v[228:231], a[56:59]
    ds_read_b64_tr_b16 a[166:167], v248 offset:14080
    v_exp_f32 v39, v199
    v_mfma_f32_16x16x32_bf16 a[60:63], a[184:187], v[208:211], a[60:63]
    v_add_f32 v55, v55, v62
    v_add_f32 v55, v55, v63
    v_mfma_f32_16x16x32_bf16 a[60:63], a[188:191], v[220:223], a[60:63]
    v_cvt_pk_bf16_f32 v78, v62, v63
    v_add_f32 v55, v55, v38
    v_mfma_f32_16x16x32_bf16 a[64:67], a[184:187], v[212:215], a[64:67]
    v_add_f32 v55, v55, v39
    v_cvt_pk_bf16_f32 v79, v38, v39
    v_mfma_f32_16x16x32_bf16 a[64:67], a[188:191], v[224:227], a[64:67]
    v_exp_f32 v58, v200
    v_mfma_f32_16x16x32_bf16 a[68:71], a[184:187], v[216:219], a[68:71]
    v_exp_f32 v59, v201
    v_mfma_f32_16x16x32_bf16 a[68:71], a[188:191], v[228:231], a[68:71]
    v_exp_f32 v60, v202
    s_waitcnt lgkmcnt(0)
    v_mfma_f32_16x16x32_bf16 a[72:75], a[144:147], v[208:211], a[72:75]
    ds_read_b64_tr_b16 a[168:169], v249 offset:256
    v_exp_f32 v61, v203
    v_mfma_f32_16x16x32_bf16 a[72:75], a[148:151], v[220:223], a[72:75]
    ds_read_b64_tr_b16 a[170:171], v249 offset:1792
    v_add_f32 v56, v56, v58
    v_mfma_f32_16x16x32_bf16 a[76:79], a[144:147], v[212:215], a[76:79]
    ds_read_b64_tr_b16 a[172:173], v249 offset:12544
    v_add_f32 v56, v56, v59
    v_mfma_f32_16x16x32_bf16 a[76:79], a[148:151], v[224:227], a[76:79]
    ds_read_b64_tr_b16 a[174:175], v249 offset:14080
    v_cvt_pk_bf16_f32 v82, v58, v59
    v_add_f32 v56, v56, v60
    v_mfma_f32_16x16x32_bf16 a[80:83], a[144:147], v[216:219], a[80:83]
    ds_read_b64_tr_b16 a[176:177], v250 offset:256
    v_add_f32 v56, v56, v61
    v_mfma_f32_16x16x32_bf16 a[80:83], a[148:151], v[228:231], a[80:83]
    ds_read_b64_tr_b16 a[178:179], v250 offset:1792
    v_cvt_pk_bf16_f32 v83, v60, v61
    v_mfma_f32_16x16x32_bf16 a[84:87], a[152:155], v[208:211], a[84:87]
    ds_read_b64_tr_b16 a[180:181], v250 offset:12544
    v_exp_f32 v62, v204
    v_mfma_f32_16x16x32_bf16 a[84:87], a[156:159], v[220:223], a[84:87]
    ds_read_b64_tr_b16 a[182:183], v250 offset:14080
    v_mfma_f32_16x16x32_bf16 a[88:91], a[152:155], v[212:215], a[88:91]
    ds_read_b64_tr_b16 a[184:185], v251 offset:256
    v_mfma_f32_16x16x32_bf16 a[88:91], a[156:159], v[224:227], a[88:91]
    ds_read_b64_tr_b16 a[186:187], v251 offset:1792
    v_exp_f32 v63, v205
    v_mfma_f32_16x16x32_bf16 a[92:95], a[152:155], v[216:219], a[92:95]
    ds_read_b64_tr_b16 a[188:189], v251 offset:12544
    v_mfma_f32_16x16x32_bf16 a[92:95], a[156:159], v[228:231], a[92:95]
    ds_read_b64_tr_b16 a[190:191], v251 offset:14080
    v_mfma_f32_16x16x32_bf16 a[96:99], a[160:163], v[208:211], a[96:99]
    v_exp_f32 v38, v206
    v_mfma_f32_16x16x32_bf16 a[96:99], a[164:167], v[220:223], a[96:99]
    v_exp_f32 v39, v207
    v_add_f32 v57, v57, v62
    v_mfma_f32_16x16x32_bf16 a[100:103], a[160:163], v[212:215], a[100:103]
    v_add_f32 v57, v57, v63
    v_cvt_pk_bf16_f32 v86, v62, v63
    v_mfma_f32_16x16x32_bf16 a[100:103], a[164:167], v[224:227], a[100:103]
    v_add_f32 v57, v57, v38
    v_add_f32 v57, v57, v39
    v_mfma_f32_16x16x32_bf16 a[104:107], a[160:163], v[216:219], a[104:107]
    v_cvt_pk_bf16_f32 v87, v38, v39
    v_mfma_f32_16x16x32_bf16 a[104:107], a[164:167], v[228:231], a[104:107]
    s_waitcnt vmcnt(12)
    s_waitcnt lgkmcnt(0)
    s_barrier
    v_mfma_f32_16x16x32_bf16 a[108:111], a[168:171], v[208:211], a[108:111]
    ds_read_b128 a[144:147], v240 offset:24640
    v_mfma_f32_16x16x32_bf16 a[108:111], a[172:175], v[220:223], a[108:111]
    s_add_u32 m0, s29, 24640
    s_mov_b32 s35, 172032
    v_mfma_f32_16x16x32_bf16 a[112:115], a[168:171], v[212:215], a[112:115]
    ds_read_b128 a[148:151], v241 offset:24640
    v_mfma_f32_16x16x32_bf16 a[112:115], a[172:175], v[224:227], a[112:115]
    buffer_load_dwordx4 v26, s[16:19], s35 offen offset:0 nt lds
    v_mfma_f32_16x16x32_bf16 a[116:119], a[168:171], v[216:219], a[116:119]
    ds_read_b128 a[152:155], v240 offset:24768
    v_mfma_f32_16x16x32_bf16 a[116:119], a[172:175], v[228:231], a[116:119]
    buffer_load_dwordx4 v27, s[16:19], s35 offen offset:1024 nt lds
    v_mfma_f32_16x16x32_bf16 a[120:123], a[176:179], v[208:211], a[120:123]
    ds_read_b128 a[156:159], v241 offset:24768
    v_mfma_f32_16x16x32_bf16 a[120:123], a[180:183], v[220:223], a[120:123]
    buffer_load_dwordx4 v28, s[16:19], s35 offen offset:2048 nt lds
    v_mfma_f32_16x16x32_bf16 a[124:127], a[176:179], v[212:215], a[124:127]
    ds_read_b128 a[160:163], v240 offset:24896
    v_mfma_f32_16x16x32_bf16 a[124:127], a[180:183], v[224:227], a[124:127]
    buffer_load_dwordx4 v29, s[16:19], s35 offen offset:3072 nt lds
    v_mfma_f32_16x16x32_bf16 a[128:131], a[176:179], v[216:219], a[128:131]
    ds_read_b128 a[164:167], v241 offset:24896
    v_mfma_f32_16x16x32_bf16 a[128:131], a[180:183], v[228:231], a[128:131]
    s_add_u32 m0, s29, 28736
    v_mfma_f32_16x16x32_bf16 a[132:135], a[184:187], v[208:211], a[132:135]
    v_mfma_f32_16x16x32_bf16 a[132:135], a[188:191], v[220:223], a[132:135]
    buffer_load_dwordx4 v30, s[16:19], s35 offen offset:0 nt lds
    v_mfma_f32_16x16x32_bf16 a[136:139], a[184:187], v[212:215], a[136:139]
    v_mfma_f32_16x16x32_bf16 a[136:139], a[188:191], v[224:227], a[136:139]
    buffer_load_dwordx4 v31, s[16:19], s35 offen offset:1024 nt lds
    v_mfma_f32_16x16x32_bf16 a[140:143], a[184:187], v[216:219], a[140:143]
    v_mfma_f32_16x16x32_bf16 a[140:143], a[188:191], v[228:231], a[140:143]
    v_max3_f32 v1, v55, v56, v57
    v_cmp_lt_f32 vcc, s40, v1
    s_cbranch_vccnz L_stub_5
L_ret_5:
    v_add_f32 v52, v52, v55
    v_add_f32 v53, v53, v56
    v_add_f32 v54, v54, v57
    s_waitcnt lgkmcnt(0)
    v_mfma_f32_16x16x32_bf16 v[160:163], a[144:147], v[88:91], v[40:43]
    ds_read_b128 a[168:171], v240 offset:26176
    v_mfma_f32_16x16x32_bf16 v[160:163], a[148:151], v[100:103], v[160:163]
    ds_read_b128 a[172:175], v241 offset:26176
    v_mfma_f32_16x16x32_bf16 v[160:163], a[152:155], v[112:115], v[160:163]
    v_mfma_f32_16x16x32_bf16 v[160:163], a[156:159], v[124:127], v[160:163]
    ds_read_b128 a[176:179], v240 offset:26304
    v_mfma_f32_16x16x32_bf16 v[160:163], a[160:163], v[136:139], v[160:163]
    v_mfma_f32_16x16x32_bf16 v[160:163], a[164:167], v[148:151], v[160:163]
    ds_read_b128 a[180:183], v241 offset:26304
    v_mfma_f32_16x16x32_bf16 v[164:167], a[144:147], v[92:95], v[44:47]
    v_mfma_f32_16x16x32_bf16 v[164:167], a[148:151], v[104:107], v[164:167]
    ds_read_b128 a[184:187], v240 offset:26432
    v_mfma_f32_16x16x32_bf16 v[164:167], a[152:155], v[116:119], v[164:167]
    v_mfma_f32_16x16x32_bf16 v[164:167], a[156:159], v[128:131], v[164:167]
    ds_read_b128 a[188:191], v241 offset:26432
    v_mfma_f32_16x16x32_bf16 v[164:167], a[160:163], v[140:143], v[164:167]
    v_exp_f32 v58, v160
    v_mfma_f32_16x16x32_bf16 v[164:167], a[164:167], v[152:155], v[164:167]
    v_exp_f32 v59, v161
    v_mfma_f32_16x16x32_bf16 v[168:171], a[144:147], v[96:99], v[48:51]
    v_exp_f32 v60, v162
    v_mfma_f32_16x16x32_bf16 v[168:171], a[148:151], v[108:111], v[168:171]
    v_exp_f32 v61, v163
    v_mfma_f32_16x16x32_bf16 v[168:171], a[152:155], v[120:123], v[168:171]
    v_add_f32 v55, v58, v59
    v_cvt_pk_bf16_f32 v208, v58, v59
    v_add_f32 v55, v55, v60
    v_mfma_f32_16x16x32_bf16 v[168:171], a[156:159], v[132:135], v[168:171]
    v_add_f32 v55, v55, v61
    v_cvt_pk_bf16_f32 v209, v60, v61
    v_mfma_f32_16x16x32_bf16 v[168:171], a[160:163], v[144:147], v[168:171]
    v_exp_f32 v62, v164
    v_mfma_f32_16x16x32_bf16 v[168:171], a[164:167], v[156:159], v[168:171]
    v_exp_f32 v63, v165
    s_waitcnt lgkmcnt(0)
    v_mfma_f32_16x16x32_bf16 v[172:175], a[168:171], v[88:91], v[40:43]
    ds_read_b128 a[144:147], v240 offset:36928
    v_exp_f32 v38, v166
    v_mfma_f32_16x16x32_bf16 v[172:175], a[172:175], v[100:103], v[172:175]
    ds_read_b128 a[148:151], v241 offset:36928
    v_mfma_f32_16x16x32_bf16 v[172:175], a[176:179], v[112:115], v[172:175]
    v_exp_f32 v39, v167
    v_mfma_f32_16x16x32_bf16 v[172:175], a[180:183], v[124:127], v[172:175]
    ds_read_b128 a[152:155], v240 offset:37056
    v_add_f32 v56, v62, v63
    v_cvt_pk_bf16_f32 v212, v62, v63
    v_mfma_f32_16x16x32_bf16 v[172:175], a[184:187], v[136:139], v[172:175]
    v_add_f32 v56, v56, v38
    v_add_f32 v56, v56, v39
    v_mfma_f32_16x16x32_bf16 v[172:175], a[188:191], v[148:151], v[172:175]
    ds_read_b128 a[156:159], v241 offset:37056
    v_cvt_pk_bf16_f32 v213, v38, v39
    v_mfma_f32_16x16x32_bf16 v[176:179], a[168:171], v[92:95], v[44:47]
    v_exp_f32 v58, v168
    v_mfma_f32_16x16x32_bf16 v[176:179], a[172:175], v[104:107], v[176:179]
    ds_read_b128 a[160:163], v240 offset:37184
    v_exp_f32 v59, v169
    v_mfma_f32_16x16x32_bf16 v[176:179], a[176:179], v[116:119], v[176:179]
    v_exp_f32 v60, v170
    v_mfma_f32_16x16x32_bf16 v[176:179], a[180:183], v[128:131], v[176:179]
    ds_read_b128 a[164:167], v241 offset:37184
    v_mfma_f32_16x16x32_bf16 v[176:179], a[184:187], v[140:143], v[176:179]
    v_exp_f32 v61, v171
    v_mfma_f32_16x16x32_bf16 v[176:179], a[188:191], v[152:155], v[176:179]
    v_add_f32 v57, v58, v59
    v_cvt_pk_bf16_f32 v216, v58, v59
    v_add_f32 v57, v57, v60
    v_mfma_f32_16x16x32_bf16 v[180:183], a[168:171], v[96:99], v[48:51]
    v_add_f32 v57, v57, v61
    v_cvt_pk_bf16_f32 v217, v60, v61
    v_mfma_f32_16x16x32_bf16 v[180:183], a[172:175], v[108:111], v[180:183]
    v_exp_f32 v62, v172
    v_mfma_f32_16x16x32_bf16 v[180:183], a[176:179], v[120:123], v[180:183]
    v_exp_f32 v63, v173
    v_mfma_f32_16x16x32_bf16 v[180:183], a[180:183], v[132:135], v[180:183]
    v_exp_f32 v38, v174
    v_mfma_f32_16x16x32_bf16 v[180:183], a[184:187], v[144:147], v[180:183]
    v_exp_f32 v39, v175
    v_mfma_f32_16x16x32_bf16 v[180:183], a[188:191], v[156:159], v[180:183]
    v_add_f32 v55, v55, v62
    v_add_f32 v55, v55, v63
    s_waitcnt lgkmcnt(0)
    v_mfma_f32_16x16x32_bf16 v[184:187], a[144:147], v[88:91], v[40:43]
    ds_read_b128 a[168:171], v240 offset:38464
    v_cvt_pk_bf16_f32 v210, v62, v63
    v_add_f32 v55, v55, v38
    v_mfma_f32_16x16x32_bf16 v[184:187], a[148:151], v[100:103], v[184:187]
    ds_read_b128 a[172:175], v241 offset:38464
    v_add_f32 v55, v55, v39
    v_mfma_f32_16x16x32_bf16 v[184:187], a[152:155], v[112:115], v[184:187]
    v_cvt_pk_bf16_f32 v211, v38, v39
    v_mfma_f32_16x16x32_bf16 v[184:187], a[156:159], v[124:127], v[184:187]
    ds_read_b128 a[176:179], v240 offset:38592
    v_mfma_f32_16x16x32_bf16 v[184:187], a[160:163], v[136:139], v[184:187]
    v_exp_f32 v58, v176
    v_mfma_f32_16x16x32_bf16 v[184:187], a[164:167], v[148:151], v[184:187]
    ds_read_b128 a[180:183], v241 offset:38592
    v_mfma_f32_16x16x32_bf16 v[188:191], a[144:147], v[92:95], v[44:47]
    v_exp_f32 v59, v177
    v_mfma_f32_16x16x32_bf16 v[188:191], a[148:151], v[104:107], v[188:191]
    ds_read_b128 a[184:187], v240 offset:38720
    v_exp_f32 v60, v178
    v_mfma_f32_16x16x32_bf16 v[188:191], a[152:155], v[116:119], v[188:191]
    v_exp_f32 v61, v179
    v_mfma_f32_16x16x32_bf16 v[188:191], a[156:159], v[128:131], v[188:191]
    ds_read_b128 a[188:191], v241 offset:38720
    v_add_f32 v56, v56, v58
    v_mfma_f32_16x16x32_bf16 v[188:191], a[160:163], v[140:143], v[188:191]
    v_add_f32 v56, v56, v59
    v_cvt_pk_bf16_f32 v214, v58, v59
    v_mfma_f32_16x16x32_bf16 v[188:191], a[164:167], v[152:155], v[188:191]
    v_add_f32 v56, v56, v60
    v_add_f32 v56, v56, v61
    v_cvt_pk_bf16_f32 v215, v60, v61
    v_mfma_f32_16x16x32_bf16 v[192:195], a[144:147], v[96:99], v[48:51]
    v_exp_f32 v62, v180
    v_mfma_f32_16x16x32_bf16 v[192:195], a[148:151], v[108:111], v[192:195]
    v_exp_f32 v63, v181
    v_mfma_f32_16x16x32_bf16 v[192:195], a[152:155], v[120:123], v[192:195]
    v_exp_f32 v38, v182
    v_mfma_f32_16x16x32_bf16 v[192:195], a[156:159], v[132:135], v[192:195]
    v_exp_f32 v39, v183
    v_add_f32 v57, v57, v62
    v_mfma_f32_16x16x32_bf16 v[192:195], a[160:163], v[144:147], v[192:195]
    v_add_f32 v57, v57, v63
    v_cvt_pk_bf16_f32 v218, v62, v63
    v_mfma_f32_16x16x32_bf16 v[192:195], a[164:167], v[156:159], v[192:195]
    v_add_f32 v57, v57, v38
    v_add_f32 v57, v57, v39
    s_waitcnt lgkmcnt(0)
    v_mfma_f32_16x16x32_bf16 v[196:199], a[168:171], v[88:91], v[40:43]
    ds_read_b64_tr_b16 a[144:145], v252 offset:0
    v_cvt_pk_bf16_f32 v219, v38, v39
    v_mfma_f32_16x16x32_bf16 v[196:199], a[172:175], v[100:103], v[196:199]
    ds_read_b64_tr_b16 a[146:147], v252 offset:1536
    v_mfma_f32_16x16x32_bf16 v[196:199], a[176:179], v[112:115], v[196:199]
    ds_read_b64_tr_b16 a[148:149], v252 offset:12288
    v_mfma_f32_16x16x32_bf16 v[196:199], a[180:183], v[124:127], v[196:199]
    ds_read_b64_tr_b16 a[150:151], v252 offset:13824
    v_mfma_f32_16x16x32_bf16 v[196:199], a[184:187], v[136:139], v[196:199]
    ds_read_b64_tr_b16 a[152:153], v253 offset:0
    v_exp_f32 v58, v184
    v_mfma_f32_16x16x32_bf16 v[196:199], a[188:191], v[148:151], v[196:199]
    ds_read_b64_tr_b16 a[154:155], v253 offset:1536
    v_mfma_f32_16x16x32_bf16 v[200:203], a[168:171], v[92:95], v[44:47]
    ds_read_b64_tr_b16 a[156:157], v253 offset:12288
    v_mfma_f32_16x16x32_bf16 v[200:203], a[172:175], v[104:107], v[200:203]
    ds_read_b64_tr_b16 a[158:159], v253 offset:13824
    v_mfma_f32_16x16x32_bf16 v[200:203], a[176:179], v[116:119], v[200:203]
    ds_read_b64_tr_b16 a[160:161], v254 offset:0
    v_exp_f32 v59, v185
    v_mfma_f32_16x16x32_bf16 v[200:203], a[180:183], v[128:131], v[200:203]
    ds_read_b64_tr_b16 a[162:163], v254 offset:1536
    v_mfma_f32_16x16x32_bf16 v[200:203], a[184:187], v[140:143], v[200:203]
    ds_read_b64_tr_b16 a[164:165], v254 offset:12288
    v_mfma_f32_16x16x32_bf16 v[200:203], a[188:191], v[152:155], v[200:203]
    ds_read_b64_tr_b16 a[166:167], v254 offset:13824
    v_exp_f32 v60, v186
    v_mfma_f32_16x16x32_bf16 v[204:207], a[168:171], v[96:99], v[48:51]
    v_exp_f32 v61, v187
    v_mfma_f32_16x16x32_bf16 v[204:207], a[172:175], v[108:111], v[204:207]
    v_add_f32 v55, v55, v58
    v_add_f32 v55, v55, v59
    v_mfma_f32_16x16x32_bf16 v[204:207], a[176:179], v[120:123], v[204:207]
    v_cvt_pk_bf16_f32 v220, v58, v59
    v_add_f32 v55, v55, v60
    v_mfma_f32_16x16x32_bf16 v[204:207], a[180:183], v[132:135], v[204:207]
    v_add_f32 v55, v55, v61
    v_cvt_pk_bf16_f32 v221, v60, v61
    v_mfma_f32_16x16x32_bf16 v[204:207], a[184:187], v[144:147], v[204:207]
    v_exp_f32 v62, v188
    v_mfma_f32_16x16x32_bf16 v[204:207], a[188:191], v[156:159], v[204:207]
    v_exp_f32 v63, v189
    s_waitcnt lgkmcnt(0)
    v_mfma_f32_16x16x32_bf16 a[0:3], a[144:147], v[64:67], a[0:3]
    ds_read_b64_tr_b16 a[168:169], v255 offset:0
    v_exp_f32 v38, v190
    v_mfma_f32_16x16x32_bf16 a[0:3], a[148:151], v[76:79], a[0:3]
    ds_read_b64_tr_b16 a[170:171], v255 offset:1536
    v_mfma_f32_16x16x32_bf16 a[4:7], a[144:147], v[68:71], a[4:7]
    ds_read_b64_tr_b16 a[172:173], v255 offset:12288
    v_mfma_f32_16x16x32_bf16 a[4:7], a[148:151], v[80:83], a[4:7]
    ds_read_b64_tr_b16 a[174:175], v255 offset:13824
    v_mfma_f32_16x16x32_bf16 a[8:11], a[144:147], v[72:75], a[8:11]
    ds_read_b64_tr_b16 a[176:177], v252 offset:128
    v_exp_f32 v39, v191
    v_mfma_f32_16x16x32_bf16 a[8:11], a[148:151], v[84:87], a[8:11]
    ds_read_b64_tr_b16 a[178:179], v252 offset:1664
    v_add_f32 v56, v56, v62
    v_mfma_f32_16x16x32_bf16 a[12:15], a[152:155], v[64:67], a[12:15]
    ds_read_b64_tr_b16 a[180:181], v252 offset:12416
    v_add_f32 v56, v56, v63
    v_mfma_f32_16x16x32_bf16 a[12:15], a[156:159], v[76:79], a[12:15]
    ds_read_b64_tr_b16 a[182:183], v252 offset:13952
    v_cvt_pk_bf16_f32 v224, v62, v63
    v_mfma_f32_16x16x32_bf16 a[16:19], a[152:155], v[68:71], a[16:19]
    ds_read_b64_tr_b16 a[184:185], v253 offset:128
    v_add_f32 v56, v56, v38
    v_add_f32 v56, v56, v39
    v_mfma_f32_16x16x32_bf16 a[16:19], a[156:159], v[80:83], a[16:19]
    ds_read_b64_tr_b16 a[186:187], v253 offset:1664
    v_cvt_pk_bf16_f32 v225, v38, v39
    v_mfma_f32_16x16x32_bf16 a[20:23], a[152:155], v[72:75], a[20:23]
    ds_read_b64_tr_b16 a[188:189], v253 offset:12416
    v_mfma_f32_16x16x32_bf16 a[20:23], a[156:159], v[84:87], a[20:23]
    ds_read_b64_tr_b16 a[190:191], v253 offset:13952
    v_exp_f32 v58, v192
    v_mfma_f32_16x16x32_bf16 a[24:27], a[160:163], v[64:67], a[24:27]
    v_exp_f32 v59, v193
    v_mfma_f32_16x16x32_bf16 a[24:27], a[164:167], v[76:79], a[24:27]
    v_exp_f32 v60, v194
    v_mfma_f32_16x16x32_bf16 a[28:31], a[160:163], v[68:71], a[28:31]
    v_exp_f32 v61, v195
    v_mfma_f32_16x16x32_bf16 a[28:31], a[164:167], v[80:83], a[28:31]
    v_add_f32 v57, v57, v58
    v_add_f32 v57, v57, v59
    v_cvt_pk_bf16_f32 v228, v58, v59
    v_mfma_f32_16x16x32_bf16 a[32:35], a[160:163], v[72:75], a[32:35]
    v_add_f32 v57, v57, v60
    v_add_f32 v57, v57, v61
    v_mfma_f32_16x16x32_bf16 a[32:35], a[164:167], v[84:87], a[32:35]
    v_cvt_pk_bf16_f32 v229, v60, v61
    s_waitcnt lgkmcnt(0)
    v_mfma_f32_16x16x32_bf16 a[36:39], a[168:171], v[64:67], a[36:39]
    ds_read_b64_tr_b16 a[144:145], v254 offset:128
    v_mfma_f32_16x16x32_bf16 a[36:39], a[172:175], v[76:79], a[36:39]
    ds_read_b64_tr_b16 a[146:147], v254 offset:1664
    v_exp_f32 v62, v196
    v_mfma_f32_16x16x32_bf16 a[40:43], a[168:171], v[68:71], a[40:43]
    ds_read_b64_tr_b16 a[148:149], v254 offset:12416
    v_mfma_f32_16x16x32_bf16 a[40:43], a[172:175], v[80:83], a[40:43]
    ds_read_b64_tr_b16 a[150:151], v254 offset:13952
    v_mfma_f32_16x16x32_bf16 a[44:47], a[168:171], v[72:75], a[44:47]
    ds_read_b64_tr_b16 a[152:153], v255 offset:128
    v_exp_f32 v63, v197
    v_mfma_f32_16x16x32_bf16 a[44:47], a[172:175], v[84:87], a[44:47]
    ds_read_b64_tr_b16 a[154:155], v255 offset:1664
    v_mfma_f32_16x16x32_bf16 a[48:51], a[176:179], v[64:67], a[48:51]
    ds_read_b64_tr_b16 a[156:157], v255 offset:12416
    v_mfma_f32_16x16x32_bf16 a[48:51], a[180:183], v[76:79], a[48:51]
    ds_read_b64_tr_b16 a[158:159], v255 offset:13952
    v_mfma_f32_16x16x32_bf16 a[52:55], a[176:179], v[68:71], a[52:55]
    ds_read_b64_tr_b16 a[160:161], v252 offset:256
    v_exp_f32 v38, v198
    v_mfma_f32_16x16x32_bf16 a[52:55], a[180:183], v[80:83], a[52:55]
    ds_read_b64_tr_b16 a[162:163], v252 offset:1792
    v_mfma_f32_16x16x32_bf16 a[56:59], a[176:179], v[72:75], a[56:59]
    ds_read_b64_tr_b16 a[164:165], v252 offset:12544
    v_mfma_f32_16x16x32_bf16 a[56:59], a[180:183], v[84:87], a[56:59]
    ds_read_b64_tr_b16 a[166:167], v252 offset:14080
    v_mfma_f32_16x16x32_bf16 a[60:63], a[184:187], v[64:67], a[60:63]
    v_exp_f32 v39, v199
    v_add_f32 v55, v55, v62
    v_mfma_f32_16x16x32_bf16 a[60:63], a[188:191], v[76:79], a[60:63]
    v_add_f32 v55, v55, v63
    v_cvt_pk_bf16_f32 v222, v62, v63
    v_mfma_f32_16x16x32_bf16 a[64:67], a[184:187], v[68:71], a[64:67]
    v_add_f32 v55, v55, v38
    v_add_f32 v55, v55, v39
    v_mfma_f32_16x16x32_bf16 a[64:67], a[188:191], v[80:83], a[64:67]
    v_cvt_pk_bf16_f32 v223, v38, v39
    v_exp_f32 v58, v200
    v_mfma_f32_16x16x32_bf16 a[68:71], a[184:187], v[72:75], a[68:71]
    v_exp_f32 v59, v201
    v_mfma_f32_16x16x32_bf16 a[68:71], a[188:191], v[84:87], a[68:71]
    v_exp_f32 v60, v202
    s_waitcnt lgkmcnt(0)
    v_mfma_f32_16x16x32_bf16 a[72:75], a[144:147], v[64:67], a[72:75]
    ds_read_b64_tr_b16 a[168:169], v253 offset:256
    v_mfma_f32_16x16x32_bf16 a[72:75], a[148:151], v[76:79], a[72:75]
    ds_read_b64_tr_b16 a[170:171], v253 offset:1792
    v_exp_f32 v61, v203
    v_mfma_f32_16x16x32_bf16 a[76:79], a[144:147], v[68:71], a[76:79]
    ds_read_b64_tr_b16 a[172:173], v253 offset:12544
    v_add_f32 v56, v56, v58
    v_mfma_f32_16x16x32_bf16 a[76:79], a[148:151], v[80:83], a[76:79]
    ds_read_b64_tr_b16 a[174:175], v253 offset:14080
    v_add_f32 v56, v56, v59
    v_mfma_f32_16x16x32_bf16 a[80:83], a[144:147], v[72:75], a[80:83]
    ds_read_b64_tr_b16 a[176:177], v254 offset:256
    v_cvt_pk_bf16_f32 v226, v58, v59
    v_mfma_f32_16x16x32_bf16 a[80:83], a[148:151], v[84:87], a[80:83]
    ds_read_b64_tr_b16 a[178:179], v254 offset:1792
    v_add_f32 v56, v56, v60
    v_add_f32 v56, v56, v61
    v_mfma_f32_16x16x32_bf16 a[84:87], a[152:155], v[64:67], a[84:87]
    ds_read_b64_tr_b16 a[180:181], v254 offset:12544
    v_cvt_pk_bf16_f32 v227, v60, v61
    v_mfma_f32_16x16x32_bf16 a[84:87], a[156:159], v[76:79], a[84:87]
    ds_read_b64_tr_b16 a[182:183], v254 offset:14080
    v_mfma_f32_16x16x32_bf16 a[88:91], a[152:155], v[68:71], a[88:91]
    ds_read_b64_tr_b16 a[184:185], v255 offset:256
    v_exp_f32 v62, v204
    v_mfma_f32_16x16x32_bf16 a[88:91], a[156:159], v[80:83], a[88:91]
    ds_read_b64_tr_b16 a[186:187], v255 offset:1792
    v_mfma_f32_16x16x32_bf16 a[92:95], a[152:155], v[72:75], a[92:95]
    ds_read_b64_tr_b16 a[188:189], v255 offset:12544
    v_mfma_f32_16x16x32_bf16 a[92:95], a[156:159], v[84:87], a[92:95]
    ds_read_b64_tr_b16 a[190:191], v255 offset:14080
    v_mfma_f32_16x16x32_bf16 a[96:99], a[160:163], v[64:67], a[96:99]
    v_exp_f32 v63, v205
    v_mfma_f32_16x16x32_bf16 a[96:99], a[164:167], v[76:79], a[96:99]
    v_exp_f32 v38, v206
    v_mfma_f32_16x16x32_bf16 a[100:103], a[160:163], v[68:71], a[100:103]
    v_exp_f32 v39, v207
    v_mfma_f32_16x16x32_bf16 a[100:103], a[164:167], v[80:83], a[100:103]
    v_add_f32 v57, v57, v62
    v_add_f32 v57, v57, v63
    v_mfma_f32_16x16x32_bf16 a[104:107], a[160:163], v[72:75], a[104:107]
    v_cvt_pk_bf16_f32 v230, v62, v63
    v_add_f32 v57, v57, v38
    v_add_f32 v57, v57, v39
    v_mfma_f32_16x16x32_bf16 a[104:107], a[164:167], v[84:87], a[104:107]
    v_cvt_pk_bf16_f32 v231, v38, v39
    s_waitcnt vmcnt(6)
    s_waitcnt lgkmcnt(0)
    s_barrier
    s_cmp_eq_u32 s32, 0
    s_cbranch_scc0 L_last_sw
    s_add_u32 s12, s12, 786432
    s_addc_u32 s13, s13, 0
    s_add_u32 s16, s16, 786432
    s_addc_u32 s17, s17, 0
    s_mov_b32 s62, 0
    s_branch L_sw_done
L_last_sw:
    s_mul_i32 s42, s34, 245760
    s_add_u32 s12, s56, s42
    s_addc_u32 s13, s57, 0
    s_mov_b32 s14, 245760
    s_add_u32 s42, s42, 983040
    s_add_u32 s16, s56, s42
    s_addc_u32 s17, s57, 0
    s_mov_b32 s18, 245760
    s_mov_b32 s41, 128
    s_mov_b32 s38, 0
    v_mov_b32 v20, v8
    v_mov_b32 v21, v9
    v_mov_b32 v22, v10
    v_mov_b32 v23, v11
    v_mov_b32 v24, v12
    v_mov_b32 v25, v13
    v_mov_b32 v26, v8
    v_mov_b32 v27, v9
    v_mov_b32 v28, v10
    v_mov_b32 v29, v11
    v_mov_b32 v30, v12
    v_mov_b32 v31, v13
    s_and_b32 s42, s2, 3
    s_mul_i32 s42, s42, 1966080
    s_lshr_b32 s43, s2, 3
    s_mul_i32 s43, s43, 61440
    s_add_u32 s42, s42, s43
    s_add_u32 s60, s56, s42
    s_addc_u32 s61, s57, 0
    s_cmp_ge_u32 s28, 2
    s_cselect_b32 s62, 0, 61440
    s_mov_b32 s47, 128
L_sw_done:
    v_mfma_f32_16x16x32_bf16 a[108:111], a[168:171], v[64:67], a[108:111]
    ds_read_b128 a[144:147], v242 offset:24640
    v_mfma_f32_16x16x32_bf16 a[108:111], a[172:175], v[76:79], a[108:111]
    s_add_u32 m0, s29, 98560
    s_mul_i32 s35, s41, 0
    v_mfma_f32_16x16x32_bf16 a[112:115], a[168:171], v[68:71], a[112:115]
    ds_read_b128 a[148:151], v243 offset:24640
    v_mfma_f32_16x16x32_bf16 a[112:115], a[172:175], v[80:83], a[112:115]
    buffer_load_dwordx4 v20, s[12:15], s35 offen offset:0 nt lds
    v_mfma_f32_16x16x32_bf16 a[116:119], a[168:171], v[72:75], a[116:119]
    ds_read_b128 a[152:155], v242 offset:24768
    v_mfma_f32_16x16x32_bf16 a[116:119], a[172:175], v[84:87], a[116:119]
    buffer_load_dwordx4 v21, s[12:15], s35 offen offset:1024 nt lds
    v_mfma_f32_16x16x32_bf16 a[120:123], a[176:179], v[64:67], a[120:123]
    ds_read_b128 a[156:159], v243 offset:24768
    v_mfma_f32_16x16x32_bf16 a[120:123], a[180:183], v[76:79], a[120:123]
    buffer_load_dwordx4 v22, s[12:15], s35 offen offset:2048 nt lds
    v_mfma_f32_16x16x32_bf16 a[124:127], a[176:179], v[68:71], a[124:127]
    ds_read_b128 a[160:163], v242 offset:24896
    v_mfma_f32_16x16x32_bf16 a[124:127], a[180:183], v[80:83], a[124:127]
    buffer_load_dwordx4 v23, s[12:15], s35 offen offset:3072 nt lds
    v_mfma_f32_16x16x32_bf16 a[128:131], a[176:179], v[72:75], a[128:131]
    ds_read_b128 a[164:167], v243 offset:24896
    v_mfma_f32_16x16x32_bf16 a[128:131], a[180:183], v[84:87], a[128:131]
    s_add_u32 m0, s29, 102656
    v_mfma_f32_16x16x32_bf16 a[132:135], a[184:187], v[64:67], a[132:135]
    v_mfma_f32_16x16x32_bf16 a[132:135], a[188:191], v[76:79], a[132:135]
    buffer_load_dwordx4 v24, s[12:15], s35 offen offset:0 nt lds
    v_mfma_f32_16x16x32_bf16 a[136:139], a[184:187], v[68:71], a[136:139]
    v_mfma_f32_16x16x32_bf16 a[136:139], a[188:191], v[80:83], a[136:139]
    buffer_load_dwordx4 v25, s[12:15], s35 offen offset:1024 nt lds
    v_mfma_f32_16x16x32_bf16 a[140:143], a[184:187], v[72:75], a[140:143]
    v_mfma_f32_16x16x32_bf16 a[140:143], a[188:191], v[84:87], a[140:143]
    v_max3_f32 v1, v55, v56, v57
    v_cmp_lt_f32 vcc, s40, v1
    s_cbranch_vccnz L_stub_6
L_ret_6:
    v_add_f32 v52, v52, v55
    v_add_f32 v53, v53, v56
    v_add_f32 v54, v54, v57
    s_waitcnt lgkmcnt(0)
    v_mfma_f32_16x16x32_bf16 v[160:163], a[144:147], v[88:91], v[40:43]
    ds_read_b128 a[168:171], v242 offset:26176
    s_add_u32 m0, s29, 49280
    s_mul_i32 s36, s41, 1
    v_mfma_f32_16x16x32_bf16 v[160:163], a[148:151], v[100:103], v[160:163]
    ds_read_b128 a[172:175], v243 offset:26176
    v_mfma_f32_16x16x32_bf16 v[160:163], a[152:155], v[112:115], v[160:163]
    buffer_load_dwordx4 v26, s[16:19], s36 offen offset:0 nt lds
    v_mfma_f32_16x16x32_bf16 v[160:163], a[156:159], v[124:127], v[160:163]
    ds_read_b128 a[176:179], v242 offset:26304
    v_mfma_f32_16x16x32_bf16 v[160:163], a[160:163], v[136:139], v[160:163]
    buffer_load_dwordx4 v27, s[16:19], s36 offen offset:1024 nt lds
    v_mfma_f32_16x16x32_bf16 v[160:163], a[164:167], v[148:151], v[160:163]
    ds_read_b128 a[180:183], v243 offset:26304
    v_mfma_f32_16x16x32_bf16 v[164:167], a[144:147], v[92:95], v[44:47]
    buffer_load_dwordx4 v28, s[16:19], s36 offen offset:2048 nt lds
    v_mfma_f32_16x16x32_bf16 v[164:167], a[148:151], v[104:107], v[164:167]
    ds_read_b128 a[184:187], v242 offset:26432
    v_mfma_f32_16x16x32_bf16 v[164:167], a[152:155], v[116:119], v[164:167]
    buffer_load_dwordx4 v29, s[16:19], s36 offen offset:3072 nt lds
    v_mfma_f32_16x16x32_bf16 v[164:167], a[156:159], v[128:131], v[164:167]
    ds_read_b128 a[188:191], v243 offset:26432
    v_mfma_f32_16x16x32_bf16 v[164:167], a[160:163], v[140:143], v[164:167]
    s_add_u32 m0, s29, 53376
    v_exp_f32 v58, v160
    v_mfma_f32_16x16x32_bf16 v[164:167], a[164:167], v[152:155], v[164:167]
    v_exp_f32 v59, v161
    v_mfma_f32_16x16x32_bf16 v[168:171], a[144:147], v[96:99], v[48:51]
    buffer_load_dwordx4 v30, s[16:19], s36 offen offset:0 nt lds
    v_mfma_f32_16x16x32_bf16 v[168:171], a[148:151], v[108:111], v[168:171]
    v_exp_f32 v60, v162
    v_mfma_f32_16x16x32_bf16 v[168:171], a[152:155], v[120:123], v[168:171]
    buffer_load_dwordx4 v31, s[16:19], s36 offen offset:1024 nt lds
    v_mfma_f32_16x16x32_bf16 v[168:171], a[156:159], v[132:135], v[168:171]
    v_exp_f32 v61, v163
    v_mfma_f32_16x16x32_bf16 v[168:171], a[160:163], v[144:147], v[168:171]
    s_cmp_eq_u32 s32, 0
    s_cbranch_scc1 L_notouch_6
    s_mul_i32 s37, s47, 0
    buffer_load_dword v6, v36, s[60:63], s37 offen
    s_mul_i32 s37, s47, 1
    buffer_load_dword v6, v36, s[60:63], s37 offen
    s_mul_i32 s37, s47, 2
    buffer_load_dword v6, v36, s[60:63], s37 offen
    s_mul_i32 s37, s47, 3
    buffer_load_dword v6, v36, s[60:63], s37 offen
    s_mul_i32 s37, s47, 4
    buffer_load_dword v6, v36, s[60:63], s37 offen
L_notouch_6:
    v_mfma_f32_16x16x32_bf16 v[168:171], a[164:167], v[156:159], v[168:171]
    v_add_f32 v55, v58, v59
    v_cvt_pk_bf16_f32 v64, v58, v59
    v_add_f32 v55, v55, v60
    s_waitcnt lgkmcnt(0)
    v_mfma_f32_16x16x32_bf16 v[172:175], a[168:171], v[88:91], v[40:43]
    ds_read_b128 a[144:147], v242 offset:36928
    v_add_f32 v55, v55, v61
    v_mfma_f32_16x16x32_bf16 v[172:175], a[172:175], v[100:103], v[172:175]
    ds_read_b128 a[148:151], v243 offset:36928
    v_cvt_pk_bf16_f32 v65, v60, v61
    v_mfma_f32_16x16x32_bf16 v[172:175], a[176:179], v[112:115], v[172:175]
    v_exp_f32 v62, v164
    v_mfma_f32_16x16x32_bf16 v[172:175], a[180:183], v[124:127], v[172:175]
    ds_read_b128 a[152:155], v242 offset:37056
    v_mfma_f32_16x16x32_bf16 v[172:175], a[184:187], v[136:139], v[172:175]
    v_exp_f32 v63, v165
    v_mfma_f32_16x16x32_bf16 v[172:175], a[188:191], v[148:151], v[172:175]
    ds_read_b128 a[156:159], v243 offset:37056
    v_exp_f32 v38, v166
    v_mfma_f32_16x16x32_bf16 v[176:179], a[168:171], v[92:95], v[44:47]
    v_exp_f32 v39, v167
    v_mfma_f32_16x16x32_bf16 v[176:179], a[172:175], v[104:107], v[176:179]
    ds_read_b128 a[160:163], v242 offset:37184
    v_add_f32 v56, v62, v63
    v_mfma_f32_16x16x32_bf16 v[176:179], a[176:179], v[116:119], v[176:179]
    v_cvt_pk_bf16_f32 v68, v62, v63
    v_add_f32 v56, v56, v38
    v_add_f32 v56, v56, v39
    v_mfma_f32_16x16x32_bf16 v[176:179], a[180:183], v[128:131], v[176:179]
    ds_read_b128 a[164:167], v243 offset:37184
    v_cvt_pk_bf16_f32 v69, v38, v39
    v_mfma_f32_16x16x32_bf16 v[176:179], a[184:187], v[140:143], v[176:179]
    v_exp_f32 v58, v168
    v_mfma_f32_16x16x32_bf16 v[176:179], a[188:191], v[152:155], v[176:179]
    v_exp_f32 v59, v169
    v_mfma_f32_16x16x32_bf16 v[180:183], a[168:171], v[96:99], v[48:51]
    v_exp_f32 v60, v170
    v_mfma_f32_16x16x32_bf16 v[180:183], a[172:175], v[108:111], v[180:183]
    v_exp_f32 v61, v171
    v_mfma_f32_16x16x32_bf16 v[180:183], a[176:179], v[120:123], v[180:183]
    v_add_f32 v57, v58, v59
    v_cvt_pk_bf16_f32 v72, v58, v59
    v_mfma_f32_16x16x32_bf16 v[180:183], a[180:183], v[132:135], v[180:183]
    v_add_f32 v57, v57, v60
    v_add_f32 v57, v57, v61
    v_cvt_pk_bf16_f32 v73, v60, v61
    v_mfma_f32_16x16x32_bf16 v[180:183], a[184:187], v[144:147], v[180:183]
    v_exp_f32 v62, v172
    v_mfma_f32_16x16x32_bf16 v[180:183], a[188:191], v[156:159], v[180:183]
    v_exp_f32 v63, v173
    s_waitcnt lgkmcnt(0)
    v_mfma_f32_16x16x32_bf16 v[184:187], a[144:147], v[88:91], v[40:43]
    ds_read_b128 a[168:171], v242 offset:38464
    v_exp_f32 v38, v174
    v_mfma_f32_16x16x32_bf16 v[184:187], a[148:151], v[100:103], v[184:187]
    ds_read_b128 a[172:175], v243 offset:38464
    v_mfma_f32_16x16x32_bf16 v[184:187], a[152:155], v[112:115], v[184:187]
    v_exp_f32 v39, v175
    v_mfma_f32_16x16x32_bf16 v[184:187], a[156:159], v[124:127], v[184:187]
    ds_read_b128 a[176:179], v242 offset:38592
    v_add_f32 v55, v55, v62
    v_add_f32 v55, v55, v63
    v_mfma_f32_16x16x32_bf16 v[184:187], a[160:163], v[136:139], v[184:187]
    v_cvt_pk_bf16_f32 v66, v62, v63
    v_add_f32 v55, v55, v38
    v_mfma_f32_16x16x32_bf16 v[184:187], a[164:167], v[148:151], v[184:187]
    ds_read_b128 a[180:183], v243 offset:38592
    v_add_f32 v55, v55, v39
    v_mfma_f32_16x16x32_bf16 v[188:191], a[144:147], v[92:95], v[44:47]
    v_cvt_pk_bf16_f32 v67, v38, v39
    v_mfma_f32_16x16x32_bf16 v[188:191], a[148:151], v[104:107], v[188:191]
    ds_read_b128 a[184:187], v242 offset:38720
    v_exp_f32 v58, v176
    v_mfma_f32_16x16x32_bf16 v[188:191], a[152:155], v[116:119], v[188:191]
    v_exp_f32 v59, v177
    v_mfma_f32_16x16x32_bf16 v[188:191], a[156:159], v[128:131], v[188:191]
    ds_read_b128 a[188:191], v243 offset:38720
    v_mfma_f32_16x16x32_bf16 v[188:191], a[160:163], v[140:143], v[188:191]
    v_exp_f32 v60, v178
    v_mfma_f32_16x16x32_bf16 v[188:191], a[164:167], v[152:155], v[188:191]
    v_exp_f32 v61, v179
    v_mfma_f32_16x16x32_bf16 v[192:195], a[144:147], v[96:99], v[48:51]
    v_add_f32 v56, v56, v58
    v_add_f32 v56, v56, v59
    v_mfma_f32_16x16x32_bf16 v[192:195], a[148:151], v[108:111], v[192:195]
    v_cvt_pk_bf16_f32 v70, v58, v59
    v_add_f32 v56, v56, v60
    v_add_f32 v56, v56, v61
    v_mfma_f32_16x16x32_bf16 v[192:195], a[152:155], v[120:123], v[192:195]
    v_cvt_pk_bf16_f32 v71, v60, v61
    v_mfma_f32_16x16x32_bf16 v[192:195], a[156:159], v[132:135], v[192:195]
    v_exp_f32 v62, v180
    v_mfma_f32_16x16x32_bf16 v[192:195], a[160:163], v[144:147], v[192:195]
    v_exp_f32 v63, v181
    v_mfma_f32_16x16x32_bf16 v[192:195], a[164:167], v[156:159], v[192:195]
    v_exp_f32 v38, v182
    s_waitcnt lgkmcnt(0)
    v_mfma_f32_16x16x32_bf16 v[196:199], a[168:171], v[88:91], v[40:43]
    ds_read_b64_tr_b16 a[144:145], v244 offset:0
    v_mfma_f32_16x16x32_bf16 v[196:199], a[172:175], v[100:103], v[196:199]
    ds_read_b64_tr_b16 a[146:147], v244 offset:1536
    v_mfma_f32_16x16x32_bf16 v[196:199], a[176:179], v[112:115], v[196:199]
    ds_read_b64_tr_b16 a[148:149], v244 offset:12288
    v_exp_f32 v39, v183
    v_mfma_f32_16x16x32_bf16 v[196:199], a[180:183], v[124:127], v[196:199]
    ds_read_b64_tr_b16 a[150:151], v244 offset:13824
    v_add_f32 v57, v57, v62
    v_mfma_f32_16x16x32_bf16 v[196:199], a[184:187], v[136:139], v[196:199]
    ds_read_b64_tr_b16 a[152:153], v245 offset:0
    v_add_f32 v57, v57, v63
    v_mfma_f32_16x16x32_bf16 v[196:199], a[188:191], v[148:151], v[196:199]
    ds_read_b64_tr_b16 a[154:155], v245 offset:1536
    v_cvt_pk_bf16_f32 v74, v62, v63
    v_add_f32 v57, v57, v38
    v_mfma_f32_16x16x32_bf16 v[200:203], a[168:171], v[92:95], v[44:47]
    ds_read_b64_tr_b16 a[156:157], v245 offset:12288
    v_add_f32 v57, v57, v39
    v_mfma_f32_16x16x32_bf16 v[200:203], a[172:175], v[104:107], v[200:203]
    ds_read_b64_tr_b16 a[158:159], v245 offset:13824
    v_cvt_pk_bf16_f32 v75, v38, v39
    v_mfma_f32_16x16x32_bf16 v[200:203], a[176:179], v[116:119], v[200:203]
    ds_read_b64_tr_b16 a[160:161], v246 offset:0
    v_exp_f32 v58, v184
    v_mfma_f32_16x16x32_bf16 v[200:203], a[180:183], v[128:131], v[200:203]
    ds_read_b64_tr_b16 a[162:163], v246 offset:1536
    v_mfma_f32_16x16x32_bf16 v[200:203], a[184:187], v[140:143], v[200:203]
    ds_read_b64_tr_b16 a[164:165], v246 offset:12288
    v_mfma_f32_16x16x32_bf16 v[200:203], a[188:191], v[152:155], v[200:203]
    ds_read_b64_tr_b16 a[166:167], v246 offset:13824
    v_exp_f32 v59, v185
    v_mfma_f32_16x16x32_bf16 v[204:207], a[168:171], v[96:99], v[48:51]
    v_exp_f32 v60, v186
    v_mfma_f32_16x16x32_bf16 v[204:207], a[172:175], v[108:111], v[204:207]
    v_exp_f32 v61, v187
    v_mfma_f32_16x16x32_bf16 v[204:207], a[176:179], v[120:123], v[204:207]
    v_add_f32 v55, v55, v58
    v_add_f32 v55, v55, v59
    v_mfma_f32_16x16x32_bf16 v[204:207], a[180:183], v[132:135], v[204:207]
    v_cvt_pk_bf16_f32 v76, v58, v59
    v_add_f32 v55, v55, v60
    v_add_f32 v55, v55, v61
    v_mfma_f32_16x16x32_bf16 v[204:207], a[184:187], v[144:147], v[204:207]
    v_cvt_pk_bf16_f32 v77, v60, v61
    v_mfma_f32_16x16x32_bf16 v[204:207], a[188:191], v[156:159], v[204:207]
    v_exp_f32 v62, v188
    s_waitcnt lgkmcnt(0)
    v_mfma_f32_16x16x32_bf16 a[0:3], a[144:147], v[208:211], a[0:3]
    ds_read_b64_tr_b16 a[168:169], v247 offset:0
    v_exp_f32 v63, v189
    v_mfma_f32_16x16x32_bf16 a[0:3], a[148:151], v[220:223], a[0:3]
    ds_read_b64_tr_b16 a[170:171], v247 offset:1536
    v_mfma_f32_16x16x32_bf16 a[4:7], a[144:147], v[212:215], a[4:7]
    ds_read_b64_tr_b16 a[172:173], v247 offset:12288
    v_mfma_f32_16x16x32_bf16 a[4:7], a[148:151], v[224:227], a[4:7]
    ds_read_b64_tr_b16 a[174:175], v247 offset:13824
    v_exp_f32 v38, v190
    v_mfma_f32_16x16x32_bf16 a[8:11], a[144:147], v[216:219], a[8:11]
    ds_read_b64_tr_b16 a[176:177], v244 offset:128
    v_mfma_f32_16x16x32_bf16 a[8:11], a[148:151], v[228:231], a[8:11]
    ds_read_b64_tr_b16 a[178:179], v244 offset:1664
    v_mfma_f32_16x16x32_bf16 a[12:15], a[152:155], v[208:211], a[12:15]
    ds_read_b64_tr_b16 a[180:181], v244 offset:12416
    v_exp_f32 v39, v191
    v_mfma_f32_16x16x32_bf16 a[12:15], a[156:159], v[220:223], a[12:15]
    ds_read_b64_tr_b16 a[182:183], v244 offset:13952
    v_add_f32 v56, v56, v62
    v_mfma_f32_16x16x32_bf16 a[16:19], a[152:155], v[212:215], a[16:19]
    ds_read_b64_tr_b16 a[184:185], v245 offset:128
    v_add_f32 v56, v56, v63
    v_mfma_f32_16x16x32_bf16 a[16:19], a[156:159], v[224:227], a[16:19]
    ds_read_b64_tr_b16 a[186:187], v245 offset:1664
    v_cvt_pk_bf16_f32 v80, v62, v63
    v_mfma_f32_16x16x32_bf16 a[20:23], a[152:155], v[216:219], a[20:23]
    ds_read_b64_tr_b16 a[188:189], v245 offset:12416
    v_add_f32 v56, v56, v38
    v_add_f32 v56, v56, v39
    v_mfma_f32_16x16x32_bf16 a[20:23], a[156:159], v[228:231], a[20:23]
    ds_read_b64_tr_b16 a[190:191], v245 offset:13952
    v_cvt_pk_bf16_f32 v81, v38, v39
    v_mfma_f32_16x16x32_bf16 a[24:27], a[160:163], v[208:211], a[24:27]
    v_exp_f32 v58, v192
    v_mfma_f32_16x16x32_bf16 a[24:27], a[164:167], v[220:223], a[24:27]
    v_exp_f32 v59, v193
    v_mfma_f32_16x16x32_bf16 a[28:31], a[160:163], v[212:215], a[28:31]
    v_exp_f32 v60, v194
    v_mfma_f32_16x16x32_bf16 a[28:31], a[164:167], v[224:227], a[28:31]
    v_exp_f32 v61, v195
    v_mfma_f32_16x16x32_bf16 a[32:35], a[160:163], v[216:219], a[32:35]
    v_add_f32 v57, v57, v58
    v_add_f32 v57, v57, v59
    v_cvt_pk_bf16_f32 v84, v58, v59
    v_mfma_f32_16x16x32_bf16 a[32:35], a[164:167], v[228:231], a[32:35]
    v_add_f32 v57, v57, v60
    v_add_f32 v57, v57, v61
    s_waitcnt lgkmcnt(0)
    v_mfma_f32_16x16x32_bf16 a[36:39], a[168:171], v[208:211], a[36:39]
    ds_read_b64_tr_b16 a[144:145], v246 offset:128
    v_cvt_pk_bf16_f32 v85, v60, v61
    v_mfma_f32_16x16x32_bf16 a[36:39], a[172:175], v[220:223], a[36:39]
    ds_read_b64_tr_b16 a[146:147], v246 offset:1664
    v_exp_f32 v62, v196
    v_mfma_f32_16x16x32_bf16 a[40:43], a[168:171], v[212:215], a[40:43]
    ds_read_b64_tr_b16 a[148:149], v246 offset:12416
    v_mfma_f32_16x16x32_bf16 a[40:43], a[172:175], v[224:227], a[40:43]
    ds_read_b64_tr_b16 a[150:151], v246 offset:13952
    v_mfma_f32_16x16x32_bf16 a[44:47], a[168:171], v[216:219], a[44:47]
    ds_read_b64_tr_b16 a[152:153], v247 offset:128
    v_mfma_f32_16x16x32_bf16 a[44:47], a[172:175], v[228:231], a[44:47]
    ds_read_b64_tr_b16 a[154:155], v247 offset:1664
    v_exp_f32 v63, v197
    v_mfma_f32_16x16x32_bf16 a[48:51], a[176:179], v[208:211], a[48:51]
    ds_read_b64_tr_b16 a[156:157], v247 offset:12416
    v_mfma_f32_16x16x32_bf16 a[48:51], a[180:183], v[220:223], a[48:51]
    ds_read_b64_tr_b16 a[158:159], v247 offset:13952
    v_mfma_f32_16x16x32_bf16 a[52:55], a[176:179], v[212:215], a[52:55]
    ds_read_b64_tr_b16 a[160:161], v244 offset:256
    v_exp_f32 v38, v198
    v_mfma_f32_16x16x32_bf16 a[52:55], a[180:183], v[224:227], a[52:55]
    ds_read_b64_tr_b16 a[162:163], v244 offset:1792
    v_mfma_f32_16x16x32_bf16 a[56:59], a[176:179], v[216:219], a[56:59]
    ds_read_b64_tr_b16 a[164:165], v244 offset:12544
    v_mfma_f32_16x16x32_bf16 a[56:59], a[180:183], v[228:231], a[56:59]
    ds_read_b64_tr_b16 a[166:167], v244 offset:14080
    v_exp_f32 v39, v199
    v_mfma_f32_16x16x32_bf16 a[60:63], a[184:187], v[208:211], a[60:63]
    v_add_f32 v55, v55, v62
    v_add_f32 v55, v55, v63
    v_mfma_f32_16x16x32_bf16 a[60:63], a[188:191], v[220:223], a[60:63]
    v_cvt_pk_bf16_f32 v78, v62, v63
    v_add_f32 v55, v55, v38
    v_mfma_f32_16x16x32_bf16 a[64:67], a[184:187], v[212:215], a[64:67]
    v_add_f32 v55, v55, v39
    v_cvt_pk_bf16_f32 v79, v38, v39
    v_mfma_f32_16x16x32_bf16 a[64:67], a[188:191], v[224:227], a[64:67]
    v_exp_f32 v58, v200
    v_mfma_f32_16x16x32_bf16 a[68:71], a[184:187], v[216:219], a[68:71]
    v_exp_f32 v59, v201
    v_mfma_f32_16x16x32_bf16 a[68:71], a[188:191], v[228:231], a[68:71]
    v_exp_f32 v60, v202
    s_waitcnt lgkmcnt(0)
    v_mfma_f32_16x16x32_bf16 a[72:75], a[144:147], v[208:211], a[72:75]
    ds_read_b64_tr_b16 a[168:169], v245 offset:256
    v_exp_f32 v61, v203
    v_mfma_f32_16x16x32_bf16 a[72:75], a[148:151], v[220:223], a[72:75]
    ds_read_b64_tr_b16 a[170:171], v245 offset:1792
    v_add_f32 v56, v56, v58
    v_mfma_f32_16x16x32_bf16 a[76:79], a[144:147], v[212:215], a[76:79]
    ds_read_b64_tr_b16 a[172:173], v245 offset:12544
    v_add_f32 v56, v56, v59
    v_mfma_f32_16x16x32_bf16 a[76:79], a[148:151], v[224:227], a[76:79]
    ds_read_b64_tr_b16 a[174:175], v245 offset:14080
    v_cvt_pk_bf16_f32 v82, v58, v59
    v_add_f32 v56, v56, v60
    v_mfma_f32_16x16x32_bf16 a[80:83], a[144:147], v[216:219], a[80:83]
    ds_read_b64_tr_b16 a[176:177], v246 offset:256
    v_add_f32 v56, v56, v61
    v_mfma_f32_16x16x32_bf16 a[80:83], a[148:151], v[228:231], a[80:83]
    ds_read_b64_tr_b16 a[178:179], v246 offset:1792
    v_cvt_pk_bf16_f32 v83, v60, v61
    v_mfma_f32_16x16x32_bf16 a[84:87], a[152:155], v[208:211], a[84:87]
    ds_read_b64_tr_b16 a[180:181], v246 offset:12544
    v_exp_f32 v62, v204
    v_mfma_f32_16x16x32_bf16 a[84:87], a[156:159], v[220:223], a[84:87]
    ds_read_b64_tr_b16 a[182:183], v246 offset:14080
    v_mfma_f32_16x16x32_bf16 a[88:91], a[152:155], v[212:215], a[88:91]
    ds_read_b64_tr_b16 a[184:185], v247 offset:256
    v_mfma_f32_16x16x32_bf16 a[88:91], a[156:159], v[224:227], a[88:91]
    ds_read_b64_tr_b16 a[186:187], v247 offset:1792
    v_exp_f32 v63, v205
    v_mfma_f32_16x16x32_bf16 a[92:95], a[152:155], v[216:219], a[92:95]
    ds_read_b64_tr_b16 a[188:189], v247 offset:12544
    v_mfma_f32_16x16x32_bf16 a[92:95], a[156:159], v[228:231], a[92:95]
    ds_read_b64_tr_b16 a[190:191], v247 offset:14080
    v_mfma_f32_16x16x32_bf16 a[96:99], a[160:163], v[208:211], a[96:99]
    v_exp_f32 v38, v206
    v_mfma_f32_16x16x32_bf16 a[96:99], a[164:167], v[220:223], a[96:99]
    v_exp_f32 v39, v207
    v_add_f32 v57, v57, v62
    v_mfma_f32_16x16x32_bf16 a[100:103], a[160:163], v[212:215], a[100:103]
    v_add_f32 v57, v57, v63
    v_cvt_pk_bf16_f32 v86, v62, v63
    v_mfma_f32_16x16x32_bf16 a[100:103], a[164:167], v[224:227], a[100:103]
    v_add_f32 v57, v57, v38
    v_add_f32 v57, v57, v39
    v_mfma_f32_16x16x32_bf16 a[104:107], a[160:163], v[216:219], a[104:107]
    v_cvt_pk_bf16_f32 v87, v38, v39
    v_mfma_f32_16x16x32_bf16 a[104:107], a[164:167], v[228:231], a[104:107]
    s_waitcnt vmcnt(12)
    s_waitcnt lgkmcnt(0)
    s_barrier
    v_mfma_f32_16x16x32_bf16 a[108:111], a[168:171], v[208:211], a[108:111]
    ds_read_b64_tr_b16 a[144:145], v244 offset:24640
    v_mfma_f32_16x16x32_bf16 a[108:111], a[172:175], v[220:223], a[108:111]
    ds_read_b64_tr_b16 a[146:147], v244 offset:26176
    s_add_u32 m0, s29, 123200
    s_mul_i32 s35, s41, 1
    v_mfma_f32_16x16x32_bf16 a[112:115], a[168:171], v[212:215], a[112:115]
    ds_read_b64_tr_b16 a[148:149], v244 offset:36928
    v_mfma_f32_16x16x32_bf16 a[112:115], a[172:175], v[224:227], a[112:115]
    ds_read_b64_tr_b16 a[150:151], v244 offset:38464
    buffer_load_dwordx4 v20, s[12:15], s35 offen offset:0 nt lds
    v_mfma_f32_16x16x32_bf16 a[116:119], a[168:171], v[216:219], a[116:119]
    ds_read_b64_tr_b16 a[152:153], v245 offset:24640
    v_mfma_f32_16x16x32_bf16 a[116:119], a[172:175], v[228:231], a[116:119]
    ds_read_b64_tr_b16 a[154:155], v245 offset:26176
    buffer_load_dwordx4 v21, s[12:15], s35 offen offset:1024 nt lds
    v_mfma_f32_16x16x32_bf16 a[120:123], a[176:179], v[208:211], a[120:123]
    ds_read_b64_tr_b16 a[156:157], v245 offset:36928
    v_mfma_f32_16x16x32_bf16 a[120:123], a[180:183], v[220:223], a[120:123]
    ds_read_b64_tr_b16 a[158:159], v245 offset:38464
    buffer_load_dwordx4 v22, s[12:15], s35 offen offset:2048 nt lds
    v_mfma_f32_16x16x32_bf16 a[124:127], a[176:179], v[212:215], a[124:127]
    ds_read_b64_tr_b16 a[160:161], v246 offset:24640
    v_mfma_f32_16x16x32_bf16 a[124:127], a[180:183], v[224:227], a[124:127]
    ds_read_b64_tr_b16 a[162:163], v246 offset:26176
    buffer_load_dwordx4 v23, s[12:15], s35 offen offset:3072 nt lds
    v_mfma_f32_16x16x32_bf16 a[128:131], a[176:179], v[216:219], a[128:131]
    ds_read_b64_tr_b16 a[164:165], v246 offset:36928
    v_mfma_f32_16x16x32_bf16 a[128:131], a[180:183], v[228:231], a[128:131]
    ds_read_b64_tr_b16 a[166:167], v246 offset:38464
    s_add_u32 m0, s29, 127296
    v_mfma_f32_16x16x32_bf16 a[132:135], a[184:187], v[208:211], a[132:135]
    v_mfma_f32_16x16x32_bf16 a[132:135], a[188:191], v[220:223], a[132:135]
    buffer_load_dwordx4 v24, s[12:15], s35 offen offset:0 nt lds
    v_mfma_f32_16x16x32_bf16 a[136:139], a[184:187], v[212:215], a[136:139]
    v_mfma_f32_16x16x32_bf16 a[136:139], a[188:191], v[224:227], a[136:139]
    buffer_load_dwordx4 v25, s[12:15], s35 offen offset:1024 nt lds
    v_mfma_f32_16x16x32_bf16 a[140:143], a[184:187], v[216:219], a[140:143]
    v_mfma_f32_16x16x32_bf16 a[140:143], a[188:191], v[228:231], a[140:143]
    v_max3_f32 v1, v55, v56, v57
    v_cmp_lt_f32 vcc, s40, v1
    s_cbranch_vccnz L_stub_7
L_ret_7:
    v_add_f32 v52, v52, v55
    v_add_f32 v53, v53, v56
    v_add_f32 v54, v54, v57
    s_waitcnt lgkmcnt(0)
    v_mfma_f32_16x16x32_bf16 a[0:3], a[144:147], v[64:67], a[0:3]
    ds_read_b64_tr_b16 a[168:169], v247 offset:24640
    s_add_u32 m0, s29, 0
    s_mul_i32 s36, s41, 0
    v_mov_b32 v1, v52
    s_nop 1
    v_permlane32_swap_b32 v1, v52
    v_add_f32 v52, v52, v1
    v_mfma_f32_16x16x32_bf16 a[0:3], a[148:151], v[76:79], a[0:3]
    ds_read_b64_tr_b16 a[170:171], v247 offset:26176
    v_mov_b32 v1, v52
    s_nop 1
    v_permlane16_swap_b32 v1, v52
    v_add_f32 v52, v52, v1
    v_rcp_f32 v58, v52
    v_mfma_f32_16x16x32_bf16 a[4:7], a[144:147], v[68:71], a[4:7]
    ds_read_b64_tr_b16 a[172:173], v247 offset:36928
    v_mov_b32 v2, v53
    s_nop 1
    v_permlane32_swap_b32 v2, v53
    v_add_f32 v53, v53, v2
    v_mov_b32 v2, v53
    s_nop 1
    v_permlane16_swap_b32 v2, v53
    v_mfma_f32_16x16x32_bf16 a[4:7], a[148:151], v[80:83], a[4:7]
    ds_read_b64_tr_b16 a[174:175], v247 offset:38464
    buffer_load_dwordx4 v26, s[16:19], s36 offen offset:0 nt lds
    v_add_f32 v53, v53, v2
    v_rcp_f32 v60, v53
    v_mov_b32 v3, v54
    v_mfma_f32_16x16x32_bf16 a[8:11], a[144:147], v[72:75], a[8:11]
    ds_read_b64_tr_b16 a[176:177], v244 offset:24768
    v_permlane32_swap_b32 v3, v54
    v_add_f32 v54, v54, v3
    v_mov_b32 v3, v54
    s_nop 1
    v_permlane16_swap_b32 v3, v54
    v_add_f32 v54, v54, v3
    v_mfma_f32_16x16x32_bf16 a[8:11], a[148:151], v[84:87], a[8:11]
    ds_read_b64_tr_b16 a[178:179], v244 offset:26304
    v_rcp_f32 v62, v54
    v_accvgpr_read_b32 v88, a192
    v_accvgpr_read_b32 v89, a193
    v_accvgpr_read_b32 v90, a194
    v_mfma_f32_16x16x32_bf16 a[12:15], a[152:155], v[64:67], a[12:15]
    ds_read_b64_tr_b16 a[180:181], v244 offset:37056
    buffer_load_dwordx4 v27, s[16:19], s36 offen offset:1024 nt lds
    v_accvgpr_read_b32 v91, a195
    v_accvgpr_read_b32 v92, a196
    v_accvgpr_read_b32 v93, a197
    v_accvgpr_read_b32 v94, a198
    v_mfma_f32_16x16x32_bf16 a[12:15], a[156:159], v[76:79], a[12:15]
    ds_read_b64_tr_b16 a[182:183], v244 offset:38592
    v_accvgpr_read_b32 v95, a199
    v_accvgpr_read_b32 v96, a200
    v_accvgpr_read_b32 v97, a201
    v_accvgpr_read_b32 v98, a202
    v_accvgpr_read_b32 v99, a203
    v_mfma_f32_16x16x32_bf16 a[16:19], a[152:155], v[68:71], a[16:19]
    ds_read_b64_tr_b16 a[184:185], v245 offset:24768
    v_accvgpr_read_b32 v100, a204
    v_accvgpr_read_b32 v101, a205
    v_accvgpr_read_b32 v102, a206
    v_accvgpr_read_b32 v103, a207
    v_accvgpr_read_b32 v104, a208
    v_mfma_f32_16x16x32_bf16 a[16:19], a[156:159], v[80:83], a[16:19]
    ds_read_b64_tr_b16 a[186:187], v245 offset:26304
    v_accvgpr_read_b32 v105, a209
    v_accvgpr_read_b32 v106, a210
    v_accvgpr_read_b32 v107, a211
    v_accvgpr_read_b32 v108, a212
    v_accvgpr_read_b32 v109, a213
    v_mfma_f32_16x16x32_bf16 a[20:23], a[152:155], v[72:75], a[20:23]
    ds_read_b64_tr_b16 a[188:189], v245 offset:37056
    buffer_load_dwordx4 v28, s[16:19], s36 offen offset:2048 nt lds
    v_accvgpr_read_b32 v110, a214
    v_accvgpr_read_b32 v111, a215
    v_accvgpr_read_b32 v112, a216
    v_accvgpr_read_b32 v113, a217
    v_mfma_f32_16x16x32_bf16 a[20:23], a[156:159], v[84:87], a[20:23]
    ds_read_b64_tr_b16 a[190:191], v245 offset:38592
    v_accvgpr_read_b32 v114, a218
    v_accvgpr_read_b32 v115, a219
    v_accvgpr_read_b32 v116, a220
    v_accvgpr_read_b32 v117, a221
    v_accvgpr_read_b32 v118, a222
    v_mfma_f32_16x16x32_bf16 a[24:27], a[160:163], v[64:67], a[24:27]
    v_accvgpr_read_b32 v119, a223
    v_accvgpr_read_b32 v120, a224
    v_accvgpr_read_b32 v121, a225
    v_accvgpr_read_b32 v122, a226
    v_accvgpr_read_b32 v123, a227
    v_accvgpr_read_b32 v124, a228
    v_mfma_f32_16x16x32_bf16 a[24:27], a[164:167], v[76:79], a[24:27]
    buffer_load_dwordx4 v29, s[16:19], s36 offen offset:3072 nt lds
    v_accvgpr_read_b32 v125, a229
    v_accvgpr_read_b32 v126, a230
    v_accvgpr_read_b32 v127, a231
    v_accvgpr_read_b32 v128, a232
    v_accvgpr_read_b32 v129, a233
    v_mfma_f32_16x16x32_bf16 a[28:31], a[160:163], v[68:71], a[28:31]
    v_accvgpr_read_b32 v130, a234
    v_accvgpr_read_b32 v131, a235
    v_accvgpr_read_b32 v132, a236
    v_accvgpr_read_b32 v133, a237
    v_accvgpr_read_b32 v134, a238
    v_accvgpr_read_b32 v135, a239
    v_mfma_f32_16x16x32_bf16 a[28:31], a[164:167], v[80:83], a[28:31]
    v_accvgpr_read_b32 v136, a240
    v_accvgpr_read_b32 v137, a241
    v_accvgpr_read_b32 v138, a242
    v_accvgpr_read_b32 v139, a243
    v_accvgpr_read_b32 v140, a244
    v_accvgpr_read_b32 v141, a245
    v_mfma_f32_16x16x32_bf16 a[32:35], a[160:163], v[72:75], a[32:35]
    v_accvgpr_read_b32 v142, a246
    v_accvgpr_read_b32 v143, a247
    v_accvgpr_read_b32 v144, a248
    v_accvgpr_read_b32 v145, a249
    v_accvgpr_read_b32 v146, a250
    v_accvgpr_read_b32 v147, a251
    v_mfma_f32_16x16x32_bf16 a[32:35], a[164:167], v[84:87], a[32:35]
    s_add_u32 m0, s29, 4096
    v_accvgpr_read_b32 v148, a252
    v_accvgpr_read_b32 v149, a253
    v_accvgpr_read_b32 v150, a254
    v_accvgpr_read_b32 v151, a255
    ds_read_b128 v[152:155], v7 offset:0
    s_waitcnt lgkmcnt(1)
    v_mfma_f32_16x16x32_bf16 a[36:39], a[168:171], v[64:67], a[36:39]
    ds_read_b64_tr_b16 a[144:145], v246 offset:24768
    ds_read_b128 v[156:159], v7 offset:1024
    v_mfma_f32_16x16x32_bf16 a[36:39], a[172:175], v[76:79], a[36:39]
    ds_read_b64_tr_b16 a[146:147], v246 offset:26304
    v_mfma_f32_16x16x32_bf16 a[40:43], a[168:171], v[68:71], a[40:43]
    ds_read_b64_tr_b16 a[148:149], v246 offset:37056
    buffer_load_dwordx4 v30, s[16:19], s36 offen offset:0 nt lds
    v_mfma_f32_16x16x32_bf16 a[40:43], a[172:175], v[80:83], a[40:43]
    ds_read_b64_tr_b16 a[150:151], v246 offset:38592
    v_mfma_f32_16x16x32_bf16 a[44:47], a[168:171], v[72:75], a[44:47]
    ds_read_b64_tr_b16 a[152:153], v247 offset:24768
    v_accvgpr_read_b32 v160, a0
    v_accvgpr_read_b32 v161, a1
    v_accvgpr_read_b32 v162, a2
    v_accvgpr_read_b32 v163, a3
    v_accvgpr_read_b32 v164, a12
    v_mfma_f32_16x16x32_bf16 a[44:47], a[172:175], v[84:87], a[44:47]
    ds_read_b64_tr_b16 a[154:155], v247 offset:26304
    v_accvgpr_read_b32 v165, a13
    v_accvgpr_read_b32 v166, a14
    v_accvgpr_read_b32 v167, a15
    v_pk_mul_f32 v[160:161], v[160:161], v[58:59] op_sel_hi:[1,0]
    v_pk_mul_f32 v[162:163], v[162:163], v[58:59] op_sel_hi:[1,0]
    v_mfma_f32_16x16x32_bf16 a[48:51], a[176:179], v[64:67], a[48:51]
    ds_read_b64_tr_b16 a[156:157], v247 offset:37056
    buffer_load_dwordx4 v31, s[16:19], s36 offen offset:1024 nt lds
    v_pk_mul_f32 v[164:165], v[164:165], v[58:59] op_sel_hi:[1,0]
    v_pk_mul_f32 v[166:167], v[166:167], v[58:59] op_sel_hi:[1,0]
    v_cvt_pk_bf16_f32 v160, v160, v161
    v_cvt_pk_bf16_f32 v161, v162, v163
    v_mfma_f32_16x16x32_bf16 a[48:51], a[180:183], v[76:79], a[48:51]
    ds_read_b64_tr_b16 a[158:159], v247 offset:38592
    v_cvt_pk_bf16_f32 v162, v164, v165
    v_cvt_pk_bf16_f32 v163, v166, v167
    v_accvgpr_write_b32 a192, v160
    v_accvgpr_write_b32 a193, v161
    v_accvgpr_write_b32 a194, v162
    v_mfma_f32_16x16x32_bf16 a[52:55], a[176:179], v[68:71], a[52:55]
    ds_read_b64_tr_b16 a[160:161], v244 offset:24896
    v_accvgpr_write_b32 a195, v163
    v_accvgpr_read_b32 v168, a4
    v_accvgpr_read_b32 v169, a5
    v_accvgpr_read_b32 v170, a6
    v_accvgpr_read_b32 v171, a7
    v_mfma_f32_16x16x32_bf16 a[52:55], a[180:183], v[80:83], a[52:55]
    ds_read_b64_tr_b16 a[162:163], v244 offset:26432
    s_cmp_eq_u32 s32, 0
    s_cbranch_scc1 L_notouch_7
    s_mul_i32 s37, s47, 5
    buffer_load_dword v6, v36, s[60:63], s37 offen
    s_mul_i32 s37, s47, 6
    buffer_load_dword v6, v36, s[60:63], s37 offen
    s_mul_i32 s37, s47, 7
    buffer_load_dword v6, v36, s[60:63], s37 offen
    s_mul_i32 s37, s47, 8
    buffer_load_dword v6, v36, s[60:63], s37 offen
    s_mul_i32 s37, s47, 9
    buffer_load_dword v6, v36, s[60:63], s37 offen
L_notouch_7:
    v_mfma_f32_16x16x32_bf16 a[56:59], a[176:179], v[72:75], a[56:59]
    ds_read_b64_tr_b16 a[164:165], v244 offset:37184
    v_accvgpr_read_b32 v172, a16
    v_accvgpr_read_b32 v173, a17
    v_accvgpr_read_b32 v174, a18
    v_accvgpr_read_b32 v175, a19
    v_pk_mul_f32 v[168:169], v[168:169], v[60:61] op_sel_hi:[1,0]
    v_mfma_f32_16x16x32_bf16 a[56:59], a[180:183], v[84:87], a[56:59]
    ds_read_b64_tr_b16 a[166:167], v244 offset:38720
    v_pk_mul_f32 v[170:171], v[170:171], v[60:61] op_sel_hi:[1,0]
    v_pk_mul_f32 v[172:173], v[172:173], v[60:61] op_sel_hi:[1,0]
    v_pk_mul_f32 v[174:175], v[174:175], v[60:61] op_sel_hi:[1,0]
    v_cvt_pk_bf16_f32 v168, v168, v169
    v_cvt_pk_bf16_f32 v169, v170, v171
    v_mfma_f32_16x16x32_bf16 a[60:63], a[184:187], v[64:67], a[60:63]
    v_cvt_pk_bf16_f32 v170, v172, v173
    v_cvt_pk_bf16_f32 v171, v174, v175
    v_accvgpr_write_b32 a196, v168
    v_accvgpr_write_b32 a197, v169
    v_accvgpr_write_b32 a198, v170
    v_accvgpr_write_b32 a199, v171
    v_mfma_f32_16x16x32_bf16 a[60:63], a[188:191], v[76:79], a[60:63]
    v_accvgpr_read_b32 v176, a8
    v_accvgpr_read_b32 v177, a9
    v_accvgpr_read_b32 v178, a10
    v_accvgpr_read_b32 v179, a11
    v_accvgpr_read_b32 v180, a20
    v_accvgpr_read_b32 v181, a21
    v_mfma_f32_16x16x32_bf16 a[64:67], a[184:187], v[68:71], a[64:67]
    v_accvgpr_read_b32 v182, a22
    v_accvgpr_read_b32 v183, a23
    v_pk_mul_f32 v[176:177], v[176:177], v[62:63] op_sel_hi:[1,0]
    v_pk_mul_f32 v[178:179], v[178:179], v[62:63] op_sel_hi:[1,0]
    v_pk_mul_f32 v[180:181], v[180:181], v[62:63] op_sel_hi:[1,0]
    v_pk_mul_f32 v[182:183], v[182:183], v[62:63] op_sel_hi:[1,0]
    v_mfma_f32_16x16x32_bf16 a[64:67], a[188:191], v[80:83], a[64:67]
    v_cvt_pk_bf16_f32 v176, v176, v177
    v_cvt_pk_bf16_f32 v177, v178, v179
    v_cvt_pk_bf16_f32 v178, v180, v181
    v_cvt_pk_bf16_f32 v179, v182, v183
    v_accvgpr_write_b32 a200, v176
    v_accvgpr_write_b32 a201, v177
    v_mfma_f32_16x16x32_bf16 a[68:71], a[184:187], v[72:75], a[68:71]
    v_accvgpr_write_b32 a202, v178
    v_accvgpr_write_b32 a203, v179
    v_mfma_f32_16x16x32_bf16 a[68:71], a[188:191], v[84:87], a[68:71]
    s_waitcnt lgkmcnt(0)
    v_mfma_f32_16x16x32_bf16 a[72:75], a[144:147], v[64:67], a[72:75]
    ds_read_b64_tr_b16 a[168:169], v245 offset:24896
    v_mfma_f32_16x16x32_bf16 a[72:75], a[148:151], v[76:79], a[72:75]
    ds_read_b64_tr_b16 a[170:171], v245 offset:26432
    v_mfma_f32_16x16x32_bf16 a[76:79], a[144:147], v[68:71], a[76:79]
    ds_read_b64_tr_b16 a[172:173], v245 offset:37184
    v_mfma_f32_16x16x32_bf16 a[76:79], a[148:151], v[80:83], a[76:79]
    ds_read_b64_tr_b16 a[174:175], v245 offset:38720
    v_mfma_f32_16x16x32_bf16 a[80:83], a[144:147], v[72:75], a[80:83]
    ds_read_b64_tr_b16 a[176:177], v246 offset:24896
    v_accvgpr_read_b32 v184, a24
    v_accvgpr_read_b32 v185, a25
    v_accvgpr_read_b32 v186, a26
    v_accvgpr_read_b32 v187, a27
    v_accvgpr_read_b32 v188, a36
    v_mfma_f32_16x16x32_bf16 a[80:83], a[148:151], v[84:87], a[80:83]
    ds_read_b64_tr_b16 a[178:179], v246 offset:26432
    v_accvgpr_read_b32 v189, a37
    v_accvgpr_read_b32 v190, a38
    v_accvgpr_read_b32 v191, a39
    v_pk_mul_f32 v[184:185], v[184:185], v[58:59] op_sel_hi:[1,0]
    v_pk_mul_f32 v[186:187], v[186:187], v[58:59] op_sel_hi:[1,0]
    v_mfma_f32_16x16x32_bf16 a[84:87], a[152:155], v[64:67], a[84:87]
    ds_read_b64_tr_b16 a[180:181], v246 offset:37184
    v_pk_mul_f32 v[188:189], v[188:189], v[58:59] op_sel_hi:[1,0]
    v_pk_mul_f32 v[190:191], v[190:191], v[58:59] op_sel_hi:[1,0]
    v_cvt_pk_bf16_f32 v184, v184, v185
    v_cvt_pk_bf16_f32 v185, v186, v187
    v_cvt_pk_bf16_f32 v186, v188, v189
    v_mfma_f32_16x16x32_bf16 a[84:87], a[156:159], v[76:79], a[84:87]
    ds_read_b64_tr_b16 a[182:183], v246 offset:38720
    v_cvt_pk_bf16_f32 v187, v190, v191
    v_accvgpr_write_b32 a204, v184
    v_accvgpr_write_b32 a205, v185
    v_accvgpr_write_b32 a206, v186
    v_accvgpr_write_b32 a207, v187
    v_mfma_f32_16x16x32_bf16 a[88:91], a[152:155], v[68:71], a[88:91]
    ds_read_b64_tr_b16 a[184:185], v247 offset:24896
    v_accvgpr_read_b32 v160, a28
    v_accvgpr_read_b32 v161, a29
    v_accvgpr_read_b32 v162, a30
    v_accvgpr_read_b32 v163, a31
    v_accvgpr_read_b32 v164, a40
    v_mfma_f32_16x16x32_bf16 a[88:91], a[156:159], v[80:83], a[88:91]
    ds_read_b64_tr_b16 a[186:187], v247 offset:26432
    v_accvgpr_read_b32 v165, a41
    v_accvgpr_read_b32 v166, a42
    v_accvgpr_read_b32 v167, a43
    v_pk_mul_f32 v[160:161], v[160:161], v[60:61] op_sel_hi:[1,0]
    v_pk_mul_f32 v[162:163], v[162:163], v[60:61] op_sel_hi:[1,0]
    v_mfma_f32_16x16x32_bf16 a[92:95], a[152:155], v[72:75], a[92:95]
    ds_read_b64_tr_b16 a[188:189], v247 offset:37184
    v_pk_mul_f32 v[164:165], v[164:165], v[60:61] op_sel_hi:[1,0]
    v_pk_mul_f32 v[166:167], v[166:167], v[60:61] op_sel_hi:[1,0]
    v_cvt_pk_bf16_f32 v160, v160, v161
    v_cvt_pk_bf16_f32 v161, v162, v163
    v_cvt_pk_bf16_f32 v162, v164, v165
    v_mfma_f32_16x16x32_bf16 a[92:95], a[156:159], v[84:87], a[92:95]
    ds_read_b64_tr_b16 a[190:191], v247 offset:38720
    v_cvt_pk_bf16_f32 v163, v166, v167
    v_accvgpr_write_b32 a208, v160
    v_accvgpr_write_b32 a209, v161
    v_accvgpr_write_b32 a210, v162
    v_accvgpr_write_b32 a211, v163
    v_mfma_f32_16x16x32_bf16 a[96:99], a[160:163], v[64:67], a[96:99]
    v_accvgpr_read_b32 v168, a32
    v_accvgpr_read_b32 v169, a33
    v_accvgpr_read_b32 v170, a34
    v_accvgpr_read_b32 v171, a35
    v_accvgpr_read_b32 v172, a44
    v_accvgpr_read_b32 v173, a45
    v_mfma_f32_16x16x32_bf16 a[96:99], a[164:167], v[76:79], a[96:99]
    v_accvgpr_read_b32 v174, a46
    v_accvgpr_read_b32 v175, a47
    v_pk_mul_f32 v[168:169], v[168:169], v[62:63] op_sel_hi:[1,0]
    v_pk_mul_f32 v[170:171], v[170:171], v[62:63] op_sel_hi:[1,0]
    v_pk_mul_f32 v[172:173], v[172:173], v[62:63] op_sel_hi:[1,0]
    v_pk_mul_f32 v[174:175], v[174:175], v[62:63] op_sel_hi:[1,0]
    v_mfma_f32_16x16x32_bf16 a[100:103], a[160:163], v[68:71], a[100:103]
    v_cvt_pk_bf16_f32 v168, v168, v169
    v_cvt_pk_bf16_f32 v169, v170, v171
    v_cvt_pk_bf16_f32 v170, v172, v173
    v_cvt_pk_bf16_f32 v171, v174, v175
    v_accvgpr_write_b32 a212, v168
    v_accvgpr_write_b32 a213, v169
    v_mfma_f32_16x16x32_bf16 a[100:103], a[164:167], v[80:83], a[100:103]
    v_accvgpr_write_b32 a214, v170
    v_accvgpr_write_b32 a215, v171
    v_accvgpr_read_b32 v176, a48
    v_accvgpr_read_b32 v177, a49
    v_accvgpr_read_b32 v178, a50
    v_accvgpr_read_b32 v179, a51
    v_mfma_f32_16x16x32_bf16 a[104:107], a[160:163], v[72:75], a[104:107]
    v_accvgpr_read_b32 v180, a60
    v_accvgpr_read_b32 v181, a61
    v_accvgpr_read_b32 v182, a62
    v_accvgpr_read_b32 v183, a63
    v_pk_mul_f32 v[176:177], v[176:177], v[58:59] op_sel_hi:[1,0]
    v_pk_mul_f32 v[178:179], v[178:179], v[58:59] op_sel_hi:[1,0]
    v_mfma_f32_16x16x32_bf16 a[104:107], a[164:167], v[84:87], a[104:107]
    v_pk_mul_f32 v[180:181], v[180:181], v[58:59] op_sel_hi:[1,0]
    v_pk_mul_f32 v[182:183], v[182:183], v[58:59] op_sel_hi:[1,0]
    v_cvt_pk_bf16_f32 v176, v176, v177
    v_cvt_pk_bf16_f32 v177, v178, v179
    v_cvt_pk_bf16_f32 v178, v180, v181
    v_cvt_pk_bf16_f32 v179, v182, v183
    s_waitcnt lgkmcnt(0)
    v_mfma_f32_16x16x32_bf16 a[108:111], a[168:171], v[64:67], a[108:111]
    v_accvgpr_write_b32 a216, v176
    v_accvgpr_write_b32 a217, v177
    v_accvgpr_write_b32 a218, v178
    v_accvgpr_write_b32 a219, v179
    v_accvgpr_read_b32 v184, a52
    v_accvgpr_read_b32 v185, a53
    v_mfma_f32_16x16x32_bf16 a[108:111], a[172:175], v[76:79], a[108:111]
    v_accvgpr_read_b32 v186, a54
    v_accvgpr_read_b32 v187, a55
    v_accvgpr_read_b32 v188, a64
    v_accvgpr_read_b32 v189, a65
    v_accvgpr_read_b32 v190, a66
    v_accvgpr_read_b32 v191, a67
    v_mfma_f32_16x16x32_bf16 a[112:115], a[168:171], v[68:71], a[112:115]
    v_pk_mul_f32 v[184:185], v[184:185], v[60:61] op_sel_hi:[1,0]
    v_pk_mul_f32 v[186:187], v[186:187], v[60:61] op_sel_hi:[1,0]
    v_pk_mul_f32 v[188:189], v[188:189], v[60:61] op_sel_hi:[1,0]
    v_pk_mul_f32 v[190:191], v[190:191], v[60:61] op_sel_hi:[1,0]
    v_cvt_pk_bf16_f32 v184, v184, v185
    v_cvt_pk_bf16_f32 v185, v186, v187
    v_mfma_f32_16x16x32_bf16 a[112:115], a[172:175], v[80:83], a[112:115]
    v_cvt_pk_bf16_f32 v186, v188, v189
    v_cvt_pk_bf16_f32 v187, v190, v191
    v_accvgpr_write_b32 a220, v184
    v_accvgpr_write_b32 a221, v185
    v_accvgpr_write_b32 a222, v186
    v_accvgpr_write_b32 a223, v187
    v_mfma_f32_16x16x32_bf16 a[116:119], a[168:171], v[72:75], a[116:119]
    v_accvgpr_read_b32 v160, a56
    v_accvgpr_read_b32 v161, a57
    v_accvgpr_read_b32 v162, a58
    v_accvgpr_read_b32 v163, a59
    v_accvgpr_read_b32 v164, a68
    v_accvgpr_read_b32 v165, a69
    v_mfma_f32_16x16x32_bf16 a[116:119], a[172:175], v[84:87], a[116:119]
    v_accvgpr_read_b32 v166, a70
    v_accvgpr_read_b32 v167, a71
    v_pk_mul_f32 v[160:161], v[160:161], v[62:63] op_sel_hi:[1,0]
    v_pk_mul_f32 v[162:163], v[162:163], v[62:63] op_sel_hi:[1,0]
    v_pk_mul_f32 v[164:165], v[164:165], v[62:63] op_sel_hi:[1,0]
    v_pk_mul_f32 v[166:167], v[166:167], v[62:63] op_sel_hi:[1,0]
    v_mfma_f32_16x16x32_bf16 a[120:123], a[176:179], v[64:67], a[120:123]
    v_cvt_pk_bf16_f32 v160, v160, v161
    v_cvt_pk_bf16_f32 v161, v162, v163
    v_cvt_pk_bf16_f32 v162, v164, v165
    v_cvt_pk_bf16_f32 v163, v166, v167
    v_accvgpr_write_b32 a224, v160
    v_accvgpr_write_b32 a225, v161
    v_mfma_f32_16x16x32_bf16 a[120:123], a[180:183], v[76:79], a[120:123]
    v_accvgpr_write_b32 a226, v162
    v_accvgpr_write_b32 a227, v163
    v_accvgpr_read_b32 v168, a72
    v_accvgpr_read_b32 v169, a73
    v_accvgpr_read_b32 v170, a74
    v_accvgpr_read_b32 v171, a75
    v_mfma_f32_16x16x32_bf16 a[124:127], a[176:179], v[68:71], a[124:127]
    v_accvgpr_read_b32 v172, a84
    v_accvgpr_read_b32 v173, a85
    v_accvgpr_read_b32 v174, a86
    v_accvgpr_read_b32 v175, a87
    v_pk_mul_f32 v[168:169], v[168:169], v[58:59] op_sel_hi:[1,0]
    v_pk_mul_f32 v[170:171], v[170:171], v[58:59] op_sel_hi:[1,0]
    v_mfma_f32_16x16x32_bf16 a[124:127], a[180:183], v[80:83], a[124:127]
    v_pk_mul_f32 v[172:173], v[172:173], v[58:59] op_sel_hi:[1,0]
    v_pk_mul_f32 v[174:175], v[174:175], v[58:59] op_sel_hi:[1,0]
    v_cvt_pk_bf16_f32 v168, v168, v169
    v_cvt_pk_bf16_f32 v169, v170, v171
    v_cvt_pk_bf16_f32 v170, v172, v173
    v_cvt_pk_bf16_f32 v171, v174, v175
    v_mfma_f32_16x16x32_bf16 a[128:131], a[176:179], v[72:75], a[128:131]
    v_accvgpr_write_b32 a228, v168
    v_accvgpr_write_b32 a229, v169
    v_accvgpr_write_b32 a230, v170
    v_accvgpr_write_b32 a231, v171
    v_accvgpr_read_b32 v176, a76
    v_accvgpr_read_b32 v177, a77
    v_mfma_f32_16x16x32_bf16 a[128:131], a[180:183], v[84:87], a[128:131]
    v_accvgpr_read_b32 v178, a78
    v_accvgpr_read_b32 v179, a79
    v_accvgpr_read_b32 v180, a88
    v_accvgpr_read_b32 v181, a89
    v_accvgpr_read_b32 v182, a90
    v_accvgpr_read_b32 v183, a91
    v_mfma_f32_16x16x32_bf16 a[132:135], a[184:187], v[64:67], a[132:135]
    v_pk_mul_f32 v[176:177], v[176:177], v[60:61] op_sel_hi:[1,0]
    v_pk_mul_f32 v[178:179], v[178:179], v[60:61] op_sel_hi:[1,0]
    v_pk_mul_f32 v[180:181], v[180:181], v[60:61] op_sel_hi:[1,0]
    v_pk_mul_f32 v[182:183], v[182:183], v[60:61] op_sel_hi:[1,0]
    v_cvt_pk_bf16_f32 v176, v176, v177
    v_cvt_pk_bf16_f32 v177, v178, v179
    v_mfma_f32_16x16x32_bf16 a[132:135], a[188:191], v[76:79], a[132:135]
    v_cvt_pk_bf16_f32 v178, v180, v181
    v_cvt_pk_bf16_f32 v179, v182, v183
    v_accvgpr_write_b32 a232, v176
    v_accvgpr_write_b32 a233, v177
    v_accvgpr_write_b32 a234, v178
    v_accvgpr_write_b32 a235, v179
    v_mfma_f32_16x16x32_bf16 a[136:139], a[184:187], v[68:71], a[136:139]
    v_accvgpr_read_b32 v184, a80
    v_accvgpr_read_b32 v185, a81
    v_accvgpr_read_b32 v186, a82
    v_accvgpr_read_b32 v187, a83
    v_accvgpr_read_b32 v188, a92
    v_mfma_f32_16x16x32_bf16 a[136:139], a[188:191], v[80:83], a[136:139]
    v_accvgpr_read_b32 v189, a93
    v_accvgpr_read_b32 v190, a94
    v_accvgpr_read_b32 v191, a95
    v_pk_mul_f32 v[184:185], v[184:185], v[62:63] op_sel_hi:[1,0]
    v_pk_mul_f32 v[186:187], v[186:187], v[62:63] op_sel_hi:[1,0]
    v_mfma_f32_16x16x32_bf16 a[140:143], a[184:187], v[72:75], a[140:143]
    v_pk_mul_f32 v[188:189], v[188:189], v[62:63] op_sel_hi:[1,0]
    v_pk_mul_f32 v[190:191], v[190:191], v[62:63] op_sel_hi:[1,0]
    v_cvt_pk_bf16_f32 v184, v184, v185
    v_cvt_pk_bf16_f32 v185, v186, v187
    v_cvt_pk_bf16_f32 v186, v188, v189
    v_mfma_f32_16x16x32_bf16 a[140:143], a[188:191], v[84:87], a[140:143]
    v_cvt_pk_bf16_f32 v187, v190, v191
    v_accvgpr_write_b32 a236, v184
    v_accvgpr_write_b32 a237, v185
    v_accvgpr_write_b32 a238, v186
    v_accvgpr_write_b32 a239, v187
    v_accvgpr_read_b32 v160, a96
    v_accvgpr_read_b32 v161, a97
    v_accvgpr_read_b32 v162, a98
    v_accvgpr_read_b32 v163, a99
    v_accvgpr_read_b32 v164, a108
    v_accvgpr_read_b32 v165, a109
    v_accvgpr_read_b32 v166, a110
    v_accvgpr_read_b32 v167, a111
    v_pk_mul_f32 v[160:161], v[160:161], v[58:59] op_sel_hi:[1,0]
    v_pk_mul_f32 v[162:163], v[162:163], v[58:59] op_sel_hi:[1,0]
    v_pk_mul_f32 v[164:165], v[164:165], v[58:59] op_sel_hi:[1,0]
    v_pk_mul_f32 v[166:167], v[166:167], v[58:59] op_sel_hi:[1,0]
    v_cvt_pk_bf16_f32 v160, v160, v161
    v_cvt_pk_bf16_f32 v161, v162, v163
    v_cvt_pk_bf16_f32 v162, v164, v165
    v_cvt_pk_bf16_f32 v163, v166, v167
    v_accvgpr_write_b32 a240, v160
    v_accvgpr_write_b32 a241, v161
    v_accvgpr_write_b32 a242, v162
    v_accvgpr_write_b32 a243, v163
    v_accvgpr_read_b32 v168, a100
    v_accvgpr_read_b32 v169, a101
    v_accvgpr_read_b32 v170, a102
    v_accvgpr_read_b32 v171, a103
    v_accvgpr_read_b32 v172, a112
    v_accvgpr_read_b32 v173, a113
    v_accvgpr_read_b32 v174, a114
    v_accvgpr_read_b32 v175, a115
    v_pk_mul_f32 v[168:169], v[168:169], v[60:61] op_sel_hi:[1,0]
    v_pk_mul_f32 v[170:171], v[170:171], v[60:61] op_sel_hi:[1,0]
    v_pk_mul_f32 v[172:173], v[172:173], v[60:61] op_sel_hi:[1,0]
    v_pk_mul_f32 v[174:175], v[174:175], v[60:61] op_sel_hi:[1,0]
    v_cvt_pk_bf16_f32 v168, v168, v169
    v_cvt_pk_bf16_f32 v169, v170, v171
    v_cvt_pk_bf16_f32 v170, v172, v173
    v_cvt_pk_bf16_f32 v171, v174, v175
    v_accvgpr_write_b32 a244, v168
    v_accvgpr_write_b32 a245, v169
    v_accvgpr_write_b32 a246, v170
    v_accvgpr_write_b32 a247, v171
    v_accvgpr_read_b32 v176, a104
    v_accvgpr_read_b32 v177, a105
    v_accvgpr_read_b32 v178, a106
    v_accvgpr_read_b32 v179, a107
    v_accvgpr_read_b32 v180, a116
    v_accvgpr_read_b32 v181, a117
    v_accvgpr_read_b32 v182, a118
    v_accvgpr_read_b32 v183, a119
    v_pk_mul_f32 v[176:177], v[176:177], v[62:63] op_sel_hi:[1,0]
    v_pk_mul_f32 v[178:179], v[178:179], v[62:63] op_sel_hi:[1,0]
    v_pk_mul_f32 v[180:181], v[180:181], v[62:63] op_sel_hi:[1,0]
    v_pk_mul_f32 v[182:183], v[182:183], v[62:63] op_sel_hi:[1,0]
    v_cvt_pk_bf16_f32 v176, v176, v177
    v_cvt_pk_bf16_f32 v177, v178, v179
    v_cvt_pk_bf16_f32 v178, v180, v181
    v_cvt_pk_bf16_f32 v179, v182, v183
    v_accvgpr_write_b32 a248, v176
    v_accvgpr_write_b32 a249, v177
    v_accvgpr_write_b32 a250, v178
    v_accvgpr_write_b32 a251, v179
    v_accvgpr_read_b32 v184, a120
    v_accvgpr_read_b32 v185, a121
    v_accvgpr_read_b32 v186, a122
    v_accvgpr_read_b32 v187, a123
    v_accvgpr_read_b32 v188, a132
    v_accvgpr_read_b32 v189, a133
    v_accvgpr_read_b32 v190, a134
    v_accvgpr_read_b32 v191, a135
    v_pk_mul_f32 v[184:185], v[184:185], v[58:59] op_sel_hi:[1,0]
    v_pk_mul_f32 v[186:187], v[186:187], v[58:59] op_sel_hi:[1,0]
    v_pk_mul_f32 v[188:189], v[188:189], v[58:59] op_sel_hi:[1,0]
    v_pk_mul_f32 v[190:191], v[190:191], v[58:59] op_sel_hi:[1,0]
    v_cvt_pk_bf16_f32 v184, v184, v185
    v_cvt_pk_bf16_f32 v185, v186, v187
    v_cvt_pk_bf16_f32 v186, v188, v189
    v_cvt_pk_bf16_f32 v187, v190, v191
    v_accvgpr_write_b32 a252, v184
    v_accvgpr_write_b32 a253, v185
    v_accvgpr_write_b32 a254, v186
    v_accvgpr_write_b32 a255, v187
    v_accvgpr_read_b32 v160, a124
    v_accvgpr_read_b32 v161, a125
    v_accvgpr_read_b32 v162, a126
    v_accvgpr_read_b32 v163, a127
    v_accvgpr_read_b32 v164, a136
    v_accvgpr_read_b32 v165, a137
    v_accvgpr_read_b32 v166, a138
    v_accvgpr_read_b32 v167, a139
    v_pk_mul_f32 v[160:161], v[160:161], v[60:61] op_sel_hi:[1,0]
    v_pk_mul_f32 v[162:163], v[162:163], v[60:61] op_sel_hi:[1,0]
    v_pk_mul_f32 v[164:165], v[164:165], v[60:61] op_sel_hi:[1,0]
    v_pk_mul_f32 v[166:167], v[166:167], v[60:61] op_sel_hi:[1,0]
    v_cvt_pk_bf16_f32 v160, v160, v161
    v_cvt_pk_bf16_f32 v161, v162, v163
    v_cvt_pk_bf16_f32 v162, v164, v165
    v_cvt_pk_bf16_f32 v163, v166, v167
    ds_write_b128 v7, v[160:163] offset:0
    v_accvgpr_read_b32 v168, a128
    v_accvgpr_read_b32 v169, a129
    v_accvgpr_read_b32 v170, a130
    v_accvgpr_read_b32 v171, a131
    v_accvgpr_read_b32 v172, a140
    v_accvgpr_read_b32 v173, a141
    v_accvgpr_read_b32 v174, a142
    v_accvgpr_read_b32 v175, a143
    v_pk_mul_f32 v[168:169], v[168:169], v[62:63] op_sel_hi:[1,0]
    v_pk_mul_f32 v[170:171], v[170:171], v[62:63] op_sel_hi:[1,0]
    v_pk_mul_f32 v[172:173], v[172:173], v[62:63] op_sel_hi:[1,0]
    v_pk_mul_f32 v[174:175], v[174:175], v[62:63] op_sel_hi:[1,0]
    v_cvt_pk_bf16_f32 v168, v168, v169
    v_cvt_pk_bf16_f32 v169, v170, v171
    v_cvt_pk_bf16_f32 v170, v172, v173
    v_cvt_pk_bf16_f32 v171, v174, v175
    ds_write_b128 v7, v[168:171] offset:1024
    s_cmp_eq_u32 s32, 0
    s_cbranch_scc0 L_op
    s_mov_b32 s32, 1
    s_waitcnt lgkmcnt(0)
    s_branch L_head
L_op:
    s_waitcnt lgkmcnt(0)
    ds_read_b128 a[0:3], v7 offset:0
    ds_read_b128 a[4:7], v7 offset:1024
    v_lshrrev_b32 v1, 4, v0
    v_and_b32 v2, 15, v0
    v_lshrrev_b32 v3, 2, v2
    v_and_b32 v2, 3, v2
    v_lshl_add_u32 v4, v1, 2, v3
    v_and_b32 v5, 6, v4
    v_lshlrev_b32 v4, 7, v4
    v_lshrrev_b32 v3, 1, v2
    v_lshl_add_u32 v4, v3, 4, v4
    v_and_b32 v2, 1, v2
    v_lshl_add_u32 v4, v2, 3, v4
    v_xor_b32 v1, 0, v5
    v_lshl_add_u32 v1, v1, 4, v4
    v_mov_b32 v244, v1
    v_add_u32 v248, 49280, v1
    v_add_u32 v252, 98560, v1
    v_xor_b32 v1, 2, v5
    v_lshl_add_u32 v1, v1, 4, v4
    v_mov_b32 v245, v1
    v_add_u32 v249, 49280, v1
    v_add_u32 v253, 98560, v1
    v_xor_b32 v1, 4, v5
    v_lshl_add_u32 v1, v1, 4, v4
    v_mov_b32 v246, v1
    v_add_u32 v250, 49280, v1
    v_add_u32 v254, 98560, v1
    v_xor_b32 v1, 6, v5
    v_lshl_add_u32 v1, v1, 4, v4
    v_mov_b32 v247, v1
    v_add_u32 v251, 49280, v1
    v_add_u32 v255, 98560, v1
    s_waitcnt vmcnt(5)
    s_waitcnt lgkmcnt(0)
    s_barrier
    ds_read_b64_tr_b16 a[144:145], v252 offset:0
    ds_read_b64_tr_b16 a[146:147], v252 offset:2048
    ds_read_b64_tr_b16 a[148:149], v252 offset:4096
    ds_read_b64_tr_b16 a[150:151], v252 offset:6144
    ds_read_b64_tr_b16 a[152:153], v252 offset:8192
    ds_read_b64_tr_b16 a[154:155], v252 offset:10240
    ds_read_b64_tr_b16 a[156:157], v252 offset:12288
    ds_read_b64_tr_b16 a[158:159], v252 offset:14336
    ds_read_b64_tr_b16 a[160:161], v252 offset:16384
    ds_read_b64_tr_b16 a[162:163], v252 offset:18432
    ds_read_b64_tr_b16 a[164:165], v252 offset:20480
    ds_read_b64_tr_b16 a[166:167], v252 offset:22528
    s_waitcnt lgkmcnt(0)
    v_mfma_f32_16x16x32_bf16 v[160:163], a[144:147], v[88:91], 0
    ds_read_b64_tr_b16 a[168:169], v244 offset:0
    s_mov_b32 s60, s100
    v_mfma_f32_16x16x32_bf16 v[160:163], a[148:151], v[100:103], v[160:163]
    ds_read_b64_tr_b16 a[170:171], v244 offset:2048
    s_mov_b32 s61, s101
    s_mov_b32 s62, 256
    v_mfma_f32_16x16x32_bf16 v[160:163], a[152:155], v[112:115], v[160:163]
    ds_read_b64_tr_b16 a[172:173], v244 offset:4096
    s_lshl_b32 s42, s33, 2
    v_mfma_f32_16x16x32_bf16 v[160:163], a[156:159], v[124:127], v[160:163]
    ds_read_b64_tr_b16 a[174:175], v244 offset:6144
    s_add_u32 s42, s42, 64
    v_mfma_f32_16x16x32_bf16 v[160:163], a[160:163], v[136:139], v[160:163]
    ds_read_b64_tr_b16 a[176:177], v244 offset:8192
    s_mov_b32 s41, s42
    v_mfma_f32_16x16x32_bf16 v[160:163], a[164:167], v[148:151], v[160:163]
    ds_read_b64_tr_b16 a[178:179], v244 offset:10240
    s_mov_b32 s8, s46
    s_mov_b32 s9, s39
    v_mfma_f32_16x16x32_bf16 v[164:167], a[144:147], v[92:95], 0
    ds_read_b64_tr_b16 a[180:181], v244 offset:12288
    s_mov_b32 s10, 3932160
    v_mfma_f32_16x16x32_bf16 v[164:167], a[148:151], v[104:107], v[164:167]
    ds_read_b64_tr_b16 a[182:183], v244 offset:14336
    s_mov_b32 s11, 0x20000
    v_mfma_f32_16x16x32_bf16 v[164:167], a[152:155], v[116:119], v[164:167]
    ds_read_b64_tr_b16 a[184:185], v244 offset:16384
    s_mul_i32 s42, s33, 3932160
    v_mfma_f32_16x16x32_bf16 v[164:167], a[156:159], v[128:131], v[164:167]
    ds_read_b64_tr_b16 a[186:187], v244 offset:18432
    s_add_u32 s4, s58, s42
    s_addc_u32 s5, s59, 0
    v_mfma_f32_16x16x32_bf16 v[164:167], a[160:163], v[140:143], v[164:167]
    ds_read_b64_tr_b16 a[188:189], v244 offset:20480
    s_mov_b32 s6, 3932160
    v_mfma_f32_16x16x32_bf16 v[164:167], a[164:167], v[152:155], v[164:167]
    ds_read_b64_tr_b16 a[190:191], v244 offset:22528
    s_mov_b32 s7, 0x20000
    v_mfma_f32_16x16x32_bf16 v[168:171], a[144:147], v[96:99], 0
    s_and_b32 s42, s2, 3
    s_lshl_b32 s42, s42, 2
    v_mfma_f32_16x16x32_bf16 v[168:171], a[148:151], v[108:111], v[168:171]
    s_lshr_b32 s43, s2, 6
    s_add_u32 s42, s42, s43
    s_lshl_b32 s42, s42, 2
    v_mfma_f32_16x16x32_bf16 v[168:171], a[152:155], v[120:123], v[168:171]
    s_add_u32 s42, s42, s28
    s_add_u32 m0, s29, 73920
    s_mov_b32 s35, 256
    v_mfma_f32_16x16x32_bf16 v[168:171], a[156:159], v[132:135], v[168:171]
    buffer_load_dwordx4 v8, s[12:15], s35 offen offset:0 lds
    v_mfma_f32_16x16x32_bf16 v[168:171], a[160:163], v[144:147], v[168:171]
    buffer_load_dwordx4 v9, s[12:15], s35 offen offset:1024 lds
    v_mfma_f32_16x16x32_bf16 v[168:171], a[164:167], v[156:159], v[168:171]
    s_cmp_lt_u32 s42, 60
    s_cselect_b32 s6, 3932160, 0
    s_cselect_b32 s10, 3932160, 0
    s_waitcnt lgkmcnt(0)
    v_mfma_f32_16x16x32_bf16 v[160:163], a[168:171], a[192:195], v[160:163]
    ds_read_b64_tr_b16 a[144:145], v253 offset:0
    s_add_u32 s43, s42, 0
    v_mfma_f32_16x16x32_bf16 v[160:163], a[172:175], a[204:207], v[160:163]
    ds_read_b64_tr_b16 a[146:147], v253 offset:2048
    s_lshl_b32 s48, s43, 10
    v_mfma_f32_16x16x32_bf16 v[160:163], a[176:179], a[216:219], v[160:163]
    ds_read_b64_tr_b16 a[148:149], v253 offset:4096
    s_mul_i32 s44, s43, 43691
    v_mfma_f32_16x16x32_bf16 v[160:163], a[180:183], a[228:231], v[160:163]
    ds_read_b64_tr_b16 a[150:151], v253 offset:6144
    s_lshr_b32 s44, s44, 19
    s_mul_i32 s45, s44, 12
    v_mfma_f32_16x16x32_bf16 v[160:163], a[184:187], a[240:243], v[160:163]
    ds_read_b64_tr_b16 a[152:153], v253 offset:8192
    s_sub_u32 s45, s43, s45
    v_mfma_f32_16x16x32_bf16 v[160:163], a[188:191], a[252:255], v[160:163]
    ds_read_b64_tr_b16 a[154:155], v253 offset:10240
    s_lshl_b32 s45, s45, 4
    v_mfma_f32_16x16x32_bf16 v[164:167], a[168:171], a[196:199], v[164:167]
    ds_read_b64_tr_b16 a[156:157], v253 offset:12288
    s_mul_i32 s52, s33, 192
    s_add_u32 s52, s52, s45
    v_mfma_f32_16x16x32_bf16 v[164:167], a[172:175], a[208:211], v[164:167]
    ds_read_b64_tr_b16 a[158:159], v253 offset:14336
    s_mul_i32 s52, s52, 1280
    v_mfma_f32_16x16x32_bf16 v[164:167], a[176:179], a[220:223], v[164:167]
    ds_read_b64_tr_b16 a[160:161], v253 offset:16384
    s_lshl_b32 s44, s44, 6
    v_mfma_f32_16x16x32_bf16 v[164:167], a[180:183], a[232:235], v[164:167]
    ds_read_b64_tr_b16 a[162:163], v253 offset:18432
    s_add_u32 s52, s52, s44
    v_mfma_f32_16x16x32_bf16 v[164:167], a[184:187], a[244:247], v[164:167]
    ds_read_b64_tr_b16 a[164:165], v253 offset:20480
    s_add_u32 s43, s42, 60
    s_lshl_b32 s49, s43, 10
    v_mfma_f32_16x16x32_bf16 v[164:167], a[188:191], a[0:3], v[164:167]
    ds_read_b64_tr_b16 a[166:167], v253 offset:22528
    s_mul_i32 s44, s43, 43691
    v_mfma_f32_16x16x32_bf16 v[168:171], a[168:171], a[200:203], v[168:171]
    s_lshr_b32 s44, s44, 19
    s_mul_i32 s45, s44, 12
    v_mfma_f32_16x16x32_bf16 v[168:171], a[172:175], a[212:215], v[168:171]
    s_sub_u32 s45, s43, s45
    s_lshl_b32 s45, s45, 4
    v_mfma_f32_16x16x32_bf16 v[168:171], a[176:179], a[224:227], v[168:171]
    s_mul_i32 s53, s33, 192
    s_add_u32 s53, s53, s45
    s_mul_i32 s53, s53, 1280
    v_mfma_f32_16x16x32_bf16 v[168:171], a[180:183], a[236:239], v[168:171]
    s_lshl_b32 s44, s44, 6
    s_add_u32 s53, s53, s44
    v_mfma_f32_16x16x32_bf16 v[168:171], a[184:187], a[248:251], v[168:171]
    s_add_u32 s43, s42, 120
    s_lshl_b32 s50, s43, 10
    v_mfma_f32_16x16x32_bf16 v[168:171], a[188:191], a[4:7], v[168:171]
    s_mul_i32 s44, s43, 43691
    s_lshr_b32 s44, s44, 19
    s_waitcnt lgkmcnt(0)
    v_mfma_f32_16x16x32_bf16 v[172:175], a[144:147], v[88:91], 0
    ds_read_b64_tr_b16 a[168:169], v245 offset:0
    s_mul_i32 s45, s44, 12
    s_sub_u32 s45, s43, s45
    v_mfma_f32_16x16x32_bf16 v[172:175], a[148:151], v[100:103], v[172:175]
    ds_read_b64_tr_b16 a[170:171], v245 offset:2048
    s_lshl_b32 s45, s45, 4
    v_mfma_f32_16x16x32_bf16 v[172:175], a[152:155], v[112:115], v[172:175]
    ds_read_b64_tr_b16 a[172:173], v245 offset:4096
    s_mul_i32 s54, s33, 192
    v_mfma_f32_16x16x32_bf16 v[172:175], a[156:159], v[124:127], v[172:175]
    ds_read_b64_tr_b16 a[174:175], v245 offset:6144
    v_cvt_pk_bf16_f32 v208, v160, v161
    v_mfma_f32_16x16x32_bf16 v[172:175], a[160:163], v[136:139], v[172:175]
    ds_read_b64_tr_b16 a[176:177], v245 offset:8192
    v_cvt_pk_bf16_f32 v209, v162, v163
    s_add_u32 s54, s54, s45
    v_mfma_f32_16x16x32_bf16 v[172:175], a[164:167], v[148:151], v[172:175]
    ds_read_b64_tr_b16 a[178:179], v245 offset:10240
    v_cvt_pk_bf16_f32 v212, v164, v165
    v_mfma_f32_16x16x32_bf16 v[176:179], a[144:147], v[92:95], 0
    ds_read_b64_tr_b16 a[180:181], v245 offset:12288
    v_cvt_pk_bf16_f32 v213, v166, v167
    v_mfma_f32_16x16x32_bf16 v[176:179], a[148:151], v[104:107], v[176:179]
    ds_read_b64_tr_b16 a[182:183], v245 offset:14336
    v_cvt_pk_bf16_f32 v216, v168, v169
    v_mfma_f32_16x16x32_bf16 v[176:179], a[152:155], v[116:119], v[176:179]
    ds_read_b64_tr_b16 a[184:185], v245 offset:16384
    v_cvt_pk_bf16_f32 v217, v170, v171
    s_mul_i32 s54, s54, 1280
    v_mfma_f32_16x16x32_bf16 v[176:179], a[156:159], v[128:131], v[176:179]
    ds_read_b64_tr_b16 a[186:187], v245 offset:18432
    s_lshl_b32 s44, s44, 6
    v_mfma_f32_16x16x32_bf16 v[176:179], a[160:163], v[140:143], v[176:179]
    ds_read_b64_tr_b16 a[188:189], v245 offset:20480
    s_add_u32 s54, s54, s44
    v_mfma_f32_16x16x32_bf16 v[176:179], a[164:167], v[152:155], v[176:179]
    ds_read_b64_tr_b16 a[190:191], v245 offset:22528
    s_add_u32 s43, s42, 180
    v_mfma_f32_16x16x32_bf16 v[180:183], a[144:147], v[96:99], 0
    s_lshl_b32 s51, s43, 10
    s_mul_i32 s44, s43, 43691
    s_lshr_b32 s44, s44, 19
    v_mfma_f32_16x16x32_bf16 v[180:183], a[148:151], v[108:111], v[180:183]
    s_mul_i32 s45, s44, 12
    s_sub_u32 s45, s43, s45
    v_mfma_f32_16x16x32_bf16 v[180:183], a[152:155], v[120:123], v[180:183]
    s_lshl_b32 s45, s45, 4
    s_mul_i32 s55, s33, 192
    v_mfma_f32_16x16x32_bf16 v[180:183], a[156:159], v[132:135], v[180:183]
    s_add_u32 s55, s55, s45
    s_mul_i32 s55, s55, 1280
    s_lshl_b32 s44, s44, 6
    v_mfma_f32_16x16x32_bf16 v[180:183], a[160:163], v[144:147], v[180:183]
    s_add_u32 s55, s55, s44
    v_and_b32 v1, 15, v0
    v_mfma_f32_16x16x32_bf16 v[180:183], a[164:167], v[156:159], v[180:183]
    v_lshrrev_b32 v2, 4, v0
    v_mul_u32_u24 v3, 1280, v1
    s_waitcnt lgkmcnt(0)
    v_mfma_f32_16x16x32_bf16 v[172:175], a[168:171], a[192:195], v[172:175]
    ds_read_b64_tr_b16 a[144:145], v254 offset:0
    v_lshl_add_u32 v35, v2, 4, v3
    v_mfma_f32_16x16x32_bf16 v[172:175], a[172:175], a[204:207], v[172:175]
    ds_read_b64_tr_b16 a[146:147], v254 offset:2048
    v_lshlrev_b32 v34, 2, v1
    v_lshlrev_b32 v7, 4, v0
    v_mfma_f32_16x16x32_bf16 v[172:175], a[176:179], a[216:219], v[172:175]
    ds_read_b64_tr_b16 a[148:149], v254 offset:4096
    v_and_b32 v3, 1, v1
    v_mfma_f32_16x16x32_bf16 v[172:175], a[180:183], a[228:231], v[172:175]
    ds_read_b64_tr_b16 a[150:151], v254 offset:6144
    v_lshlrev_b32 v3, 4, v3
    v_mfma_f32_16x16x32_bf16 v[172:175], a[184:187], a[240:243], v[172:175]
    ds_read_b64_tr_b16 a[152:153], v254 offset:8192
    v_mov_b32 v4, 0x3f80
    v_mfma_f32_16x16x32_bf16 v[172:175], a[188:191], a[252:255], v[172:175]
    ds_read_b64_tr_b16 a[154:155], v254 offset:10240
    v_lshlrev_b32 v4, v3, v4
    v_lshrrev_b32 v3, 2, v1
    v_mfma_f32_16x16x32_bf16 v[176:179], a[168:171], a[196:199], v[176:179]
    ds_read_b64_tr_b16 a[156:157], v254 offset:12288
    v_mfma_f32_16x16x32_bf16 v[176:179], a[172:175], a[208:211], v[176:179]
    ds_read_b64_tr_b16 a[158:159], v254 offset:14336
    v_mfma_f32_16x16x32_bf16 v[176:179], a[176:179], a[220:223], v[176:179]
    ds_read_b64_tr_b16 a[160:161], v254 offset:16384
    v_mfma_f32_16x16x32_bf16 v[176:179], a[180:183], a[232:235], v[176:179]
    ds_read_b64_tr_b16 a[162:163], v254 offset:18432
    v_mfma_f32_16x16x32_bf16 v[176:179], a[184:187], a[244:247], v[176:179]
    ds_read_b64_tr_b16 a[164:165], v254 offset:20480
    v_mfma_f32_16x16x32_bf16 v[176:179], a[188:191], a[0:3], v[176:179]
    ds_read_b64_tr_b16 a[166:167], v254 offset:22528
    v_mfma_f32_16x16x32_bf16 v[180:183], a[168:171], a[200:203], v[180:183]
    buffer_load_dwordx4 v10, s[12:15], s35 offen offset:2048 lds
    v_mfma_f32_16x16x32_bf16 v[180:183], a[172:175], a[212:215], v[180:183]
    v_cmp_eq_u32 vcc, v3, v2
    v_mov_b32 v5, 0
    s_nop 0
    v_cndmask_b32 v4, v5, v4, vcc
    v_mfma_f32_16x16x32_bf16 v[180:183], a[176:179], a[224:227], v[180:183]
    v_and_b32 v3, 2, v1
    v_mfma_f32_16x16x32_bf16 v[180:183], a[180:183], a[236:239], v[180:183]
    v_cmp_eq_u32 vcc, 0, v3
    v_mov_b32 v40, 0
    v_mfma_f32_16x16x32_bf16 v[180:183], a[184:187], a[248:251], v[180:183]
    v_mov_b32 v41, 0
    v_mov_b32 v44, 0
    v_mfma_f32_16x16x32_bf16 v[180:183], a[188:191], a[4:7], v[180:183]
    v_mov_b32 v45, 0
    v_cndmask_b32 v42, v5, v4, vcc
    v_cndmask_b32 v43, v4, v5, vcc
    s_waitcnt lgkmcnt(0)
    v_mfma_f32_16x16x32_bf16 v[160:163], a[144:147], v[88:91], 0
    ds_read_b64_tr_b16 a[168:169], v246 offset:0
    v_mov_b32 v4, 0
    v_mfma_f32_16x16x32_bf16 v[160:163], a[148:151], v[100:103], v[160:163]
    ds_read_b64_tr_b16 a[170:171], v246 offset:2048
    v_mfma_f32_16x16x32_bf16 v[160:163], a[152:155], v[112:115], v[160:163]
    ds_read_b64_tr_b16 a[172:173], v246 offset:4096
    v_mfma_f32_16x16x32_bf16 v[160:163], a[156:159], v[124:127], v[160:163]
    ds_read_b64_tr_b16 a[174:175], v246 offset:6144
    v_cvt_pk_bf16_f32 v210, v172, v173
    v_mfma_f32_16x16x32_bf16 v[160:163], a[160:163], v[136:139], v[160:163]
    ds_read_b64_tr_b16 a[176:177], v246 offset:8192
    v_cvt_pk_bf16_f32 v211, v174, v175
    v_mfma_f32_16x16x32_bf16 v[160:163], a[164:167], v[148:151], v[160:163]
    ds_read_b64_tr_b16 a[178:179], v246 offset:10240
    v_cvt_pk_bf16_f32 v214, v176, v177
    v_mfma_f32_16x16x32_bf16 v[164:167], a[144:147], v[92:95], 0
    ds_read_b64_tr_b16 a[180:181], v246 offset:12288
    v_cvt_pk_bf16_f32 v215, v178, v179
    v_mfma_f32_16x16x32_bf16 v[164:167], a[148:151], v[104:107], v[164:167]
    ds_read_b64_tr_b16 a[182:183], v246 offset:14336
    v_cvt_pk_bf16_f32 v218, v180, v181
    v_mfma_f32_16x16x32_bf16 v[164:167], a[152:155], v[116:119], v[164:167]
    ds_read_b64_tr_b16 a[184:185], v246 offset:16384
    v_cvt_pk_bf16_f32 v219, v182, v183
    v_mfma_f32_16x16x32_bf16 v[164:167], a[156:159], v[128:131], v[164:167]
    ds_read_b64_tr_b16 a[186:187], v246 offset:18432
    v_mfma_f32_16x16x32_bf16 v[164:167], a[160:163], v[140:143], v[164:167]
    ds_read_b64_tr_b16 a[188:189], v246 offset:20480
    s_mov_b32 s45, 0
    v_mfma_f32_16x16x32_bf16 v[164:167], a[164:167], v[152:155], v[164:167]
    ds_read_b64_tr_b16 a[190:191], v246 offset:22528
    buffer_store_dwordx4 v[208:211], v32, s[20:23], s45 offen offset:0 sc1
    v_mfma_f32_16x16x32_bf16 v[168:171], a[144:147], v[96:99], 0
    buffer_store_dwordx4 v[212:215], v32, s[20:23], s45 offen offset:1024 sc1
    v_mfma_f32_16x16x32_bf16 v[168:171], a[148:151], v[108:111], v[168:171]
    buffer_store_dwordx4 v[216:219], v32, s[20:23], s45 offen offset:2048 sc1
    v_mfma_f32_16x16x32_bf16 v[168:171], a[152:155], v[120:123], v[168:171]
    buffer_load_dwordx4 v11, s[12:15], s35 offen offset:3072 lds
    s_add_u32 m0, s29, 78016
    v_mfma_f32_16x16x32_bf16 v[168:171], a[156:159], v[132:135], v[168:171]
    buffer_load_dwordx4 v12, s[12:15], s35 offen offset:0 lds
    v_mfma_f32_16x16x32_bf16 v[168:171], a[160:163], v[144:147], v[168:171]
    buffer_load_dwordx4 v13, s[12:15], s35 offen offset:1024 lds
    s_add_u32 m0, s29, 24640
    s_mov_b32 s36, 256
    v_mfma_f32_16x16x32_bf16 v[168:171], a[164:167], v[156:159], v[168:171]
    buffer_load_dwordx4 v8, s[16:19], s36 offen offset:0 lds
    s_waitcnt lgkmcnt(0)
    v_mfma_f32_16x16x32_bf16 v[160:163], a[168:171], a[192:195], v[160:163]
    ds_read_b64_tr_b16 a[144:145], v255 offset:0
    v_mfma_f32_16x16x32_bf16 v[160:163], a[172:175], a[204:207], v[160:163]
    ds_read_b64_tr_b16 a[146:147], v255 offset:2048
    v_mfma_f32_16x16x32_bf16 v[160:163], a[176:179], a[216:219], v[160:163]
    ds_read_b64_tr_b16 a[148:149], v255 offset:4096
    v_mfma_f32_16x16x32_bf16 v[160:163], a[180:183], a[228:231], v[160:163]
    ds_read_b64_tr_b16 a[150:151], v255 offset:6144
    v_mfma_f32_16x16x32_bf16 v[160:163], a[184:187], a[240:243], v[160:163]
    ds_read_b64_tr_b16 a[152:153], v255 offset:8192
    v_mfma_f32_16x16x32_bf16 v[160:163], a[188:191], a[252:255], v[160:163]
    ds_read_b64_tr_b16 a[154:155], v255 offset:10240
    v_mfma_f32_16x16x32_bf16 v[164:167], a[168:171], a[196:199], v[164:167]
    ds_read_b64_tr_b16 a[156:157], v255 offset:12288
    v_mfma_f32_16x16x32_bf16 v[164:167], a[172:175], a[208:211], v[164:167]
    ds_read_b64_tr_b16 a[158:159], v255 offset:14336
    v_mfma_f32_16x16x32_bf16 v[164:167], a[176:179], a[220:223], v[164:167]
    ds_read_b64_tr_b16 a[160:161], v255 offset:16384
    v_mfma_f32_16x16x32_bf16 v[164:167], a[180:183], a[232:235], v[164:167]
    ds_read_b64_tr_b16 a[162:163], v255 offset:18432
    v_mfma_f32_16x16x32_bf16 v[164:167], a[184:187], a[244:247], v[164:167]
    ds_read_b64_tr_b16 a[164:165], v255 offset:20480
    buffer_load_dword v2, v4, s[60:63], s41 offen sc1
    v_mfma_f32_16x16x32_bf16 v[164:167], a[188:191], a[0:3], v[164:167]
    ds_read_b64_tr_b16 a[166:167], v255 offset:22528
    v_mfma_f32_16x16x32_bf16 v[168:171], a[168:171], a[200:203], v[168:171]
    buffer_load_dwordx4 v9, s[16:19], s36 offen offset:1024 lds
    v_mfma_f32_16x16x32_bf16 v[168:171], a[172:175], a[212:215], v[168:171]
    buffer_load_dwordx4 v10, s[16:19], s36 offen offset:2048 lds
    v_mfma_f32_16x16x32_bf16 v[168:171], a[176:179], a[224:227], v[168:171]
    buffer_load_dwordx4 v11, s[16:19], s36 offen offset:3072 lds
    s_add_u32 m0, s29, 28736
    v_mfma_f32_16x16x32_bf16 v[168:171], a[180:183], a[236:239], v[168:171]
    buffer_load_dwordx4 v12, s[16:19], s36 offen offset:0 lds
    v_mfma_f32_16x16x32_bf16 v[168:171], a[184:187], a[248:251], v[168:171]
    buffer_load_dwordx4 v13, s[16:19], s36 offen offset:1024 lds
    v_mfma_f32_16x16x32_bf16 v[168:171], a[188:191], a[4:7], v[168:171]
    s_waitcnt lgkmcnt(0)
    v_mfma_f32_16x16x32_bf16 v[172:175], a[144:147], v[88:91], 0
    ds_read_b64_tr_b16 a[168:169], v247 offset:0
    v_mfma_f32_16x16x32_bf16 v[172:175], a[148:151], v[100:103], v[172:175]
    ds_read_b64_tr_b16 a[170:171], v247 offset:2048
    v_mfma_f32_16x16x32_bf16 v[172:175], a[152:155], v[112:115], v[172:175]
    ds_read_b64_tr_b16 a[172:173], v247 offset:4096
    v_mfma_f32_16x16x32_bf16 v[172:175], a[156:159], v[124:127], v[172:175]
    ds_read_b64_tr_b16 a[174:175], v247 offset:6144
    v_cvt_pk_bf16_f32 v220, v160, v161
    v_mfma_f32_16x16x32_bf16 v[172:175], a[160:163], v[136:139], v[172:175]
    ds_read_b64_tr_b16 a[176:177], v247 offset:8192
    v_cvt_pk_bf16_f32 v221, v162, v163
    v_mfma_f32_16x16x32_bf16 v[172:175], a[164:167], v[148:151], v[172:175]
    ds_read_b64_tr_b16 a[178:179], v247 offset:10240
    v_cvt_pk_bf16_f32 v224, v164, v165
    v_mfma_f32_16x16x32_bf16 v[176:179], a[144:147], v[92:95], 0
    ds_read_b64_tr_b16 a[180:181], v247 offset:12288
    v_cvt_pk_bf16_f32 v225, v166, v167
    v_mfma_f32_16x16x32_bf16 v[176:179], a[148:151], v[104:107], v[176:179]
    ds_read_b64_tr_b16 a[182:183], v247 offset:14336
    v_cvt_pk_bf16_f32 v228, v168, v169
    v_mfma_f32_16x16x32_bf16 v[176:179], a[152:155], v[116:119], v[176:179]
    ds_read_b64_tr_b16 a[184:185], v247 offset:16384
    v_cvt_pk_bf16_f32 v229, v170, v171
    v_mfma_f32_16x16x32_bf16 v[176:179], a[156:159], v[128:131], v[176:179]
    ds_read_b64_tr_b16 a[186:187], v247 offset:18432
    v_mfma_f32_16x16x32_bf16 v[176:179], a[160:163], v[140:143], v[176:179]
    ds_read_b64_tr_b16 a[188:189], v247 offset:20480
    v_mfma_f32_16x16x32_bf16 v[176:179], a[164:167], v[152:155], v[176:179]
    ds_read_b64_tr_b16 a[190:191], v247 offset:22528
    v_mfma_f32_16x16x32_bf16 v[180:183], a[144:147], v[96:99], 0
    v_mfma_f32_16x16x32_bf16 v[180:183], a[148:151], v[108:111], v[180:183]
    v_mfma_f32_16x16x32_bf16 v[180:183], a[152:155], v[120:123], v[180:183]
    v_mfma_f32_16x16x32_bf16 v[180:183], a[156:159], v[132:135], v[180:183]
    v_mfma_f32_16x16x32_bf16 v[180:183], a[160:163], v[144:147], v[180:183]
    v_mfma_f32_16x16x32_bf16 v[180:183], a[164:167], v[156:159], v[180:183]
    s_waitcnt vmcnt(21)
    s_waitcnt lgkmcnt(0)
    s_barrier
    v_mfma_f32_16x16x32_bf16 v[172:175], a[168:171], a[192:195], v[172:175]
    ds_read_b64_tr_b16 a[144:145], v252 offset:24640
    v_mfma_f32_16x16x32_bf16 v[172:175], a[172:175], a[204:207], v[172:175]
    ds_read_b64_tr_b16 a[146:147], v252 offset:26688
    v_mfma_f32_16x16x32_bf16 v[172:175], a[176:179], a[216:219], v[172:175]
    ds_read_b64_tr_b16 a[148:149], v252 offset:28736
    v_mfma_f32_16x16x32_bf16 v[172:175], a[180:183], a[228:231], v[172:175]
    ds_read_b64_tr_b16 a[150:151], v252 offset:30784
    v_mfma_f32_16x16x32_bf16 v[172:175], a[184:187], a[240:243], v[172:175]
    ds_read_b64_tr_b16 a[152:153], v252 offset:32832
    v_mfma_f32_16x16x32_bf16 v[172:175], a[188:191], a[252:255], v[172:175]
    ds_read_b64_tr_b16 a[154:155], v252 offset:34880
    v_mfma_f32_16x16x32_bf16 v[176:179], a[168:171], a[196:199], v[176:179]
    ds_read_b64_tr_b16 a[156:157], v252 offset:36928
    v_mfma_f32_16x16x32_bf16 v[176:179], a[172:175], a[208:211], v[176:179]
    ds_read_b64_tr_b16 a[158:159], v252 offset:38976
    v_mfma_f32_16x16x32_bf16 v[176:179], a[176:179], a[220:223], v[176:179]
    ds_read_b64_tr_b16 a[160:161], v252 offset:41024
    v_mfma_f32_16x16x32_bf16 v[176:179], a[180:183], a[232:235], v[176:179]
    ds_read_b64_tr_b16 a[162:163], v252 offset:43072
    v_mfma_f32_16x16x32_bf16 v[176:179], a[184:187], a[244:247], v[176:179]
    ds_read_b64_tr_b16 a[164:165], v252 offset:45120
    v_mfma_f32_16x16x32_bf16 v[176:179], a[188:191], a[0:3], v[176:179]
    ds_read_b64_tr_b16 a[166:167], v252 offset:47168
    s_add_u32 m0, s29, 98560
    s_mov_b32 s35, 384
    v_mfma_f32_16x16x32_bf16 v[180:183], a[168:171], a[200:203], v[180:183]
    buffer_load_dwordx4 v8, s[12:15], s35 offen offset:0 lds
    v_mfma_f32_16x16x32_bf16 v[180:183], a[172:175], a[212:215], v[180:183]
    v_mfma_f32_16x16x32_bf16 v[180:183], a[176:179], a[224:227], v[180:183]
    v_mfma_f32_16x16x32_bf16 v[180:183], a[180:183], a[236:239], v[180:183]
    buffer_load_dwordx4 v9, s[12:15], s35 offen offset:1024 lds
    v_mfma_f32_16x16x32_bf16 v[180:183], a[184:187], a[248:251], v[180:183]
    v_mfma_f32_16x16x32_bf16 v[180:183], a[188:191], a[4:7], v[180:183]
    s_waitcnt lgkmcnt(0)
    v_mfma_f32_16x16x32_bf16 v[160:163], a[144:147], v[88:91], 0
    ds_read_b64_tr_b16 a[168:169], v248 offset:0
    v_mfma_f32_16x16x32_bf16 v[160:163], a[148:151], v[100:103], v[160:163]
    ds_read_b64_tr_b16 a[170:171], v248 offset:2048
    v_mfma_f32_16x16x32_bf16 v[160:163], a[152:155], v[112:115], v[160:163]
    ds_read_b64_tr_b16 a[172:173], v248 offset:4096
    v_mfma_f32_16x16x32_bf16 v[160:163], a[156:159], v[124:127], v[160:163]
    ds_read_b64_tr_b16 a[174:175], v248 offset:6144
    v_cvt_pk_bf16_f32 v222, v172, v173
    v_mfma_f32_16x16x32_bf16 v[160:163], a[160:163], v[136:139], v[160:163]
    ds_read_b64_tr_b16 a[176:177], v248 offset:8192
    v_cvt_pk_bf16_f32 v223, v174, v175
    v_mfma_f32_16x16x32_bf16 v[160:163], a[164:167], v[148:151], v[160:163]
    ds_read_b64_tr_b16 a[178:179], v248 offset:10240
    v_cvt_pk_bf16_f32 v226, v176, v177
    v_mfma_f32_16x16x32_bf16 v[164:167], a[144:147], v[92:95], 0
    ds_read_b64_tr_b16 a[180:181], v248 offset:12288
    v_cvt_pk_bf16_f32 v227, v178, v179
    v_mfma_f32_16x16x32_bf16 v[164:167], a[148:151], v[104:107], v[164:167]
    ds_read_b64_tr_b16 a[182:183], v248 offset:14336
    v_cvt_pk_bf16_f32 v230, v180, v181
    v_mfma_f32_16x16x32_bf16 v[164:167], a[152:155], v[116:119], v[164:167]
    ds_read_b64_tr_b16 a[184:185], v248 offset:16384
    v_cvt_pk_bf16_f32 v231, v182, v183
    v_mfma_f32_16x16x32_bf16 v[164:167], a[156:159], v[128:131], v[164:167]
    ds_read_b64_tr_b16 a[186:187], v248 offset:18432
    v_mfma_f32_16x16x32_bf16 v[164:167], a[160:163], v[140:143], v[164:167]
    ds_read_b64_tr_b16 a[188:189], v248 offset:20480
    s_mov_b32 s45, 12288
    v_mfma_f32_16x16x32_bf16 v[164:167], a[164:167], v[152:155], v[164:167]
    ds_read_b64_tr_b16 a[190:191], v248 offset:22528
    buffer_store_dwordx4 v[220:223], v32, s[20:23], s45 offen offset:0 sc1
    v_mfma_f32_16x16x32_bf16 v[168:171], a[144:147], v[96:99], 0
    buffer_store_dwordx4 v[224:227], v32, s[20:23], s45 offen offset:1024 sc1
    v_mfma_f32_16x16x32_bf16 v[168:171], a[148:151], v[108:111], v[168:171]
    buffer_store_dwordx4 v[228:231], v32, s[20:23], s45 offen offset:2048 sc1
    v_mfma_f32_16x16x32_bf16 v[168:171], a[152:155], v[120:123], v[168:171]
    buffer_load_dwordx4 v10, s[12:15], s35 offen offset:2048 lds
    v_mfma_f32_16x16x32_bf16 v[168:171], a[156:159], v[132:135], v[168:171]
    v_mfma_f32_16x16x32_bf16 v[168:171], a[160:163], v[144:147], v[168:171]
    v_mfma_f32_16x16x32_bf16 v[168:171], a[164:167], v[156:159], v[168:171]
    buffer_load_dwordx4 v11, s[12:15], s35 offen offset:3072 lds
    s_waitcnt lgkmcnt(0)
    v_mfma_f32_16x16x32_bf16 v[160:163], a[168:171], a[192:195], v[160:163]
    ds_read_b64_tr_b16 a[144:145], v253 offset:24640
    v_mfma_f32_16x16x32_bf16 v[160:163], a[172:175], a[204:207], v[160:163]
    ds_read_b64_tr_b16 a[146:147], v253 offset:26688
    v_mfma_f32_16x16x32_bf16 v[160:163], a[176:179], a[216:219], v[160:163]
    ds_read_b64_tr_b16 a[148:149], v253 offset:28736
    v_mfma_f32_16x16x32_bf16 v[160:163], a[180:183], a[228:231], v[160:163]
    ds_read_b64_tr_b16 a[150:151], v253 offset:30784
    v_mfma_f32_16x16x32_bf16 v[160:163], a[184:187], a[240:243], v[160:163]
    ds_read_b64_tr_b16 a[152:153], v253 offset:32832
    v_mfma_f32_16x16x32_bf16 v[160:163], a[188:191], a[252:255], v[160:163]
    ds_read_b64_tr_b16 a[154:155], v253 offset:34880
    v_mfma_f32_16x16x32_bf16 v[164:167], a[168:171], a[196:199], v[164:167]
    ds_read_b64_tr_b16 a[156:157], v253 offset:36928
    v_mfma_f32_16x16x32_bf16 v[164:167], a[172:175], a[208:211], v[164:167]
    ds_read_b64_tr_b16 a[158:159], v253 offset:38976
    v_mfma_f32_16x16x32_bf16 v[164:167], a[176:179], a[220:223], v[164:167]
    ds_read_b64_tr_b16 a[160:161], v253 offset:41024
    v_mfma_f32_16x16x32_bf16 v[164:167], a[180:183], a[232:235], v[164:167]
    ds_read_b64_tr_b16 a[162:163], v253 offset:43072
    v_mfma_f32_16x16x32_bf16 v[164:167], a[184:187], a[244:247], v[164:167]
    ds_read_b64_tr_b16 a[164:165], v253 offset:45120
    v_mfma_f32_16x16x32_bf16 v[164:167], a[188:191], a[0:3], v[164:167]
    ds_read_b64_tr_b16 a[166:167], v253 offset:47168
    v_mfma_f32_16x16x32_bf16 v[168:171], a[168:171], a[200:203], v[168:171]
    v_mfma_f32_16x16x32_bf16 v[168:171], a[172:175], a[212:215], v[168:171]
    s_add_u32 m0, s29, 102656
    v_mfma_f32_16x16x32_bf16 v[168:171], a[176:179], a[224:227], v[168:171]
    buffer_load_dwordx4 v12, s[12:15], s35 offen offset:0 lds
    v_mfma_f32_16x16x32_bf16 v[168:171], a[180:183], a[236:239], v[168:171]
    v_mfma_f32_16x16x32_bf16 v[168:171], a[184:187], a[248:251], v[168:171]
    v_mfma_f32_16x16x32_bf16 v[168:171], a[188:191], a[4:7], v[168:171]
    buffer_load_dwordx4 v13, s[12:15], s35 offen offset:1024 lds
    s_waitcnt lgkmcnt(0)
    v_mfma_f32_16x16x32_bf16 v[172:175], a[144:147], v[88:91], 0
    ds_read_b64_tr_b16 a[168:169], v249 offset:0
    v_mfma_f32_16x16x32_bf16 v[172:175], a[148:151], v[100:103], v[172:175]
    ds_read_b64_tr_b16 a[170:171], v249 offset:2048
    v_mfma_f32_16x16x32_bf16 v[172:175], a[152:155], v[112:115], v[172:175]
    ds_read_b64_tr_b16 a[172:173], v249 offset:4096
    v_mfma_f32_16x16x32_bf16 v[172:175], a[156:159], v[124:127], v[172:175]
    ds_read_b64_tr_b16 a[174:175], v249 offset:6144
    v_cvt_pk_bf16_f32 v64, v160, v161
    v_mfma_f32_16x16x32_bf16 v[172:175], a[160:163], v[136:139], v[172:175]
    ds_read_b64_tr_b16 a[176:177], v249 offset:8192
    v_cvt_pk_bf16_f32 v65, v162, v163
    v_mfma_f32_16x16x32_bf16 v[172:175], a[164:167], v[148:151], v[172:175]
    ds_read_b64_tr_b16 a[178:179], v249 offset:10240
    v_cvt_pk_bf16_f32 v68, v164, v165
    v_mfma_f32_16x16x32_bf16 v[176:179], a[144:147], v[92:95], 0
    ds_read_b64_tr_b16 a[180:181], v249 offset:12288
    v_cvt_pk_bf16_f32 v69, v166, v167
    v_mfma_f32_16x16x32_bf16 v[176:179], a[148:151], v[104:107], v[176:179]
    ds_read_b64_tr_b16 a[182:183], v249 offset:14336
    v_cvt_pk_bf16_f32 v72, v168, v169
    v_mfma_f32_16x16x32_bf16 v[176:179], a[152:155], v[116:119], v[176:179]
    ds_read_b64_tr_b16 a[184:185], v249 offset:16384
    v_cvt_pk_bf16_f32 v73, v170, v171
    v_mfma_f32_16x16x32_bf16 v[176:179], a[156:159], v[128:131], v[176:179]
    ds_read_b64_tr_b16 a[186:187], v249 offset:18432
    v_mfma_f32_16x16x32_bf16 v[176:179], a[160:163], v[140:143], v[176:179]
    ds_read_b64_tr_b16 a[188:189], v249 offset:20480
    v_mfma_f32_16x16x32_bf16 v[176:179], a[164:167], v[152:155], v[176:179]
    ds_read_b64_tr_b16 a[190:191], v249 offset:22528
    v_mfma_f32_16x16x32_bf16 v[180:183], a[144:147], v[96:99], 0
    v_mfma_f32_16x16x32_bf16 v[180:183], a[148:151], v[108:111], v[180:183]
    v_mfma_f32_16x16x32_bf16 v[180:183], a[152:155], v[120:123], v[180:183]
    s_add_u32 m0, s29, 0
    s_mov_b32 s36, 384
    v_mfma_f32_16x16x32_bf16 v[180:183], a[156:159], v[132:135], v[180:183]
    buffer_load_dwordx4 v8, s[16:19], s36 offen offset:0 lds
    v_mfma_f32_16x16x32_bf16 v[180:183], a[160:163], v[144:147], v[180:183]
    v_mfma_f32_16x16x32_bf16 v[180:183], a[164:167], v[156:159], v[180:183]
    s_waitcnt lgkmcnt(0)
    v_mfma_f32_16x16x32_bf16 v[172:175], a[168:171], a[192:195], v[172:175]
    ds_read_b64_tr_b16 a[144:145], v254 offset:24640
    v_mfma_f32_16x16x32_bf16 v[172:175], a[172:175], a[204:207], v[172:175]
    ds_read_b64_tr_b16 a[146:147], v254 offset:26688
    v_mfma_f32_16x16x32_bf16 v[172:175], a[176:179], a[216:219], v[172:175]
    ds_read_b64_tr_b16 a[148:149], v254 offset:28736
    v_mfma_f32_16x16x32_bf16 v[172:175], a[180:183], a[228:231], v[172:175]
    ds_read_b64_tr_b16 a[150:151], v254 offset:30784
    v_mfma_f32_16x16x32_bf16 v[172:175], a[184:187], a[240:243], v[172:175]
    ds_read_b64_tr_b16 a[152:153], v254 offset:32832
    v_mfma_f32_16x16x32_bf16 v[172:175], a[188:191], a[252:255], v[172:175]
    ds_read_b64_tr_b16 a[154:155], v254 offset:34880
    v_mfma_f32_16x16x32_bf16 v[176:179], a[168:171], a[196:199], v[176:179]
    ds_read_b64_tr_b16 a[156:157], v254 offset:36928
    v_mfma_f32_16x16x32_bf16 v[176:179], a[172:175], a[208:211], v[176:179]
    ds_read_b64_tr_b16 a[158:159], v254 offset:38976
    v_mfma_f32_16x16x32_bf16 v[176:179], a[176:179], a[220:223], v[176:179]
    ds_read_b64_tr_b16 a[160:161], v254 offset:41024
    v_mfma_f32_16x16x32_bf16 v[176:179], a[180:183], a[232:235], v[176:179]
    ds_read_b64_tr_b16 a[162:163], v254 offset:43072
    v_mfma_f32_16x16x32_bf16 v[176:179], a[184:187], a[244:247], v[176:179]
    ds_read_b64_tr_b16 a[164:165], v254 offset:45120
    v_mfma_f32_16x16x32_bf16 v[176:179], a[188:191], a[0:3], v[176:179]
    ds_read_b64_tr_b16 a[166:167], v254 offset:47168
    v_mfma_f32_16x16x32_bf16 v[180:183], a[168:171], a[200:203], v[180:183]
    buffer_load_dwordx4 v9, s[16:19], s36 offen offset:1024 lds
    v_mfma_f32_16x16x32_bf16 v[180:183], a[172:175], a[212:215], v[180:183]
    v_mfma_f32_16x16x32_bf16 v[180:183], a[176:179], a[224:227], v[180:183]
    v_mfma_f32_16x16x32_bf16 v[180:183], a[180:183], a[236:239], v[180:183]
    buffer_load_dwordx4 v10, s[16:19], s36 offen offset:2048 lds
    v_mfma_f32_16x16x32_bf16 v[180:183], a[184:187], a[248:251], v[180:183]
    v_mfma_f32_16x16x32_bf16 v[180:183], a[188:191], a[4:7], v[180:183]
    s_waitcnt lgkmcnt(0)
    v_mfma_f32_16x16x32_bf16 v[160:163], a[144:147], v[88:91], 0
    ds_read_b64_tr_b16 a[168:169], v250 offset:0
    v_mfma_f32_16x16x32_bf16 v[160:163], a[148:151], v[100:103], v[160:163]
    ds_read_b64_tr_b16 a[170:171], v250 offset:2048
    v_mfma_f32_16x16x32_bf16 v[160:163], a[152:155], v[112:115], v[160:163]
    ds_read_b64_tr_b16 a[172:173], v250 offset:4096
    v_mfma_f32_16x16x32_bf16 v[160:163], a[156:159], v[124:127], v[160:163]
    ds_read_b64_tr_b16 a[174:175], v250 offset:6144
    v_cvt_pk_bf16_f32 v66, v172, v173
    v_mfma_f32_16x16x32_bf16 v[160:163], a[160:163], v[136:139], v[160:163]
    ds_read_b64_tr_b16 a[176:177], v250 offset:8192
    v_cvt_pk_bf16_f32 v67, v174, v175
    v_mfma_f32_16x16x32_bf16 v[160:163], a[164:167], v[148:151], v[160:163]
    ds_read_b64_tr_b16 a[178:179], v250 offset:10240
    v_cvt_pk_bf16_f32 v70, v176, v177
    v_mfma_f32_16x16x32_bf16 v[164:167], a[144:147], v[92:95], 0
    ds_read_b64_tr_b16 a[180:181], v250 offset:12288
    v_cvt_pk_bf16_f32 v71, v178, v179
    v_mfma_f32_16x16x32_bf16 v[164:167], a[148:151], v[104:107], v[164:167]
    ds_read_b64_tr_b16 a[182:183], v250 offset:14336
    v_cvt_pk_bf16_f32 v74, v180, v181
    v_mfma_f32_16x16x32_bf16 v[164:167], a[152:155], v[116:119], v[164:167]
    ds_read_b64_tr_b16 a[184:185], v250 offset:16384
    v_cvt_pk_bf16_f32 v75, v182, v183
    v_mfma_f32_16x16x32_bf16 v[164:167], a[156:159], v[128:131], v[164:167]
    ds_read_b64_tr_b16 a[186:187], v250 offset:18432
    v_mfma_f32_16x16x32_bf16 v[164:167], a[160:163], v[140:143], v[164:167]
    ds_read_b64_tr_b16 a[188:189], v250 offset:20480
    s_mov_b32 s45, 24576
    v_mfma_f32_16x16x32_bf16 v[164:167], a[164:167], v[152:155], v[164:167]
    ds_read_b64_tr_b16 a[190:191], v250 offset:22528
    buffer_store_dwordx4 v[64:67], v32, s[20:23], s45 offen offset:0 sc1
    v_mfma_f32_16x16x32_bf16 v[168:171], a[144:147], v[96:99], 0
    buffer_store_dwordx4 v[68:71], v32, s[20:23], s45 offen offset:1024 sc1
    v_mfma_f32_16x16x32_bf16 v[168:171], a[148:151], v[108:111], v[168:171]
    buffer_store_dwordx4 v[72:75], v32, s[20:23], s45 offen offset:2048 sc1
    v_mfma_f32_16x16x32_bf16 v[168:171], a[152:155], v[120:123], v[168:171]
    buffer_load_dwordx4 v11, s[16:19], s36 offen offset:3072 lds
    v_mfma_f32_16x16x32_bf16 v[168:171], a[156:159], v[132:135], v[168:171]
    v_mfma_f32_16x16x32_bf16 v[168:171], a[160:163], v[144:147], v[168:171]
    s_add_u32 m0, s29, 4096
    v_mfma_f32_16x16x32_bf16 v[168:171], a[164:167], v[156:159], v[168:171]
    buffer_load_dwordx4 v12, s[16:19], s36 offen offset:0 lds
    s_waitcnt lgkmcnt(0)
    v_mfma_f32_16x16x32_bf16 v[160:163], a[168:171], a[192:195], v[160:163]
    ds_read_b64_tr_b16 a[144:145], v255 offset:24640
    v_mfma_f32_16x16x32_bf16 v[160:163], a[172:175], a[204:207], v[160:163]
    ds_read_b64_tr_b16 a[146:147], v255 offset:26688
    v_mfma_f32_16x16x32_bf16 v[160:163], a[176:179], a[216:219], v[160:163]
    ds_read_b64_tr_b16 a[148:149], v255 offset:28736
    v_mfma_f32_16x16x32_bf16 v[160:163], a[180:183], a[228:231], v[160:163]
    ds_read_b64_tr_b16 a[150:151], v255 offset:30784
    v_mfma_f32_16x16x32_bf16 v[160:163], a[184:187], a[240:243], v[160:163]
    ds_read_b64_tr_b16 a[152:153], v255 offset:32832
    v_mfma_f32_16x16x32_bf16 v[160:163], a[188:191], a[252:255], v[160:163]
    ds_read_b64_tr_b16 a[154:155], v255 offset:34880
    v_mfma_f32_16x16x32_bf16 v[164:167], a[168:171], a[196:199], v[164:167]
    ds_read_b64_tr_b16 a[156:157], v255 offset:36928
    v_mfma_f32_16x16x32_bf16 v[164:167], a[172:175], a[208:211], v[164:167]
    ds_read_b64_tr_b16 a[158:159], v255 offset:38976
    v_mfma_f32_16x16x32_bf16 v[164:167], a[176:179], a[220:223], v[164:167]
    ds_read_b64_tr_b16 a[160:161], v255 offset:41024
    v_mfma_f32_16x16x32_bf16 v[164:167], a[180:183], a[232:235], v[164:167]
    ds_read_b64_tr_b16 a[162:163], v255 offset:43072
    v_mfma_f32_16x16x32_bf16 v[164:167], a[184:187], a[244:247], v[164:167]
    ds_read_b64_tr_b16 a[164:165], v255 offset:45120
    v_mfma_f32_16x16x32_bf16 v[164:167], a[188:191], a[0:3], v[164:167]
    ds_read_b64_tr_b16 a[166:167], v255 offset:47168
    v_mfma_f32_16x16x32_bf16 v[168:171], a[168:171], a[200:203], v[168:171]
    v_mfma_f32_16x16x32_bf16 v[168:171], a[172:175], a[212:215], v[168:171]
    v_mfma_f32_16x16x32_bf16 v[168:171], a[176:179], a[224:227], v[168:171]
    buffer_load_dwordx4 v13, s[16:19], s36 offen offset:1024 lds
    v_mfma_f32_16x16x32_bf16 v[168:171], a[180:183], a[236:239], v[168:171]
    v_mfma_f32_16x16x32_bf16 v[168:171], a[184:187], a[248:251], v[168:171]
    v_mfma_f32_16x16x32_bf16 v[168:171], a[188:191], a[4:7], v[168:171]
    s_waitcnt lgkmcnt(0)
    v_mfma_f32_16x16x32_bf16 v[172:175], a[144:147], v[88:91], 0
    ds_read_b64_tr_b16 a[168:169], v251 offset:0
    v_mfma_f32_16x16x32_bf16 v[172:175], a[148:151], v[100:103], v[172:175]
    ds_read_b64_tr_b16 a[170:171], v251 offset:2048
    v_mfma_f32_16x16x32_bf16 v[172:175], a[152:155], v[112:115], v[172:175]
    ds_read_b64_tr_b16 a[172:173], v251 offset:4096
    v_mfma_f32_16x16x32_bf16 v[172:175], a[156:159], v[124:127], v[172:175]
    ds_read_b64_tr_b16 a[174:175], v251 offset:6144
    v_cvt_pk_bf16_f32 v76, v160, v161
    v_mfma_f32_16x16x32_bf16 v[172:175], a[160:163], v[136:139], v[172:175]
    ds_read_b64_tr_b16 a[176:177], v251 offset:8192
    v_cvt_pk_bf16_f32 v77, v162, v163
    v_mfma_f32_16x16x32_bf16 v[172:175], a[164:167], v[148:151], v[172:175]
    ds_read_b64_tr_b16 a[178:179], v251 offset:10240
    v_cvt_pk_bf16_f32 v80, v164, v165
    v_mfma_f32_16x16x32_bf16 v[176:179], a[144:147], v[92:95], 0
    ds_read_b64_tr_b16 a[180:181], v251 offset:12288
    v_cvt_pk_bf16_f32 v81, v166, v167
    v_mfma_f32_16x16x32_bf16 v[176:179], a[148:151], v[104:107], v[176:179]
    ds_read_b64_tr_b16 a[182:183], v251 offset:14336
    v_cvt_pk_bf16_f32 v84, v168, v169
    v_mfma_f32_16x16x32_bf16 v[176:179], a[152:155], v[116:119], v[176:179]
    ds_read_b64_tr_b16 a[184:185], v251 offset:16384
    v_cvt_pk_bf16_f32 v85, v170, v171
    v_mfma_f32_16x16x32_bf16 v[176:179], a[156:159], v[128:131], v[176:179]
    ds_read_b64_tr_b16 a[186:187], v251 offset:18432
    v_mfma_f32_16x16x32_bf16 v[176:179], a[160:163], v[140:143], v[176:179]
    ds_read_b64_tr_b16 a[188:189], v251 offset:20480
    v_mfma_f32_16x16x32_bf16 v[176:179], a[164:167], v[152:155], v[176:179]
    ds_read_b64_tr_b16 a[190:191], v251 offset:22528
    v_mfma_f32_16x16x32_bf16 v[180:183], a[144:147], v[96:99], 0
    v_mfma_f32_16x16x32_bf16 v[180:183], a[148:151], v[108:111], v[180:183]
    v_mfma_f32_16x16x32_bf16 v[180:183], a[152:155], v[120:123], v[180:183]
    v_mfma_f32_16x16x32_bf16 v[180:183], a[156:159], v[132:135], v[180:183]
    v_mfma_f32_16x16x32_bf16 v[180:183], a[160:163], v[144:147], v[180:183]
    v_mfma_f32_16x16x32_bf16 v[180:183], a[164:167], v[156:159], v[180:183]
    s_waitcnt vmcnt(18)
    s_waitcnt lgkmcnt(0)
    s_barrier
    v_mfma_f32_16x16x32_bf16 v[172:175], a[168:171], a[192:195], v[172:175]
    ds_read_b64_tr_b16 a[144:145], v248 offset:24640
    v_mfma_f32_16x16x32_bf16 v[172:175], a[172:175], a[204:207], v[172:175]
    ds_read_b64_tr_b16 a[146:147], v248 offset:26688
    v_mfma_f32_16x16x32_bf16 v[172:175], a[176:179], a[216:219], v[172:175]
    ds_read_b64_tr_b16 a[148:149], v248 offset:28736
    v_mfma_f32_16x16x32_bf16 v[172:175], a[180:183], a[228:231], v[172:175]
    ds_read_b64_tr_b16 a[150:151], v248 offset:30784
    v_mfma_f32_16x16x32_bf16 v[172:175], a[184:187], a[240:243], v[172:175]
    ds_read_b64_tr_b16 a[152:153], v248 offset:32832
    v_mfma_f32_16x16x32_bf16 v[172:175], a[188:191], a[252:255], v[172:175]
    ds_read_b64_tr_b16 a[154:155], v248 offset:34880
    v_cmp_gt_u32 vcc, 16, v2
    s_cbranch_vccnz L_hs_spin
L_hs_ok:
    v_mfma_f32_16x16x32_bf16 v[176:179], a[168:171], a[196:199], v[176:179]
    ds_read_b64_tr_b16 a[156:157], v248 offset:36928
    v_mfma_f32_16x16x32_bf16 v[176:179], a[172:175], a[208:211], v[176:179]
    ds_read_b64_tr_b16 a[158:159], v248 offset:38976
    v_mfma_f32_16x16x32_bf16 v[176:179], a[176:179], a[220:223], v[176:179]
    ds_read_b64_tr_b16 a[160:161], v248 offset:41024
    v_mfma_f32_16x16x32_bf16 v[176:179], a[180:183], a[232:235], v[176:179]
    ds_read_b64_tr_b16 a[162:163], v248 offset:43072
    v_mfma_f32_16x16x32_bf16 v[176:179], a[184:187], a[244:247], v[176:179]
    ds_read_b64_tr_b16 a[164:165], v248 offset:45120
    v_mfma_f32_16x16x32_bf16 v[176:179], a[188:191], a[0:3], v[176:179]
    ds_read_b64_tr_b16 a[166:167], v248 offset:47168
    s_add_u32 m0, s29, 123200
    s_mov_b32 s35, 512
    v_mfma_f32_16x16x32_bf16 v[180:183], a[168:171], a[200:203], v[180:183]
    buffer_load_dwordx4 v8, s[12:15], s35 offen offset:0 lds
    v_mfma_f32_16x16x32_bf16 v[180:183], a[172:175], a[212:215], v[180:183]
    v_mfma_f32_16x16x32_bf16 v[180:183], a[176:179], a[224:227], v[180:183]
    v_mfma_f32_16x16x32_bf16 v[180:183], a[180:183], a[236:239], v[180:183]
    buffer_load_dwordx4 v9, s[12:15], s35 offen offset:1024 lds
    v_mfma_f32_16x16x32_bf16 v[180:183], a[184:187], a[248:251], v[180:183]
    v_mfma_f32_16x16x32_bf16 v[180:183], a[188:191], a[4:7], v[180:183]
    s_waitcnt lgkmcnt(0)
    v_mfma_f32_16x16x32_bf16 v[160:163], a[144:147], v[88:91], 0
    ds_read_b64_tr_b16 a[168:169], v244 offset:24640
    v_mfma_f32_16x16x32_bf16 v[160:163], a[148:151], v[100:103], v[160:163]
    ds_read_b64_tr_b16 a[170:171], v244 offset:26688
    v_mfma_f32_16x16x32_bf16 v[160:163], a[152:155], v[112:115], v[160:163]
    ds_read_b64_tr_b16 a[172:173], v244 offset:28736
    v_mfma_f32_16x16x32_bf16 v[160:163], a[156:159], v[124:127], v[160:163]
    ds_read_b64_tr_b16 a[174:175], v244 offset:30784
    v_cvt_pk_bf16_f32 v78, v172, v173
    v_mfma_f32_16x16x32_bf16 v[160:163], a[160:163], v[136:139], v[160:163]
    ds_read_b64_tr_b16 a[176:177], v244 offset:32832
    v_cvt_pk_bf16_f32 v79, v174, v175
    v_mfma_f32_16x16x32_bf16 v[160:163], a[164:167], v[148:151], v[160:163]
    ds_read_b64_tr_b16 a[178:179], v244 offset:34880
    v_cvt_pk_bf16_f32 v82, v176, v177
    v_mfma_f32_16x16x32_bf16 v[164:167], a[144:147], v[92:95], 0
    ds_read_b64_tr_b16 a[180:181], v244 offset:36928
    v_cvt_pk_bf16_f32 v83, v178, v179
    v_mfma_f32_16x16x32_bf16 v[164:167], a[148:151], v[104:107], v[164:167]
    ds_read_b64_tr_b16 a[182:183], v244 offset:38976
    v_cvt_pk_bf16_f32 v86, v180, v181
    v_mfma_f32_16x16x32_bf16 v[164:167], a[152:155], v[116:119], v[164:167]
    ds_read_b64_tr_b16 a[184:185], v244 offset:41024
    v_cvt_pk_bf16_f32 v87, v182, v183
    v_mfma_f32_16x16x32_bf16 v[164:167], a[156:159], v[128:131], v[164:167]
    ds_read_b64_tr_b16 a[186:187], v244 offset:43072
    v_mfma_f32_16x16x32_bf16 v[164:167], a[160:163], v[140:143], v[164:167]
    ds_read_b64_tr_b16 a[188:189], v244 offset:45120
    s_mov_b32 s45, 36864
    v_mfma_f32_16x16x32_bf16 v[164:167], a[164:167], v[152:155], v[164:167]
    ds_read_b64_tr_b16 a[190:191], v244 offset:47168
    buffer_store_dwordx4 v[76:79], v32, s[20:23], s45 offen offset:0 sc1
    v_mfma_f32_16x16x32_bf16 v[168:171], a[144:147], v[96:99], 0
    buffer_store_dwordx4 v[80:83], v32, s[20:23], s45 offen offset:1024 sc1
    v_mfma_f32_16x16x32_bf16 v[168:171], a[148:151], v[108:111], v[168:171]
    buffer_store_dwordx4 v[84:87], v32, s[20:23], s45 offen offset:2048 sc1
    v_mfma_f32_16x16x32_bf16 v[168:171], a[152:155], v[120:123], v[168:171]
    buffer_load_dwordx4 v10, s[12:15], s35 offen offset:2048 lds
    v_mfma_f32_16x16x32_bf16 v[168:171], a[156:159], v[132:135], v[168:171]
    v_mfma_f32_16x16x32_bf16 v[168:171], a[160:163], v[144:147], v[168:171]
    v_mfma_f32_16x16x32_bf16 v[168:171], a[164:167], v[156:159], v[168:171]
    buffer_load_dwordx4 v11, s[12:15], s35 offen offset:3072 lds
    s_waitcnt lgkmcnt(0)
    v_mfma_f32_16x16x32_bf16 v[160:163], a[168:171], a[192:195], v[160:163]
    ds_read_b64_tr_b16 a[144:145], v249 offset:24640
    v_mfma_f32_16x16x32_bf16 v[160:163], a[172:175], a[204:207], v[160:163]
    ds_read_b64_tr_b16 a[146:147], v249 offset:26688
    v_mfma_f32_16x16x32_bf16 v[160:163], a[176:179], a[216:219], v[160:163]
    ds_read_b64_tr_b16 a[148:149], v249 offset:28736
    v_mfma_f32_16x16x32_bf16 v[160:163], a[180:183], a[228:231], v[160:163]
    ds_read_b64_tr_b16 a[150:151], v249 offset:30784
    v_mfma_f32_16x16x32_bf16 v[160:163], a[184:187], a[240:243], v[160:163]
    ds_read_b64_tr_b16 a[152:153], v249 offset:32832
    v_mfma_f32_16x16x32_bf16 v[160:163], a[188:191], a[252:255], v[160:163]
    ds_read_b64_tr_b16 a[154:155], v249 offset:34880
    v_mfma_f32_16x16x32_bf16 v[164:167], a[168:171], a[196:199], v[164:167]
    ds_read_b64_tr_b16 a[156:157], v249 offset:36928
    v_mfma_f32_16x16x32_bf16 v[164:167], a[172:175], a[208:211], v[164:167]
    ds_read_b64_tr_b16 a[158:159], v249 offset:38976
    v_mfma_f32_16x16x32_bf16 v[164:167], a[176:179], a[220:223], v[164:167]
    ds_read_b64_tr_b16 a[160:161], v249 offset:41024
    v_mfma_f32_16x16x32_bf16 v[164:167], a[180:183], a[232:235], v[164:167]
    ds_read_b64_tr_b16 a[162:163], v249 offset:43072
    v_mfma_f32_16x16x32_bf16 v[164:167], a[184:187], a[244:247], v[164:167]
    ds_read_b64_tr_b16 a[164:165], v249 offset:45120
    v_mfma_f32_16x16x32_bf16 v[164:167], a[188:191], a[0:3], v[164:167]
    ds_read_b64_tr_b16 a[166:167], v249 offset:47168
    v_mfma_f32_16x16x32_bf16 v[168:171], a[168:171], a[200:203], v[168:171]
    v_mfma_f32_16x16x32_bf16 v[168:171], a[172:175], a[212:215], v[168:171]
    s_add_u32 m0, s29, 127296
    v_mfma_f32_16x16x32_bf16 v[168:171], a[176:179], a[224:227], v[168:171]
    buffer_load_dwordx4 v12, s[12:15], s35 offen offset:0 lds
    v_mfma_f32_16x16x32_bf16 v[168:171], a[180:183], a[236:239], v[168:171]
    v_mfma_f32_16x16x32_bf16 v[168:171], a[184:187], a[248:251], v[168:171]
    v_mfma_f32_16x16x32_bf16 v[168:171], a[188:191], a[4:7], v[168:171]
    buffer_load_dwordx4 v13, s[12:15], s35 offen offset:1024 lds
    s_waitcnt lgkmcnt(0)
    v_mfma_f32_16x16x32_bf16 v[172:175], a[144:147], v[88:91], 0
    ds_read_b64_tr_b16 a[168:169], v245 offset:24640
    v_mfma_f32_16x16x32_bf16 v[172:175], a[148:151], v[100:103], v[172:175]
    ds_read_b64_tr_b16 a[170:171], v245 offset:26688
    v_mfma_f32_16x16x32_bf16 v[172:175], a[152:155], v[112:115], v[172:175]
    ds_read_b64_tr_b16 a[172:173], v245 offset:28736
    v_mfma_f32_16x16x32_bf16 v[172:175], a[156:159], v[124:127], v[172:175]
    ds_read_b64_tr_b16 a[174:175], v245 offset:30784
    v_cvt_pk_bf16_f32 v208, v160, v161
    v_mfma_f32_16x16x32_bf16 v[172:175], a[160:163], v[136:139], v[172:175]
    ds_read_b64_tr_b16 a[176:177], v245 offset:32832
    v_cvt_pk_bf16_f32 v209, v162, v163
    v_mfma_f32_16x16x32_bf16 v[172:175], a[164:167], v[148:151], v[172:175]
    ds_read_b64_tr_b16 a[178:179], v245 offset:34880
    v_cvt_pk_bf16_f32 v212, v164, v165
    v_mfma_f32_16x16x32_bf16 v[176:179], a[144:147], v[92:95], 0
    ds_read_b64_tr_b16 a[180:181], v245 offset:36928
    v_cvt_pk_bf16_f32 v213, v166, v167
    v_mfma_f32_16x16x32_bf16 v[176:179], a[148:151], v[104:107], v[176:179]
    ds_read_b64_tr_b16 a[182:183], v245 offset:38976
    v_cvt_pk_bf16_f32 v216, v168, v169
    v_mfma_f32_16x16x32_bf16 v[176:179], a[152:155], v[116:119], v[176:179]
    ds_read_b64_tr_b16 a[184:185], v245 offset:41024
    v_cvt_pk_bf16_f32 v217, v170, v171
    v_mfma_f32_16x16x32_bf16 v[176:179], a[156:159], v[128:131], v[176:179]
    ds_read_b64_tr_b16 a[186:187], v245 offset:43072
    v_mfma_f32_16x16x32_bf16 v[176:179], a[160:163], v[140:143], v[176:179]
    ds_read_b64_tr_b16 a[188:189], v245 offset:45120
    v_mfma_f32_16x16x32_bf16 v[176:179], a[164:167], v[152:155], v[176:179]
    ds_read_b64_tr_b16 a[190:191], v245 offset:47168
    v_mfma_f32_16x16x32_bf16 v[180:183], a[144:147], v[96:99], 0
    v_mfma_f32_16x16x32_bf16 v[180:183], a[148:151], v[108:111], v[180:183]
    v_mfma_f32_16x16x32_bf16 v[180:183], a[152:155], v[120:123], v[180:183]
    s_add_u32 m0, s29, 49280
    s_mov_b32 s36, 512
    v_mfma_f32_16x16x32_bf16 v[180:183], a[156:159], v[132:135], v[180:183]
    buffer_load_dwordx4 v8, s[16:19], s36 offen offset:0 lds
    v_mfma_f32_16x16x32_bf16 v[180:183], a[160:163], v[144:147], v[180:183]
    v_mfma_f32_16x16x32_bf16 v[180:183], a[164:167], v[156:159], v[180:183]
    s_waitcnt lgkmcnt(0)
    v_mfma_f32_16x16x32_bf16 v[172:175], a[168:171], a[192:195], v[172:175]
    ds_read_b64_tr_b16 a[144:145], v250 offset:24640
    v_mfma_f32_16x16x32_bf16 v[172:175], a[172:175], a[204:207], v[172:175]
    ds_read_b64_tr_b16 a[146:147], v250 offset:26688
    v_mfma_f32_16x16x32_bf16 v[172:175], a[176:179], a[216:219], v[172:175]
    ds_read_b64_tr_b16 a[148:149], v250 offset:28736
    v_mfma_f32_16x16x32_bf16 v[172:175], a[180:183], a[228:231], v[172:175]
    ds_read_b64_tr_b16 a[150:151], v250 offset:30784
    v_mfma_f32_16x16x32_bf16 v[172:175], a[184:187], a[240:243], v[172:175]
    ds_read_b64_tr_b16 a[152:153], v250 offset:32832
    v_mfma_f32_16x16x32_bf16 v[172:175], a[188:191], a[252:255], v[172:175]
    ds_read_b64_tr_b16 a[154:155], v250 offset:34880
    v_mfma_f32_16x16x32_bf16 v[176:179], a[168:171], a[196:199], v[176:179]
    ds_read_b64_tr_b16 a[156:157], v250 offset:36928
    v_mfma_f32_16x16x32_bf16 v[176:179], a[172:175], a[208:211], v[176:179]
    ds_read_b64_tr_b16 a[158:159], v250 offset:38976
    v_mfma_f32_16x16x32_bf16 v[176:179], a[176:179], a[220:223], v[176:179]
    ds_read_b64_tr_b16 a[160:161], v250 offset:41024
    v_mfma_f32_16x16x32_bf16 v[176:179], a[180:183], a[232:235], v[176:179]
    ds_read_b64_tr_b16 a[162:163], v250 offset:43072
    v_mfma_f32_16x16x32_bf16 v[176:179], a[184:187], a[244:247], v[176:179]
    ds_read_b64_tr_b16 a[164:165], v250 offset:45120
    v_mfma_f32_16x16x32_bf16 v[176:179], a[188:191], a[0:3], v[176:179]
    ds_read_b64_tr_b16 a[166:167], v250 offset:47168
    v_mfma_f32_16x16x32_bf16 v[180:183], a[168:171], a[200:203], v[180:183]
    buffer_load_dwordx4 v9, s[16:19], s36 offen offset:1024 lds
    v_mfma_f32_16x16x32_bf16 v[180:183], a[172:175], a[212:215], v[180:183]
    v_mfma_f32_16x16x32_bf16 v[180:183], a[176:179], a[224:227], v[180:183]
    v_mfma_f32_16x16x32_bf16 v[180:183], a[180:183], a[236:239], v[180:183]
    buffer_load_dwordx4 v10, s[16:19], s36 offen offset:2048 lds
    v_mfma_f32_16x16x32_bf16 v[180:183], a[184:187], a[248:251], v[180:183]
    v_mfma_f32_16x16x32_bf16 v[180:183], a[188:191], a[4:7], v[180:183]
    s_waitcnt lgkmcnt(0)
    v_mfma_f32_16x16x32_bf16 v[160:163], a[144:147], v[88:91], 0
    ds_read_b64_tr_b16 a[168:169], v246 offset:24640
    v_mfma_f32_16x16x32_bf16 v[160:163], a[148:151], v[100:103], v[160:163]
    ds_read_b64_tr_b16 a[170:171], v246 offset:26688
    v_mfma_f32_16x16x32_bf16 v[160:163], a[152:155], v[112:115], v[160:163]
    ds_read_b64_tr_b16 a[172:173], v246 offset:28736
    v_mfma_f32_16x16x32_bf16 v[160:163], a[156:159], v[124:127], v[160:163]
    ds_read_b64_tr_b16 a[174:175], v246 offset:30784
    v_cvt_pk_bf16_f32 v210, v172, v173
    v_mfma_f32_16x16x32_bf16 v[160:163], a[160:163], v[136:139], v[160:163]
    ds_read_b64_tr_b16 a[176:177], v246 offset:32832
    v_cvt_pk_bf16_f32 v211, v174, v175
    v_mfma_f32_16x16x32_bf16 v[160:163], a[164:167], v[148:151], v[160:163]
    ds_read_b64_tr_b16 a[178:179], v246 offset:34880
    v_cvt_pk_bf16_f32 v214, v176, v177
    v_mfma_f32_16x16x32_bf16 v[164:167], a[144:147], v[92:95], 0
    ds_read_b64_tr_b16 a[180:181], v246 offset:36928
    v_cvt_pk_bf16_f32 v215, v178, v179
    v_mfma_f32_16x16x32_bf16 v[164:167], a[148:151], v[104:107], v[164:167]
    ds_read_b64_tr_b16 a[182:183], v246 offset:38976
    v_cvt_pk_bf16_f32 v218, v180, v181
    v_mfma_f32_16x16x32_bf16 v[164:167], a[152:155], v[116:119], v[164:167]
    ds_read_b64_tr_b16 a[184:185], v246 offset:41024
    v_cvt_pk_bf16_f32 v219, v182, v183
    v_mfma_f32_16x16x32_bf16 v[164:167], a[156:159], v[128:131], v[164:167]
    ds_read_b64_tr_b16 a[186:187], v246 offset:43072
    v_mfma_f32_16x16x32_bf16 v[164:167], a[160:163], v[140:143], v[164:167]
    ds_read_b64_tr_b16 a[188:189], v246 offset:45120
    s_mov_b32 s45, 49152
    v_mfma_f32_16x16x32_bf16 v[164:167], a[164:167], v[152:155], v[164:167]
    ds_read_b64_tr_b16 a[190:191], v246 offset:47168
    buffer_store_dwordx4 v[208:211], v32, s[20:23], s45 offen offset:0 sc1
    v_mfma_f32_16x16x32_bf16 v[168:171], a[144:147], v[96:99], 0
    buffer_store_dwordx4 v[212:215], v32, s[20:23], s45 offen offset:1024 sc1
    v_mfma_f32_16x16x32_bf16 v[168:171], a[148:151], v[108:111], v[168:171]
    buffer_store_dwordx4 v[216:219], v32, s[20:23], s45 offen offset:2048 sc1
    v_mfma_f32_16x16x32_bf16 v[168:171], a[152:155], v[120:123], v[168:171]
    buffer_load_dwordx4 v11, s[16:19], s36 offen offset:3072 lds
    v_mfma_f32_16x16x32_bf16 v[168:171], a[156:159], v[132:135], v[168:171]
    v_mfma_f32_16x16x32_bf16 v[168:171], a[160:163], v[144:147], v[168:171]
    s_add_u32 m0, s29, 53376
    v_mfma_f32_16x16x32_bf16 v[168:171], a[164:167], v[156:159], v[168:171]
    buffer_load_dwordx4 v12, s[16:19], s36 offen offset:0 lds
    s_waitcnt lgkmcnt(0)
    v_mfma_f32_16x16x32_bf16 v[160:163], a[168:171], a[192:195], v[160:163]
    ds_read_b64_tr_b16 a[144:145], v251 offset:24640
    v_mfma_f32_16x16x32_bf16 v[160:163], a[172:175], a[204:207], v[160:163]
    ds_read_b64_tr_b16 a[146:147], v251 offset:26688
    v_mfma_f32_16x16x32_bf16 v[160:163], a[176:179], a[216:219], v[160:163]
    ds_read_b64_tr_b16 a[148:149], v251 offset:28736
    v_mfma_f32_16x16x32_bf16 v[160:163], a[180:183], a[228:231], v[160:163]
    ds_read_b64_tr_b16 a[150:151], v251 offset:30784
    v_mfma_f32_16x16x32_bf16 v[160:163], a[184:187], a[240:243], v[160:163]
    ds_read_b64_tr_b16 a[152:153], v251 offset:32832
    v_mfma_f32_16x16x32_bf16 v[160:163], a[188:191], a[252:255], v[160:163]
    ds_read_b64_tr_b16 a[154:155], v251 offset:34880
    v_mfma_f32_16x16x32_bf16 v[164:167], a[168:171], a[196:199], v[164:167]
    ds_read_b64_tr_b16 a[156:157], v251 offset:36928
    v_mfma_f32_16x16x32_bf16 v[164:167], a[172:175], a[208:211], v[164:167]
    ds_read_b64_tr_b16 a[158:159], v251 offset:38976
    v_mfma_f32_16x16x32_bf16 v[164:167], a[176:179], a[220:223], v[164:167]
    ds_read_b64_tr_b16 a[160:161], v251 offset:41024
    v_mfma_f32_16x16x32_bf16 v[164:167], a[180:183], a[232:235], v[164:167]
    ds_read_b64_tr_b16 a[162:163], v251 offset:43072
    v_mfma_f32_16x16x32_bf16 v[164:167], a[184:187], a[244:247], v[164:167]
    ds_read_b64_tr_b16 a[164:165], v251 offset:45120
    v_mfma_f32_16x16x32_bf16 v[164:167], a[188:191], a[0:3], v[164:167]
    ds_read_b64_tr_b16 a[166:167], v251 offset:47168
    v_mfma_f32_16x16x32_bf16 v[168:171], a[168:171], a[200:203], v[168:171]
    v_mfma_f32_16x16x32_bf16 v[168:171], a[172:175], a[212:215], v[168:171]
    v_mfma_f32_16x16x32_bf16 v[168:171], a[176:179], a[224:227], v[168:171]
    buffer_load_dwordx4 v13, s[16:19], s36 offen offset:1024 lds
    v_mfma_f32_16x16x32_bf16 v[168:171], a[180:183], a[236:239], v[168:171]
    v_mfma_f32_16x16x32_bf16 v[168:171], a[184:187], a[248:251], v[168:171]
    v_mfma_f32_16x16x32_bf16 v[168:171], a[188:191], a[4:7], v[168:171]
    s_waitcnt lgkmcnt(0)
    v_mfma_f32_16x16x32_bf16 v[172:175], a[144:147], v[88:91], 0
    ds_read_b64_tr_b16 a[168:169], v247 offset:24640
    v_mfma_f32_16x16x32_bf16 v[172:175], a[148:151], v[100:103], v[172:175]
    ds_read_b64_tr_b16 a[170:171], v247 offset:26688
    v_mfma_f32_16x16x32_bf16 v[172:175], a[152:155], v[112:115], v[172:175]
    ds_read_b64_tr_b16 a[172:173], v247 offset:28736
    v_mfma_f32_16x16x32_bf16 v[172:175], a[156:159], v[124:127], v[172:175]
    ds_read_b64_tr_b16 a[174:175], v247 offset:30784
    v_cvt_pk_bf16_f32 v220, v160, v161
    v_mfma_f32_16x16x32_bf16 v[172:175], a[160:163], v[136:139], v[172:175]
    ds_read_b64_tr_b16 a[176:177], v247 offset:32832
    v_cvt_pk_bf16_f32 v221, v162, v163
    v_mfma_f32_16x16x32_bf16 v[172:175], a[164:167], v[148:151], v[172:175]
    ds_read_b64_tr_b16 a[178:179], v247 offset:34880
    v_cvt_pk_bf16_f32 v224, v164, v165
    v_mfma_f32_16x16x32_bf16 v[176:179], a[144:147], v[92:95], 0
    ds_read_b64_tr_b16 a[180:181], v247 offset:36928
    v_cvt_pk_bf16_f32 v225, v166, v167
    v_mfma_f32_16x16x32_bf16 v[176:179], a[148:151], v[104:107], v[176:179]
    ds_read_b64_tr_b16 a[182:183], v247 offset:38976
    v_cvt_pk_bf16_f32 v228, v168, v169
    v_mfma_f32_16x16x32_bf16 v[176:179], a[152:155], v[116:119], v[176:179]
    ds_read_b64_tr_b16 a[184:185], v247 offset:41024
    v_cvt_pk_bf16_f32 v229, v170, v171
    v_mfma_f32_16x16x32_bf16 v[176:179], a[156:159], v[128:131], v[176:179]
    ds_read_b64_tr_b16 a[186:187], v247 offset:43072
    v_mfma_f32_16x16x32_bf16 v[176:179], a[160:163], v[140:143], v[176:179]
    ds_read_b64_tr_b16 a[188:189], v247 offset:45120
    v_mfma_f32_16x16x32_bf16 v[176:179], a[164:167], v[152:155], v[176:179]
    ds_read_b64_tr_b16 a[190:191], v247 offset:47168
    v_mfma_f32_16x16x32_bf16 v[180:183], a[144:147], v[96:99], 0
    v_mfma_f32_16x16x32_bf16 v[180:183], a[148:151], v[108:111], v[180:183]
    v_mfma_f32_16x16x32_bf16 v[180:183], a[152:155], v[120:123], v[180:183]
    v_mfma_f32_16x16x32_bf16 v[180:183], a[156:159], v[132:135], v[180:183]
    v_mfma_f32_16x16x32_bf16 v[180:183], a[160:163], v[144:147], v[180:183]
    v_mfma_f32_16x16x32_bf16 v[180:183], a[164:167], v[156:159], v[180:183]
    s_waitcnt vmcnt(18)
    s_waitcnt lgkmcnt(0)
    s_barrier
    v_mfma_f32_16x16x32_bf16 v[172:175], a[168:171], a[192:195], v[172:175]
    ds_read_b64_tr_b16 a[144:145], v252 offset:0
    v_mfma_f32_16x16x32_bf16 v[172:175], a[172:175], a[204:207], v[172:175]
    ds_read_b64_tr_b16 a[146:147], v252 offset:2048
    v_mfma_f32_16x16x32_bf16 v[172:175], a[176:179], a[216:219], v[172:175]
    ds_read_b64_tr_b16 a[148:149], v252 offset:4096
    v_mfma_f32_16x16x32_bf16 v[172:175], a[180:183], a[228:231], v[172:175]
    ds_read_b64_tr_b16 a[150:151], v252 offset:6144
    v_mfma_f32_16x16x32_bf16 v[172:175], a[184:187], a[240:243], v[172:175]
    ds_read_b64_tr_b16 a[152:153], v252 offset:8192
    v_mfma_f32_16x16x32_bf16 v[172:175], a[188:191], a[252:255], v[172:175]
    ds_read_b64_tr_b16 a[154:155], v252 offset:10240
    v_mfma_f32_16x16x32_bf16 v[176:179], a[168:171], a[196:199], v[176:179]
    ds_read_b64_tr_b16 a[156:157], v252 offset:12288
    v_mfma_f32_16x16x32_bf16 v[176:179], a[172:175], a[208:211], v[176:179]
    ds_read_b64_tr_b16 a[158:159], v252 offset:14336
    v_mfma_f32_16x16x32_bf16 v[176:179], a[176:179], a[220:223], v[176:179]
    ds_read_b64_tr_b16 a[160:161], v252 offset:16384
    v_mfma_f32_16x16x32_bf16 v[176:179], a[180:183], a[232:235], v[176:179]
    ds_read_b64_tr_b16 a[162:163], v252 offset:18432
    v_mfma_f32_16x16x32_bf16 v[176:179], a[184:187], a[244:247], v[176:179]
    ds_read_b64_tr_b16 a[164:165], v252 offset:20480
    v_mfma_f32_16x16x32_bf16 v[176:179], a[188:191], a[0:3], v[176:179]
    ds_read_b64_tr_b16 a[166:167], v252 offset:22528
    s_add_u32 m0, s29, 73920
    s_mov_b32 s35, 640
    v_mfma_f32_16x16x32_bf16 v[180:183], a[168:171], a[200:203], v[180:183]
    buffer_load_dwordx4 v8, s[12:15], s35 offen offset:0 lds
    v_mfma_f32_16x16x32_bf16 v[180:183], a[172:175], a[212:215], v[180:183]
    v_mfma_f32_16x16x32_bf16 v[180:183], a[176:179], a[224:227], v[180:183]
    v_mfma_f32_16x16x32_bf16 v[180:183], a[180:183], a[236:239], v[180:183]
    buffer_load_dwordx4 v9, s[12:15], s35 offen offset:1024 lds
    v_mfma_f32_16x16x32_bf16 v[180:183], a[184:187], a[248:251], v[180:183]
    v_mfma_f32_16x16x32_bf16 v[180:183], a[188:191], a[4:7], v[180:183]
    s_waitcnt lgkmcnt(0)
    v_mfma_f32_16x16x32_bf16 v[160:163], a[144:147], v[88:91], 0
    ds_read_b64_tr_b16 a[168:169], v244 offset:0
    v_mfma_f32_16x16x32_bf16 v[160:163], a[148:151], v[100:103], v[160:163]
    ds_read_b64_tr_b16 a[170:171], v244 offset:2048
    v_mfma_f32_16x16x32_bf16 v[160:163], a[152:155], v[112:115], v[160:163]
    ds_read_b64_tr_b16 a[172:173], v244 offset:4096
    v_mfma_f32_16x16x32_bf16 v[160:163], a[156:159], v[124:127], v[160:163]
    ds_read_b64_tr_b16 a[174:175], v244 offset:6144
    v_cvt_pk_bf16_f32 v222, v172, v173
    v_mfma_f32_16x16x32_bf16 v[160:163], a[160:163], v[136:139], v[160:163]
    ds_read_b64_tr_b16 a[176:177], v244 offset:8192
    v_cvt_pk_bf16_f32 v223, v174, v175
    v_mfma_f32_16x16x32_bf16 v[160:163], a[164:167], v[148:151], v[160:163]
    ds_read_b64_tr_b16 a[178:179], v244 offset:10240
    v_cvt_pk_bf16_f32 v226, v176, v177
    v_mfma_f32_16x16x32_bf16 v[164:167], a[144:147], v[92:95], 0
    ds_read_b64_tr_b16 a[180:181], v244 offset:12288
    v_cvt_pk_bf16_f32 v227, v178, v179
    v_mfma_f32_16x16x32_bf16 v[164:167], a[148:151], v[104:107], v[164:167]
    ds_read_b64_tr_b16 a[182:183], v244 offset:14336
    v_cvt_pk_bf16_f32 v230, v180, v181
    v_mfma_f32_16x16x32_bf16 v[164:167], a[152:155], v[116:119], v[164:167]
    ds_read_b64_tr_b16 a[184:185], v244 offset:16384
    v_cvt_pk_bf16_f32 v231, v182, v183
    v_mfma_f32_16x16x32_bf16 v[164:167], a[156:159], v[128:131], v[164:167]
    ds_read_b64_tr_b16 a[186:187], v244 offset:18432
    v_mfma_f32_16x16x32_bf16 v[164:167], a[160:163], v[140:143], v[164:167]
    ds_read_b64_tr_b16 a[188:189], v244 offset:20480
    s_mov_b32 s45, 61440
    v_mfma_f32_16x16x32_bf16 v[164:167], a[164:167], v[152:155], v[164:167]
    ds_read_b64_tr_b16 a[190:191], v244 offset:22528
    buffer_store_dwordx4 v[220:223], v32, s[20:23], s45 offen offset:0 sc1
    v_mfma_f32_16x16x32_bf16 v[168:171], a[144:147], v[96:99], 0
    buffer_store_dwordx4 v[224:227], v32, s[20:23], s45 offen offset:1024 sc1
    v_mfma_f32_16x16x32_bf16 v[168:171], a[148:151], v[108:111], v[168:171]
    buffer_store_dwordx4 v[228:231], v32, s[20:23], s45 offen offset:2048 sc1
    v_mfma_f32_16x16x32_bf16 v[168:171], a[152:155], v[120:123], v[168:171]
    buffer_load_dwordx4 v10, s[12:15], s35 offen offset:2048 lds
    v_mfma_f32_16x16x32_bf16 v[168:171], a[156:159], v[132:135], v[168:171]
    v_mfma_f32_16x16x32_bf16 v[168:171], a[160:163], v[144:147], v[168:171]
    v_mfma_f32_16x16x32_bf16 v[168:171], a[164:167], v[156:159], v[168:171]
    buffer_load_dwordx4 v11, s[12:15], s35 offen offset:3072 lds
    s_waitcnt lgkmcnt(0)
    v_mfma_f32_16x16x32_bf16 v[160:163], a[168:171], a[192:195], v[160:163]
    ds_read_b64_tr_b16 a[144:145], v253 offset:0
    v_mfma_f32_16x16x32_bf16 v[160:163], a[172:175], a[204:207], v[160:163]
    ds_read_b64_tr_b16 a[146:147], v253 offset:2048
    v_mfma_f32_16x16x32_bf16 v[160:163], a[176:179], a[216:219], v[160:163]
    ds_read_b64_tr_b16 a[148:149], v253 offset:4096
    v_mfma_f32_16x16x32_bf16 v[160:163], a[180:183], a[228:231], v[160:163]
    ds_read_b64_tr_b16 a[150:151], v253 offset:6144
    v_mfma_f32_16x16x32_bf16 v[160:163], a[184:187], a[240:243], v[160:163]
    ds_read_b64_tr_b16 a[152:153], v253 offset:8192
    v_mfma_f32_16x16x32_bf16 v[160:163], a[188:191], a[252:255], v[160:163]
    ds_read_b64_tr_b16 a[154:155], v253 offset:10240
    v_mfma_f32_16x16x32_bf16 v[164:167], a[168:171], a[196:199], v[164:167]
    ds_read_b64_tr_b16 a[156:157], v253 offset:12288
    v_mfma_f32_16x16x32_bf16 v[164:167], a[172:175], a[208:211], v[164:167]
    ds_read_b64_tr_b16 a[158:159], v253 offset:14336
    v_mfma_f32_16x16x32_bf16 v[164:167], a[176:179], a[220:223], v[164:167]
    ds_read_b64_tr_b16 a[160:161], v253 offset:16384
    v_mfma_f32_16x16x32_bf16 v[164:167], a[180:183], a[232:235], v[164:167]
    ds_read_b64_tr_b16 a[162:163], v253 offset:18432
    v_mfma_f32_16x16x32_bf16 v[164:167], a[184:187], a[244:247], v[164:167]
    ds_read_b64_tr_b16 a[164:165], v253 offset:20480
    v_mfma_f32_16x16x32_bf16 v[164:167], a[188:191], a[0:3], v[164:167]
    ds_read_b64_tr_b16 a[166:167], v253 offset:22528
    v_mfma_f32_16x16x32_bf16 v[168:171], a[168:171], a[200:203], v[168:171]
    v_mfma_f32_16x16x32_bf16 v[168:171], a[172:175], a[212:215], v[168:171]
    s_add_u32 m0, s29, 78016
    v_mfma_f32_16x16x32_bf16 v[168:171], a[176:179], a[224:227], v[168:171]
    buffer_load_dwordx4 v12, s[12:15], s35 offen offset:0 lds
    v_mfma_f32_16x16x32_bf16 v[168:171], a[180:183], a[236:239], v[168:171]
    v_mfma_f32_16x16x32_bf16 v[168:171], a[184:187], a[248:251], v[168:171]
    v_mfma_f32_16x16x32_bf16 v[168:171], a[188:191], a[4:7], v[168:171]
    buffer_load_dwordx4 v13, s[12:15], s35 offen offset:1024 lds
    s_waitcnt lgkmcnt(0)
    v_mfma_f32_16x16x32_bf16 v[172:175], a[144:147], v[88:91], 0
    ds_read_b64_tr_b16 a[168:169], v245 offset:0
    v_mfma_f32_16x16x32_bf16 v[172:175], a[148:151], v[100:103], v[172:175]
    ds_read_b64_tr_b16 a[170:171], v245 offset:2048
    v_mfma_f32_16x16x32_bf16 v[172:175], a[152:155], v[112:115], v[172:175]
    ds_read_b64_tr_b16 a[172:173], v245 offset:4096
    v_mfma_f32_16x16x32_bf16 v[172:175], a[156:159], v[124:127], v[172:175]
    ds_read_b64_tr_b16 a[174:175], v245 offset:6144
    v_cvt_pk_bf16_f32 v64, v160, v161
    v_mfma_f32_16x16x32_bf16 v[172:175], a[160:163], v[136:139], v[172:175]
    ds_read_b64_tr_b16 a[176:177], v245 offset:8192
    v_cvt_pk_bf16_f32 v65, v162, v163
    v_mfma_f32_16x16x32_bf16 v[172:175], a[164:167], v[148:151], v[172:175]
    ds_read_b64_tr_b16 a[178:179], v245 offset:10240
    v_cvt_pk_bf16_f32 v68, v164, v165
    v_mfma_f32_16x16x32_bf16 v[176:179], a[144:147], v[92:95], 0
    ds_read_b64_tr_b16 a[180:181], v245 offset:12288
    v_cvt_pk_bf16_f32 v69, v166, v167
    v_mfma_f32_16x16x32_bf16 v[176:179], a[148:151], v[104:107], v[176:179]
    ds_read_b64_tr_b16 a[182:183], v245 offset:14336
    v_cvt_pk_bf16_f32 v72, v168, v169
    v_mfma_f32_16x16x32_bf16 v[176:179], a[152:155], v[116:119], v[176:179]
    ds_read_b64_tr_b16 a[184:185], v245 offset:16384
    v_cvt_pk_bf16_f32 v73, v170, v171
    v_mfma_f32_16x16x32_bf16 v[176:179], a[156:159], v[128:131], v[176:179]
    ds_read_b64_tr_b16 a[186:187], v245 offset:18432
    v_mfma_f32_16x16x32_bf16 v[176:179], a[160:163], v[140:143], v[176:179]
    ds_read_b64_tr_b16 a[188:189], v245 offset:20480
    v_mfma_f32_16x16x32_bf16 v[176:179], a[164:167], v[152:155], v[176:179]
    ds_read_b64_tr_b16 a[190:191], v245 offset:22528
    v_mfma_f32_16x16x32_bf16 v[180:183], a[144:147], v[96:99], 0
    v_mfma_f32_16x16x32_bf16 v[180:183], a[148:151], v[108:111], v[180:183]
    v_mfma_f32_16x16x32_bf16 v[180:183], a[152:155], v[120:123], v[180:183]
    s_add_u32 m0, s29, 24640
    s_mov_b32 s36, 640
    v_mfma_f32_16x16x32_bf16 v[180:183], a[156:159], v[132:135], v[180:183]
    buffer_load_dwordx4 v8, s[16:19], s36 offen offset:0 lds
    v_mfma_f32_16x16x32_bf16 v[180:183], a[160:163], v[144:147], v[180:183]
    v_mfma_f32_16x16x32_bf16 v[180:183], a[164:167], v[156:159], v[180:183]
    s_waitcnt lgkmcnt(0)
    v_mfma_f32_16x16x32_bf16 v[172:175], a[168:171], a[192:195], v[172:175]
    ds_read_b64_tr_b16 a[144:145], v254 offset:0
    v_mfma_f32_16x16x32_bf16 v[172:175], a[172:175], a[204:207], v[172:175]
    ds_read_b64_tr_b16 a[146:147], v254 offset:2048
    v_mfma_f32_16x16x32_bf16 v[172:175], a[176:179], a[216:219], v[172:175]
    ds_read_b64_tr_b16 a[148:149], v254 offset:4096
    v_mfma_f32_16x16x32_bf16 v[172:175], a[180:183], a[228:231], v[172:175]
    ds_read_b64_tr_b16 a[150:151], v254 offset:6144
    v_mfma_f32_16x16x32_bf16 v[172:175], a[184:187], a[240:243], v[172:175]
    ds_read_b64_tr_b16 a[152:153], v254 offset:8192
    v_mfma_f32_16x16x32_bf16 v[172:175], a[188:191], a[252:255], v[172:175]
    ds_read_b64_tr_b16 a[154:155], v254 offset:10240
    v_mfma_f32_16x16x32_bf16 v[176:179], a[168:171], a[196:199], v[176:179]
    ds_read_b64_tr_b16 a[156:157], v254 offset:12288
    v_mfma_f32_16x16x32_bf16 v[176:179], a[172:175], a[208:211], v[176:179]
    ds_read_b64_tr_b16 a[158:159], v254 offset:14336
    v_mfma_f32_16x16x32_bf16 v[176:179], a[176:179], a[220:223], v[176:179]
    ds_read_b64_tr_b16 a[160:161], v254 offset:16384
    v_mfma_f32_16x16x32_bf16 v[176:179], a[180:183], a[232:235], v[176:179]
    ds_read_b64_tr_b16 a[162:163], v254 offset:18432
    v_mfma_f32_16x16x32_bf16 v[176:179], a[184:187], a[244:247], v[176:179]
    ds_read_b64_tr_b16 a[164:165], v254 offset:20480
    v_mfma_f32_16x16x32_bf16 v[176:179], a[188:191], a[0:3], v[176:179]
    ds_read_b64_tr_b16 a[166:167], v254 offset:22528
    v_mfma_f32_16x16x32_bf16 v[180:183], a[168:171], a[200:203], v[180:183]
    buffer_load_dwordx4 v9, s[16:19], s36 offen offset:1024 lds
    v_mfma_f32_16x16x32_bf16 v[180:183], a[172:175], a[212:215], v[180:183]
    v_mfma_f32_16x16x32_bf16 v[180:183], a[176:179], a[224:227], v[180:183]
    v_mfma_f32_16x16x32_bf16 v[180:183], a[180:183], a[236:239], v[180:183]
    buffer_load_dwordx4 v10, s[16:19], s36 offen offset:2048 lds
    v_mfma_f32_16x16x32_bf16 v[180:183], a[184:187], a[248:251], v[180:183]
    v_mfma_f32_16x16x32_bf16 v[180:183], a[188:191], a[4:7], v[180:183]
    s_waitcnt lgkmcnt(0)
    v_mfma_f32_16x16x32_bf16 v[160:163], a[144:147], v[88:91], 0
    ds_read_b64_tr_b16 a[168:169], v246 offset:0
    v_mfma_f32_16x16x32_bf16 v[160:163], a[148:151], v[100:103], v[160:163]
    ds_read_b64_tr_b16 a[170:171], v246 offset:2048
    v_mfma_f32_16x16x32_bf16 v[160:163], a[152:155], v[112:115], v[160:163]
    ds_read_b64_tr_b16 a[172:173], v246 offset:4096
    v_mfma_f32_16x16x32_bf16 v[160:163], a[156:159], v[124:127], v[160:163]
    ds_read_b64_tr_b16 a[174:175], v246 offset:6144
    v_cvt_pk_bf16_f32 v66, v172, v173
    v_mfma_f32_16x16x32_bf16 v[160:163], a[160:163], v[136:139], v[160:163]
    ds_read_b64_tr_b16 a[176:177], v246 offset:8192
    v_cvt_pk_bf16_f32 v67, v174, v175
    v_mfma_f32_16x16x32_bf16 v[160:163], a[164:167], v[148:151], v[160:163]
    ds_read_b64_tr_b16 a[178:179], v246 offset:10240
    v_cvt_pk_bf16_f32 v70, v176, v177
    v_mfma_f32_16x16x32_bf16 v[164:167], a[144:147], v[92:95], 0
    ds_read_b64_tr_b16 a[180:181], v246 offset:12288
    v_cvt_pk_bf16_f32 v71, v178, v179
    v_mfma_f32_16x16x32_bf16 v[164:167], a[148:151], v[104:107], v[164:167]
    ds_read_b64_tr_b16 a[182:183], v246 offset:14336
    v_cvt_pk_bf16_f32 v74, v180, v181
    v_mfma_f32_16x16x32_bf16 v[164:167], a[152:155], v[116:119], v[164:167]
    ds_read_b64_tr_b16 a[184:185], v246 offset:16384
    v_cvt_pk_bf16_f32 v75, v182, v183
    v_mfma_f32_16x16x32_bf16 v[164:167], a[156:159], v[128:131], v[164:167]
    ds_read_b64_tr_b16 a[186:187], v246 offset:18432
    v_mfma_f32_16x16x32_bf16 v[164:167], a[160:163], v[140:143], v[164:167]
    ds_read_b64_tr_b16 a[188:189], v246 offset:20480
    s_mov_b32 s45, 73728
    v_mfma_f32_16x16x32_bf16 v[164:167], a[164:167], v[152:155], v[164:167]
    ds_read_b64_tr_b16 a[190:191], v246 offset:22528
    buffer_store_dwordx4 v[64:67], v32, s[20:23], s45 offen offset:0 sc1
    v_mfma_f32_16x16x32_bf16 v[168:171], a[144:147], v[96:99], 0
    buffer_store_dwordx4 v[68:71], v32, s[20:23], s45 offen offset:1024 sc1
    v_mfma_f32_16x16x32_bf16 v[168:171], a[148:151], v[108:111], v[168:171]
    buffer_store_dwordx4 v[72:75], v32, s[20:23], s45 offen offset:2048 sc1
    v_mfma_f32_16x16x32_bf16 v[168:171], a[152:155], v[120:123], v[168:171]
    buffer_load_dwordx4 v11, s[16:19], s36 offen offset:3072 lds
    v_mfma_f32_16x16x32_bf16 v[168:171], a[156:159], v[132:135], v[168:171]
    v_mfma_f32_16x16x32_bf16 v[168:171], a[160:163], v[144:147], v[168:171]
    s_add_u32 m0, s29, 28736
    v_mfma_f32_16x16x32_bf16 v[168:171], a[164:167], v[156:159], v[168:171]
    buffer_load_dwordx4 v12, s[16:19], s36 offen offset:0 lds
    s_waitcnt lgkmcnt(0)
    v_mfma_f32_16x16x32_bf16 v[160:163], a[168:171], a[192:195], v[160:163]
    ds_read_b64_tr_b16 a[144:145], v255 offset:0
    v_mfma_f32_16x16x32_bf16 v[160:163], a[172:175], a[204:207], v[160:163]
    ds_read_b64_tr_b16 a[146:147], v255 offset:2048
    v_mfma_f32_16x16x32_bf16 v[160:163], a[176:179], a[216:219], v[160:163]
    ds_read_b64_tr_b16 a[148:149], v255 offset:4096
    v_mfma_f32_16x16x32_bf16 v[160:163], a[180:183], a[228:231], v[160:163]
    ds_read_b64_tr_b16 a[150:151], v255 offset:6144
    v_mfma_f32_16x16x32_bf16 v[160:163], a[184:187], a[240:243], v[160:163]
    ds_read_b64_tr_b16 a[152:153], v255 offset:8192
    v_mfma_f32_16x16x32_bf16 v[160:163], a[188:191], a[252:255], v[160:163]
    ds_read_b64_tr_b16 a[154:155], v255 offset:10240
    v_mfma_f32_16x16x32_bf16 v[164:167], a[168:171], a[196:199], v[164:167]
    ds_read_b64_tr_b16 a[156:157], v255 offset:12288
    v_mfma_f32_16x16x32_bf16 v[164:167], a[172:175], a[208:211], v[164:167]
    ds_read_b64_tr_b16 a[158:159], v255 offset:14336
    v_mfma_f32_16x16x32_bf16 v[164:167], a[176:179], a[220:223], v[164:167]
    ds_read_b64_tr_b16 a[160:161], v255 offset:16384
    v_mfma_f32_16x16x32_bf16 v[164:167], a[180:183], a[232:235], v[164:167]
    ds_read_b64_tr_b16 a[162:163], v255 offset:18432
    v_mfma_f32_16x16x32_bf16 v[164:167], a[184:187], a[244:247], v[164:167]
    ds_read_b64_tr_b16 a[164:165], v255 offset:20480
    v_mfma_f32_16x16x32_bf16 v[164:167], a[188:191], a[0:3], v[164:167]
    ds_read_b64_tr_b16 a[166:167], v255 offset:22528
    v_mfma_f32_16x16x32_bf16 v[168:171], a[168:171], a[200:203], v[168:171]
    v_mfma_f32_16x16x32_bf16 v[168:171], a[172:175], a[212:215], v[168:171]
    v_mfma_f32_16x16x32_bf16 v[168:171], a[176:179], a[224:227], v[168:171]
    buffer_load_dwordx4 v13, s[16:19], s36 offen offset:1024 lds
    v_mfma_f32_16x16x32_bf16 v[168:171], a[180:183], a[236:239], v[168:171]
    v_mfma_f32_16x16x32_bf16 v[168:171], a[184:187], a[248:251], v[168:171]
    v_mfma_f32_16x16x32_bf16 v[168:171], a[188:191], a[4:7], v[168:171]
    s_waitcnt lgkmcnt(0)
    v_mfma_f32_16x16x32_bf16 v[172:175], a[144:147], v[88:91], 0
    ds_read_b64_tr_b16 a[168:169], v247 offset:0
    v_mfma_f32_16x16x32_bf16 v[172:175], a[148:151], v[100:103], v[172:175]
    ds_read_b64_tr_b16 a[170:171], v247 offset:2048
    v_mfma_f32_16x16x32_bf16 v[172:175], a[152:155], v[112:115], v[172:175]
    ds_read_b64_tr_b16 a[172:173], v247 offset:4096
    v_mfma_f32_16x16x32_bf16 v[172:175], a[156:159], v[124:127], v[172:175]
    ds_read_b64_tr_b16 a[174:175], v247 offset:6144
    v_cvt_pk_bf16_f32 v76, v160, v161
    v_mfma_f32_16x16x32_bf16 v[172:175], a[160:163], v[136:139], v[172:175]
    ds_read_b64_tr_b16 a[176:177], v247 offset:8192
    v_cvt_pk_bf16_f32 v77, v162, v163
    v_mfma_f32_16x16x32_bf16 v[172:175], a[164:167], v[148:151], v[172:175]
    ds_read_b64_tr_b16 a[178:179], v247 offset:10240
    v_cvt_pk_bf16_f32 v80, v164, v165
    v_mfma_f32_16x16x32_bf16 v[176:179], a[144:147], v[92:95], 0
    ds_read_b64_tr_b16 a[180:181], v247 offset:12288
    v_cvt_pk_bf16_f32 v81, v166, v167
    v_mfma_f32_16x16x32_bf16 v[176:179], a[148:151], v[104:107], v[176:179]
    ds_read_b64_tr_b16 a[182:183], v247 offset:14336
    v_cvt_pk_bf16_f32 v84, v168, v169
    v_mfma_f32_16x16x32_bf16 v[176:179], a[152:155], v[116:119], v[176:179]
    ds_read_b64_tr_b16 a[184:185], v247 offset:16384
    v_cvt_pk_bf16_f32 v85, v170, v171
    v_mfma_f32_16x16x32_bf16 v[176:179], a[156:159], v[128:131], v[176:179]
    ds_read_b64_tr_b16 a[186:187], v247 offset:18432
    v_mfma_f32_16x16x32_bf16 v[176:179], a[160:163], v[140:143], v[176:179]
    ds_read_b64_tr_b16 a[188:189], v247 offset:20480
    v_mfma_f32_16x16x32_bf16 v[176:179], a[164:167], v[152:155], v[176:179]
    ds_read_b64_tr_b16 a[190:191], v247 offset:22528
    v_mfma_f32_16x16x32_bf16 v[180:183], a[144:147], v[96:99], 0
    v_mfma_f32_16x16x32_bf16 v[180:183], a[148:151], v[108:111], v[180:183]
    v_mfma_f32_16x16x32_bf16 v[180:183], a[152:155], v[120:123], v[180:183]
    v_mfma_f32_16x16x32_bf16 v[180:183], a[156:159], v[132:135], v[180:183]
    v_mfma_f32_16x16x32_bf16 v[180:183], a[160:163], v[144:147], v[180:183]
    v_mfma_f32_16x16x32_bf16 v[180:183], a[164:167], v[156:159], v[180:183]
    s_waitcnt vmcnt(18)
    s_waitcnt lgkmcnt(0)
    s_barrier
    v_mov_b32 v37, 1
    buffer_store_dword v37, v33, s[24:27], 0 offen sc1
    v_mfma_f32_16x16x32_bf16 v[172:175], a[168:171], a[192:195], v[172:175]
    ds_read_b64_tr_b16 a[144:145], v252 offset:24640
    v_mfma_f32_16x16x32_bf16 v[172:175], a[172:175], a[204:207], v[172:175]
    ds_read_b64_tr_b16 a[146:147], v252 offset:26688
    v_mfma_f32_16x16x32_bf16 v[172:175], a[176:179], a[216:219], v[172:175]
    ds_read_b64_tr_b16 a[148:149], v252 offset:28736
    v_mfma_f32_16x16x32_bf16 v[172:175], a[180:183], a[228:231], v[172:175]
    ds_read_b64_tr_b16 a[150:151], v252 offset:30784
    v_mfma_f32_16x16x32_bf16 v[172:175], a[184:187], a[240:243], v[172:175]
    ds_read_b64_tr_b16 a[152:153], v252 offset:32832
    v_mfma_f32_16x16x32_bf16 v[172:175], a[188:191], a[252:255], v[172:175]
    ds_read_b64_tr_b16 a[154:155], v252 offset:34880
    v_mfma_f32_16x16x32_bf16 v[176:179], a[168:171], a[196:199], v[176:179]
    ds_read_b64_tr_b16 a[156:157], v252 offset:36928
    v_mfma_f32_16x16x32_bf16 v[176:179], a[172:175], a[208:211], v[176:179]
    ds_read_b64_tr_b16 a[158:159], v252 offset:38976
    v_mfma_f32_16x16x32_bf16 v[176:179], a[176:179], a[220:223], v[176:179]
    ds_read_b64_tr_b16 a[160:161], v252 offset:41024
    v_mfma_f32_16x16x32_bf16 v[176:179], a[180:183], a[232:235], v[176:179]
    ds_read_b64_tr_b16 a[162:163], v252 offset:43072
    v_mfma_f32_16x16x32_bf16 v[176:179], a[184:187], a[244:247], v[176:179]
    ds_read_b64_tr_b16 a[164:165], v252 offset:45120
    v_mfma_f32_16x16x32_bf16 v[176:179], a[188:191], a[0:3], v[176:179]
    ds_read_b64_tr_b16 a[166:167], v252 offset:47168
    s_add_u32 m0, s29, 98560
    s_mov_b32 s35, 768
    v_mfma_f32_16x16x32_bf16 v[180:183], a[168:171], a[200:203], v[180:183]
    buffer_load_dwordx4 v8, s[12:15], s35 offen offset:0 lds
    v_mfma_f32_16x16x32_bf16 v[180:183], a[172:175], a[212:215], v[180:183]
    v_mfma_f32_16x16x32_bf16 v[180:183], a[176:179], a[224:227], v[180:183]
    v_mfma_f32_16x16x32_bf16 v[180:183], a[180:183], a[236:239], v[180:183]
    buffer_load_dwordx4 v9, s[12:15], s35 offen offset:1024 lds
    v_mfma_f32_16x16x32_bf16 v[180:183], a[184:187], a[248:251], v[180:183]
    v_mfma_f32_16x16x32_bf16 v[180:183], a[188:191], a[4:7], v[180:183]
    s_waitcnt lgkmcnt(0)
    v_mfma_f32_16x16x32_bf16 v[160:163], a[144:147], v[88:91], 0
    ds_read_b64_tr_b16 a[168:169], v248 offset:0
    v_mfma_f32_16x16x32_bf16 v[160:163], a[148:151], v[100:103], v[160:163]
    ds_read_b64_tr_b16 a[170:171], v248 offset:2048
    v_mfma_f32_16x16x32_bf16 v[160:163], a[152:155], v[112:115], v[160:163]
    ds_read_b64_tr_b16 a[172:173], v248 offset:4096
    v_mfma_f32_16x16x32_bf16 v[160:163], a[156:159], v[124:127], v[160:163]
    ds_read_b64_tr_b16 a[174:175], v248 offset:6144
    v_cvt_pk_bf16_f32 v78, v172, v173
    v_mfma_f32_16x16x32_bf16 v[160:163], a[160:163], v[136:139], v[160:163]
    ds_read_b64_tr_b16 a[176:177], v248 offset:8192
    v_cvt_pk_bf16_f32 v79, v174, v175
    v_mfma_f32_16x16x32_bf16 v[160:163], a[164:167], v[148:151], v[160:163]
    ds_read_b64_tr_b16 a[178:179], v248 offset:10240
    v_cvt_pk_bf16_f32 v82, v176, v177
    v_mfma_f32_16x16x32_bf16 v[164:167], a[144:147], v[92:95], 0
    ds_read_b64_tr_b16 a[180:181], v248 offset:12288
    v_cvt_pk_bf16_f32 v83, v178, v179
    v_mfma_f32_16x16x32_bf16 v[164:167], a[148:151], v[104:107], v[164:167]
    ds_read_b64_tr_b16 a[182:183], v248 offset:14336
    v_cvt_pk_bf16_f32 v86, v180, v181
    v_mfma_f32_16x16x32_bf16 v[164:167], a[152:155], v[116:119], v[164:167]
    ds_read_b64_tr_b16 a[184:185], v248 offset:16384
    v_cvt_pk_bf16_f32 v87, v182, v183
    v_mfma_f32_16x16x32_bf16 v[164:167], a[156:159], v[128:131], v[164:167]
    ds_read_b64_tr_b16 a[186:187], v248 offset:18432
    v_mfma_f32_16x16x32_bf16 v[164:167], a[160:163], v[140:143], v[164:167]
    ds_read_b64_tr_b16 a[188:189], v248 offset:20480
    s_mov_b32 s45, 86016
    v_mfma_f32_16x16x32_bf16 v[164:167], a[164:167], v[152:155], v[164:167]
    ds_read_b64_tr_b16 a[190:191], v248 offset:22528
    buffer_store_dwordx4 v[76:79], v32, s[20:23], s45 offen offset:0 sc1
    v_mfma_f32_16x16x32_bf16 v[168:171], a[144:147], v[96:99], 0
    buffer_store_dwordx4 v[80:83], v32, s[20:23], s45 offen offset:1024 sc1
    v_mfma_f32_16x16x32_bf16 v[168:171], a[148:151], v[108:111], v[168:171]
    buffer_store_dwordx4 v[84:87], v32, s[20:23], s45 offen offset:2048 sc1
    v_mfma_f32_16x16x32_bf16 v[168:171], a[152:155], v[120:123], v[168:171]
    buffer_load_dwordx4 v10, s[12:15], s35 offen offset:2048 lds
    v_mfma_f32_16x16x32_bf16 v[168:171], a[156:159], v[132:135], v[168:171]
    v_mfma_f32_16x16x32_bf16 v[168:171], a[160:163], v[144:147], v[168:171]
    v_mfma_f32_16x16x32_bf16 v[168:171], a[164:167], v[156:159], v[168:171]
    buffer_load_dwordx4 v11, s[12:15], s35 offen offset:3072 lds
    s_waitcnt lgkmcnt(0)
    v_mfma_f32_16x16x32_bf16 v[160:163], a[168:171], a[192:195], v[160:163]
    ds_read_b64_tr_b16 a[144:145], v253 offset:24640
    v_mfma_f32_16x16x32_bf16 v[160:163], a[172:175], a[204:207], v[160:163]
    ds_read_b64_tr_b16 a[146:147], v253 offset:26688
    v_mfma_f32_16x16x32_bf16 v[160:163], a[176:179], a[216:219], v[160:163]
    ds_read_b64_tr_b16 a[148:149], v253 offset:28736
    v_mfma_f32_16x16x32_bf16 v[160:163], a[180:183], a[228:231], v[160:163]
    ds_read_b64_tr_b16 a[150:151], v253 offset:30784
    v_mfma_f32_16x16x32_bf16 v[160:163], a[184:187], a[240:243], v[160:163]
    ds_read_b64_tr_b16 a[152:153], v253 offset:32832
    v_mfma_f32_16x16x32_bf16 v[160:163], a[188:191], a[252:255], v[160:163]
    ds_read_b64_tr_b16 a[154:155], v253 offset:34880
    v_mfma_f32_16x16x32_bf16 v[164:167], a[168:171], a[196:199], v[164:167]
    ds_read_b64_tr_b16 a[156:157], v253 offset:36928
    v_mfma_f32_16x16x32_bf16 v[164:167], a[172:175], a[208:211], v[164:167]
    ds_read_b64_tr_b16 a[158:159], v253 offset:38976
    v_mfma_f32_16x16x32_bf16 v[164:167], a[176:179], a[220:223], v[164:167]
    ds_read_b64_tr_b16 a[160:161], v253 offset:41024
    v_mfma_f32_16x16x32_bf16 v[164:167], a[180:183], a[232:235], v[164:167]
    ds_read_b64_tr_b16 a[162:163], v253 offset:43072
    v_mfma_f32_16x16x32_bf16 v[164:167], a[184:187], a[244:247], v[164:167]
    ds_read_b64_tr_b16 a[164:165], v253 offset:45120
    v_mfma_f32_16x16x32_bf16 v[164:167], a[188:191], a[0:3], v[164:167]
    ds_read_b64_tr_b16 a[166:167], v253 offset:47168
    v_mfma_f32_16x16x32_bf16 v[168:171], a[168:171], a[200:203], v[168:171]
    v_mfma_f32_16x16x32_bf16 v[168:171], a[172:175], a[212:215], v[168:171]
    s_add_u32 m0, s29, 102656
    v_mfma_f32_16x16x32_bf16 v[168:171], a[176:179], a[224:227], v[168:171]
    buffer_load_dwordx4 v12, s[12:15], s35 offen offset:0 lds
    v_mfma_f32_16x16x32_bf16 v[168:171], a[180:183], a[236:239], v[168:171]
    v_mfma_f32_16x16x32_bf16 v[168:171], a[184:187], a[248:251], v[168:171]
    v_mfma_f32_16x16x32_bf16 v[168:171], a[188:191], a[4:7], v[168:171]
    buffer_load_dwordx4 v13, s[12:15], s35 offen offset:1024 lds
    s_waitcnt lgkmcnt(0)
    v_mfma_f32_16x16x32_bf16 v[172:175], a[144:147], v[88:91], 0
    ds_read_b64_tr_b16 a[168:169], v249 offset:0
    v_mfma_f32_16x16x32_bf16 v[172:175], a[148:151], v[100:103], v[172:175]
    ds_read_b64_tr_b16 a[170:171], v249 offset:2048
    v_mfma_f32_16x16x32_bf16 v[172:175], a[152:155], v[112:115], v[172:175]
    ds_read_b64_tr_b16 a[172:173], v249 offset:4096
    v_mfma_f32_16x16x32_bf16 v[172:175], a[156:159], v[124:127], v[172:175]
    ds_read_b64_tr_b16 a[174:175], v249 offset:6144
    v_cvt_pk_bf16_f32 v208, v160, v161
    v_mfma_f32_16x16x32_bf16 v[172:175], a[160:163], v[136:139], v[172:175]
    ds_read_b64_tr_b16 a[176:177], v249 offset:8192
    v_cvt_pk_bf16_f32 v209, v162, v163
    v_mfma_f32_16x16x32_bf16 v[172:175], a[164:167], v[148:151], v[172:175]
    ds_read_b64_tr_b16 a[178:179], v249 offset:10240
    v_cvt_pk_bf16_f32 v212, v164, v165
    v_mfma_f32_16x16x32_bf16 v[176:179], a[144:147], v[92:95], 0
    ds_read_b64_tr_b16 a[180:181], v249 offset:12288
    v_cvt_pk_bf16_f32 v213, v166, v167
    v_mfma_f32_16x16x32_bf16 v[176:179], a[148:151], v[104:107], v[176:179]
    ds_read_b64_tr_b16 a[182:183], v249 offset:14336
    v_cvt_pk_bf16_f32 v216, v168, v169
    v_mfma_f32_16x16x32_bf16 v[176:179], a[152:155], v[116:119], v[176:179]
    ds_read_b64_tr_b16 a[184:185], v249 offset:16384
    v_cvt_pk_bf16_f32 v217, v170, v171
    v_mfma_f32_16x16x32_bf16 v[176:179], a[156:159], v[128:131], v[176:179]
    ds_read_b64_tr_b16 a[186:187], v249 offset:18432
    v_mfma_f32_16x16x32_bf16 v[176:179], a[160:163], v[140:143], v[176:179]
    ds_read_b64_tr_b16 a[188:189], v249 offset:20480
    v_mfma_f32_16x16x32_bf16 v[176:179], a[164:167], v[152:155], v[176:179]
    ds_read_b64_tr_b16 a[190:191], v249 offset:22528
    v_mfma_f32_16x16x32_bf16 v[180:183], a[144:147], v[96:99], 0
    v_mfma_f32_16x16x32_bf16 v[180:183], a[148:151], v[108:111], v[180:183]
    v_mfma_f32_16x16x32_bf16 v[180:183], a[152:155], v[120:123], v[180:183]
    s_add_u32 m0, s29, 0
    s_mov_b32 s36, 768
    v_mfma_f32_16x16x32_bf16 v[180:183], a[156:159], v[132:135], v[180:183]
    buffer_load_dwordx4 v8, s[16:19], s36 offen offset:0 lds
    v_mfma_f32_16x16x32_bf16 v[180:183], a[160:163], v[144:147], v[180:183]
    v_mfma_f32_16x16x32_bf16 v[180:183], a[164:167], v[156:159], v[180:183]
    s_waitcnt lgkmcnt(0)
    v_mfma_f32_16x16x32_bf16 v[172:175], a[168:171], a[192:195], v[172:175]
    ds_read_b64_tr_b16 a[144:145], v254 offset:24640
    v_mfma_f32_16x16x32_bf16 v[172:175], a[172:175], a[204:207], v[172:175]
    ds_read_b64_tr_b16 a[146:147], v254 offset:26688
    v_mfma_f32_16x16x32_bf16 v[172:175], a[176:179], a[216:219], v[172:175]
    ds_read_b64_tr_b16 a[148:149], v254 offset:28736
    v_mfma_f32_16x16x32_bf16 v[172:175], a[180:183], a[228:231], v[172:175]
    ds_read_b64_tr_b16 a[150:151], v254 offset:30784
    v_mfma_f32_16x16x32_bf16 v[172:175], a[184:187], a[240:243], v[172:175]
    ds_read_b64_tr_b16 a[152:153], v254 offset:32832
    v_mfma_f32_16x16x32_bf16 v[172:175], a[188:191], a[252:255], v[172:175]
    ds_read_b64_tr_b16 a[154:155], v254 offset:34880
    v_mfma_f32_16x16x32_bf16 v[176:179], a[168:171], a[196:199], v[176:179]
    ds_read_b64_tr_b16 a[156:157], v254 offset:36928
    v_mfma_f32_16x16x32_bf16 v[176:179], a[172:175], a[208:211], v[176:179]
    ds_read_b64_tr_b16 a[158:159], v254 offset:38976
    v_mfma_f32_16x16x32_bf16 v[176:179], a[176:179], a[220:223], v[176:179]
    ds_read_b64_tr_b16 a[160:161], v254 offset:41024
    v_mfma_f32_16x16x32_bf16 v[176:179], a[180:183], a[232:235], v[176:179]
    ds_read_b64_tr_b16 a[162:163], v254 offset:43072
    v_mfma_f32_16x16x32_bf16 v[176:179], a[184:187], a[244:247], v[176:179]
    ds_read_b64_tr_b16 a[164:165], v254 offset:45120
    v_mfma_f32_16x16x32_bf16 v[176:179], a[188:191], a[0:3], v[176:179]
    ds_read_b64_tr_b16 a[166:167], v254 offset:47168
    v_mfma_f32_16x16x32_bf16 v[180:183], a[168:171], a[200:203], v[180:183]
    buffer_load_dwordx4 v9, s[16:19], s36 offen offset:1024 lds
    v_mfma_f32_16x16x32_bf16 v[180:183], a[172:175], a[212:215], v[180:183]
    v_mfma_f32_16x16x32_bf16 v[180:183], a[176:179], a[224:227], v[180:183]
    v_mfma_f32_16x16x32_bf16 v[180:183], a[180:183], a[236:239], v[180:183]
    buffer_load_dwordx4 v10, s[16:19], s36 offen offset:2048 lds
    v_mfma_f32_16x16x32_bf16 v[180:183], a[184:187], a[248:251], v[180:183]
    v_mfma_f32_16x16x32_bf16 v[180:183], a[188:191], a[4:7], v[180:183]
    s_waitcnt lgkmcnt(0)
    v_mfma_f32_16x16x32_bf16 v[160:163], a[144:147], v[88:91], 0
    ds_read_b64_tr_b16 a[168:169], v250 offset:0
    v_mfma_f32_16x16x32_bf16 v[160:163], a[148:151], v[100:103], v[160:163]
    ds_read_b64_tr_b16 a[170:171], v250 offset:2048
    v_mfma_f32_16x16x32_bf16 v[160:163], a[152:155], v[112:115], v[160:163]
    ds_read_b64_tr_b16 a[172:173], v250 offset:4096
    v_mfma_f32_16x16x32_bf16 v[160:163], a[156:159], v[124:127], v[160:163]
    ds_read_b64_tr_b16 a[174:175], v250 offset:6144
    v_cvt_pk_bf16_f32 v210, v172, v173
    v_mfma_f32_16x16x32_bf16 v[160:163], a[160:163], v[136:139], v[160:163]
    ds_read_b64_tr_b16 a[176:177], v250 offset:8192
    v_cvt_pk_bf16_f32 v211, v174, v175
    v_mfma_f32_16x16x32_bf16 v[160:163], a[164:167], v[148:151], v[160:163]
    ds_read_b64_tr_b16 a[178:179], v250 offset:10240
    v_cvt_pk_bf16_f32 v214, v176, v177
    v_mfma_f32_16x16x32_bf16 v[164:167], a[144:147], v[92:95], 0
    ds_read_b64_tr_b16 a[180:181], v250 offset:12288
    v_cvt_pk_bf16_f32 v215, v178, v179
    v_mfma_f32_16x16x32_bf16 v[164:167], a[148:151], v[104:107], v[164:167]
    ds_read_b64_tr_b16 a[182:183], v250 offset:14336
    v_cvt_pk_bf16_f32 v218, v180, v181
    v_mfma_f32_16x16x32_bf16 v[164:167], a[152:155], v[116:119], v[164:167]
    ds_read_b64_tr_b16 a[184:185], v250 offset:16384
    v_cvt_pk_bf16_f32 v219, v182, v183
    v_mfma_f32_16x16x32_bf16 v[164:167], a[156:159], v[128:131], v[164:167]
    ds_read_b64_tr_b16 a[186:187], v250 offset:18432
    v_mfma_f32_16x16x32_bf16 v[164:167], a[160:163], v[140:143], v[164:167]
    ds_read_b64_tr_b16 a[188:189], v250 offset:20480
    s_mov_b32 s45, 98304
    buffer_load_dword v1, v34, s[24:27], 0 offen sc1
    v_mfma_f32_16x16x32_bf16 v[164:167], a[164:167], v[152:155], v[164:167]
    ds_read_b64_tr_b16 a[190:191], v250 offset:22528
    buffer_store_dwordx4 v[208:211], v32, s[20:23], s45 offen offset:0 sc1
    v_mfma_f32_16x16x32_bf16 v[168:171], a[144:147], v[96:99], 0
    buffer_store_dwordx4 v[212:215], v32, s[20:23], s45 offen offset:1024 sc1
    v_mfma_f32_16x16x32_bf16 v[168:171], a[148:151], v[108:111], v[168:171]
    buffer_store_dwordx4 v[216:219], v32, s[20:23], s45 offen offset:2048 sc1
    v_mfma_f32_16x16x32_bf16 v[168:171], a[152:155], v[120:123], v[168:171]
    buffer_load_dwordx4 v11, s[16:19], s36 offen offset:3072 lds
    v_mfma_f32_16x16x32_bf16 v[168:171], a[156:159], v[132:135], v[168:171]
    v_mfma_f32_16x16x32_bf16 v[168:171], a[160:163], v[144:147], v[168:171]
    s_add_u32 m0, s29, 4096
    v_mfma_f32_16x16x32_bf16 v[168:171], a[164:167], v[156:159], v[168:171]
    buffer_load_dwordx4 v12, s[16:19], s36 offen offset:0 lds
    s_waitcnt lgkmcnt(0)
    v_mfma_f32_16x16x32_bf16 v[160:163], a[168:171], a[192:195], v[160:163]
    ds_read_b64_tr_b16 a[144:145], v255 offset:24640
    v_mfma_f32_16x16x32_bf16 v[160:163], a[172:175], a[204:207], v[160:163]
    ds_read_b64_tr_b16 a[146:147], v255 offset:26688
    v_mfma_f32_16x16x32_bf16 v[160:163], a[176:179], a[216:219], v[160:163]
    ds_read_b64_tr_b16 a[148:149], v255 offset:28736
    v_mfma_f32_16x16x32_bf16 v[160:163], a[180:183], a[228:231], v[160:163]
    ds_read_b64_tr_b16 a[150:151], v255 offset:30784
    v_mfma_f32_16x16x32_bf16 v[160:163], a[184:187], a[240:243], v[160:163]
    ds_read_b64_tr_b16 a[152:153], v255 offset:32832
    v_mfma_f32_16x16x32_bf16 v[160:163], a[188:191], a[252:255], v[160:163]
    ds_read_b64_tr_b16 a[154:155], v255 offset:34880
    v_mfma_f32_16x16x32_bf16 v[164:167], a[168:171], a[196:199], v[164:167]
    ds_read_b64_tr_b16 a[156:157], v255 offset:36928
    v_mfma_f32_16x16x32_bf16 v[164:167], a[172:175], a[208:211], v[164:167]
    ds_read_b64_tr_b16 a[158:159], v255 offset:38976
    v_mfma_f32_16x16x32_bf16 v[164:167], a[176:179], a[220:223], v[164:167]
    ds_read_b64_tr_b16 a[160:161], v255 offset:41024
    v_mfma_f32_16x16x32_bf16 v[164:167], a[180:183], a[232:235], v[164:167]
    ds_read_b64_tr_b16 a[162:163], v255 offset:43072
    v_mfma_f32_16x16x32_bf16 v[164:167], a[184:187], a[244:247], v[164:167]
    ds_read_b64_tr_b16 a[164:165], v255 offset:45120
    v_mfma_f32_16x16x32_bf16 v[164:167], a[188:191], a[0:3], v[164:167]
    ds_read_b64_tr_b16 a[166:167], v255 offset:47168
    v_mfma_f32_16x16x32_bf16 v[168:171], a[168:171], a[200:203], v[168:171]
    v_mfma_f32_16x16x32_bf16 v[168:171], a[172:175], a[212:215], v[168:171]
    v_mfma_f32_16x16x32_bf16 v[168:171], a[176:179], a[224:227], v[168:171]
    buffer_load_dwordx4 v13, s[16:19], s36 offen offset:1024 lds
    v_mfma_f32_16x16x32_bf16 v[168:171], a[180:183], a[236:239], v[168:171]
    v_mfma_f32_16x16x32_bf16 v[168:171], a[184:187], a[248:251], v[168:171]
    v_mfma_f32_16x16x32_bf16 v[168:171], a[188:191], a[4:7], v[168:171]
    s_waitcnt lgkmcnt(0)
    v_mfma_f32_16x16x32_bf16 v[172:175], a[144:147], v[88:91], 0
    ds_read_b64_tr_b16 a[168:169], v251 offset:0
    v_mfma_f32_16x16x32_bf16 v[172:175], a[148:151], v[100:103], v[172:175]
    ds_read_b64_tr_b16 a[170:171], v251 offset:2048
    v_mfma_f32_16x16x32_bf16 v[172:175], a[152:155], v[112:115], v[172:175]
    ds_read_b64_tr_b16 a[172:173], v251 offset:4096
    v_mfma_f32_16x16x32_bf16 v[172:175], a[156:159], v[124:127], v[172:175]
    ds_read_b64_tr_b16 a[174:175], v251 offset:6144
    v_cvt_pk_bf16_f32 v220, v160, v161
    v_mfma_f32_16x16x32_bf16 v[172:175], a[160:163], v[136:139], v[172:175]
    ds_read_b64_tr_b16 a[176:177], v251 offset:8192
    v_cvt_pk_bf16_f32 v221, v162, v163
    v_mfma_f32_16x16x32_bf16 v[172:175], a[164:167], v[148:151], v[172:175]
    ds_read_b64_tr_b16 a[178:179], v251 offset:10240
    v_cvt_pk_bf16_f32 v224, v164, v165
    v_mfma_f32_16x16x32_bf16 v[176:179], a[144:147], v[92:95], 0
    ds_read_b64_tr_b16 a[180:181], v251 offset:12288
    v_cvt_pk_bf16_f32 v225, v166, v167
    v_mfma_f32_16x16x32_bf16 v[176:179], a[148:151], v[104:107], v[176:179]
    ds_read_b64_tr_b16 a[182:183], v251 offset:14336
    v_cvt_pk_bf16_f32 v228, v168, v169
    v_mfma_f32_16x16x32_bf16 v[176:179], a[152:155], v[116:119], v[176:179]
    ds_read_b64_tr_b16 a[184:185], v251 offset:16384
    v_cvt_pk_bf16_f32 v229, v170, v171
    v_mfma_f32_16x16x32_bf16 v[176:179], a[156:159], v[128:131], v[176:179]
    ds_read_b64_tr_b16 a[186:187], v251 offset:18432
    v_mfma_f32_16x16x32_bf16 v[176:179], a[160:163], v[140:143], v[176:179]
    ds_read_b64_tr_b16 a[188:189], v251 offset:20480
    v_mfma_f32_16x16x32_bf16 v[176:179], a[164:167], v[152:155], v[176:179]
    ds_read_b64_tr_b16 a[190:191], v251 offset:22528
    v_mfma_f32_16x16x32_bf16 v[180:183], a[144:147], v[96:99], 0
    v_mfma_f32_16x16x32_bf16 v[180:183], a[148:151], v[108:111], v[180:183]
    v_mfma_f32_16x16x32_bf16 v[180:183], a[152:155], v[120:123], v[180:183]
    v_mfma_f32_16x16x32_bf16 v[180:183], a[156:159], v[132:135], v[180:183]
    v_mfma_f32_16x16x32_bf16 v[180:183], a[160:163], v[144:147], v[180:183]
    v_mfma_f32_16x16x32_bf16 v[180:183], a[164:167], v[156:159], v[180:183]
    s_waitcnt vmcnt(20)
    s_waitcnt lgkmcnt(0)
    s_barrier
    v_mfma_f32_16x16x32_bf16 v[172:175], a[168:171], a[192:195], v[172:175]
    ds_read_b64_tr_b16 a[144:145], v248 offset:24640
    v_mfma_f32_16x16x32_bf16 v[172:175], a[172:175], a[204:207], v[172:175]
    ds_read_b64_tr_b16 a[146:147], v248 offset:26688
    v_mfma_f32_16x16x32_bf16 v[172:175], a[176:179], a[216:219], v[172:175]
    ds_read_b64_tr_b16 a[148:149], v248 offset:28736
    v_mfma_f32_16x16x32_bf16 v[172:175], a[180:183], a[228:231], v[172:175]
    ds_read_b64_tr_b16 a[150:151], v248 offset:30784
    v_mfma_f32_16x16x32_bf16 v[172:175], a[184:187], a[240:243], v[172:175]
    ds_read_b64_tr_b16 a[152:153], v248 offset:32832
    v_mfma_f32_16x16x32_bf16 v[172:175], a[188:191], a[252:255], v[172:175]
    ds_read_b64_tr_b16 a[154:155], v248 offset:34880
    v_mfma_f32_16x16x32_bf16 v[176:179], a[168:171], a[196:199], v[176:179]
    ds_read_b64_tr_b16 a[156:157], v248 offset:36928
    v_mfma_f32_16x16x32_bf16 v[176:179], a[172:175], a[208:211], v[176:179]
    ds_read_b64_tr_b16 a[158:159], v248 offset:38976
    v_mfma_f32_16x16x32_bf16 v[176:179], a[176:179], a[220:223], v[176:179]
    ds_read_b64_tr_b16 a[160:161], v248 offset:41024
    v_mfma_f32_16x16x32_bf16 v[176:179], a[180:183], a[232:235], v[176:179]
    ds_read_b64_tr_b16 a[162:163], v248 offset:43072
    v_mfma_f32_16x16x32_bf16 v[176:179], a[184:187], a[244:247], v[176:179]
    ds_read_b64_tr_b16 a[164:165], v248 offset:45120
    v_mfma_f32_16x16x32_bf16 v[176:179], a[188:191], a[0:3], v[176:179]
    ds_read_b64_tr_b16 a[166:167], v248 offset:47168
    s_add_u32 m0, s29, 123200
    s_mov_b32 s35, 896
    v_mfma_f32_16x16x32_bf16 v[180:183], a[168:171], a[200:203], v[180:183]
    buffer_load_dwordx4 v8, s[12:15], s35 offen offset:0 lds
    v_mfma_f32_16x16x32_bf16 v[180:183], a[172:175], a[212:215], v[180:183]
    v_mfma_f32_16x16x32_bf16 v[180:183], a[176:179], a[224:227], v[180:183]
    buffer_load_dwordx4 v9, s[12:15], s35 offen offset:1024 lds
    v_mfma_f32_16x16x32_bf16 v[180:183], a[180:183], a[236:239], v[180:183]
    v_mfma_f32_16x16x32_bf16 v[180:183], a[184:187], a[248:251], v[180:183]
    v_mfma_f32_16x16x32_bf16 v[180:183], a[188:191], a[4:7], v[180:183]
    buffer_load_dwordx4 v10, s[12:15], s35 offen offset:2048 lds
    s_waitcnt lgkmcnt(0)
    v_mfma_f32_16x16x32_bf16 v[160:163], a[144:147], v[88:91], 0
    ds_read_b64_tr_b16 a[168:169], v244 offset:24640
    v_mfma_f32_16x16x32_bf16 v[160:163], a[148:151], v[100:103], v[160:163]
    ds_read_b64_tr_b16 a[170:171], v244 offset:26688
    v_mfma_f32_16x16x32_bf16 v[160:163], a[152:155], v[112:115], v[160:163]
    ds_read_b64_tr_b16 a[172:173], v244 offset:28736
    v_mfma_f32_16x16x32_bf16 v[160:163], a[156:159], v[124:127], v[160:163]
    ds_read_b64_tr_b16 a[174:175], v244 offset:30784
    v_cvt_pk_bf16_f32 v222, v172, v173
    v_mfma_f32_16x16x32_bf16 v[160:163], a[160:163], v[136:139], v[160:163]
    ds_read_b64_tr_b16 a[176:177], v244 offset:32832
    v_cvt_pk_bf16_f32 v223, v174, v175
    v_mfma_f32_16x16x32_bf16 v[160:163], a[164:167], v[148:151], v[160:163]
    ds_read_b64_tr_b16 a[178:179], v244 offset:34880
    v_cvt_pk_bf16_f32 v226, v176, v177
    v_mfma_f32_16x16x32_bf16 v[164:167], a[144:147], v[92:95], 0
    ds_read_b64_tr_b16 a[180:181], v244 offset:36928
    v_cvt_pk_bf16_f32 v227, v178, v179
    v_mfma_f32_16x16x32_bf16 v[164:167], a[148:151], v[104:107], v[164:167]
    ds_read_b64_tr_b16 a[182:183], v244 offset:38976
    v_cvt_pk_bf16_f32 v230, v180, v181
    v_mfma_f32_16x16x32_bf16 v[164:167], a[152:155], v[116:119], v[164:167]
    ds_read_b64_tr_b16 a[184:185], v244 offset:41024
    v_cvt_pk_bf16_f32 v231, v182, v183
    s_waitcnt vmcnt(9)
    v_cmp_gt_u32 vcc, 1, v1
    s_cbranch_vccnz L_spin_0
L_ready_0:
    v_mfma_f32_16x16x32_bf16 v[164:167], a[156:159], v[128:131], v[164:167]
    ds_read_b64_tr_b16 a[186:187], v244 offset:43072
    v_mfma_f32_16x16x32_bf16 v[164:167], a[160:163], v[140:143], v[164:167]
    ds_read_b64_tr_b16 a[188:189], v244 offset:45120
    s_mov_b32 s45, 110592
    v_mfma_f32_16x16x32_bf16 v[164:167], a[164:167], v[152:155], v[164:167]
    ds_read_b64_tr_b16 a[190:191], v244 offset:47168
    buffer_store_dwordx4 v[220:223], v32, s[20:23], s45 offen offset:0 sc1
    v_mfma_f32_16x16x32_bf16 v[168:171], a[144:147], v[96:99], 0
    buffer_store_dwordx4 v[224:227], v32, s[20:23], s45 offen offset:1024 sc1
    v_mfma_f32_16x16x32_bf16 v[168:171], a[148:151], v[108:111], v[168:171]
    buffer_store_dwordx4 v[228:231], v32, s[20:23], s45 offen offset:2048 sc1
    v_mfma_f32_16x16x32_bf16 v[168:171], a[152:155], v[120:123], v[168:171]
    s_add_u32 s44, s48, 0
    buffer_load_dwordx4 a[8:11], v7, s[4:7], s44 offen sc1
    v_mfma_f32_16x16x32_bf16 v[168:171], a[156:159], v[132:135], v[168:171]
    s_add_u32 s44, s48, 245760
    buffer_load_dwordx4 a[12:15], v7, s[4:7], s44 offen sc1
    v_mfma_f32_16x16x32_bf16 v[168:171], a[160:163], v[144:147], v[168:171]
    s_add_u32 s44, s48, 491520
    buffer_load_dwordx4 a[16:19], v7, s[4:7], s44 offen sc1
    v_mfma_f32_16x16x32_bf16 v[168:171], a[164:167], v[156:159], v[168:171]
    s_add_u32 s44, s48, 737280
    buffer_load_dwordx4 a[20:23], v7, s[4:7], s44 offen sc1
    s_waitcnt lgkmcnt(0)
    v_mfma_f32_16x16x32_bf16 v[160:163], a[168:171], a[192:195], v[160:163]
    ds_read_b64_tr_b16 a[144:145], v249 offset:24640
    v_mfma_f32_16x16x32_bf16 v[160:163], a[172:175], a[204:207], v[160:163]
    ds_read_b64_tr_b16 a[146:147], v249 offset:26688
    v_mfma_f32_16x16x32_bf16 v[160:163], a[176:179], a[216:219], v[160:163]
    ds_read_b64_tr_b16 a[148:149], v249 offset:28736
    v_mfma_f32_16x16x32_bf16 v[160:163], a[180:183], a[228:231], v[160:163]
    ds_read_b64_tr_b16 a[150:151], v249 offset:30784
    v_mfma_f32_16x16x32_bf16 v[160:163], a[184:187], a[240:243], v[160:163]
    ds_read_b64_tr_b16 a[152:153], v249 offset:32832
    v_mfma_f32_16x16x32_bf16 v[160:163], a[188:191], a[252:255], v[160:163]
    ds_read_b64_tr_b16 a[154:155], v249 offset:34880
    v_mfma_f32_16x16x32_bf16 v[164:167], a[168:171], a[196:199], v[164:167]
    ds_read_b64_tr_b16 a[156:157], v249 offset:36928
    v_mfma_f32_16x16x32_bf16 v[164:167], a[172:175], a[208:211], v[164:167]
    ds_read_b64_tr_b16 a[158:159], v249 offset:38976
    v_mfma_f32_16x16x32_bf16 v[164:167], a[176:179], a[220:223], v[164:167]
    ds_read_b64_tr_b16 a[160:161], v249 offset:41024
    v_mfma_f32_16x16x32_bf16 v[164:167], a[180:183], a[232:235], v[164:167]
    ds_read_b64_tr_b16 a[162:163], v249 offset:43072
    v_mfma_f32_16x16x32_bf16 v[164:167], a[184:187], a[244:247], v[164:167]
    ds_read_b64_tr_b16 a[164:165], v249 offset:45120
    v_mfma_f32_16x16x32_bf16 v[164:167], a[188:191], a[0:3], v[164:167]
    ds_read_b64_tr_b16 a[166:167], v249 offset:47168
    v_mfma_f32_16x16x32_bf16 v[168:171], a[168:171], a[200:203], v[168:171]
    v_mfma_f32_16x16x32_bf16 v[168:171], a[172:175], a[212:215], v[168:171]
    buffer_load_dwordx4 v11, s[12:15], s35 offen offset:3072 lds
    v_mfma_f32_16x16x32_bf16 v[168:171], a[176:179], a[224:227], v[168:171]
    v_mfma_f32_16x16x32_bf16 v[168:171], a[180:183], a[236:239], v[168:171]
    s_add_u32 m0, s29, 127296
    v_mfma_f32_16x16x32_bf16 v[168:171], a[184:187], a[248:251], v[168:171]
    buffer_load_dwordx4 v12, s[12:15], s35 offen offset:0 lds
    v_mfma_f32_16x16x32_bf16 v[168:171], a[188:191], a[4:7], v[168:171]
    s_waitcnt lgkmcnt(0)
    v_mfma_f32_16x16x32_bf16 v[172:175], a[144:147], v[88:91], 0
    ds_read_b64_tr_b16 a[168:169], v245 offset:24640
    v_mfma_f32_16x16x32_bf16 v[172:175], a[148:151], v[100:103], v[172:175]
    ds_read_b64_tr_b16 a[170:171], v245 offset:26688
    v_mfma_f32_16x16x32_bf16 v[172:175], a[152:155], v[112:115], v[172:175]
    ds_read_b64_tr_b16 a[172:173], v245 offset:28736
    v_mfma_f32_16x16x32_bf16 v[172:175], a[156:159], v[124:127], v[172:175]
    ds_read_b64_tr_b16 a[174:175], v245 offset:30784
    v_cvt_pk_bf16_f32 v64, v160, v161
    v_mfma_f32_16x16x32_bf16 v[172:175], a[160:163], v[136:139], v[172:175]
    ds_read_b64_tr_b16 a[176:177], v245 offset:32832
    v_cvt_pk_bf16_f32 v65, v162, v163
    v_mfma_f32_16x16x32_bf16 v[172:175], a[164:167], v[148:151], v[172:175]
    ds_read_b64_tr_b16 a[178:179], v245 offset:34880
    v_cvt_pk_bf16_f32 v68, v164, v165
    v_mfma_f32_16x16x32_bf16 v[176:179], a[144:147], v[92:95], 0
    ds_read_b64_tr_b16 a[180:181], v245 offset:36928
    v_cvt_pk_bf16_f32 v69, v166, v167
    v_mfma_f32_16x16x32_bf16 v[176:179], a[148:151], v[104:107], v[176:179]
    ds_read_b64_tr_b16 a[182:183], v245 offset:38976
    v_cvt_pk_bf16_f32 v72, v168, v169
    v_mfma_f32_16x16x32_bf16 v[176:179], a[152:155], v[116:119], v[176:179]
    ds_read_b64_tr_b16 a[184:185], v245 offset:41024
    v_cvt_pk_bf16_f32 v73, v170, v171
    v_mfma_f32_16x16x32_bf16 v[176:179], a[156:159], v[128:131], v[176:179]
    ds_read_b64_tr_b16 a[186:187], v245 offset:43072
    v_mfma_f32_16x16x32_bf16 v[176:179], a[160:163], v[140:143], v[176:179]
    ds_read_b64_tr_b16 a[188:189], v245 offset:45120
    v_mfma_f32_16x16x32_bf16 v[176:179], a[164:167], v[152:155], v[176:179]
    ds_read_b64_tr_b16 a[190:191], v245 offset:47168
    v_mfma_f32_16x16x32_bf16 v[180:183], a[144:147], v[96:99], 0
    buffer_load_dwordx4 v13, s[12:15], s35 offen offset:1024 lds
    v_mfma_f32_16x16x32_bf16 v[180:183], a[148:151], v[108:111], v[180:183]
    v_mfma_f32_16x16x32_bf16 v[180:183], a[152:155], v[120:123], v[180:183]
    s_add_u32 m0, s29, 49280
    s_mov_b32 s36, 896
    v_mfma_f32_16x16x32_bf16 v[180:183], a[156:159], v[132:135], v[180:183]
    buffer_load_dwordx4 v8, s[16:19], s36 offen offset:0 lds
    v_mfma_f32_16x16x32_bf16 v[180:183], a[160:163], v[144:147], v[180:183]
    v_mfma_f32_16x16x32_bf16 v[180:183], a[164:167], v[156:159], v[180:183]
    buffer_load_dwordx4 v9, s[16:19], s36 offen offset:1024 lds
    s_waitcnt lgkmcnt(0)
    v_mfma_f32_16x16x32_bf16 v[172:175], a[168:171], a[192:195], v[172:175]
    ds_read_b64_tr_b16 a[144:145], v250 offset:24640
    v_mfma_f32_16x16x32_bf16 v[172:175], a[172:175], a[204:207], v[172:175]
    ds_read_b64_tr_b16 a[146:147], v250 offset:26688
    v_mfma_f32_16x16x32_bf16 v[172:175], a[176:179], a[216:219], v[172:175]
    ds_read_b64_tr_b16 a[148:149], v250 offset:28736
    v_mfma_f32_16x16x32_bf16 v[172:175], a[180:183], a[228:231], v[172:175]
    ds_read_b64_tr_b16 a[150:151], v250 offset:30784
    v_mfma_f32_16x16x32_bf16 v[172:175], a[184:187], a[240:243], v[172:175]
    ds_read_b64_tr_b16 a[152:153], v250 offset:32832
    v_mfma_f32_16x16x32_bf16 v[172:175], a[188:191], a[252:255], v[172:175]
    ds_read_b64_tr_b16 a[154:155], v250 offset:34880
    v_mfma_f32_16x16x32_bf16 v[176:179], a[168:171], a[196:199], v[176:179]
    ds_read_b64_tr_b16 a[156:157], v250 offset:36928
    v_mfma_f32_16x16x32_bf16 v[176:179], a[172:175], a[208:211], v[176:179]
    ds_read_b64_tr_b16 a[158:159], v250 offset:38976
    v_mfma_f32_16x16x32_bf16 v[176:179], a[176:179], a[220:223], v[176:179]
    ds_read_b64_tr_b16 a[160:161], v250 offset:41024
    v_mfma_f32_16x16x32_bf16 v[176:179], a[180:183], a[232:235], v[176:179]
    ds_read_b64_tr_b16 a[162:163], v250 offset:43072
    v_mfma_f32_16x16x32_bf16 v[176:179], a[184:187], a[244:247], v[176:179]
    ds_read_b64_tr_b16 a[164:165], v250 offset:45120
    v_mfma_f32_16x16x32_bf16 v[176:179], a[188:191], a[0:3], v[176:179]
    ds_read_b64_tr_b16 a[166:167], v250 offset:47168
    v_mfma_f32_16x16x32_bf16 v[180:183], a[168:171], a[200:203], v[180:183]
    v_mfma_f32_16x16x32_bf16 v[180:183], a[172:175], a[212:215], v[180:183]
    v_mfma_f32_16x16x32_bf16 v[180:183], a[176:179], a[224:227], v[180:183]
    buffer_load_dwordx4 v10, s[16:19], s36 offen offset:2048 lds
    v_mfma_f32_16x16x32_bf16 v[180:183], a[180:183], a[236:239], v[180:183]
    v_mfma_f32_16x16x32_bf16 v[180:183], a[184:187], a[248:251], v[180:183]
    buffer_load_dwordx4 v11, s[16:19], s36 offen offset:3072 lds
    v_mfma_f32_16x16x32_bf16 v[180:183], a[188:191], a[4:7], v[180:183]
    s_waitcnt lgkmcnt(0)
    v_mfma_f32_16x16x32_bf16 v[160:163], a[144:147], v[88:91], 0
    ds_read_b64_tr_b16 a[168:169], v246 offset:24640
    v_mfma_f32_16x16x32_bf16 v[160:163], a[148:151], v[100:103], v[160:163]
    ds_read_b64_tr_b16 a[170:171], v246 offset:26688
    v_mfma_f32_16x16x32_bf16 v[160:163], a[152:155], v[112:115], v[160:163]
    ds_read_b64_tr_b16 a[172:173], v246 offset:28736
    v_mfma_f32_16x16x32_bf16 v[160:163], a[156:159], v[124:127], v[160:163]
    ds_read_b64_tr_b16 a[174:175], v246 offset:30784
    v_cvt_pk_bf16_f32 v66, v172, v173
    v_mfma_f32_16x16x32_bf16 v[160:163], a[160:163], v[136:139], v[160:163]
    ds_read_b64_tr_b16 a[176:177], v246 offset:32832
    v_cvt_pk_bf16_f32 v67, v174, v175
    v_mfma_f32_16x16x32_bf16 v[160:163], a[164:167], v[148:151], v[160:163]
    ds_read_b64_tr_b16 a[178:179], v246 offset:34880
    v_cvt_pk_bf16_f32 v70, v176, v177
    v_mfma_f32_16x16x32_bf16 v[164:167], a[144:147], v[92:95], 0
    ds_read_b64_tr_b16 a[180:181], v246 offset:36928
    v_cvt_pk_bf16_f32 v71, v178, v179
    v_mfma_f32_16x16x32_bf16 v[164:167], a[148:151], v[104:107], v[164:167]
    ds_read_b64_tr_b16 a[182:183], v246 offset:38976
    v_cvt_pk_bf16_f32 v74, v180, v181
    v_mfma_f32_16x16x32_bf16 v[164:167], a[152:155], v[116:119], v[164:167]
    ds_read_b64_tr_b16 a[184:185], v246 offset:41024
    v_cvt_pk_bf16_f32 v75, v182, v183
    v_mfma_f32_16x16x32_bf16 v[164:167], a[156:159], v[128:131], v[164:167]
    ds_read_b64_tr_b16 a[186:187], v246 offset:43072
    v_mfma_f32_16x16x32_bf16 v[164:167], a[160:163], v[140:143], v[164:167]
    ds_read_b64_tr_b16 a[188:189], v246 offset:45120
    s_mov_b32 s45, 122880
    v_mfma_f32_16x16x32_bf16 v[164:167], a[164:167], v[152:155], v[164:167]
    ds_read_b64_tr_b16 a[190:191], v246 offset:47168
    buffer_store_dwordx4 v[64:67], v32, s[20:23], s45 offen offset:0 sc1
    v_mfma_f32_16x16x32_bf16 v[168:171], a[144:147], v[96:99], 0
    buffer_store_dwordx4 v[68:71], v32, s[20:23], s45 offen offset:1024 sc1
    v_mfma_f32_16x16x32_bf16 v[168:171], a[148:151], v[108:111], v[168:171]
    buffer_store_dwordx4 v[72:75], v32, s[20:23], s45 offen offset:2048 sc1
    v_mfma_f32_16x16x32_bf16 v[168:171], a[152:155], v[120:123], v[168:171]
    s_add_u32 s44, s48, 983040
    buffer_load_dwordx4 a[24:27], v7, s[4:7], s44 offen sc1
    v_mfma_f32_16x16x32_bf16 v[168:171], a[156:159], v[132:135], v[168:171]
    s_add_u32 s44, s48, 1228800
    buffer_load_dwordx4 a[28:31], v7, s[4:7], s44 offen sc1
    v_mfma_f32_16x16x32_bf16 v[168:171], a[160:163], v[144:147], v[168:171]
    s_add_u32 s44, s48, 1474560
    buffer_load_dwordx4 a[32:35], v7, s[4:7], s44 offen sc1
    v_mfma_f32_16x16x32_bf16 v[168:171], a[164:167], v[156:159], v[168:171]
    s_add_u32 s44, s48, 1720320
    buffer_load_dwordx4 a[36:39], v7, s[4:7], s44 offen sc1
    s_waitcnt lgkmcnt(0)
    v_mfma_f32_16x16x32_bf16 v[160:163], a[168:171], a[192:195], v[160:163]
    ds_read_b64_tr_b16 a[144:145], v251 offset:24640
    v_mfma_f32_16x16x32_bf16 v[160:163], a[172:175], a[204:207], v[160:163]
    ds_read_b64_tr_b16 a[146:147], v251 offset:26688
    v_mfma_f32_16x16x32_bf16 v[160:163], a[176:179], a[216:219], v[160:163]
    ds_read_b64_tr_b16 a[148:149], v251 offset:28736
    v_mfma_f32_16x16x32_bf16 v[160:163], a[180:183], a[228:231], v[160:163]
    ds_read_b64_tr_b16 a[150:151], v251 offset:30784
    v_mfma_f32_16x16x32_bf16 v[160:163], a[184:187], a[240:243], v[160:163]
    ds_read_b64_tr_b16 a[152:153], v251 offset:32832
    v_mfma_f32_16x16x32_bf16 v[160:163], a[188:191], a[252:255], v[160:163]
    ds_read_b64_tr_b16 a[154:155], v251 offset:34880
    v_mfma_f32_16x16x32_bf16 v[164:167], a[168:171], a[196:199], v[164:167]
    ds_read_b64_tr_b16 a[156:157], v251 offset:36928
    v_mfma_f32_16x16x32_bf16 v[164:167], a[172:175], a[208:211], v[164:167]
    ds_read_b64_tr_b16 a[158:159], v251 offset:38976
    v_mfma_f32_16x16x32_bf16 v[164:167], a[176:179], a[220:223], v[164:167]
    ds_read_b64_tr_b16 a[160:161], v251 offset:41024
    v_mfma_f32_16x16x32_bf16 v[164:167], a[180:183], a[232:235], v[164:167]
    ds_read_b64_tr_b16 a[162:163], v251 offset:43072
    v_mfma_f32_16x16x32_bf16 v[164:167], a[184:187], a[244:247], v[164:167]
    ds_read_b64_tr_b16 a[164:165], v251 offset:45120
    v_mfma_f32_16x16x32_bf16 v[164:167], a[188:191], a[0:3], v[164:167]
    ds_read_b64_tr_b16 a[166:167], v251 offset:47168
    v_mfma_f32_16x16x32_bf16 v[168:171], a[168:171], a[200:203], v[168:171]
    s_add_u32 m0, s29, 53376
    v_mfma_f32_16x16x32_bf16 v[168:171], a[172:175], a[212:215], v[168:171]
    buffer_load_dwordx4 v12, s[16:19], s36 offen offset:0 lds
    v_mfma_f32_16x16x32_bf16 v[168:171], a[176:179], a[224:227], v[168:171]
    v_mfma_f32_16x16x32_bf16 v[168:171], a[180:183], a[236:239], v[168:171]
    buffer_load_dwordx4 v13, s[16:19], s36 offen offset:1024 lds
    v_mfma_f32_16x16x32_bf16 v[168:171], a[184:187], a[248:251], v[168:171]
    v_mfma_f32_16x16x32_bf16 v[168:171], a[188:191], a[4:7], v[168:171]
    s_waitcnt lgkmcnt(0)
    v_mfma_f32_16x16x32_bf16 v[172:175], a[144:147], v[88:91], 0
    ds_read_b64_tr_b16 a[168:169], v247 offset:24640
    v_mfma_f32_16x16x32_bf16 v[172:175], a[148:151], v[100:103], v[172:175]
    ds_read_b64_tr_b16 a[170:171], v247 offset:26688
    v_mfma_f32_16x16x32_bf16 v[172:175], a[152:155], v[112:115], v[172:175]
    ds_read_b64_tr_b16 a[172:173], v247 offset:28736
    v_mfma_f32_16x16x32_bf16 v[172:175], a[156:159], v[124:127], v[172:175]
    ds_read_b64_tr_b16 a[174:175], v247 offset:30784
    v_cvt_pk_bf16_f32 v76, v160, v161
    v_mfma_f32_16x16x32_bf16 v[172:175], a[160:163], v[136:139], v[172:175]
    ds_read_b64_tr_b16 a[176:177], v247 offset:32832
    v_cvt_pk_bf16_f32 v77, v162, v163
    v_mfma_f32_16x16x32_bf16 v[172:175], a[164:167], v[148:151], v[172:175]
    ds_read_b64_tr_b16 a[178:179], v247 offset:34880
    v_cvt_pk_bf16_f32 v80, v164, v165
    v_mfma_f32_16x16x32_bf16 v[176:179], a[144:147], v[92:95], 0
    ds_read_b64_tr_b16 a[180:181], v247 offset:36928
    v_cvt_pk_bf16_f32 v81, v166, v167
    v_mfma_f32_16x16x32_bf16 v[176:179], a[148:151], v[104:107], v[176:179]
    ds_read_b64_tr_b16 a[182:183], v247 offset:38976
    v_cvt_pk_bf16_f32 v84, v168, v169
    v_mfma_f32_16x16x32_bf16 v[176:179], a[152:155], v[116:119], v[176:179]
    ds_read_b64_tr_b16 a[184:185], v247 offset:41024
    v_cvt_pk_bf16_f32 v85, v170, v171
    v_mfma_f32_16x16x32_bf16 v[176:179], a[156:159], v[128:131], v[176:179]
    ds_read_b64_tr_b16 a[186:187], v247 offset:43072
    v_mfma_f32_16x16x32_bf16 v[176:179], a[160:163], v[140:143], v[176:179]
    ds_read_b64_tr_b16 a[188:189], v247 offset:45120
    v_mfma_f32_16x16x32_bf16 v[176:179], a[164:167], v[152:155], v[176:179]
    ds_read_b64_tr_b16 a[190:191], v247 offset:47168
    v_mfma_f32_16x16x32_bf16 v[180:183], a[144:147], v[96:99], 0
    v_mfma_f32_16x16x32_bf16 v[180:183], a[148:151], v[108:111], v[180:183]
    v_mfma_f32_16x16x32_bf16 v[180:183], a[152:155], v[120:123], v[180:183]
    v_mfma_f32_16x16x32_bf16 v[180:183], a[156:159], v[132:135], v[180:183]
    v_mfma_f32_16x16x32_bf16 v[180:183], a[160:163], v[144:147], v[180:183]
    v_mfma_f32_16x16x32_bf16 v[180:183], a[164:167], v[156:159], v[180:183]
    s_waitcnt vmcnt(20)
    s_waitcnt lgkmcnt(0)
    s_barrier
    v_mov_b32 v37, 2
    buffer_store_dword v37, v33, s[24:27], 0 offen sc1
    v_mfma_f32_16x16x32_bf16 v[172:175], a[168:171], a[192:195], v[172:175]
    ds_read_b64_tr_b16 a[144:145], v252 offset:0
    v_mfma_f32_16x16x32_bf16 v[172:175], a[172:175], a[204:207], v[172:175]
    ds_read_b64_tr_b16 a[146:147], v252 offset:2048
    v_mfma_f32_16x16x32_bf16 v[172:175], a[176:179], a[216:219], v[172:175]
    ds_read_b64_tr_b16 a[148:149], v252 offset:4096
    v_mfma_f32_16x16x32_bf16 v[172:175], a[180:183], a[228:231], v[172:175]
    ds_read_b64_tr_b16 a[150:151], v252 offset:6144
    v_mfma_f32_16x16x32_bf16 v[172:175], a[184:187], a[240:243], v[172:175]
    ds_read_b64_tr_b16 a[152:153], v252 offset:8192
    v_mfma_f32_16x16x32_bf16 v[172:175], a[188:191], a[252:255], v[172:175]
    ds_read_b64_tr_b16 a[154:155], v252 offset:10240
    v_mfma_f32_16x16x32_bf16 v[176:179], a[168:171], a[196:199], v[176:179]
    ds_read_b64_tr_b16 a[156:157], v252 offset:12288
    v_mfma_f32_16x16x32_bf16 v[176:179], a[172:175], a[208:211], v[176:179]
    ds_read_b64_tr_b16 a[158:159], v252 offset:14336
    v_mfma_f32_16x16x32_bf16 v[176:179], a[176:179], a[220:223], v[176:179]
    ds_read_b64_tr_b16 a[160:161], v252 offset:16384
    v_mfma_f32_16x16x32_bf16 v[176:179], a[180:183], a[232:235], v[176:179]
    ds_read_b64_tr_b16 a[162:163], v252 offset:18432
    v_mfma_f32_16x16x32_bf16 v[176:179], a[184:187], a[244:247], v[176:179]
    ds_read_b64_tr_b16 a[164:165], v252 offset:20480
    v_mfma_f32_16x16x32_bf16 v[176:179], a[188:191], a[0:3], v[176:179]
    ds_read_b64_tr_b16 a[166:167], v252 offset:22528
    s_add_u32 m0, s29, 73920
    s_mov_b32 s35, 1024
    v_mfma_f32_16x16x32_bf16 v[180:183], a[168:171], a[200:203], v[180:183]
    buffer_load_dwordx4 v8, s[12:15], s35 offen offset:0 lds
    v_mfma_f32_16x16x32_bf16 v[180:183], a[172:175], a[212:215], v[180:183]
    v_mfma_f32_16x16x32_bf16 v[180:183], a[176:179], a[224:227], v[180:183]
    buffer_load_dwordx4 v9, s[12:15], s35 offen offset:1024 lds
    v_mfma_f32_16x16x32_bf16 v[180:183], a[180:183], a[236:239], v[180:183]
    v_mfma_f32_16x16x32_bf16 v[180:183], a[184:187], a[248:251], v[180:183]
    v_mfma_f32_16x16x32_bf16 v[180:183], a[188:191], a[4:7], v[180:183]
    buffer_load_dwordx4 v10, s[12:15], s35 offen offset:2048 lds
    s_waitcnt lgkmcnt(0)
    v_mfma_f32_16x16x32_bf16 v[160:163], a[144:147], v[88:91], 0
    ds_read_b64_tr_b16 a[168:169], v244 offset:0
    v_mfma_f32_16x16x32_bf16 v[160:163], a[148:151], v[100:103], v[160:163]
    ds_read_b64_tr_b16 a[170:171], v244 offset:2048
    v_mfma_f32_16x16x32_bf16 v[160:163], a[152:155], v[112:115], v[160:163]
    ds_read_b64_tr_b16 a[172:173], v244 offset:4096
    v_mfma_f32_16x16x32_bf16 v[160:163], a[156:159], v[124:127], v[160:163]
    ds_read_b64_tr_b16 a[174:175], v244 offset:6144
    v_cvt_pk_bf16_f32 v78, v172, v173
    v_mfma_f32_16x16x32_bf16 v[160:163], a[160:163], v[136:139], v[160:163]
    ds_read_b64_tr_b16 a[176:177], v244 offset:8192
    v_cvt_pk_bf16_f32 v79, v174, v175
    v_mfma_f32_16x16x32_bf16 v[160:163], a[164:167], v[148:151], v[160:163]
    ds_read_b64_tr_b16 a[178:179], v244 offset:10240
    v_cvt_pk_bf16_f32 v82, v176, v177
    v_mfma_f32_16x16x32_bf16 v[164:167], a[144:147], v[92:95], 0
    ds_read_b64_tr_b16 a[180:181], v244 offset:12288
    v_cvt_pk_bf16_f32 v83, v178, v179
    v_mfma_f32_16x16x32_bf16 v[164:167], a[148:151], v[104:107], v[164:167]
    ds_read_b64_tr_b16 a[182:183], v244 offset:14336
    v_cvt_pk_bf16_f32 v86, v180, v181
    v_mfma_f32_16x16x32_bf16 v[164:167], a[152:155], v[116:119], v[164:167]
    ds_read_b64_tr_b16 a[184:185], v244 offset:16384
    v_cvt_pk_bf16_f32 v87, v182, v183
    v_mfma_f32_16x16x32_bf16 v[164:167], a[156:159], v[128:131], v[164:167]
    ds_read_b64_tr_b16 a[186:187], v244 offset:18432
    v_mfma_f32_16x16x32_bf16 v[164:167], a[160:163], v[140:143], v[164:167]
    ds_read_b64_tr_b16 a[188:189], v244 offset:20480
    s_mov_b32 s45, 135168
    v_mfma_f32_16x16x32_bf16 v[164:167], a[164:167], v[152:155], v[164:167]
    ds_read_b64_tr_b16 a[190:191], v244 offset:22528
    buffer_store_dwordx4 v[76:79], v32, s[20:23], s45 offen offset:0 sc1
    v_mfma_f32_16x16x32_bf16 v[168:171], a[144:147], v[96:99], 0
    buffer_store_dwordx4 v[80:83], v32, s[20:23], s45 offen offset:1024 sc1
    v_mfma_f32_16x16x32_bf16 v[168:171], a[148:151], v[108:111], v[168:171]
    buffer_store_dwordx4 v[84:87], v32, s[20:23], s45 offen offset:2048 sc1
    v_mfma_f32_16x16x32_bf16 v[168:171], a[152:155], v[120:123], v[168:171]
    s_add_u32 s44, s48, 1966080
    buffer_load_dwordx4 a[40:43], v7, s[4:7], s44 offen sc1
    v_mfma_f32_16x16x32_bf16 v[168:171], a[156:159], v[132:135], v[168:171]
    s_add_u32 s44, s48, 2211840
    buffer_load_dwordx4 a[44:47], v7, s[4:7], s44 offen sc1
    v_mfma_f32_16x16x32_bf16 v[168:171], a[160:163], v[144:147], v[168:171]
    s_add_u32 s44, s48, 2457600
    buffer_load_dwordx4 a[48:51], v7, s[4:7], s44 offen sc1
    v_mfma_f32_16x16x32_bf16 v[168:171], a[164:167], v[156:159], v[168:171]
    s_add_u32 s44, s48, 2703360
    buffer_load_dwordx4 a[52:55], v7, s[4:7], s44 offen sc1
    s_waitcnt lgkmcnt(0)
    v_mfma_f32_16x16x32_bf16 v[160:163], a[168:171], a[192:195], v[160:163]
    ds_read_b64_tr_b16 a[144:145], v253 offset:0
    v_mfma_f32_16x16x32_bf16 v[160:163], a[172:175], a[204:207], v[160:163]
    ds_read_b64_tr_b16 a[146:147], v253 offset:2048
    v_mfma_f32_16x16x32_bf16 v[160:163], a[176:179], a[216:219], v[160:163]
    ds_read_b64_tr_b16 a[148:149], v253 offset:4096
    v_mfma_f32_16x16x32_bf16 v[160:163], a[180:183], a[228:231], v[160:163]
    ds_read_b64_tr_b16 a[150:151], v253 offset:6144
    v_mfma_f32_16x16x32_bf16 v[160:163], a[184:187], a[240:243], v[160:163]
    ds_read_b64_tr_b16 a[152:153], v253 offset:8192
    v_mfma_f32_16x16x32_bf16 v[160:163], a[188:191], a[252:255], v[160:163]
    ds_read_b64_tr_b16 a[154:155], v253 offset:10240
    v_mfma_f32_16x16x32_bf16 v[164:167], a[168:171], a[196:199], v[164:167]
    ds_read_b64_tr_b16 a[156:157], v253 offset:12288
    v_mfma_f32_16x16x32_bf16 v[164:167], a[172:175], a[208:211], v[164:167]
    ds_read_b64_tr_b16 a[158:159], v253 offset:14336
    v_mfma_f32_16x16x32_bf16 v[164:167], a[176:179], a[220:223], v[164:167]
    ds_read_b64_tr_b16 a[160:161], v253 offset:16384
    v_mfma_f32_16x16x32_bf16 v[164:167], a[180:183], a[232:235], v[164:167]
    ds_read_b64_tr_b16 a[162:163], v253 offset:18432
    v_mfma_f32_16x16x32_bf16 v[164:167], a[184:187], a[244:247], v[164:167]
    ds_read_b64_tr_b16 a[164:165], v253 offset:20480
    v_mfma_f32_16x16x32_bf16 v[164:167], a[188:191], a[0:3], v[164:167]
    ds_read_b64_tr_b16 a[166:167], v253 offset:22528
    v_mfma_f32_16x16x32_bf16 v[168:171], a[168:171], a[200:203], v[168:171]
    v_mfma_f32_16x16x32_bf16 v[168:171], a[172:175], a[212:215], v[168:171]
    buffer_load_dwordx4 v11, s[12:15], s35 offen offset:3072 lds
    v_mfma_f32_16x16x32_bf16 v[168:171], a[176:179], a[224:227], v[168:171]
    v_mfma_f32_16x16x32_bf16 v[168:171], a[180:183], a[236:239], v[168:171]
    s_add_u32 m0, s29, 78016
    v_mfma_f32_16x16x32_bf16 v[168:171], a[184:187], a[248:251], v[168:171]
    buffer_load_dwordx4 v12, s[12:15], s35 offen offset:0 lds
    v_mfma_f32_16x16x32_bf16 v[168:171], a[188:191], a[4:7], v[168:171]
    s_waitcnt lgkmcnt(0)
    v_mfma_f32_16x16x32_bf16 v[172:175], a[144:147], v[88:91], 0
    ds_read_b64_tr_b16 a[168:169], v245 offset:0
    v_mfma_f32_16x16x32_bf16 v[172:175], a[148:151], v[100:103], v[172:175]
    ds_read_b64_tr_b16 a[170:171], v245 offset:2048
    v_mfma_f32_16x16x32_bf16 v[172:175], a[152:155], v[112:115], v[172:175]
    ds_read_b64_tr_b16 a[172:173], v245 offset:4096
    v_mfma_f32_16x16x32_bf16 v[172:175], a[156:159], v[124:127], v[172:175]
    ds_read_b64_tr_b16 a[174:175], v245 offset:6144
    v_cvt_pk_bf16_f32 v208, v160, v161
    v_mfma_f32_16x16x32_bf16 v[172:175], a[160:163], v[136:139], v[172:175]
    ds_read_b64_tr_b16 a[176:177], v245 offset:8192
    v_cvt_pk_bf16_f32 v209, v162, v163
    v_mfma_f32_16x16x32_bf16 v[172:175], a[164:167], v[148:151], v[172:175]
    ds_read_b64_tr_b16 a[178:179], v245 offset:10240
    v_cvt_pk_bf16_f32 v212, v164, v165
    v_mfma_f32_16x16x32_bf16 v[176:179], a[144:147], v[92:95], 0
    ds_read_b64_tr_b16 a[180:181], v245 offset:12288
    v_cvt_pk_bf16_f32 v213, v166, v167
    v_mfma_f32_16x16x32_bf16 v[176:179], a[148:151], v[104:107], v[176:179]
    ds_read_b64_tr_b16 a[182:183], v245 offset:14336
    v_cvt_pk_bf16_f32 v216, v168, v169
    v_mfma_f32_16x16x32_bf16 v[176:179], a[152:155], v[116:119], v[176:179]
    ds_read_b64_tr_b16 a[184:185], v245 offset:16384
    v_cvt_pk_bf16_f32 v217, v170, v171
    v_mfma_f32_16x16x32_bf16 v[176:179], a[156:159], v[128:131], v[176:179]
    ds_read_b64_tr_b16 a[186:187], v245 offset:18432
    v_mfma_f32_16x16x32_bf16 v[176:179], a[160:163], v[140:143], v[176:179]
    ds_read_b64_tr_b16 a[188:189], v245 offset:20480
    v_mfma_f32_16x16x32_bf16 v[176:179], a[164:167], v[152:155], v[176:179]
    ds_read_b64_tr_b16 a[190:191], v245 offset:22528
    v_mfma_f32_16x16x32_bf16 v[180:183], a[144:147], v[96:99], 0
    buffer_load_dwordx4 v13, s[12:15], s35 offen offset:1024 lds
    v_mfma_f32_16x16x32_bf16 v[180:183], a[148:151], v[108:111], v[180:183]
    v_mfma_f32_16x16x32_bf16 v[180:183], a[152:155], v[120:123], v[180:183]
    s_add_u32 m0, s29, 24640
    s_mov_b32 s36, 1024
    v_mfma_f32_16x16x32_bf16 v[180:183], a[156:159], v[132:135], v[180:183]
    buffer_load_dwordx4 v8, s[16:19], s36 offen offset:0 lds
    v_mfma_f32_16x16x32_bf16 v[180:183], a[160:163], v[144:147], v[180:183]
    v_mfma_f32_16x16x32_bf16 v[180:183], a[164:167], v[156:159], v[180:183]
    buffer_load_dwordx4 v9, s[16:19], s36 offen offset:1024 lds
    s_waitcnt lgkmcnt(0)
    v_mfma_f32_16x16x32_bf16 v[172:175], a[168:171], a[192:195], v[172:175]
    ds_read_b64_tr_b16 a[144:145], v254 offset:0
    v_mfma_f32_16x16x32_bf16 v[172:175], a[172:175], a[204:207], v[172:175]
    ds_read_b64_tr_b16 a[146:147], v254 offset:2048
    v_mfma_f32_16x16x32_bf16 v[172:175], a[176:179], a[216:219], v[172:175]
    ds_read_b64_tr_b16 a[148:149], v254 offset:4096
    v_mfma_f32_16x16x32_bf16 v[172:175], a[180:183], a[228:231], v[172:175]
    ds_read_b64_tr_b16 a[150:151], v254 offset:6144
    v_mfma_f32_16x16x32_bf16 v[172:175], a[184:187], a[240:243], v[172:175]
    ds_read_b64_tr_b16 a[152:153], v254 offset:8192
    v_mfma_f32_16x16x32_bf16 v[172:175], a[188:191], a[252:255], v[172:175]
    ds_read_b64_tr_b16 a[154:155], v254 offset:10240
    v_mfma_f32_16x16x32_bf16 v[176:179], a[168:171], a[196:199], v[176:179]
    ds_read_b64_tr_b16 a[156:157], v254 offset:12288
    v_mfma_f32_16x16x32_bf16 v[176:179], a[172:175], a[208:211], v[176:179]
    ds_read_b64_tr_b16 a[158:159], v254 offset:14336
    v_mfma_f32_16x16x32_bf16 v[176:179], a[176:179], a[220:223], v[176:179]
    ds_read_b64_tr_b16 a[160:161], v254 offset:16384
    v_mfma_f32_16x16x32_bf16 v[176:179], a[180:183], a[232:235], v[176:179]
    ds_read_b64_tr_b16 a[162:163], v254 offset:18432
    v_mfma_f32_16x16x32_bf16 v[176:179], a[184:187], a[244:247], v[176:179]
    ds_read_b64_tr_b16 a[164:165], v254 offset:20480
    v_mfma_f32_16x16x32_bf16 v[176:179], a[188:191], a[0:3], v[176:179]
    ds_read_b64_tr_b16 a[166:167], v254 offset:22528
    v_mfma_f32_16x16x32_bf16 v[180:183], a[168:171], a[200:203], v[180:183]
    v_mfma_f32_16x16x32_bf16 v[180:183], a[172:175], a[212:215], v[180:183]
    v_mfma_f32_16x16x32_bf16 v[180:183], a[176:179], a[224:227], v[180:183]
    buffer_load_dwordx4 v10, s[16:19], s36 offen offset:2048 lds
    v_mfma_f32_16x16x32_bf16 v[180:183], a[180:183], a[236:239], v[180:183]
    v_mfma_f32_16x16x32_bf16 v[180:183], a[184:187], a[248:251], v[180:183]
    buffer_load_dwordx4 v11, s[16:19], s36 offen offset:3072 lds
    v_mfma_f32_16x16x32_bf16 v[180:183], a[188:191], a[4:7], v[180:183]
    s_waitcnt lgkmcnt(0)
    v_mfma_f32_16x16x32_bf16 v[160:163], a[144:147], v[88:91], 0
    ds_read_b64_tr_b16 a[168:169], v246 offset:0
    v_mfma_f32_16x16x32_bf16 v[160:163], a[148:151], v[100:103], v[160:163]
    ds_read_b64_tr_b16 a[170:171], v246 offset:2048
    v_mfma_f32_16x16x32_bf16 v[160:163], a[152:155], v[112:115], v[160:163]
    ds_read_b64_tr_b16 a[172:173], v246 offset:4096
    v_mfma_f32_16x16x32_bf16 v[160:163], a[156:159], v[124:127], v[160:163]
    ds_read_b64_tr_b16 a[174:175], v246 offset:6144
    v_cvt_pk_bf16_f32 v210, v172, v173
    v_mfma_f32_16x16x32_bf16 v[160:163], a[160:163], v[136:139], v[160:163]
    ds_read_b64_tr_b16 a[176:177], v246 offset:8192
    v_cvt_pk_bf16_f32 v211, v174, v175
    v_mfma_f32_16x16x32_bf16 v[160:163], a[164:167], v[148:151], v[160:163]
    ds_read_b64_tr_b16 a[178:179], v246 offset:10240
    v_cvt_pk_bf16_f32 v214, v176, v177
    v_mfma_f32_16x16x32_bf16 v[164:167], a[144:147], v[92:95], 0
    ds_read_b64_tr_b16 a[180:181], v246 offset:12288
    v_cvt_pk_bf16_f32 v215, v178, v179
    v_mfma_f32_16x16x32_bf16 v[164:167], a[148:151], v[104:107], v[164:167]
    ds_read_b64_tr_b16 a[182:183], v246 offset:14336
    v_cvt_pk_bf16_f32 v218, v180, v181
    v_mfma_f32_16x16x32_bf16 v[164:167], a[152:155], v[116:119], v[164:167]
    ds_read_b64_tr_b16 a[184:185], v246 offset:16384
    v_cvt_pk_bf16_f32 v219, v182, v183
    v_mfma_f32_16x16x32_bf16 v[164:167], a[156:159], v[128:131], v[164:167]
    ds_read_b64_tr_b16 a[186:187], v246 offset:18432
    v_mfma_f32_16x16x32_bf16 v[164:167], a[160:163], v[140:143], v[164:167]
    ds_read_b64_tr_b16 a[188:189], v246 offset:20480
    s_mov_b32 s45, 147456
    buffer_load_dword v1, v34, s[24:27], 0 offen sc1
    v_mfma_f32_16x16x32_bf16 v[164:167], a[164:167], v[152:155], v[164:167]
    ds_read_b64_tr_b16 a[190:191], v246 offset:22528
    buffer_store_dwordx4 v[208:211], v32, s[20:23], s45 offen offset:0 sc1
    v_mfma_f32_16x16x32_bf16 v[168:171], a[144:147], v[96:99], 0
    buffer_store_dwordx4 v[212:215], v32, s[20:23], s45 offen offset:1024 sc1
    v_mfma_f32_16x16x32_bf16 v[168:171], a[148:151], v[108:111], v[168:171]
    buffer_store_dwordx4 v[216:219], v32, s[20:23], s45 offen offset:2048 sc1
    v_mfma_f32_16x16x32_bf16 v[168:171], a[152:155], v[120:123], v[168:171]
    s_add_u32 s44, s48, 2949120
    buffer_load_dwordx4 a[56:59], v7, s[4:7], s44 offen sc1
    v_mfma_f32_16x16x32_bf16 v[168:171], a[156:159], v[132:135], v[168:171]
    s_add_u32 s44, s48, 3194880
    buffer_load_dwordx4 a[60:63], v7, s[4:7], s44 offen sc1
    v_mfma_f32_16x16x32_bf16 v[168:171], a[160:163], v[144:147], v[168:171]
    s_add_u32 s44, s48, 3440640
    buffer_load_dwordx4 a[64:67], v7, s[4:7], s44 offen sc1
    v_mfma_f32_16x16x32_bf16 v[168:171], a[164:167], v[156:159], v[168:171]
    s_add_u32 s44, s48, 3686400
    buffer_load_dwordx4 a[68:71], v7, s[4:7], s44 offen sc1
    s_waitcnt lgkmcnt(0)
    v_mfma_f32_16x16x32_bf16 v[160:163], a[168:171], a[192:195], v[160:163]
    ds_read_b64_tr_b16 a[144:145], v255 offset:0
    v_mfma_f32_16x16x32_bf16 v[160:163], a[172:175], a[204:207], v[160:163]
    ds_read_b64_tr_b16 a[146:147], v255 offset:2048
    v_mfma_f32_16x16x32_bf16 v[160:163], a[176:179], a[216:219], v[160:163]
    ds_read_b64_tr_b16 a[148:149], v255 offset:4096
    v_mfma_f32_16x16x32_bf16 v[160:163], a[180:183], a[228:231], v[160:163]
    ds_read_b64_tr_b16 a[150:151], v255 offset:6144
    v_mfma_f32_16x16x32_bf16 v[160:163], a[184:187], a[240:243], v[160:163]
    ds_read_b64_tr_b16 a[152:153], v255 offset:8192
    v_mfma_f32_16x16x32_bf16 v[160:163], a[188:191], a[252:255], v[160:163]
    ds_read_b64_tr_b16 a[154:155], v255 offset:10240
    v_mfma_f32_16x16x32_bf16 v[164:167], a[168:171], a[196:199], v[164:167]
    ds_read_b64_tr_b16 a[156:157], v255 offset:12288
    v_mfma_f32_16x16x32_bf16 v[164:167], a[172:175], a[208:211], v[164:167]
    ds_read_b64_tr_b16 a[158:159], v255 offset:14336
    v_mfma_f32_16x16x32_bf16 v[164:167], a[176:179], a[220:223], v[164:167]
    ds_read_b64_tr_b16 a[160:161], v255 offset:16384
    v_mfma_f32_16x16x32_bf16 v[164:167], a[180:183], a[232:235], v[164:167]
    ds_read_b64_tr_b16 a[162:163], v255 offset:18432
    v_mfma_f32_16x16x32_bf16 v[164:167], a[184:187], a[244:247], v[164:167]
    ds_read_b64_tr_b16 a[164:165], v255 offset:20480
    v_mfma_f32_16x16x32_bf16 v[164:167], a[188:191], a[0:3], v[164:167]
    ds_read_b64_tr_b16 a[166:167], v255 offset:22528
    v_mfma_f32_16x16x32_bf16 v[168:171], a[168:171], a[200:203], v[168:171]
    s_add_u32 m0, s29, 28736
    v_mfma_f32_16x16x32_bf16 v[168:171], a[172:175], a[212:215], v[168:171]
    buffer_load_dwordx4 v12, s[16:19], s36 offen offset:0 lds
    v_mfma_f32_16x16x32_bf16 v[168:171], a[176:179], a[224:227], v[168:171]
    v_mfma_f32_16x16x32_bf16 v[168:171], a[180:183], a[236:239], v[168:171]
    buffer_load_dwordx4 v13, s[16:19], s36 offen offset:1024 lds
    v_mfma_f32_16x16x32_bf16 v[168:171], a[184:187], a[248:251], v[168:171]
    v_mfma_f32_16x16x32_bf16 v[168:171], a[188:191], a[4:7], v[168:171]
    s_waitcnt lgkmcnt(0)
    v_mfma_f32_16x16x32_bf16 v[172:175], a[144:147], v[88:91], 0
    ds_read_b64_tr_b16 a[168:169], v247 offset:0
    v_mfma_f32_16x16x32_bf16 v[172:175], a[148:151], v[100:103], v[172:175]
    ds_read_b64_tr_b16 a[170:171], v247 offset:2048
    v_mfma_f32_16x16x32_bf16 v[172:175], a[152:155], v[112:115], v[172:175]
    ds_read_b64_tr_b16 a[172:173], v247 offset:4096
    v_mfma_f32_16x16x32_bf16 v[172:175], a[156:159], v[124:127], v[172:175]
    ds_read_b64_tr_b16 a[174:175], v247 offset:6144
    v_cvt_pk_bf16_f32 v220, v160, v161
    v_mfma_f32_16x16x32_bf16 v[172:175], a[160:163], v[136:139], v[172:175]
    ds_read_b64_tr_b16 a[176:177], v247 offset:8192
    v_cvt_pk_bf16_f32 v221, v162, v163
    v_mfma_f32_16x16x32_bf16 v[172:175], a[164:167], v[148:151], v[172:175]
    ds_read_b64_tr_b16 a[178:179], v247 offset:10240
    v_cvt_pk_bf16_f32 v224, v164, v165
    v_mfma_f32_16x16x32_bf16 v[176:179], a[144:147], v[92:95], 0
    ds_read_b64_tr_b16 a[180:181], v247 offset:12288
    v_cvt_pk_bf16_f32 v225, v166, v167
    v_mfma_f32_16x16x32_bf16 v[176:179], a[148:151], v[104:107], v[176:179]
    ds_read_b64_tr_b16 a[182:183], v247 offset:14336
    v_cvt_pk_bf16_f32 v228, v168, v169
    v_mfma_f32_16x16x32_bf16 v[176:179], a[152:155], v[116:119], v[176:179]
    ds_read_b64_tr_b16 a[184:185], v247 offset:16384
    v_cvt_pk_bf16_f32 v229, v170, v171
    v_mfma_f32_16x16x32_bf16 v[176:179], a[156:159], v[128:131], v[176:179]
    ds_read_b64_tr_b16 a[186:187], v247 offset:18432
    v_mfma_f32_16x16x32_bf16 v[176:179], a[160:163], v[140:143], v[176:179]
    ds_read_b64_tr_b16 a[188:189], v247 offset:20480
    v_mfma_f32_16x16x32_bf16 v[176:179], a[164:167], v[152:155], v[176:179]
    ds_read_b64_tr_b16 a[190:191], v247 offset:22528
    v_mfma_f32_16x16x32_bf16 v[180:183], a[144:147], v[96:99], 0
    v_mfma_f32_16x16x32_bf16 v[180:183], a[148:151], v[108:111], v[180:183]
    v_mfma_f32_16x16x32_bf16 v[180:183], a[152:155], v[120:123], v[180:183]
    v_mfma_f32_16x16x32_bf16 v[180:183], a[156:159], v[132:135], v[180:183]
    v_mfma_f32_16x16x32_bf16 v[180:183], a[160:163], v[144:147], v[180:183]
    v_mfma_f32_16x16x32_bf16 v[180:183], a[164:167], v[156:159], v[180:183]
    s_waitcnt vmcnt(28)
    s_waitcnt lgkmcnt(0)
    s_barrier
    v_mfma_f32_16x16x32_bf16 v[172:175], a[168:171], a[192:195], v[172:175]
    ds_read_b64_tr_b16 a[144:145], v252 offset:24640
    v_mfma_f32_16x16x32_bf16 v[172:175], a[172:175], a[204:207], v[172:175]
    ds_read_b64_tr_b16 a[146:147], v252 offset:26688
    v_mfma_f32_16x16x32_bf16 v[172:175], a[176:179], a[216:219], v[172:175]
    ds_read_b64_tr_b16 a[148:149], v252 offset:28736
    v_mfma_f32_16x16x32_bf16 v[172:175], a[180:183], a[228:231], v[172:175]
    ds_read_b64_tr_b16 a[150:151], v252 offset:30784
    v_mfma_f32_16x16x32_bf16 v[172:175], a[184:187], a[240:243], v[172:175]
    ds_read_b64_tr_b16 a[152:153], v252 offset:32832
    v_mfma_f32_16x16x32_bf16 v[172:175], a[188:191], a[252:255], v[172:175]
    ds_read_b64_tr_b16 a[154:155], v252 offset:34880
    v_mfma_f32_16x16x32_bf16 v[176:179], a[168:171], a[196:199], v[176:179]
    ds_read_b64_tr_b16 a[156:157], v252 offset:36928
    v_mfma_f32_16x16x32_bf16 v[176:179], a[172:175], a[208:211], v[176:179]
    ds_read_b64_tr_b16 a[158:159], v252 offset:38976
    v_mfma_f32_16x16x32_bf16 v[176:179], a[176:179], a[220:223], v[176:179]
    ds_read_b64_tr_b16 a[160:161], v252 offset:41024
    v_mfma_f32_16x16x32_bf16 v[176:179], a[180:183], a[232:235], v[176:179]
    ds_read_b64_tr_b16 a[162:163], v252 offset:43072
    v_mfma_f32_16x16x32_bf16 v[176:179], a[184:187], a[244:247], v[176:179]
    ds_read_b64_tr_b16 a[164:165], v252 offset:45120
    v_mfma_f32_16x16x32_bf16 v[176:179], a[188:191], a[0:3], v[176:179]
    ds_read_b64_tr_b16 a[166:167], v252 offset:47168
    s_add_u32 m0, s29, 98560
    s_mov_b32 s35, 1152
    v_mfma_f32_16x16x32_bf16 v[180:183], a[168:171], a[200:203], v[180:183]
    buffer_load_dwordx4 v8, s[12:15], s35 offen offset:0 lds
    v_mfma_f32_16x16x32_bf16 v[180:183], a[172:175], a[212:215], v[180:183]
    v_mfma_f32_16x16x32_bf16 v[180:183], a[176:179], a[224:227], v[180:183]
    buffer_load_dwordx4 v9, s[12:15], s35 offen offset:1024 lds
    v_mfma_f32_16x16x32_bf16 v[180:183], a[180:183], a[236:239], v[180:183]
    v_mfma_f32_16x16x32_bf16 v[180:183], a[184:187], a[248:251], v[180:183]
    v_mfma_f32_16x16x32_bf16 v[180:183], a[188:191], a[4:7], v[180:183]
    buffer_load_dwordx4 v10, s[12:15], s35 offen offset:2048 lds
    s_waitcnt lgkmcnt(0)
    v_mfma_f32_16x16x32_bf16 v[160:163], a[144:147], v[88:91], 0
    ds_read_b64_tr_b16 a[168:169], v248 offset:0
    v_mfma_f32_16x16x32_bf16 v[160:163], a[148:151], v[100:103], v[160:163]
    ds_read_b64_tr_b16 a[170:171], v248 offset:2048
    v_mfma_f32_16x16x32_bf16 v[160:163], a[152:155], v[112:115], v[160:163]
    ds_read_b64_tr_b16 a[172:173], v248 offset:4096
    v_mfma_f32_16x16x32_bf16 v[160:163], a[156:159], v[124:127], v[160:163]
    ds_read_b64_tr_b16 a[174:175], v248 offset:6144
    v_cvt_pk_bf16_f32 v222, v172, v173
    v_mfma_f32_16x16x32_bf16 v[160:163], a[160:163], v[136:139], v[160:163]
    ds_read_b64_tr_b16 a[176:177], v248 offset:8192
    v_cvt_pk_bf16_f32 v223, v174, v175
    v_mfma_f32_16x16x32_bf16 v[160:163], a[164:167], v[148:151], v[160:163]
    ds_read_b64_tr_b16 a[178:179], v248 offset:10240
    v_cvt_pk_bf16_f32 v226, v176, v177
    v_mfma_f32_16x16x32_bf16 v[164:167], a[144:147], v[92:95], 0
    ds_read_b64_tr_b16 a[180:181], v248 offset:12288
    v_cvt_pk_bf16_f32 v227, v178, v179
    v_mfma_f32_16x16x32_bf16 v[164:167], a[148:151], v[104:107], v[164:167]
    ds_read_b64_tr_b16 a[182:183], v248 offset:14336
    v_cvt_pk_bf16_f32 v230, v180, v181
    v_mfma_f32_16x16x32_bf16 v[164:167], a[152:155], v[116:119], v[164:167]
    ds_read_b64_tr_b16 a[184:185], v248 offset:16384
    v_cvt_pk_bf16_f32 v231, v182, v183
    s_waitcnt vmcnt(12)
    v_cmp_gt_u32 vcc, 2, v1
    s_cbranch_vccnz L_spin_1
L_ready_1:
    v_mfma_f32_16x16x32_bf16 v[164:167], a[156:159], v[128:131], v[164:167]
    ds_read_b64_tr_b16 a[186:187], v248 offset:18432
    v_mfma_f32_16x16x32_bf16 v[164:167], a[160:163], v[140:143], v[164:167]
    ds_read_b64_tr_b16 a[188:189], v248 offset:20480
    s_mov_b32 s45, 159744
    v_mfma_f32_16x16x32_bf16 v[164:167], a[164:167], v[152:155], v[164:167]
    ds_read_b64_tr_b16 a[190:191], v248 offset:22528
    buffer_store_dwordx4 v[220:223], v32, s[20:23], s45 offen offset:0 sc1
    v_mfma_f32_16x16x32_bf16 v[168:171], a[144:147], v[96:99], 0
    buffer_store_dwordx4 v[224:227], v32, s[20:23], s45 offen offset:1024 sc1
    v_mfma_f32_16x16x32_bf16 v[168:171], a[148:151], v[108:111], v[168:171]
    buffer_store_dwordx4 v[228:231], v32, s[20:23], s45 offen offset:2048 sc1
    v_mfma_f32_16x16x32_bf16 v[168:171], a[152:155], v[120:123], v[168:171]
    s_add_u32 s44, s49, 0
    buffer_load_dwordx4 a[72:75], v7, s[4:7], s44 offen sc1
    v_mfma_f32_16x16x32_bf16 v[168:171], a[156:159], v[132:135], v[168:171]
    s_add_u32 s44, s49, 245760
    buffer_load_dwordx4 a[76:79], v7, s[4:7], s44 offen sc1
    v_mfma_f32_16x16x32_bf16 v[168:171], a[160:163], v[144:147], v[168:171]
    s_add_u32 s44, s49, 491520
    buffer_load_dwordx4 a[80:83], v7, s[4:7], s44 offen sc1
    v_mfma_f32_16x16x32_bf16 v[168:171], a[164:167], v[156:159], v[168:171]
    s_add_u32 s44, s49, 737280
    buffer_load_dwordx4 a[84:87], v7, s[4:7], s44 offen sc1
    s_waitcnt lgkmcnt(0)
    v_mfma_f32_16x16x32_bf16 v[160:163], a[168:171], a[192:195], v[160:163]
    ds_read_b64_tr_b16 a[144:145], v253 offset:24640
    v_mfma_f32_16x16x32_bf16 v[160:163], a[172:175], a[204:207], v[160:163]
    ds_read_b64_tr_b16 a[146:147], v253 offset:26688
    v_mfma_f32_16x16x32_bf16 v[160:163], a[176:179], a[216:219], v[160:163]
    ds_read_b64_tr_b16 a[148:149], v253 offset:28736
    v_mfma_f32_16x16x32_bf16 v[160:163], a[180:183], a[228:231], v[160:163]
    ds_read_b64_tr_b16 a[150:151], v253 offset:30784
    v_mfma_f32_16x16x32_bf16 v[160:163], a[184:187], a[240:243], v[160:163]
    ds_read_b64_tr_b16 a[152:153], v253 offset:32832
    v_mfma_f32_16x16x32_bf16 v[160:163], a[188:191], a[252:255], v[160:163]
    ds_read_b64_tr_b16 a[154:155], v253 offset:34880
    v_mfma_f32_16x16x32_bf16 v[164:167], a[168:171], a[196:199], v[164:167]
    ds_read_b64_tr_b16 a[156:157], v253 offset:36928
    v_mfma_f32_16x16x32_bf16 v[164:167], a[172:175], a[208:211], v[164:167]
    ds_read_b64_tr_b16 a[158:159], v253 offset:38976
    v_mfma_f32_16x16x32_bf16 v[164:167], a[176:179], a[220:223], v[164:167]
    ds_read_b64_tr_b16 a[160:161], v253 offset:41024
    v_mfma_f32_16x16x32_bf16 v[164:167], a[180:183], a[232:235], v[164:167]
    ds_read_b64_tr_b16 a[162:163], v253 offset:43072
    v_mfma_f32_16x16x32_bf16 v[164:167], a[184:187], a[244:247], v[164:167]
    ds_read_b64_tr_b16 a[164:165], v253 offset:45120
    v_mfma_f32_16x16x32_bf16 v[164:167], a[188:191], a[0:3], v[164:167]
    ds_read_b64_tr_b16 a[166:167], v253 offset:47168
    v_mfma_f32_16x16x32_bf16 v[168:171], a[168:171], a[200:203], v[168:171]
    v_mfma_f32_16x16x32_bf16 v[168:171], a[172:175], a[212:215], v[168:171]
    buffer_load_dwordx4 v11, s[12:15], s35 offen offset:3072 lds
    v_mfma_f32_16x16x32_bf16 v[168:171], a[176:179], a[224:227], v[168:171]
    v_mfma_f32_16x16x32_bf16 v[168:171], a[180:183], a[236:239], v[168:171]
    s_add_u32 m0, s29, 102656
    v_mfma_f32_16x16x32_bf16 v[168:171], a[184:187], a[248:251], v[168:171]
    buffer_load_dwordx4 v12, s[12:15], s35 offen offset:0 lds
    v_mfma_f32_16x16x32_bf16 v[168:171], a[188:191], a[4:7], v[168:171]
    s_waitcnt lgkmcnt(0)
    v_mfma_f32_16x16x32_bf16 v[172:175], a[144:147], v[88:91], 0
    ds_read_b64_tr_b16 a[168:169], v249 offset:0
    v_mfma_f32_16x16x32_bf16 v[172:175], a[148:151], v[100:103], v[172:175]
    ds_read_b64_tr_b16 a[170:171], v249 offset:2048
    v_mfma_f32_16x16x32_bf16 v[172:175], a[152:155], v[112:115], v[172:175]
    ds_read_b64_tr_b16 a[172:173], v249 offset:4096
    v_mfma_f32_16x16x32_bf16 v[172:175], a[156:159], v[124:127], v[172:175]
    ds_read_b64_tr_b16 a[174:175], v249 offset:6144
    v_cvt_pk_bf16_f32 v64, v160, v161
    v_mfma_f32_16x16x32_bf16 v[172:175], a[160:163], v[136:139], v[172:175]
    ds_read_b64_tr_b16 a[176:177], v249 offset:8192
    v_cvt_pk_bf16_f32 v65, v162, v163
    v_mfma_f32_16x16x32_bf16 v[172:175], a[164:167], v[148:151], v[172:175]
    ds_read_b64_tr_b16 a[178:179], v249 offset:10240
    v_cvt_pk_bf16_f32 v68, v164, v165
    v_mfma_f32_16x16x32_bf16 v[176:179], a[144:147], v[92:95], 0
    ds_read_b64_tr_b16 a[180:181], v249 offset:12288
    v_cvt_pk_bf16_f32 v69, v166, v167
    v_mfma_f32_16x16x32_bf16 v[176:179], a[148:151], v[104:107], v[176:179]
    ds_read_b64_tr_b16 a[182:183], v249 offset:14336
    v_cvt_pk_bf16_f32 v72, v168, v169
    v_mfma_f32_16x16x32_bf16 v[176:179], a[152:155], v[116:119], v[176:179]
    ds_read_b64_tr_b16 a[184:185], v249 offset:16384
    v_cvt_pk_bf16_f32 v73, v170, v171
    v_mfma_f32_16x16x32_bf16 v[176:179], a[156:159], v[128:131], v[176:179]
    ds_read_b64_tr_b16 a[186:187], v249 offset:18432
    v_mfma_f32_16x16x32_bf16 v[176:179], a[160:163], v[140:143], v[176:179]
    ds_read_b64_tr_b16 a[188:189], v249 offset:20480
    v_mfma_f32_16x16x32_bf16 v[176:179], a[164:167], v[152:155], v[176:179]
    ds_read_b64_tr_b16 a[190:191], v249 offset:22528
    v_mfma_f32_16x16x32_bf16 v[180:183], a[144:147], v[96:99], 0
    buffer_load_dwordx4 v13, s[12:15], s35 offen offset:1024 lds
    v_mfma_f32_16x16x32_bf16 v[180:183], a[148:151], v[108:111], v[180:183]
    v_mfma_f32_16x16x32_bf16 v[180:183], a[152:155], v[120:123], v[180:183]
    s_add_u32 m0, s29, 0
    s_mov_b32 s36, 1152
    v_mfma_f32_16x16x32_bf16 v[180:183], a[156:159], v[132:135], v[180:183]
    buffer_load_dwordx4 v8, s[16:19], s36 offen offset:0 lds
    v_mfma_f32_16x16x32_bf16 v[180:183], a[160:163], v[144:147], v[180:183]
    v_mfma_f32_16x16x32_bf16 v[180:183], a[164:167], v[156:159], v[180:183]
    buffer_load_dwordx4 v9, s[16:19], s36 offen offset:1024 lds
    s_waitcnt lgkmcnt(0)
    v_mfma_f32_16x16x32_bf16 v[172:175], a[168:171], a[192:195], v[172:175]
    ds_read_b64_tr_b16 a[144:145], v254 offset:24640
    v_mfma_f32_16x16x32_bf16 v[172:175], a[172:175], a[204:207], v[172:175]
    ds_read_b64_tr_b16 a[146:147], v254 offset:26688
    v_mfma_f32_16x16x32_bf16 v[172:175], a[176:179], a[216:219], v[172:175]
    ds_read_b64_tr_b16 a[148:149], v254 offset:28736
    v_mfma_f32_16x16x32_bf16 v[172:175], a[180:183], a[228:231], v[172:175]
    ds_read_b64_tr_b16 a[150:151], v254 offset:30784
    v_mfma_f32_16x16x32_bf16 v[172:175], a[184:187], a[240:243], v[172:175]
    ds_read_b64_tr_b16 a[152:153], v254 offset:32832
    v_mfma_f32_16x16x32_bf16 v[172:175], a[188:191], a[252:255], v[172:175]
    ds_read_b64_tr_b16 a[154:155], v254 offset:34880
    v_mfma_f32_16x16x32_bf16 v[176:179], a[168:171], a[196:199], v[176:179]
    ds_read_b64_tr_b16 a[156:157], v254 offset:36928
    v_mfma_f32_16x16x32_bf16 v[176:179], a[172:175], a[208:211], v[176:179]
    ds_read_b64_tr_b16 a[158:159], v254 offset:38976
    v_mfma_f32_16x16x32_bf16 v[176:179], a[176:179], a[220:223], v[176:179]
    ds_read_b64_tr_b16 a[160:161], v254 offset:41024
    v_mfma_f32_16x16x32_bf16 v[176:179], a[180:183], a[232:235], v[176:179]
    ds_read_b64_tr_b16 a[162:163], v254 offset:43072
    v_mfma_f32_16x16x32_bf16 v[176:179], a[184:187], a[244:247], v[176:179]
    ds_read_b64_tr_b16 a[164:165], v254 offset:45120
    v_mfma_f32_16x16x32_bf16 v[176:179], a[188:191], a[0:3], v[176:179]
    ds_read_b64_tr_b16 a[166:167], v254 offset:47168
    v_mfma_f32_16x16x32_bf16 v[180:183], a[168:171], a[200:203], v[180:183]
    v_mfma_f32_16x16x32_bf16 v[180:183], a[172:175], a[212:215], v[180:183]
    v_mfma_f32_16x16x32_bf16 v[180:183], a[176:179], a[224:227], v[180:183]
    buffer_load_dwordx4 v10, s[16:19], s36 offen offset:2048 lds
    v_mfma_f32_16x16x32_bf16 v[180:183], a[180:183], a[236:239], v[180:183]
    v_mfma_f32_16x16x32_bf16 v[180:183], a[184:187], a[248:251], v[180:183]
    buffer_load_dwordx4 v11, s[16:19], s36 offen offset:3072 lds
    v_mfma_f32_16x16x32_bf16 v[180:183], a[188:191], a[4:7], v[180:183]
    s_waitcnt lgkmcnt(0)
    v_mfma_f32_16x16x32_bf16 v[160:163], a[144:147], v[88:91], 0
    ds_read_b64_tr_b16 a[168:169], v250 offset:0
    v_mfma_f32_16x16x32_bf16 v[160:163], a[148:151], v[100:103], v[160:163]
    ds_read_b64_tr_b16 a[170:171], v250 offset:2048
    v_mfma_f32_16x16x32_bf16 v[160:163], a[152:155], v[112:115], v[160:163]
    ds_read_b64_tr_b16 a[172:173], v250 offset:4096
    v_mfma_f32_16x16x32_bf16 v[160:163], a[156:159], v[124:127], v[160:163]
    ds_read_b64_tr_b16 a[174:175], v250 offset:6144
    v_cvt_pk_bf16_f32 v66, v172, v173
    v_mfma_f32_16x16x32_bf16 v[160:163], a[160:163], v[136:139], v[160:163]
    ds_read_b64_tr_b16 a[176:177], v250 offset:8192
    v_cvt_pk_bf16_f32 v67, v174, v175
    v_mfma_f32_16x16x32_bf16 v[160:163], a[164:167], v[148:151], v[160:163]
    ds_read_b64_tr_b16 a[178:179], v250 offset:10240
    v_cvt_pk_bf16_f32 v70, v176, v177
    v_mfma_f32_16x16x32_bf16 v[164:167], a[144:147], v[92:95], 0
    ds_read_b64_tr_b16 a[180:181], v250 offset:12288
    v_cvt_pk_bf16_f32 v71, v178, v179
    v_mfma_f32_16x16x32_bf16 v[164:167], a[148:151], v[104:107], v[164:167]
    ds_read_b64_tr_b16 a[182:183], v250 offset:14336
    v_cvt_pk_bf16_f32 v74, v180, v181
    v_mfma_f32_16x16x32_bf16 v[164:167], a[152:155], v[116:119], v[164:167]
    ds_read_b64_tr_b16 a[184:185], v250 offset:16384
    v_cvt_pk_bf16_f32 v75, v182, v183
    v_mfma_f32_16x16x32_bf16 v[164:167], a[156:159], v[128:131], v[164:167]
    ds_read_b64_tr_b16 a[186:187], v250 offset:18432
    v_mfma_f32_16x16x32_bf16 v[164:167], a[160:163], v[140:143], v[164:167]
    ds_read_b64_tr_b16 a[188:189], v250 offset:20480
    s_mov_b32 s45, 172032
    v_mfma_f32_16x16x32_bf16 v[164:167], a[164:167], v[152:155], v[164:167]
    ds_read_b64_tr_b16 a[190:191], v250 offset:22528
    buffer_store_dwordx4 v[64:67], v32, s[20:23], s45 offen offset:0 sc1
    v_mfma_f32_16x16x32_bf16 v[168:171], a[144:147], v[96:99], 0
    buffer_store_dwordx4 v[68:71], v32, s[20:23], s45 offen offset:1024 sc1
    v_mfma_f32_16x16x32_bf16 v[168:171], a[148:151], v[108:111], v[168:171]
    buffer_store_dwordx4 v[72:75], v32, s[20:23], s45 offen offset:2048 sc1
    v_mfma_f32_16x16x32_bf16 v[168:171], a[152:155], v[120:123], v[168:171]
    s_add_u32 s44, s49, 983040
    buffer_load_dwordx4 a[88:91], v7, s[4:7], s44 offen sc1
    v_mfma_f32_16x16x32_bf16 v[168:171], a[156:159], v[132:135], v[168:171]
    s_add_u32 s44, s49, 1228800
    buffer_load_dwordx4 a[92:95], v7, s[4:7], s44 offen sc1
    v_mfma_f32_16x16x32_bf16 v[168:171], a[160:163], v[144:147], v[168:171]
    s_add_u32 s44, s49, 1474560
    buffer_load_dwordx4 a[96:99], v7, s[4:7], s44 offen sc1
    v_mfma_f32_16x16x32_bf16 v[168:171], a[164:167], v[156:159], v[168:171]
    s_add_u32 s44, s49, 1720320
    buffer_load_dwordx4 a[100:103], v7, s[4:7], s44 offen sc1
    s_waitcnt lgkmcnt(0)
    v_mfma_f32_16x16x32_bf16 v[160:163], a[168:171], a[192:195], v[160:163]
    ds_read_b64_tr_b16 a[144:145], v255 offset:24640
    v_mfma_f32_16x16x32_bf16 v[160:163], a[172:175], a[204:207], v[160:163]
    ds_read_b64_tr_b16 a[146:147], v255 offset:26688
    v_mfma_f32_16x16x32_bf16 v[160:163], a[176:179], a[216:219], v[160:163]
    ds_read_b64_tr_b16 a[148:149], v255 offset:28736
    v_mfma_f32_16x16x32_bf16 v[160:163], a[180:183], a[228:231], v[160:163]
    ds_read_b64_tr_b16 a[150:151], v255 offset:30784
    v_mfma_f32_16x16x32_bf16 v[160:163], a[184:187], a[240:243], v[160:163]
    ds_read_b64_tr_b16 a[152:153], v255 offset:32832
    v_mfma_f32_16x16x32_bf16 v[160:163], a[188:191], a[252:255], v[160:163]
    ds_read_b64_tr_b16 a[154:155], v255 offset:34880
    v_mfma_f32_16x16x32_bf16 v[164:167], a[168:171], a[196:199], v[164:167]
    ds_read_b64_tr_b16 a[156:157], v255 offset:36928
    v_mfma_f32_16x16x32_bf16 v[164:167], a[172:175], a[208:211], v[164:167]
    ds_read_b64_tr_b16 a[158:159], v255 offset:38976
    v_mfma_f32_16x16x32_bf16 v[164:167], a[176:179], a[220:223], v[164:167]
    ds_read_b64_tr_b16 a[160:161], v255 offset:41024
    v_mfma_f32_16x16x32_bf16 v[164:167], a[180:183], a[232:235], v[164:167]
    ds_read_b64_tr_b16 a[162:163], v255 offset:43072
    v_mfma_f32_16x16x32_bf16 v[164:167], a[184:187], a[244:247], v[164:167]
    ds_read_b64_tr_b16 a[164:165], v255 offset:45120
    v_mfma_f32_16x16x32_bf16 v[164:167], a[188:191], a[0:3], v[164:167]
    ds_read_b64_tr_b16 a[166:167], v255 offset:47168
    v_mfma_f32_16x16x32_bf16 v[168:171], a[168:171], a[200:203], v[168:171]
    s_add_u32 m0, s29, 4096
    v_mfma_f32_16x16x32_bf16 v[168:171], a[172:175], a[212:215], v[168:171]
    buffer_load_dwordx4 v12, s[16:19], s36 offen offset:0 lds
    v_mfma_f32_16x16x32_bf16 v[168:171], a[176:179], a[224:227], v[168:171]
    v_mfma_f32_16x16x32_bf16 v[168:171], a[180:183], a[236:239], v[168:171]
    buffer_load_dwordx4 v13, s[16:19], s36 offen offset:1024 lds
    v_mfma_f32_16x16x32_bf16 v[168:171], a[184:187], a[248:251], v[168:171]
    v_mfma_f32_16x16x32_bf16 v[168:171], a[188:191], a[4:7], v[168:171]
    s_waitcnt lgkmcnt(0)
    v_mfma_f32_16x16x32_bf16 v[172:175], a[144:147], v[88:91], 0
    ds_read_b64_tr_b16 a[168:169], v251 offset:0
    v_mfma_f32_16x16x32_bf16 v[172:175], a[148:151], v[100:103], v[172:175]
    ds_read_b64_tr_b16 a[170:171], v251 offset:2048
    v_mfma_f32_16x16x32_bf16 v[172:175], a[152:155], v[112:115], v[172:175]
    ds_read_b64_tr_b16 a[172:173], v251 offset:4096
    v_mfma_f32_16x16x32_bf16 v[172:175], a[156:159], v[124:127], v[172:175]
    ds_read_b64_tr_b16 a[174:175], v251 offset:6144
    v_cvt_pk_bf16_f32 v76, v160, v161
    v_mfma_f32_16x16x32_bf16 v[172:175], a[160:163], v[136:139], v[172:175]
    ds_read_b64_tr_b16 a[176:177], v251 offset:8192
    v_cvt_pk_bf16_f32 v77, v162, v163
    v_mfma_f32_16x16x32_bf16 v[172:175], a[164:167], v[148:151], v[172:175]
    ds_read_b64_tr_b16 a[178:179], v251 offset:10240
    v_cvt_pk_bf16_f32 v80, v164, v165
    v_mfma_f32_16x16x32_bf16 v[176:179], a[144:147], v[92:95], 0
    ds_read_b64_tr_b16 a[180:181], v251 offset:12288
    v_cvt_pk_bf16_f32 v81, v166, v167
    v_mfma_f32_16x16x32_bf16 v[176:179], a[148:151], v[104:107], v[176:179]
    ds_read_b64_tr_b16 a[182:183], v251 offset:14336
    v_cvt_pk_bf16_f32 v84, v168, v169
    v_mfma_f32_16x16x32_bf16 v[176:179], a[152:155], v[116:119], v[176:179]
    ds_read_b64_tr_b16 a[184:185], v251 offset:16384
    v_cvt_pk_bf16_f32 v85, v170, v171
    v_mfma_f32_16x16x32_bf16 v[176:179], a[156:159], v[128:131], v[176:179]
    ds_read_b64_tr_b16 a[186:187], v251 offset:18432
    v_mfma_f32_16x16x32_bf16 v[176:179], a[160:163], v[140:143], v[176:179]
    ds_read_b64_tr_b16 a[188:189], v251 offset:20480
    v_mfma_f32_16x16x32_bf16 v[176:179], a[164:167], v[152:155], v[176:179]
    ds_read_b64_tr_b16 a[190:191], v251 offset:22528
    v_mfma_f32_16x16x32_bf16 v[180:183], a[144:147], v[96:99], 0
    v_mfma_f32_16x16x32_bf16 v[180:183], a[148:151], v[108:111], v[180:183]
    v_mfma_f32_16x16x32_bf16 v[180:183], a[152:155], v[120:123], v[180:183]
    v_mfma_f32_16x16x32_bf16 v[180:183], a[156:159], v[132:135], v[180:183]
    v_mfma_f32_16x16x32_bf16 v[180:183], a[160:163], v[144:147], v[180:183]
    v_mfma_f32_16x16x32_bf16 v[180:183], a[164:167], v[156:159], v[180:183]
    v_mfma_f32_16x16x32_bf16 v[46:49], v[42:45], a[8:11], 0
    v_mfma_f32_16x16x32_bf16 v[46:49], v[42:45], a[12:15], v[46:49]
    v_mfma_f32_16x16x32_bf16 v[46:49], v[42:45], a[16:19], v[46:49]
    v_mfma_f32_16x16x32_bf16 v[46:49], v[42:45], a[20:23], v[46:49]
    v_mfma_f32_16x16x32_bf16 v[46:49], v[42:45], a[24:27], v[46:49]
    v_mfma_f32_16x16x32_bf16 v[46:49], v[42:45], a[28:31], v[46:49]
    v_mfma_f32_16x16x32_bf16 v[46:49], v[42:45], a[32:35], v[46:49]
    v_mfma_f32_16x16x32_bf16 v[46:49], v[42:45], a[36:39], v[46:49]
    v_mfma_f32_16x16x32_bf16 v[46:49], v[42:45], a[40:43], v[46:49]
    v_mfma_f32_16x16x32_bf16 v[46:49], v[42:45], a[44:47], v[46:49]
    v_mfma_f32_16x16x32_bf16 v[46:49], v[42:45], a[48:51], v[46:49]
    v_mfma_f32_16x16x32_bf16 v[46:49], v[42:45], a[52:55], v[46:49]
    s_waitcnt vmcnt(31)
    v_mfma_f32_16x16x32_bf16 v[46:49], v[42:45], a[56:59], v[46:49]
    s_waitcnt vmcnt(30)
    v_mfma_f32_16x16x32_bf16 v[46:49], v[42:45], a[60:63], v[46:49]
    s_waitcnt vmcnt(29)
    v_mfma_f32_16x16x32_bf16 v[46:49], v[42:45], a[64:67], v[46:49]
    s_waitcnt vmcnt(28)
    v_mfma_f32_16x16x32_bf16 v[46:49], v[42:45], a[68:71], v[46:49]
    v_mfma_f32_16x16x32_bf16 v[50:53], v[40:43], a[8:11], 0
    v_mfma_f32_16x16x32_bf16 v[50:53], v[40:43], a[12:15], v[50:53]
    v_mfma_f32_16x16x32_bf16 v[50:53], v[40:43], a[16:19], v[50:53]
    v_mfma_f32_16x16x32_bf16 v[50:53], v[40:43], a[20:23], v[50:53]
    v_mfma_f32_16x16x32_bf16 v[50:53], v[40:43], a[24:27], v[50:53]
    v_mfma_f32_16x16x32_bf16 v[50:53], v[40:43], a[28:31], v[50:53]
    v_mfma_f32_16x16x32_bf16 v[50:53], v[40:43], a[32:35], v[50:53]
    v_mfma_f32_16x16x32_bf16 v[50:53], v[40:43], a[36:39], v[50:53]
    v_mfma_f32_16x16x32_bf16 v[50:53], v[40:43], a[40:43], v[50:53]
    v_mfma_f32_16x16x32_bf16 v[50:53], v[40:43], a[44:47], v[50:53]
    v_mfma_f32_16x16x32_bf16 v[50:53], v[40:43], a[48:51], v[50:53]
    v_mfma_f32_16x16x32_bf16 v[50:53], v[40:43], a[52:55], v[50:53]
    v_mfma_f32_16x16x32_bf16 v[50:53], v[40:43], a[56:59], v[50:53]
    v_mfma_f32_16x16x32_bf16 v[50:53], v[40:43], a[60:63], v[50:53]
    v_mfma_f32_16x16x32_bf16 v[50:53], v[40:43], a[64:67], v[50:53]
    v_mfma_f32_16x16x32_bf16 v[50:53], v[40:43], a[68:71], v[50:53]
    s_waitcnt vmcnt(26)
    s_waitcnt lgkmcnt(0)
    s_barrier
    v_mfma_f32_16x16x32_bf16 v[172:175], a[168:171], a[192:195], v[172:175]
    ds_read_b64_tr_b16 a[144:145], v248 offset:24640
    v_mfma_f32_16x16x32_bf16 v[172:175], a[172:175], a[204:207], v[172:175]
    ds_read_b64_tr_b16 a[146:147], v248 offset:26688
    v_mfma_f32_16x16x32_bf16 v[172:175], a[176:179], a[216:219], v[172:175]
    ds_read_b64_tr_b16 a[148:149], v248 offset:28736
    v_mfma_f32_16x16x32_bf16 v[172:175], a[180:183], a[228:231], v[172:175]
    ds_read_b64_tr_b16 a[150:151], v248 offset:30784
    v_cvt_pk_bf16_f32 v46, v46, v47
    v_mfma_f32_16x16x32_bf16 v[172:175], a[184:187], a[240:243], v[172:175]
    ds_read_b64_tr_b16 a[152:153], v248 offset:32832
    v_cvt_pk_bf16_f32 v47, v48, v49
    v_mfma_f32_16x16x32_bf16 v[172:175], a[188:191], a[252:255], v[172:175]
    ds_read_b64_tr_b16 a[154:155], v248 offset:34880
    v_cvt_pk_bf16_f32 v48, v50, v51
    v_mfma_f32_16x16x32_bf16 v[176:179], a[168:171], a[196:199], v[176:179]
    ds_read_b64_tr_b16 a[156:157], v248 offset:36928
    v_cvt_pk_bf16_f32 v49, v52, v53
    v_mfma_f32_16x16x32_bf16 v[176:179], a[172:175], a[208:211], v[176:179]
    ds_read_b64_tr_b16 a[158:159], v248 offset:38976
    v_permlane32_swap_b32 v46, v48
    v_mfma_f32_16x16x32_bf16 v[176:179], a[176:179], a[220:223], v[176:179]
    ds_read_b64_tr_b16 a[160:161], v248 offset:41024
    v_permlane32_swap_b32 v47, v49
    v_mfma_f32_16x16x32_bf16 v[176:179], a[180:183], a[232:235], v[176:179]
    ds_read_b64_tr_b16 a[162:163], v248 offset:43072
    v_permlane16_swap_b32 v46, v48
    v_mfma_f32_16x16x32_bf16 v[176:179], a[184:187], a[244:247], v[176:179]
    ds_read_b64_tr_b16 a[164:165], v248 offset:45120
    v_permlane16_swap_b32 v47, v49
    v_mfma_f32_16x16x32_bf16 v[176:179], a[188:191], a[0:3], v[176:179]
    ds_read_b64_tr_b16 a[166:167], v248 offset:47168
    buffer_store_dwordx4 v[46:49], v35, s[8:11], s52 offen
    v_mfma_f32_16x16x32_bf16 v[180:183], a[168:171], a[200:203], v[180:183]
    v_mfma_f32_16x16x32_bf16 v[180:183], a[172:175], a[212:215], v[180:183]
    v_mfma_f32_16x16x32_bf16 v[180:183], a[176:179], a[224:227], v[180:183]
    v_mfma_f32_16x16x32_bf16 v[180:183], a[180:183], a[236:239], v[180:183]
    v_mfma_f32_16x16x32_bf16 v[180:183], a[184:187], a[248:251], v[180:183]
    v_mfma_f32_16x16x32_bf16 v[180:183], a[188:191], a[4:7], v[180:183]
    s_waitcnt lgkmcnt(0)
    v_mfma_f32_16x16x32_bf16 v[160:163], a[144:147], v[88:91], 0
    ds_read_b64_tr_b16 a[168:169], v244 offset:24640
    v_mfma_f32_16x16x32_bf16 v[160:163], a[148:151], v[100:103], v[160:163]
    ds_read_b64_tr_b16 a[170:171], v244 offset:26688
    v_mfma_f32_16x16x32_bf16 v[160:163], a[152:155], v[112:115], v[160:163]
    ds_read_b64_tr_b16 a[172:173], v244 offset:28736
    v_mfma_f32_16x16x32_bf16 v[160:163], a[156:159], v[124:127], v[160:163]
    ds_read_b64_tr_b16 a[174:175], v244 offset:30784
    v_cvt_pk_bf16_f32 v78, v172, v173
    v_mfma_f32_16x16x32_bf16 v[160:163], a[160:163], v[136:139], v[160:163]
    ds_read_b64_tr_b16 a[176:177], v244 offset:32832
    v_cvt_pk_bf16_f32 v79, v174, v175
    v_mfma_f32_16x16x32_bf16 v[160:163], a[164:167], v[148:151], v[160:163]
    ds_read_b64_tr_b16 a[178:179], v244 offset:34880
    v_cvt_pk_bf16_f32 v82, v176, v177
    v_mfma_f32_16x16x32_bf16 v[164:167], a[144:147], v[92:95], 0
    ds_read_b64_tr_b16 a[180:181], v244 offset:36928
    v_cvt_pk_bf16_f32 v83, v178, v179
    v_mfma_f32_16x16x32_bf16 v[164:167], a[148:151], v[104:107], v[164:167]
    ds_read_b64_tr_b16 a[182:183], v244 offset:38976
    v_cvt_pk_bf16_f32 v86, v180, v181
    v_mfma_f32_16x16x32_bf16 v[164:167], a[152:155], v[116:119], v[164:167]
    ds_read_b64_tr_b16 a[184:185], v244 offset:41024
    v_cvt_pk_bf16_f32 v87, v182, v183
    v_mfma_f32_16x16x32_bf16 v[164:167], a[156:159], v[128:131], v[164:167]
    ds_read_b64_tr_b16 a[186:187], v244 offset:43072
    v_mfma_f32_16x16x32_bf16 v[164:167], a[160:163], v[140:143], v[164:167]
    ds_read_b64_tr_b16 a[188:189], v244 offset:45120
    s_mov_b32 s45, 184320
    v_mfma_f32_16x16x32_bf16 v[164:167], a[164:167], v[152:155], v[164:167]
    ds_read_b64_tr_b16 a[190:191], v244 offset:47168
    buffer_store_dwordx4 v[76:79], v32, s[20:23], s45 offen offset:0 sc1
    v_mfma_f32_16x16x32_bf16 v[168:171], a[144:147], v[96:99], 0
    buffer_store_dwordx4 v[80:83], v32, s[20:23], s45 offen offset:1024 sc1
    v_mfma_f32_16x16x32_bf16 v[168:171], a[148:151], v[108:111], v[168:171]
    buffer_store_dwordx4 v[84:87], v32, s[20:23], s45 offen offset:2048 sc1
    v_mfma_f32_16x16x32_bf16 v[168:171], a[152:155], v[120:123], v[168:171]
    s_add_u32 s44, s49, 1966080
    buffer_load_dwordx4 a[104:107], v7, s[4:7], s44 offen sc1
    v_mfma_f32_16x16x32_bf16 v[168:171], a[156:159], v[132:135], v[168:171]
    s_add_u32 s44, s49, 2211840
    buffer_load_dwordx4 a[108:111], v7, s[4:7], s44 offen sc1
    v_mfma_f32_16x16x32_bf16 v[168:171], a[160:163], v[144:147], v[168:171]
    s_add_u32 s44, s49, 2457600
    buffer_load_dwordx4 a[112:115], v7, s[4:7], s44 offen sc1
    v_mfma_f32_16x16x32_bf16 v[168:171], a[164:167], v[156:159], v[168:171]
    s_add_u32 s44, s49, 2703360
    buffer_load_dwordx4 a[116:119], v7, s[4:7], s44 offen sc1
    s_waitcnt lgkmcnt(0)
    v_mfma_f32_16x16x32_bf16 v[160:163], a[168:171], a[192:195], v[160:163]
    ds_read_b64_tr_b16 a[144:145], v249 offset:24640
    v_mfma_f32_16x16x32_bf16 v[160:163], a[172:175], a[204:207], v[160:163]
    ds_read_b64_tr_b16 a[146:147], v249 offset:26688
    v_mfma_f32_16x16x32_bf16 v[160:163], a[176:179], a[216:219], v[160:163]
    ds_read_b64_tr_b16 a[148:149], v249 offset:28736
    v_mfma_f32_16x16x32_bf16 v[160:163], a[180:183], a[228:231], v[160:163]
    ds_read_b64_tr_b16 a[150:151], v249 offset:30784
    v_mfma_f32_16x16x32_bf16 v[160:163], a[184:187], a[240:243], v[160:163]
    ds_read_b64_tr_b16 a[152:153], v249 offset:32832
    v_mfma_f32_16x16x32_bf16 v[160:163], a[188:191], a[252:255], v[160:163]
    ds_read_b64_tr_b16 a[154:155], v249 offset:34880
    v_mfma_f32_16x16x32_bf16 v[164:167], a[168:171], a[196:199], v[164:167]
    ds_read_b64_tr_b16 a[156:157], v249 offset:36928
    v_mfma_f32_16x16x32_bf16 v[164:167], a[172:175], a[208:211], v[164:167]
    ds_read_b64_tr_b16 a[158:159], v249 offset:38976
    v_mfma_f32_16x16x32_bf16 v[164:167], a[176:179], a[220:223], v[164:167]
    ds_read_b64_tr_b16 a[160:161], v249 offset:41024
    v_mfma_f32_16x16x32_bf16 v[164:167], a[180:183], a[232:235], v[164:167]
    ds_read_b64_tr_b16 a[162:163], v249 offset:43072
    v_mfma_f32_16x16x32_bf16 v[164:167], a[184:187], a[244:247], v[164:167]
    ds_read_b64_tr_b16 a[164:165], v249 offset:45120
    v_mfma_f32_16x16x32_bf16 v[164:167], a[188:191], a[0:3], v[164:167]
    ds_read_b64_tr_b16 a[166:167], v249 offset:47168
    v_mfma_f32_16x16x32_bf16 v[168:171], a[168:171], a[200:203], v[168:171]
    v_mfma_f32_16x16x32_bf16 v[168:171], a[172:175], a[212:215], v[168:171]
    v_mfma_f32_16x16x32_bf16 v[168:171], a[176:179], a[224:227], v[168:171]
    v_mfma_f32_16x16x32_bf16 v[168:171], a[180:183], a[236:239], v[168:171]
    v_mfma_f32_16x16x32_bf16 v[168:171], a[184:187], a[248:251], v[168:171]
    v_mfma_f32_16x16x32_bf16 v[168:171], a[188:191], a[4:7], v[168:171]
    s_waitcnt lgkmcnt(0)
    v_mfma_f32_16x16x32_bf16 v[172:175], a[144:147], v[88:91], 0
    ds_read_b64_tr_b16 a[168:169], v245 offset:24640
    v_mfma_f32_16x16x32_bf16 v[172:175], a[148:151], v[100:103], v[172:175]
    ds_read_b64_tr_b16 a[170:171], v245 offset:26688
    v_mfma_f32_16x16x32_bf16 v[172:175], a[152:155], v[112:115], v[172:175]
    ds_read_b64_tr_b16 a[172:173], v245 offset:28736
    v_mfma_f32_16x16x32_bf16 v[172:175], a[156:159], v[124:127], v[172:175]
    ds_read_b64_tr_b16 a[174:175], v245 offset:30784
    v_cvt_pk_bf16_f32 v208, v160, v161
    v_mfma_f32_16x16x32_bf16 v[172:175], a[160:163], v[136:139], v[172:175]
    ds_read_b64_tr_b16 a[176:177], v245 offset:32832
    v_cvt_pk_bf16_f32 v209, v162, v163
    v_mfma_f32_16x16x32_bf16 v[172:175], a[164:167], v[148:151], v[172:175]
    ds_read_b64_tr_b16 a[178:179], v245 offset:34880
    v_cvt_pk_bf16_f32 v212, v164, v165
    v_mfma_f32_16x16x32_bf16 v[176:179], a[144:147], v[92:95], 0
    ds_read_b64_tr_b16 a[180:181], v245 offset:36928
    v_cvt_pk_bf16_f32 v213, v166, v167
    v_mfma_f32_16x16x32_bf16 v[176:179], a[148:151], v[104:107], v[176:179]
    ds_read_b64_tr_b16 a[182:183], v245 offset:38976
    v_cvt_pk_bf16_f32 v216, v168, v169
    v_mfma_f32_16x16x32_bf16 v[176:179], a[152:155], v[116:119], v[176:179]
    ds_read_b64_tr_b16 a[184:185], v245 offset:41024
    v_cvt_pk_bf16_f32 v217, v170, v171
    v_mfma_f32_16x16x32_bf16 v[176:179], a[156:159], v[128:131], v[176:179]
    ds_read_b64_tr_b16 a[186:187], v245 offset:43072
    v_mfma_f32_16x16x32_bf16 v[176:179], a[160:163], v[140:143], v[176:179]
    ds_read_b64_tr_b16 a[188:189], v245 offset:45120
    v_mfma_f32_16x16x32_bf16 v[176:179], a[164:167], v[152:155], v[176:179]
    ds_read_b64_tr_b16 a[190:191], v245 offset:47168
    v_mfma_f32_16x16x32_bf16 v[180:183], a[144:147], v[96:99], 0
    v_mfma_f32_16x16x32_bf16 v[180:183], a[148:151], v[108:111], v[180:183]
    v_mfma_f32_16x16x32_bf16 v[180:183], a[152:155], v[120:123], v[180:183]
    v_mfma_f32_16x16x32_bf16 v[180:183], a[156:159], v[132:135], v[180:183]
    v_mfma_f32_16x16x32_bf16 v[180:183], a[160:163], v[144:147], v[180:183]
    v_mfma_f32_16x16x32_bf16 v[180:183], a[164:167], v[156:159], v[180:183]
    s_waitcnt lgkmcnt(0)
    v_mfma_f32_16x16x32_bf16 v[172:175], a[168:171], a[192:195], v[172:175]
    ds_read_b64_tr_b16 a[144:145], v250 offset:24640
    v_mfma_f32_16x16x32_bf16 v[172:175], a[172:175], a[204:207], v[172:175]
    ds_read_b64_tr_b16 a[146:147], v250 offset:26688
    v_mfma_f32_16x16x32_bf16 v[172:175], a[176:179], a[216:219], v[172:175]
    ds_read_b64_tr_b16 a[148:149], v250 offset:28736
    v_mfma_f32_16x16x32_bf16 v[172:175], a[180:183], a[228:231], v[172:175]
    ds_read_b64_tr_b16 a[150:151], v250 offset:30784
    v_mfma_f32_16x16x32_bf16 v[172:175], a[184:187], a[240:243], v[172:175]
    ds_read_b64_tr_b16 a[152:153], v250 offset:32832
    v_mfma_f32_16x16x32_bf16 v[172:175], a[188:191], a[252:255], v[172:175]
    ds_read_b64_tr_b16 a[154:155], v250 offset:34880
    v_mfma_f32_16x16x32_bf16 v[176:179], a[168:171], a[196:199], v[176:179]
    ds_read_b64_tr_b16 a[156:157], v250 offset:36928
    v_mfma_f32_16x16x32_bf16 v[176:179], a[172:175], a[208:211], v[176:179]
    ds_read_b64_tr_b16 a[158:159], v250 offset:38976
    v_mfma_f32_16x16x32_bf16 v[176:179], a[176:179], a[220:223], v[176:179]
    ds_read_b64_tr_b16 a[160:161], v250 offset:41024
    v_mfma_f32_16x16x32_bf16 v[176:179], a[180:183], a[232:235], v[176:179]
    ds_read_b64_tr_b16 a[162:163], v250 offset:43072
    v_mfma_f32_16x16x32_bf16 v[176:179], a[184:187], a[244:247], v[176:179]
    ds_read_b64_tr_b16 a[164:165], v250 offset:45120
    v_mfma_f32_16x16x32_bf16 v[176:179], a[188:191], a[0:3], v[176:179]
    ds_read_b64_tr_b16 a[166:167], v250 offset:47168
    v_mfma_f32_16x16x32_bf16 v[180:183], a[168:171], a[200:203], v[180:183]
    v_mfma_f32_16x16x32_bf16 v[180:183], a[172:175], a[212:215], v[180:183]
    v_mfma_f32_16x16x32_bf16 v[180:183], a[176:179], a[224:227], v[180:183]
    v_mfma_f32_16x16x32_bf16 v[180:183], a[180:183], a[236:239], v[180:183]
    v_mfma_f32_16x16x32_bf16 v[180:183], a[184:187], a[248:251], v[180:183]
    v_mfma_f32_16x16x32_bf16 v[180:183], a[188:191], a[4:7], v[180:183]
    s_waitcnt lgkmcnt(0)
    v_mfma_f32_16x16x32_bf16 v[160:163], a[144:147], v[88:91], 0
    ds_read_b64_tr_b16 a[168:169], v246 offset:24640
    v_mfma_f32_16x16x32_bf16 v[160:163], a[148:151], v[100:103], v[160:163]
    ds_read_b64_tr_b16 a[170:171], v246 offset:26688
    v_mfma_f32_16x16x32_bf16 v[160:163], a[152:155], v[112:115], v[160:163]
    ds_read_b64_tr_b16 a[172:173], v246 offset:28736
    v_mfma_f32_16x16x32_bf16 v[160:163], a[156:159], v[124:127], v[160:163]
    ds_read_b64_tr_b16 a[174:175], v246 offset:30784
    v_cvt_pk_bf16_f32 v210, v172, v173
    v_mfma_f32_16x16x32_bf16 v[160:163], a[160:163], v[136:139], v[160:163]
    ds_read_b64_tr_b16 a[176:177], v246 offset:32832
    v_cvt_pk_bf16_f32 v211, v174, v175
    v_mfma_f32_16x16x32_bf16 v[160:163], a[164:167], v[148:151], v[160:163]
    ds_read_b64_tr_b16 a[178:179], v246 offset:34880
    v_cvt_pk_bf16_f32 v214, v176, v177
    v_mfma_f32_16x16x32_bf16 v[164:167], a[144:147], v[92:95], 0
    ds_read_b64_tr_b16 a[180:181], v246 offset:36928
    v_cvt_pk_bf16_f32 v215, v178, v179
    v_mfma_f32_16x16x32_bf16 v[164:167], a[148:151], v[104:107], v[164:167]
    ds_read_b64_tr_b16 a[182:183], v246 offset:38976
    v_cvt_pk_bf16_f32 v218, v180, v181
    v_mfma_f32_16x16x32_bf16 v[164:167], a[152:155], v[116:119], v[164:167]
    ds_read_b64_tr_b16 a[184:185], v246 offset:41024
    v_cvt_pk_bf16_f32 v219, v182, v183
    v_mfma_f32_16x16x32_bf16 v[164:167], a[156:159], v[128:131], v[164:167]
    ds_read_b64_tr_b16 a[186:187], v246 offset:43072
    v_mfma_f32_16x16x32_bf16 v[164:167], a[160:163], v[140:143], v[164:167]
    ds_read_b64_tr_b16 a[188:189], v246 offset:45120
    s_mov_b32 s45, 196608
    v_mfma_f32_16x16x32_bf16 v[164:167], a[164:167], v[152:155], v[164:167]
    ds_read_b64_tr_b16 a[190:191], v246 offset:47168
    buffer_store_dwordx4 v[208:211], v32, s[20:23], s45 offen offset:0 sc1
    v_mfma_f32_16x16x32_bf16 v[168:171], a[144:147], v[96:99], 0
    buffer_store_dwordx4 v[212:215], v32, s[20:23], s45 offen offset:1024 sc1
    v_mfma_f32_16x16x32_bf16 v[168:171], a[148:151], v[108:111], v[168:171]
    buffer_store_dwordx4 v[216:219], v32, s[20:23], s45 offen offset:2048 sc1
    v_mfma_f32_16x16x32_bf16 v[168:171], a[152:155], v[120:123], v[168:171]
    s_add_u32 s44, s49, 2949120
    buffer_load_dwordx4 a[120:123], v7, s[4:7], s44 offen sc1
    v_mfma_f32_16x16x32_bf16 v[168:171], a[156:159], v[132:135], v[168:171]
    s_add_u32 s44, s49, 3194880
    buffer_load_dwordx4 a[124:127], v7, s[4:7], s44 offen sc1
    v_mfma_f32_16x16x32_bf16 v[168:171], a[160:163], v[144:147], v[168:171]
    s_add_u32 s44, s49, 3440640
    buffer_load_dwordx4 a[128:131], v7, s[4:7], s44 offen sc1
    v_mfma_f32_16x16x32_bf16 v[168:171], a[164:167], v[156:159], v[168:171]
    s_add_u32 s44, s49, 3686400
    buffer_load_dwordx4 a[132:135], v7, s[4:7], s44 offen sc1
    s_waitcnt lgkmcnt(0)
    v_mfma_f32_16x16x32_bf16 v[160:163], a[168:171], a[192:195], v[160:163]
    ds_read_b64_tr_b16 a[144:145], v251 offset:24640
    v_mfma_f32_16x16x32_bf16 v[160:163], a[172:175], a[204:207], v[160:163]
    ds_read_b64_tr_b16 a[146:147], v251 offset:26688
    v_mfma_f32_16x16x32_bf16 v[160:163], a[176:179], a[216:219], v[160:163]
    ds_read_b64_tr_b16 a[148:149], v251 offset:28736
    v_mfma_f32_16x16x32_bf16 v[160:163], a[180:183], a[228:231], v[160:163]
    ds_read_b64_tr_b16 a[150:151], v251 offset:30784
    v_mfma_f32_16x16x32_bf16 v[160:163], a[184:187], a[240:243], v[160:163]
    ds_read_b64_tr_b16 a[152:153], v251 offset:32832
    v_mfma_f32_16x16x32_bf16 v[160:163], a[188:191], a[252:255], v[160:163]
    ds_read_b64_tr_b16 a[154:155], v251 offset:34880
    v_mfma_f32_16x16x32_bf16 v[164:167], a[168:171], a[196:199], v[164:167]
    ds_read_b64_tr_b16 a[156:157], v251 offset:36928
    v_mfma_f32_16x16x32_bf16 v[164:167], a[172:175], a[208:211], v[164:167]
    ds_read_b64_tr_b16 a[158:159], v251 offset:38976
    v_mfma_f32_16x16x32_bf16 v[164:167], a[176:179], a[220:223], v[164:167]
    ds_read_b64_tr_b16 a[160:161], v251 offset:41024
    v_mfma_f32_16x16x32_bf16 v[164:167], a[180:183], a[232:235], v[164:167]
    ds_read_b64_tr_b16 a[162:163], v251 offset:43072
    v_mfma_f32_16x16x32_bf16 v[164:167], a[184:187], a[244:247], v[164:167]
    ds_read_b64_tr_b16 a[164:165], v251 offset:45120
    v_mfma_f32_16x16x32_bf16 v[164:167], a[188:191], a[0:3], v[164:167]
    ds_read_b64_tr_b16 a[166:167], v251 offset:47168
    v_mfma_f32_16x16x32_bf16 v[168:171], a[168:171], a[200:203], v[168:171]
    v_mfma_f32_16x16x32_bf16 v[168:171], a[172:175], a[212:215], v[168:171]
    v_mfma_f32_16x16x32_bf16 v[168:171], a[176:179], a[224:227], v[168:171]
    v_mfma_f32_16x16x32_bf16 v[168:171], a[180:183], a[236:239], v[168:171]
    v_mfma_f32_16x16x32_bf16 v[168:171], a[184:187], a[248:251], v[168:171]
    v_mfma_f32_16x16x32_bf16 v[168:171], a[188:191], a[4:7], v[168:171]
    s_waitcnt lgkmcnt(0)
    v_mfma_f32_16x16x32_bf16 v[172:175], a[144:147], v[88:91], 0
    ds_read_b64_tr_b16 a[168:169], v247 offset:24640
    v_mfma_f32_16x16x32_bf16 v[172:175], a[148:151], v[100:103], v[172:175]
    ds_read_b64_tr_b16 a[170:171], v247 offset:26688
    v_mfma_f32_16x16x32_bf16 v[172:175], a[152:155], v[112:115], v[172:175]
    ds_read_b64_tr_b16 a[172:173], v247 offset:28736
    v_mfma_f32_16x16x32_bf16 v[172:175], a[156:159], v[124:127], v[172:175]
    ds_read_b64_tr_b16 a[174:175], v247 offset:30784
    v_cvt_pk_bf16_f32 v220, v160, v161
    v_mfma_f32_16x16x32_bf16 v[172:175], a[160:163], v[136:139], v[172:175]
    ds_read_b64_tr_b16 a[176:177], v247 offset:32832
    v_cvt_pk_bf16_f32 v221, v162, v163
    v_mfma_f32_16x16x32_bf16 v[172:175], a[164:167], v[148:151], v[172:175]
    ds_read_b64_tr_b16 a[178:179], v247 offset:34880
    v_cvt_pk_bf16_f32 v224, v164, v165
    v_mfma_f32_16x16x32_bf16 v[176:179], a[144:147], v[92:95], 0
    ds_read_b64_tr_b16 a[180:181], v247 offset:36928
    v_cvt_pk_bf16_f32 v225, v166, v167
    v_mfma_f32_16x16x32_bf16 v[176:179], a[148:151], v[104:107], v[176:179]
    ds_read_b64_tr_b16 a[182:183], v247 offset:38976
    v_cvt_pk_bf16_f32 v228, v168, v169
    v_mfma_f32_16x16x32_bf16 v[176:179], a[152:155], v[116:119], v[176:179]
    ds_read_b64_tr_b16 a[184:185], v247 offset:41024
    v_cvt_pk_bf16_f32 v229, v170, v171
    v_mfma_f32_16x16x32_bf16 v[176:179], a[156:159], v[128:131], v[176:179]
    ds_read_b64_tr_b16 a[186:187], v247 offset:43072
    v_mfma_f32_16x16x32_bf16 v[176:179], a[160:163], v[140:143], v[176:179]
    ds_read_b64_tr_b16 a[188:189], v247 offset:45120
    v_mfma_f32_16x16x32_bf16 v[176:179], a[164:167], v[152:155], v[176:179]
    ds_read_b64_tr_b16 a[190:191], v247 offset:47168
    v_mfma_f32_16x16x32_bf16 v[180:183], a[144:147], v[96:99], 0
    v_mfma_f32_16x16x32_bf16 v[180:183], a[148:151], v[108:111], v[180:183]
    v_mfma_f32_16x16x32_bf16 v[180:183], a[152:155], v[120:123], v[180:183]
    v_mfma_f32_16x16x32_bf16 v[180:183], a[156:159], v[132:135], v[180:183]
    v_mfma_f32_16x16x32_bf16 v[180:183], a[160:163], v[144:147], v[180:183]
    v_mfma_f32_16x16x32_bf16 v[180:183], a[164:167], v[156:159], v[180:183]
    s_waitcnt vmcnt(15)
    s_waitcnt lgkmcnt(0)
    s_barrier
    v_mov_b32 v37, 3
    buffer_store_dword v37, v33, s[24:27], 0 offen sc1
    v_mfma_f32_16x16x32_bf16 v[172:175], a[168:171], a[192:195], v[172:175]
    ds_read_b64_tr_b16 a[144:145], v252 offset:0
    v_mfma_f32_16x16x32_bf16 v[172:175], a[172:175], a[204:207], v[172:175]
    ds_read_b64_tr_b16 a[146:147], v252 offset:2048
    v_mfma_f32_16x16x32_bf16 v[172:175], a[176:179], a[216:219], v[172:175]
    ds_read_b64_tr_b16 a[148:149], v252 offset:4096
    v_mfma_f32_16x16x32_bf16 v[172:175], a[180:183], a[228:231], v[172:175]
    ds_read_b64_tr_b16 a[150:151], v252 offset:6144
    v_mfma_f32_16x16x32_bf16 v[172:175], a[184:187], a[240:243], v[172:175]
    ds_read_b64_tr_b16 a[152:153], v252 offset:8192
    v_mfma_f32_16x16x32_bf16 v[172:175], a[188:191], a[252:255], v[172:175]
    ds_read_b64_tr_b16 a[154:155], v252 offset:10240
    v_mfma_f32_16x16x32_bf16 v[176:179], a[168:171], a[196:199], v[176:179]
    ds_read_b64_tr_b16 a[156:157], v252 offset:12288
    v_mfma_f32_16x16x32_bf16 v[176:179], a[172:175], a[208:211], v[176:179]
    ds_read_b64_tr_b16 a[158:159], v252 offset:14336
    v_mfma_f32_16x16x32_bf16 v[176:179], a[176:179], a[220:223], v[176:179]
    ds_read_b64_tr_b16 a[160:161], v252 offset:16384
    v_mfma_f32_16x16x32_bf16 v[176:179], a[180:183], a[232:235], v[176:179]
    ds_read_b64_tr_b16 a[162:163], v252 offset:18432
    v_mfma_f32_16x16x32_bf16 v[176:179], a[184:187], a[244:247], v[176:179]
    ds_read_b64_tr_b16 a[164:165], v252 offset:20480
    v_mfma_f32_16x16x32_bf16 v[176:179], a[188:191], a[0:3], v[176:179]
    ds_read_b64_tr_b16 a[166:167], v252 offset:22528
    v_mfma_f32_16x16x32_bf16 v[180:183], a[168:171], a[200:203], v[180:183]
    v_mfma_f32_16x16x32_bf16 v[180:183], a[172:175], a[212:215], v[180:183]
    v_mfma_f32_16x16x32_bf16 v[180:183], a[176:179], a[224:227], v[180:183]
    v_mfma_f32_16x16x32_bf16 v[180:183], a[180:183], a[236:239], v[180:183]
    v_mfma_f32_16x16x32_bf16 v[180:183], a[184:187], a[248:251], v[180:183]
    v_mfma_f32_16x16x32_bf16 v[180:183], a[188:191], a[4:7], v[180:183]
    s_waitcnt lgkmcnt(0)
    v_mfma_f32_16x16x32_bf16 v[160:163], a[144:147], v[88:91], 0
    ds_read_b64_tr_b16 a[168:169], v244 offset:0
    v_mfma_f32_16x16x32_bf16 v[160:163], a[148:151], v[100:103], v[160:163]
    ds_read_b64_tr_b16 a[170:171], v244 offset:2048
    v_mfma_f32_16x16x32_bf16 v[160:163], a[152:155], v[112:115], v[160:163]
    ds_read_b64_tr_b16 a[172:173], v244 offset:4096
    v_mfma_f32_16x16x32_bf16 v[160:163], a[156:159], v[124:127], v[160:163]
    ds_read_b64_tr_b16 a[174:175], v244 offset:6144
    v_cvt_pk_bf16_f32 v222, v172, v173
    v_mfma_f32_16x16x32_bf16 v[160:163], a[160:163], v[136:139], v[160:163]
    ds_read_b64_tr_b16 a[176:177], v244 offset:8192
    v_cvt_pk_bf16_f32 v223, v174, v175
    v_mfma_f32_16x16x32_bf16 v[160:163], a[164:167], v[148:151], v[160:163]
    ds_read_b64_tr_b16 a[178:179], v244 offset:10240
    v_cvt_pk_bf16_f32 v226, v176, v177
    v_mfma_f32_16x16x32_bf16 v[164:167], a[144:147], v[92:95], 0
    ds_read_b64_tr_b16 a[180:181], v244 offset:12288
    v_cvt_pk_bf16_f32 v227, v178, v179
    v_mfma_f32_16x16x32_bf16 v[164:167], a[148:151], v[104:107], v[164:167]
    ds_read_b64_tr_b16 a[182:183], v244 offset:14336
    v_cvt_pk_bf16_f32 v230, v180, v181
    v_mfma_f32_16x16x32_bf16 v[164:167], a[152:155], v[116:119], v[164:167]
    ds_read_b64_tr_b16 a[184:185], v244 offset:16384
    v_cvt_pk_bf16_f32 v231, v182, v183
    v_mfma_f32_16x16x32_bf16 v[164:167], a[156:159], v[128:131], v[164:167]
    ds_read_b64_tr_b16 a[186:187], v244 offset:18432
    v_mfma_f32_16x16x32_bf16 v[164:167], a[160:163], v[140:143], v[164:167]
    ds_read_b64_tr_b16 a[188:189], v244 offset:20480
    s_mov_b32 s45, 208896
    v_mfma_f32_16x16x32_bf16 v[164:167], a[164:167], v[152:155], v[164:167]
    ds_read_b64_tr_b16 a[190:191], v244 offset:22528
    buffer_store_dwordx4 v[220:223], v32, s[20:23], s45 offen offset:0 sc1
    v_mfma_f32_16x16x32_bf16 v[168:171], a[144:147], v[96:99], 0
    buffer_store_dwordx4 v[224:227], v32, s[20:23], s45 offen offset:1024 sc1
    v_mfma_f32_16x16x32_bf16 v[168:171], a[148:151], v[108:111], v[168:171]
    buffer_store_dwordx4 v[228:231], v32, s[20:23], s45 offen offset:2048 sc1
    v_mfma_f32_16x16x32_bf16 v[168:171], a[152:155], v[120:123], v[168:171]
    v_mfma_f32_16x16x32_bf16 v[168:171], a[156:159], v[132:135], v[168:171]
    v_mfma_f32_16x16x32_bf16 v[168:171], a[160:163], v[144:147], v[168:171]
    v_mfma_f32_16x16x32_bf16 v[168:171], a[164:167], v[156:159], v[168:171]
    s_waitcnt lgkmcnt(0)
    v_mfma_f32_16x16x32_bf16 v[160:163], a[168:171], a[192:195], v[160:163]
    ds_read_b64_tr_b16 a[144:145], v253 offset:0
    v_mfma_f32_16x16x32_bf16 v[160:163], a[172:175], a[204:207], v[160:163]
    ds_read_b64_tr_b16 a[146:147], v253 offset:2048
    v_mfma_f32_16x16x32_bf16 v[160:163], a[176:179], a[216:219], v[160:163]
    ds_read_b64_tr_b16 a[148:149], v253 offset:4096
    v_mfma_f32_16x16x32_bf16 v[160:163], a[180:183], a[228:231], v[160:163]
    ds_read_b64_tr_b16 a[150:151], v253 offset:6144
    v_mfma_f32_16x16x32_bf16 v[160:163], a[184:187], a[240:243], v[160:163]
    ds_read_b64_tr_b16 a[152:153], v253 offset:8192
    v_mfma_f32_16x16x32_bf16 v[160:163], a[188:191], a[252:255], v[160:163]
    ds_read_b64_tr_b16 a[154:155], v253 offset:10240
    v_mfma_f32_16x16x32_bf16 v[164:167], a[168:171], a[196:199], v[164:167]
    ds_read_b64_tr_b16 a[156:157], v253 offset:12288
    v_mfma_f32_16x16x32_bf16 v[164:167], a[172:175], a[208:211], v[164:167]
    ds_read_b64_tr_b16 a[158:159], v253 offset:14336
    v_mfma_f32_16x16x32_bf16 v[164:167], a[176:179], a[220:223], v[164:167]
    ds_read_b64_tr_b16 a[160:161], v253 offset:16384
    v_mfma_f32_16x16x32_bf16 v[164:167], a[180:183], a[232:235], v[164:167]
    ds_read_b64_tr_b16 a[162:163], v253 offset:18432
    v_mfma_f32_16x16x32_bf16 v[164:167], a[184:187], a[244:247], v[164:167]
    ds_read_b64_tr_b16 a[164:165], v253 offset:20480
    v_mfma_f32_16x16x32_bf16 v[164:167], a[188:191], a[0:3], v[164:167]
    ds_read_b64_tr_b16 a[166:167], v253 offset:22528
    v_mfma_f32_16x16x32_bf16 v[168:171], a[168:171], a[200:203], v[168:171]
    v_mfma_f32_16x16x32_bf16 v[168:171], a[172:175], a[212:215], v[168:171]
    v_mfma_f32_16x16x32_bf16 v[168:171], a[176:179], a[224:227], v[168:171]
    buffer_load_dword v1, v34, s[24:27], 0 offen sc1
    v_mfma_f32_16x16x32_bf16 v[168:171], a[180:183], a[236:239], v[168:171]
    v_mfma_f32_16x16x32_bf16 v[168:171], a[184:187], a[248:251], v[168:171]
    v_mfma_f32_16x16x32_bf16 v[168:171], a[188:191], a[4:7], v[168:171]
    s_waitcnt lgkmcnt(0)
    v_mfma_f32_16x16x32_bf16 v[172:175], a[144:147], v[88:91], 0
    ds_read_b64_tr_b16 a[168:169], v245 offset:0
    v_mfma_f32_16x16x32_bf16 v[172:175], a[148:151], v[100:103], v[172:175]
    ds_read_b64_tr_b16 a[170:171], v245 offset:2048
    v_mfma_f32_16x16x32_bf16 v[172:175], a[152:155], v[112:115], v[172:175]
    ds_read_b64_tr_b16 a[172:173], v245 offset:4096
    v_mfma_f32_16x16x32_bf16 v[172:175], a[156:159], v[124:127], v[172:175]
    ds_read_b64_tr_b16 a[174:175], v245 offset:6144
    v_cvt_pk_bf16_f32 v64, v160, v161
    v_mfma_f32_16x16x32_bf16 v[172:175], a[160:163], v[136:139], v[172:175]
    ds_read_b64_tr_b16 a[176:177], v245 offset:8192
    v_cvt_pk_bf16_f32 v65, v162, v163
    v_mfma_f32_16x16x32_bf16 v[172:175], a[164:167], v[148:151], v[172:175]
    ds_read_b64_tr_b16 a[178:179], v245 offset:10240
    v_cvt_pk_bf16_f32 v68, v164, v165
    v_mfma_f32_16x16x32_bf16 v[176:179], a[144:147], v[92:95], 0
    ds_read_b64_tr_b16 a[180:181], v245 offset:12288
    v_cvt_pk_bf16_f32 v69, v166, v167
    v_mfma_f32_16x16x32_bf16 v[176:179], a[148:151], v[104:107], v[176:179]
    ds_read_b64_tr_b16 a[182:183], v245 offset:14336
    v_cvt_pk_bf16_f32 v72, v168, v169
    v_mfma_f32_16x16x32_bf16 v[176:179], a[152:155], v[116:119], v[176:179]
    ds_read_b64_tr_b16 a[184:185], v245 offset:16384
    v_cvt_pk_bf16_f32 v73, v170, v171
    v_mfma_f32_16x16x32_bf16 v[176:179], a[156:159], v[128:131], v[176:179]
    ds_read_b64_tr_b16 a[186:187], v245 offset:18432
    v_mfma_f32_16x16x32_bf16 v[176:179], a[160:163], v[140:143], v[176:179]
    ds_read_b64_tr_b16 a[188:189], v245 offset:20480
    v_mfma_f32_16x16x32_bf16 v[176:179], a[164:167], v[152:155], v[176:179]
    ds_read_b64_tr_b16 a[190:191], v245 offset:22528
    v_mfma_f32_16x16x32_bf16 v[180:183], a[144:147], v[96:99], 0
    v_mfma_f32_16x16x32_bf16 v[180:183], a[148:151], v[108:111], v[180:183]
    v_mfma_f32_16x16x32_bf16 v[180:183], a[152:155], v[120:123], v[180:183]
    v_mfma_f32_16x16x32_bf16 v[180:183], a[156:159], v[132:135], v[180:183]
    v_mfma_f32_16x16x32_bf16 v[180:183], a[160:163], v[144:147], v[180:183]
    v_mfma_f32_16x16x32_bf16 v[180:183], a[164:167], v[156:159], v[180:183]
    s_waitcnt lgkmcnt(0)
    v_mfma_f32_16x16x32_bf16 v[172:175], a[168:171], a[192:195], v[172:175]
    ds_read_b64_tr_b16 a[144:145], v254 offset:0
    v_mfma_f32_16x16x32_bf16 v[172:175], a[172:175], a[204:207], v[172:175]
    ds_read_b64_tr_b16 a[146:147], v254 offset:2048
    v_mfma_f32_16x16x32_bf16 v[172:175], a[176:179], a[216:219], v[172:175]
    ds_read_b64_tr_b16 a[148:149], v254 offset:4096
    v_mfma_f32_16x16x32_bf16 v[172:175], a[180:183], a[228:231], v[172:175]
    ds_read_b64_tr_b16 a[150:151], v254 offset:6144
    v_mfma_f32_16x16x32_bf16 v[172:175], a[184:187], a[240:243], v[172:175]
    ds_read_b64_tr_b16 a[152:153], v254 offset:8192
    v_mfma_f32_16x16x32_bf16 v[172:175], a[188:191], a[252:255], v[172:175]
    ds_read_b64_tr_b16 a[154:155], v254 offset:10240
    v_mfma_f32_16x16x32_bf16 v[176:179], a[168:171], a[196:199], v[176:179]
    ds_read_b64_tr_b16 a[156:157], v254 offset:12288
    v_mfma_f32_16x16x32_bf16 v[176:179], a[172:175], a[208:211], v[176:179]
    ds_read_b64_tr_b16 a[158:159], v254 offset:14336
    v_mfma_f32_16x16x32_bf16 v[176:179], a[176:179], a[220:223], v[176:179]
    ds_read_b64_tr_b16 a[160:161], v254 offset:16384
    v_mfma_f32_16x16x32_bf16 v[176:179], a[180:183], a[232:235], v[176:179]
    ds_read_b64_tr_b16 a[162:163], v254 offset:18432
    v_mfma_f32_16x16x32_bf16 v[176:179], a[184:187], a[244:247], v[176:179]
    ds_read_b64_tr_b16 a[164:165], v254 offset:20480
    v_mfma_f32_16x16x32_bf16 v[176:179], a[188:191], a[0:3], v[176:179]
    ds_read_b64_tr_b16 a[166:167], v254 offset:22528
    v_mfma_f32_16x16x32_bf16 v[180:183], a[168:171], a[200:203], v[180:183]
    v_mfma_f32_16x16x32_bf16 v[180:183], a[172:175], a[212:215], v[180:183]
    v_mfma_f32_16x16x32_bf16 v[180:183], a[176:179], a[224:227], v[180:183]
    v_mfma_f32_16x16x32_bf16 v[180:183], a[180:183], a[236:239], v[180:183]
    v_mfma_f32_16x16x32_bf16 v[180:183], a[184:187], a[248:251], v[180:183]
    v_mfma_f32_16x16x32_bf16 v[180:183], a[188:191], a[4:7], v[180:183]
    s_waitcnt lgkmcnt(0)
    v_mfma_f32_16x16x32_bf16 v[160:163], a[144:147], v[88:91], 0
    ds_read_b64_tr_b16 a[168:169], v246 offset:0
    v_mfma_f32_16x16x32_bf16 v[160:163], a[148:151], v[100:103], v[160:163]
    ds_read_b64_tr_b16 a[170:171], v246 offset:2048
    v_mfma_f32_16x16x32_bf16 v[160:163], a[152:155], v[112:115], v[160:163]
    ds_read_b64_tr_b16 a[172:173], v246 offset:4096
    v_mfma_f32_16x16x32_bf16 v[160:163], a[156:159], v[124:127], v[160:163]
    ds_read_b64_tr_b16 a[174:175], v246 offset:6144
    v_cvt_pk_bf16_f32 v66, v172, v173
    v_mfma_f32_16x16x32_bf16 v[160:163], a[160:163], v[136:139], v[160:163]
    ds_read_b64_tr_b16 a[176:177], v246 offset:8192
    v_cvt_pk_bf16_f32 v67, v174, v175
    v_mfma_f32_16x16x32_bf16 v[160:163], a[164:167], v[148:151], v[160:163]
    ds_read_b64_tr_b16 a[178:179], v246 offset:10240
    v_cvt_pk_bf16_f32 v70, v176, v177
    v_mfma_f32_16x16x32_bf16 v[164:167], a[144:147], v[92:95], 0
    ds_read_b64_tr_b16 a[180:181], v246 offset:12288
    v_cvt_pk_bf16_f32 v71, v178, v179
    v_mfma_f32_16x16x32_bf16 v[164:167], a[148:151], v[104:107], v[164:167]
    ds_read_b64_tr_b16 a[182:183], v246 offset:14336
    v_cvt_pk_bf16_f32 v74, v180, v181
    v_mfma_f32_16x16x32_bf16 v[164:167], a[152:155], v[116:119], v[164:167]
    ds_read_b64_tr_b16 a[184:185], v246 offset:16384
    v_cvt_pk_bf16_f32 v75, v182, v183
    v_mfma_f32_16x16x32_bf16 v[164:167], a[156:159], v[128:131], v[164:167]
    ds_read_b64_tr_b16 a[186:187], v246 offset:18432
    v_mfma_f32_16x16x32_bf16 v[164:167], a[160:163], v[140:143], v[164:167]
    ds_read_b64_tr_b16 a[188:189], v246 offset:20480
    s_mov_b32 s45, 221184
    v_mfma_f32_16x16x32_bf16 v[164:167], a[164:167], v[152:155], v[164:167]
    ds_read_b64_tr_b16 a[190:191], v246 offset:22528
    buffer_store_dwordx4 v[64:67], v32, s[20:23], s45 offen offset:0 sc1
    v_mfma_f32_16x16x32_bf16 v[168:171], a[144:147], v[96:99], 0
    buffer_store_dwordx4 v[68:71], v32, s[20:23], s45 offen offset:1024 sc1
    v_mfma_f32_16x16x32_bf16 v[168:171], a[148:151], v[108:111], v[168:171]
    buffer_store_dwordx4 v[72:75], v32, s[20:23], s45 offen offset:2048 sc1
    v_mfma_f32_16x16x32_bf16 v[168:171], a[152:155], v[120:123], v[168:171]
    v_mfma_f32_16x16x32_bf16 v[168:171], a[156:159], v[132:135], v[168:171]
    v_mfma_f32_16x16x32_bf16 v[168:171], a[160:163], v[144:147], v[168:171]
    v_mfma_f32_16x16x32_bf16 v[168:171], a[164:167], v[156:159], v[168:171]
    s_waitcnt lgkmcnt(0)
    v_mfma_f32_16x16x32_bf16 v[160:163], a[168:171], a[192:195], v[160:163]
    ds_read_b64_tr_b16 a[144:145], v255 offset:0
    v_mfma_f32_16x16x32_bf16 v[160:163], a[172:175], a[204:207], v[160:163]
    ds_read_b64_tr_b16 a[146:147], v255 offset:2048
    v_mfma_f32_16x16x32_bf16 v[160:163], a[176:179], a[216:219], v[160:163]
    ds_read_b64_tr_b16 a[148:149], v255 offset:4096
    s_waitcnt vmcnt(3)
    v_cmp_gt_u32 vcc, 3, v1
    s_cbranch_vccnz L_spin_2
L_ready_2:
    v_mfma_f32_16x16x32_bf16 v[160:163], a[180:183], a[228:231], v[160:163]
    ds_read_b64_tr_b16 a[150:151], v255 offset:6144
    s_add_u32 s44, s50, 0
    buffer_load_dwordx4 a[8:11], v7, s[4:7], s44 offen sc1
    v_mfma_f32_16x16x32_bf16 v[160:163], a[184:187], a[240:243], v[160:163]
    ds_read_b64_tr_b16 a[152:153], v255 offset:8192
    s_add_u32 s44, s50, 245760
    buffer_load_dwordx4 a[12:15], v7, s[4:7], s44 offen sc1
    v_mfma_f32_16x16x32_bf16 v[160:163], a[188:191], a[252:255], v[160:163]
    ds_read_b64_tr_b16 a[154:155], v255 offset:10240
    s_add_u32 s44, s50, 491520
    buffer_load_dwordx4 a[16:19], v7, s[4:7], s44 offen sc1
    v_mfma_f32_16x16x32_bf16 v[164:167], a[168:171], a[196:199], v[164:167]
    ds_read_b64_tr_b16 a[156:157], v255 offset:12288
    s_add_u32 s44, s50, 737280
    buffer_load_dwordx4 a[20:23], v7, s[4:7], s44 offen sc1
    v_mfma_f32_16x16x32_bf16 v[164:167], a[172:175], a[208:211], v[164:167]
    ds_read_b64_tr_b16 a[158:159], v255 offset:14336
    s_add_u32 s44, s50, 983040
    buffer_load_dwordx4 a[24:27], v7, s[4:7], s44 offen sc1
    v_mfma_f32_16x16x32_bf16 v[164:167], a[176:179], a[220:223], v[164:167]
    ds_read_b64_tr_b16 a[160:161], v255 offset:16384
    s_add_u32 s44, s50, 1228800
    buffer_load_dwordx4 a[28:31], v7, s[4:7], s44 offen sc1
    v_mfma_f32_16x16x32_bf16 v[164:167], a[180:183], a[232:235], v[164:167]
    ds_read_b64_tr_b16 a[162:163], v255 offset:18432
    s_add_u32 s44, s50, 1474560
    buffer_load_dwordx4 a[32:35], v7, s[4:7], s44 offen sc1
    v_mfma_f32_16x16x32_bf16 v[164:167], a[184:187], a[244:247], v[164:167]
    ds_read_b64_tr_b16 a[164:165], v255 offset:20480
    s_add_u32 s44, s50, 1720320
    buffer_load_dwordx4 a[36:39], v7, s[4:7], s44 offen sc1
    v_mfma_f32_16x16x32_bf16 v[164:167], a[188:191], a[0:3], v[164:167]
    ds_read_b64_tr_b16 a[166:167], v255 offset:22528
    v_mfma_f32_16x16x32_bf16 v[168:171], a[168:171], a[200:203], v[168:171]
    v_mfma_f32_16x16x32_bf16 v[168:171], a[172:175], a[212:215], v[168:171]
    v_mfma_f32_16x16x32_bf16 v[168:171], a[176:179], a[224:227], v[168:171]
    v_mfma_f32_16x16x32_bf16 v[168:171], a[180:183], a[236:239], v[168:171]
    v_mfma_f32_16x16x32_bf16 v[168:171], a[184:187], a[248:251], v[168:171]
    v_mfma_f32_16x16x32_bf16 v[168:171], a[188:191], a[4:7], v[168:171]
    s_waitcnt lgkmcnt(0)
    v_mfma_f32_16x16x32_bf16 v[172:175], a[144:147], v[88:91], 0
    ds_read_b64_tr_b16 a[168:169], v247 offset:0
    v_mfma_f32_16x16x32_bf16 v[172:175], a[148:151], v[100:103], v[172:175]
    ds_read_b64_tr_b16 a[170:171], v247 offset:2048
    v_mfma_f32_16x16x32_bf16 v[172:175], a[152:155], v[112:115], v[172:175]
    ds_read_b64_tr_b16 a[172:173], v247 offset:4096
    v_mfma_f32_16x16x32_bf16 v[172:175], a[156:159], v[124:127], v[172:175]
    ds_read_b64_tr_b16 a[174:175], v247 offset:6144
    v_cvt_pk_bf16_f32 v76, v160, v161
    v_mfma_f32_16x16x32_bf16 v[172:175], a[160:163], v[136:139], v[172:175]
    ds_read_b64_tr_b16 a[176:177], v247 offset:8192
    v_cvt_pk_bf16_f32 v77, v162, v163
    v_mfma_f32_16x16x32_bf16 v[172:175], a[164:167], v[148:151], v[172:175]
    ds_read_b64_tr_b16 a[178:179], v247 offset:10240
    v_cvt_pk_bf16_f32 v80, v164, v165
    v_mfma_f32_16x16x32_bf16 v[176:179], a[144:147], v[92:95], 0
    ds_read_b64_tr_b16 a[180:181], v247 offset:12288
    v_cvt_pk_bf16_f32 v81, v166, v167
    v_mfma_f32_16x16x32_bf16 v[176:179], a[148:151], v[104:107], v[176:179]
    ds_read_b64_tr_b16 a[182:183], v247 offset:14336
    v_cvt_pk_bf16_f32 v84, v168, v169
    v_mfma_f32_16x16x32_bf16 v[176:179], a[152:155], v[116:119], v[176:179]
    ds_read_b64_tr_b16 a[184:185], v247 offset:16384
    v_cvt_pk_bf16_f32 v85, v170, v171
    v_mfma_f32_16x16x32_bf16 v[176:179], a[156:159], v[128:131], v[176:179]
    ds_read_b64_tr_b16 a[186:187], v247 offset:18432
    v_mfma_f32_16x16x32_bf16 v[176:179], a[160:163], v[140:143], v[176:179]
    ds_read_b64_tr_b16 a[188:189], v247 offset:20480
    v_mfma_f32_16x16x32_bf16 v[176:179], a[164:167], v[152:155], v[176:179]
    ds_read_b64_tr_b16 a[190:191], v247 offset:22528
    v_mfma_f32_16x16x32_bf16 v[180:183], a[144:147], v[96:99], 0
    v_mfma_f32_16x16x32_bf16 v[180:183], a[148:151], v[108:111], v[180:183]
    v_mfma_f32_16x16x32_bf16 v[180:183], a[152:155], v[120:123], v[180:183]
    v_mfma_f32_16x16x32_bf16 v[180:183], a[156:159], v[132:135], v[180:183]
    v_mfma_f32_16x16x32_bf16 v[180:183], a[160:163], v[144:147], v[180:183]
    v_mfma_f32_16x16x32_bf16 v[180:183], a[164:167], v[156:159], v[180:183]
    v_mfma_f32_16x16x32_bf16 v[54:57], v[42:45], a[72:75], 0
    v_mfma_f32_16x16x32_bf16 v[54:57], v[42:45], a[76:79], v[54:57]
    v_mfma_f32_16x16x32_bf16 v[54:57], v[42:45], a[80:83], v[54:57]
    v_mfma_f32_16x16x32_bf16 v[54:57], v[42:45], a[84:87], v[54:57]
    v_mfma_f32_16x16x32_bf16 v[54:57], v[42:45], a[88:91], v[54:57]
    v_mfma_f32_16x16x32_bf16 v[54:57], v[42:45], a[92:95], v[54:57]
    v_mfma_f32_16x16x32_bf16 v[54:57], v[42:45], a[96:99], v[54:57]
    v_mfma_f32_16x16x32_bf16 v[54:57], v[42:45], a[100:103], v[54:57]
    v_mfma_f32_16x16x32_bf16 v[54:57], v[42:45], a[104:107], v[54:57]
    v_mfma_f32_16x16x32_bf16 v[54:57], v[42:45], a[108:111], v[54:57]
    v_mfma_f32_16x16x32_bf16 v[54:57], v[42:45], a[112:115], v[54:57]
    v_mfma_f32_16x16x32_bf16 v[54:57], v[42:45], a[116:119], v[54:57]
    v_mfma_f32_16x16x32_bf16 v[54:57], v[42:45], a[120:123], v[54:57]
    v_mfma_f32_16x16x32_bf16 v[54:57], v[42:45], a[124:127], v[54:57]
    v_mfma_f32_16x16x32_bf16 v[54:57], v[42:45], a[128:131], v[54:57]
    v_mfma_f32_16x16x32_bf16 v[54:57], v[42:45], a[132:135], v[54:57]
    v_mfma_f32_16x16x32_bf16 v[58:61], v[40:43], a[72:75], 0
    v_mfma_f32_16x16x32_bf16 v[58:61], v[40:43], a[76:79], v[58:61]
    v_mfma_f32_16x16x32_bf16 v[58:61], v[40:43], a[80:83], v[58:61]
    v_mfma_f32_16x16x32_bf16 v[58:61], v[40:43], a[84:87], v[58:61]
    v_mfma_f32_16x16x32_bf16 v[58:61], v[40:43], a[88:91], v[58:61]
    v_mfma_f32_16x16x32_bf16 v[58:61], v[40:43], a[92:95], v[58:61]
    v_mfma_f32_16x16x32_bf16 v[58:61], v[40:43], a[96:99], v[58:61]
    v_mfma_f32_16x16x32_bf16 v[58:61], v[40:43], a[100:103], v[58:61]
    v_mfma_f32_16x16x32_bf16 v[58:61], v[40:43], a[104:107], v[58:61]
    v_mfma_f32_16x16x32_bf16 v[58:61], v[40:43], a[108:111], v[58:61]
    v_mfma_f32_16x16x32_bf16 v[58:61], v[40:43], a[112:115], v[58:61]
    v_mfma_f32_16x16x32_bf16 v[58:61], v[40:43], a[116:119], v[58:61]
    v_mfma_f32_16x16x32_bf16 v[58:61], v[40:43], a[120:123], v[58:61]
    v_mfma_f32_16x16x32_bf16 v[58:61], v[40:43], a[124:127], v[58:61]
    v_mfma_f32_16x16x32_bf16 v[58:61], v[40:43], a[128:131], v[58:61]
    v_mfma_f32_16x16x32_bf16 v[58:61], v[40:43], a[132:135], v[58:61]
    s_waitcnt lgkmcnt(0)
    v_mfma_f32_16x16x32_bf16 v[172:175], a[168:171], a[192:195], v[172:175]
    v_mfma_f32_16x16x32_bf16 v[172:175], a[172:175], a[204:207], v[172:175]
    v_mfma_f32_16x16x32_bf16 v[172:175], a[176:179], a[216:219], v[172:175]
    v_cvt_pk_bf16_f32 v54, v54, v55
    v_mfma_f32_16x16x32_bf16 v[172:175], a[180:183], a[228:231], v[172:175]
    v_cvt_pk_bf16_f32 v55, v56, v57
    v_mfma_f32_16x16x32_bf16 v[172:175], a[184:187], a[240:243], v[172:175]
    v_cvt_pk_bf16_f32 v56, v58, v59
    v_mfma_f32_16x16x32_bf16 v[172:175], a[188:191], a[252:255], v[172:175]
    v_cvt_pk_bf16_f32 v57, v60, v61
    v_mfma_f32_16x16x32_bf16 v[176:179], a[168:171], a[196:199], v[176:179]
    v_permlane32_swap_b32 v54, v56
    v_mfma_f32_16x16x32_bf16 v[176:179], a[172:175], a[208:211], v[176:179]
    v_permlane32_swap_b32 v55, v57
    v_mfma_f32_16x16x32_bf16 v[176:179], a[176:179], a[220:223], v[176:179]
    v_permlane16_swap_b32 v54, v56
    v_mfma_f32_16x16x32_bf16 v[176:179], a[180:183], a[232:235], v[176:179]
    v_permlane16_swap_b32 v55, v57
    v_mfma_f32_16x16x32_bf16 v[176:179], a[184:187], a[244:247], v[176:179]
    buffer_store_dwordx4 v[54:57], v35, s[8:11], s53 offen
    v_mfma_f32_16x16x32_bf16 v[176:179], a[188:191], a[0:3], v[176:179]
    v_mfma_f32_16x16x32_bf16 v[180:183], a[168:171], a[200:203], v[180:183]
    v_mfma_f32_16x16x32_bf16 v[180:183], a[172:175], a[212:215], v[180:183]
    v_mfma_f32_16x16x32_bf16 v[180:183], a[176:179], a[224:227], v[180:183]
    v_mfma_f32_16x16x32_bf16 v[180:183], a[180:183], a[236:239], v[180:183]
    v_mfma_f32_16x16x32_bf16 v[180:183], a[184:187], a[248:251], v[180:183]
    v_mfma_f32_16x16x32_bf16 v[180:183], a[188:191], a[4:7], v[180:183]
    s_nop 7
    v_cvt_pk_bf16_f32 v78, v172, v173
    v_cvt_pk_bf16_f32 v79, v174, v175
    v_cvt_pk_bf16_f32 v82, v176, v177
    v_cvt_pk_bf16_f32 v83, v178, v179
    v_cvt_pk_bf16_f32 v86, v180, v181
    v_cvt_pk_bf16_f32 v87, v182, v183
    s_mov_b32 s45, 233472
    buffer_store_dwordx4 v[76:79], v32, s[20:23], s45 offen offset:0 sc1
    buffer_store_dwordx4 v[80:83], v32, s[20:23], s45 offen offset:1024 sc1
    buffer_store_dwordx4 v[84:87], v32, s[20:23], s45 offen offset:2048 sc1
    s_add_u32 s44, s50, 1966080
    buffer_load_dwordx4 a[40:43], v7, s[4:7], s44 offen sc1
    s_add_u32 s44, s50, 2211840
    buffer_load_dwordx4 a[44:47], v7, s[4:7], s44 offen sc1
    s_add_u32 s44, s50, 2457600
    buffer_load_dwordx4 a[48:51], v7, s[4:7], s44 offen sc1
    s_add_u32 s44, s50, 2703360
    buffer_load_dwordx4 a[52:55], v7, s[4:7], s44 offen sc1
    s_add_u32 s44, s50, 2949120
    buffer_load_dwordx4 a[56:59], v7, s[4:7], s44 offen sc1
    s_add_u32 s44, s50, 3194880
    buffer_load_dwordx4 a[60:63], v7, s[4:7], s44 offen sc1
    s_add_u32 s44, s50, 3440640
    buffer_load_dwordx4 a[64:67], v7, s[4:7], s44 offen sc1
    s_add_u32 s44, s50, 3686400
    buffer_load_dwordx4 a[68:71], v7, s[4:7], s44 offen sc1
    s_waitcnt vmcnt(8)
    s_barrier
    v_mov_b32 v37, 4
    buffer_store_dword v37, v33, s[24:27], 0 offen sc1
    v_mfma_f32_16x16x32_bf16 v[46:49], v[42:45], a[8:11], 0
    v_mfma_f32_16x16x32_bf16 v[46:49], v[42:45], a[12:15], v[46:49]
    v_mfma_f32_16x16x32_bf16 v[46:49], v[42:45], a[16:19], v[46:49]
    v_mfma_f32_16x16x32_bf16 v[46:49], v[42:45], a[20:23], v[46:49]
    v_mfma_f32_16x16x32_bf16 v[46:49], v[42:45], a[24:27], v[46:49]
    v_mfma_f32_16x16x32_bf16 v[46:49], v[42:45], a[28:31], v[46:49]
    v_mfma_f32_16x16x32_bf16 v[46:49], v[42:45], a[32:35], v[46:49]
    v_mfma_f32_16x16x32_bf16 v[46:49], v[42:45], a[36:39], v[46:49]
    s_waitcnt vmcnt(8)
    v_mfma_f32_16x16x32_bf16 v[46:49], v[42:45], a[40:43], v[46:49]
    s_waitcnt vmcnt(7)
    v_mfma_f32_16x16x32_bf16 v[46:49], v[42:45], a[44:47], v[46:49]
    s_waitcnt vmcnt(6)
    v_mfma_f32_16x16x32_bf16 v[46:49], v[42:45], a[48:51], v[46:49]
    s_waitcnt vmcnt(5)
    v_mfma_f32_16x16x32_bf16 v[46:49], v[42:45], a[52:55], v[46:49]
    s_waitcnt vmcnt(4)
    v_mfma_f32_16x16x32_bf16 v[46:49], v[42:45], a[56:59], v[46:49]
    s_waitcnt vmcnt(3)
    v_mfma_f32_16x16x32_bf16 v[46:49], v[42:45], a[60:63], v[46:49]
    s_waitcnt vmcnt(2)
    v_mfma_f32_16x16x32_bf16 v[46:49], v[42:45], a[64:67], v[46:49]
    s_waitcnt vmcnt(1)
    v_mfma_f32_16x16x32_bf16 v[46:49], v[42:45], a[68:71], v[46:49]
    v_mfma_f32_16x16x32_bf16 v[50:53], v[40:43], a[8:11], 0
    v_mfma_f32_16x16x32_bf16 v[50:53], v[40:43], a[12:15], v[50:53]
    v_mfma_f32_16x16x32_bf16 v[50:53], v[40:43], a[16:19], v[50:53]
    v_mfma_f32_16x16x32_bf16 v[50:53], v[40:43], a[20:23], v[50:53]
    v_mfma_f32_16x16x32_bf16 v[50:53], v[40:43], a[24:27], v[50:53]
    v_mfma_f32_16x16x32_bf16 v[50:53], v[40:43], a[28:31], v[50:53]
    v_mfma_f32_16x16x32_bf16 v[50:53], v[40:43], a[32:35], v[50:53]
    v_mfma_f32_16x16x32_bf16 v[50:53], v[40:43], a[36:39], v[50:53]
    v_mfma_f32_16x16x32_bf16 v[50:53], v[40:43], a[40:43], v[50:53]
    v_mfma_f32_16x16x32_bf16 v[50:53], v[40:43], a[44:47], v[50:53]
    v_mfma_f32_16x16x32_bf16 v[50:53], v[40:43], a[48:51], v[50:53]
    v_mfma_f32_16x16x32_bf16 v[50:53], v[40:43], a[52:55], v[50:53]
    v_mfma_f32_16x16x32_bf16 v[50:53], v[40:43], a[56:59], v[50:53]
    v_mfma_f32_16x16x32_bf16 v[50:53], v[40:43], a[60:63], v[50:53]
    v_mfma_f32_16x16x32_bf16 v[50:53], v[40:43], a[64:67], v[50:53]
    v_mfma_f32_16x16x32_bf16 v[50:53], v[40:43], a[68:71], v[50:53]
    buffer_load_dword v1, v34, s[24:27], 0 offen sc1
    s_nop 7
    v_cvt_pk_bf16_f32 v46, v46, v47
    v_cvt_pk_bf16_f32 v47, v48, v49
    v_cvt_pk_bf16_f32 v48, v50, v51
    v_cvt_pk_bf16_f32 v49, v52, v53
    s_nop 0
    v_permlane32_swap_b32 v46, v48
    v_permlane32_swap_b32 v47, v49
    s_nop 0
    v_permlane16_swap_b32 v46, v48
    v_permlane16_swap_b32 v47, v49
    buffer_store_dwordx4 v[46:49], v35, s[8:11], s54 offen
    s_waitcnt vmcnt(1)
    v_cmp_gt_u32 vcc, 4, v1
    s_cbranch_vccnz L_spin_3
L_ready_3:
    s_add_u32 s44, s51, 0
    buffer_load_dwordx4 a[72:75], v7, s[4:7], s44 offen sc1
    s_add_u32 s44, s51, 245760
    buffer_load_dwordx4 a[76:79], v7, s[4:7], s44 offen sc1
    s_add_u32 s44, s51, 491520
    buffer_load_dwordx4 a[80:83], v7, s[4:7], s44 offen sc1
    s_add_u32 s44, s51, 737280
    buffer_load_dwordx4 a[84:87], v7, s[4:7], s44 offen sc1
    s_add_u32 s44, s51, 983040
    buffer_load_dwordx4 a[88:91], v7, s[4:7], s44 offen sc1
    s_add_u32 s44, s51, 1228800
    buffer_load_dwordx4 a[92:95], v7, s[4:7], s44 offen sc1
    s_add_u32 s44, s51, 1474560
    buffer_load_dwordx4 a[96:99], v7, s[4:7], s44 offen sc1
    s_add_u32 s44, s51, 1720320
    buffer_load_dwordx4 a[100:103], v7, s[4:7], s44 offen sc1
    s_add_u32 s44, s51, 1966080
    buffer_load_dwordx4 a[104:107], v7, s[4:7], s44 offen sc1
    s_add_u32 s44, s51, 2211840
    buffer_load_dwordx4 a[108:111], v7, s[4:7], s44 offen sc1
    s_add_u32 s44, s51, 2457600
    buffer_load_dwordx4 a[112:115], v7, s[4:7], s44 offen sc1
    s_add_u32 s44, s51, 2703360
    buffer_load_dwordx4 a[116:119], v7, s[4:7], s44 offen sc1
    s_add_u32 s44, s51, 2949120
    buffer_load_dwordx4 a[120:123], v7, s[4:7], s44 offen sc1
    s_add_u32 s44, s51, 3194880
    buffer_load_dwordx4 a[124:127], v7, s[4:7], s44 offen sc1
    s_add_u32 s44, s51, 3440640
    buffer_load_dwordx4 a[128:131], v7, s[4:7], s44 offen sc1
    s_add_u32 s44, s51, 3686400
    buffer_load_dwordx4 a[132:135], v7, s[4:7], s44 offen sc1
    s_waitcnt vmcnt(15)
    v_mfma_f32_16x16x32_bf16 v[54:57], v[42:45], a[72:75], 0
    s_waitcnt vmcnt(14)
    v_mfma_f32_16x16x32_bf16 v[54:57], v[42:45], a[76:79], v[54:57]
    s_waitcnt vmcnt(13)
    v_mfma_f32_16x16x32_bf16 v[54:57], v[42:45], a[80:83], v[54:57]
    s_waitcnt vmcnt(12)
    v_mfma_f32_16x16x32_bf16 v[54:57], v[42:45], a[84:87], v[54:57]
    s_waitcnt vmcnt(11)
    v_mfma_f32_16x16x32_bf16 v[54:57], v[42:45], a[88:91], v[54:57]
    s_waitcnt vmcnt(10)
    v_mfma_f32_16x16x32_bf16 v[54:57], v[42:45], a[92:95], v[54:57]
    s_waitcnt vmcnt(9)
    v_mfma_f32_16x16x32_bf16 v[54:57], v[42:45], a[96:99], v[54:57]
    s_waitcnt vmcnt(8)
    v_mfma_f32_16x16x32_bf16 v[54:57], v[42:45], a[100:103], v[54:57]
    s_waitcnt vmcnt(7)
    v_mfma_f32_16x16x32_bf16 v[54:57], v[42:45], a[104:107], v[54:57]
    s_waitcnt vmcnt(6)
    v_mfma_f32_16x16x32_bf16 v[54:57], v[42:45], a[108:111], v[54:57]
    s_waitcnt vmcnt(5)
    v_mfma_f32_16x16x32_bf16 v[54:57], v[42:45], a[112:115], v[54:57]
    s_waitcnt vmcnt(4)
    v_mfma_f32_16x16x32_bf16 v[54:57], v[42:45], a[116:119], v[54:57]
    s_waitcnt vmcnt(3)
    v_mfma_f32_16x16x32_bf16 v[54:57], v[42:45], a[120:123], v[54:57]
    s_waitcnt vmcnt(2)
    v_mfma_f32_16x16x32_bf16 v[54:57], v[42:45], a[124:127], v[54:57]
    s_waitcnt vmcnt(1)
    v_mfma_f32_16x16x32_bf16 v[54:57], v[42:45], a[128:131], v[54:57]
    s_waitcnt vmcnt(0)
    v_mfma_f32_16x16x32_bf16 v[54:57], v[42:45], a[132:135], v[54:57]
    v_mfma_f32_16x16x32_bf16 v[58:61], v[40:43], a[72:75], 0
    v_mfma_f32_16x16x32_bf16 v[58:61], v[40:43], a[76:79], v[58:61]
    v_mfma_f32_16x16x32_bf16 v[58:61], v[40:43], a[80:83], v[58:61]
    v_mfma_f32_16x16x32_bf16 v[58:61], v[40:43], a[84:87], v[58:61]
    v_mfma_f32_16x16x32_bf16 v[58:61], v[40:43], a[88:91], v[58:61]
    v_mfma_f32_16x16x32_bf16 v[58:61], v[40:43], a[92:95], v[58:61]
    v_mfma_f32_16x16x32_bf16 v[58:61], v[40:43], a[96:99], v[58:61]
    v_mfma_f32_16x16x32_bf16 v[58:61], v[40:43], a[100:103], v[58:61]
    v_mfma_f32_16x16x32_bf16 v[58:61], v[40:43], a[104:107], v[58:61]
    v_mfma_f32_16x16x32_bf16 v[58:61], v[40:43], a[108:111], v[58:61]
    v_mfma_f32_16x16x32_bf16 v[58:61], v[40:43], a[112:115], v[58:61]
    v_mfma_f32_16x16x32_bf16 v[58:61], v[40:43], a[116:119], v[58:61]
    v_mfma_f32_16x16x32_bf16 v[58:61], v[40:43], a[120:123], v[58:61]
    v_mfma_f32_16x16x32_bf16 v[58:61], v[40:43], a[124:127], v[58:61]
    v_mfma_f32_16x16x32_bf16 v[58:61], v[40:43], a[128:131], v[58:61]
    v_mfma_f32_16x16x32_bf16 v[58:61], v[40:43], a[132:135], v[58:61]
    s_nop 7
    v_cvt_pk_bf16_f32 v54, v54, v55
    v_cvt_pk_bf16_f32 v55, v56, v57
    v_cvt_pk_bf16_f32 v56, v58, v59
    v_cvt_pk_bf16_f32 v57, v60, v61
    s_nop 0
    v_permlane32_swap_b32 v54, v56
    v_permlane32_swap_b32 v55, v57
    s_nop 0
    v_permlane16_swap_b32 v54, v56
    v_permlane16_swap_b32 v55, v57
    buffer_store_dwordx4 v[54:57], v35, s[8:11], s55 offen
L_standalone__mha_block_cached__near_ridge_kernel_exit:
    s_endpgm
L_stub_0:
    s_call_b64 s[30:31], L_slow_0
    s_branch L_ret_0
L_stub_1:
    s_call_b64 s[30:31], L_slow_1
    s_branch L_ret_1
L_stub_2:
    s_call_b64 s[30:31], L_slow_0
    s_branch L_ret_2
L_stub_3:
    s_call_b64 s[30:31], L_slow_1
    s_branch L_ret_3
L_stub_4:
    s_call_b64 s[30:31], L_slow_0
    s_branch L_ret_4
L_stub_5:
    s_call_b64 s[30:31], L_slow_1
    s_branch L_ret_5
L_stub_6:
    s_call_b64 s[30:31], L_slow_0
    s_branch L_ret_6
L_stub_7:
    s_call_b64 s[30:31], L_slow_1
    s_branch L_ret_7
L_slow_0:
    s_nop 15
    v_max3_f32 v1, v160, v161, v162
    v_max3_f32 v1, v1, v163, v172
    v_max3_f32 v1, v1, v173, v174
    v_max3_f32 v1, v1, v175, v184
    v_max3_f32 v1, v1, v185, v186
    v_max3_f32 v1, v1, v187, v196
    v_max3_f32 v1, v1, v197, v198
    v_max_f32 v1, v1, v199
    v_mov_b32 v2, v1
    s_nop 1
    v_permlane32_swap_b32 v2, v1
    v_max_f32 v1, v1, v2
    v_mov_b32 v2, v1
    s_nop 1
    v_permlane16_swap_b32 v2, v1
    v_max_f32 v1, v1, v2
    v_max_f32 v1, 0, v1
    v_sub_f32 v3, 0, v1
    v_exp_f32 v3, v3
    s_nop 0
    v_mul_f32 v52, v52, v3
    v_sub_f32 v40, v40, v1
    v_sub_f32 v41, v41, v1
    v_sub_f32 v42, v42, v1
    v_sub_f32 v43, v43, v1
    v_sub_f32 v160, v160, v1
    v_sub_f32 v161, v161, v1
    v_sub_f32 v162, v162, v1
    v_sub_f32 v163, v163, v1
    v_sub_f32 v172, v172, v1
    v_sub_f32 v173, v173, v1
    v_sub_f32 v174, v174, v1
    v_sub_f32 v175, v175, v1
    v_sub_f32 v184, v184, v1
    v_sub_f32 v185, v185, v1
    v_sub_f32 v186, v186, v1
    v_sub_f32 v187, v187, v1
    v_sub_f32 v196, v196, v1
    v_sub_f32 v197, v197, v1
    v_sub_f32 v198, v198, v1
    v_sub_f32 v199, v199, v1
    v_accvgpr_read_b32 v58, a0
    v_accvgpr_read_b32 v59, a1
    v_accvgpr_read_b32 v60, a2
    v_accvgpr_read_b32 v61, a3
    v_mul_f32 v58, v58, v3
    v_mul_f32 v59, v59, v3
    v_mul_f32 v60, v60, v3
    v_mul_f32 v61, v61, v3
    v_accvgpr_write_b32 a0, v58
    v_accvgpr_write_b32 a1, v59
    v_accvgpr_write_b32 a2, v60
    v_accvgpr_write_b32 a3, v61
    v_accvgpr_read_b32 v58, a12
    v_accvgpr_read_b32 v59, a13
    v_accvgpr_read_b32 v60, a14
    v_accvgpr_read_b32 v61, a15
    v_mul_f32 v58, v58, v3
    v_mul_f32 v59, v59, v3
    v_mul_f32 v60, v60, v3
    v_mul_f32 v61, v61, v3
    v_accvgpr_write_b32 a12, v58
    v_accvgpr_write_b32 a13, v59
    v_accvgpr_write_b32 a14, v60
    v_accvgpr_write_b32 a15, v61
    v_accvgpr_read_b32 v58, a24
    v_accvgpr_read_b32 v59, a25
    v_accvgpr_read_b32 v60, a26
    v_accvgpr_read_b32 v61, a27
    v_mul_f32 v58, v58, v3
    v_mul_f32 v59, v59, v3
    v_mul_f32 v60, v60, v3
    v_mul_f32 v61, v61, v3
    v_accvgpr_write_b32 a24, v58
    v_accvgpr_write_b32 a25, v59
    v_accvgpr_write_b32 a26, v60
    v_accvgpr_write_b32 a27, v61
    v_accvgpr_read_b32 v58, a36
    v_accvgpr_read_b32 v59, a37
    v_accvgpr_read_b32 v60, a38
    v_accvgpr_read_b32 v61, a39
    v_mul_f32 v58, v58, v3
    v_mul_f32 v59, v59, v3
    v_mul_f32 v60, v60, v3
    v_mul_f32 v61, v61, v3
    v_accvgpr_write_b32 a36, v58
    v_accvgpr_write_b32 a37, v59
    v_accvgpr_write_b32 a38, v60
    v_accvgpr_write_b32 a39, v61
    v_accvgpr_read_b32 v58, a48
    v_accvgpr_read_b32 v59, a49
    v_accvgpr_read_b32 v60, a50
    v_accvgpr_read_b32 v61, a51
    v_mul_f32 v58, v58, v3
    v_mul_f32 v59, v59, v3
    v_mul_f32 v60, v60, v3
    v_mul_f32 v61, v61, v3
    v_accvgpr_write_b32 a48, v58
    v_accvgpr_write_b32 a49, v59
    v_accvgpr_write_b32 a50, v60
    v_accvgpr_write_b32 a51, v61
    v_accvgpr_read_b32 v58, a60
    v_accvgpr_read_b32 v59, a61
    v_accvgpr_read_b32 v60, a62
    v_accvgpr_read_b32 v61, a63
    v_mul_f32 v58, v58, v3
    v_mul_f32 v59, v59, v3
    v_mul_f32 v60, v60, v3
    v_mul_f32 v61, v61, v3
    v_accvgpr_write_b32 a60, v58
    v_accvgpr_write_b32 a61, v59
    v_accvgpr_write_b32 a62, v60
    v_accvgpr_write_b32 a63, v61
    v_accvgpr_read_b32 v58, a72
    v_accvgpr_read_b32 v59, a73
    v_accvgpr_read_b32 v60, a74
    v_accvgpr_read_b32 v61, a75
    v_mul_f32 v58, v58, v3
    v_mul_f32 v59, v59, v3
    v_mul_f32 v60, v60, v3
    v_mul_f32 v61, v61, v3
    v_accvgpr_write_b32 a72, v58
    v_accvgpr_write_b32 a73, v59
    v_accvgpr_write_b32 a74, v60
    v_accvgpr_write_b32 a75, v61
    v_accvgpr_read_b32 v58, a84
    v_accvgpr_read_b32 v59, a85
    v_accvgpr_read_b32 v60, a86
    v_accvgpr_read_b32 v61, a87
    v_mul_f32 v58, v58, v3
    v_mul_f32 v59, v59, v3
    v_mul_f32 v60, v60, v3
    v_mul_f32 v61, v61, v3
    v_accvgpr_write_b32 a84, v58
    v_accvgpr_write_b32 a85, v59
    v_accvgpr_write_b32 a86, v60
    v_accvgpr_write_b32 a87, v61
    v_accvgpr_read_b32 v58, a96
    v_accvgpr_read_b32 v59, a97
    v_accvgpr_read_b32 v60, a98
    v_accvgpr_read_b32 v61, a99
    v_mul_f32 v58, v58, v3
    v_mul_f32 v59, v59, v3
    v_mul_f32 v60, v60, v3
    v_mul_f32 v61, v61, v3
    v_accvgpr_write_b32 a96, v58
    v_accvgpr_write_b32 a97, v59
    v_accvgpr_write_b32 a98, v60
    v_accvgpr_write_b32 a99, v61
    v_accvgpr_read_b32 v58, a108
    v_accvgpr_read_b32 v59, a109
    v_accvgpr_read_b32 v60, a110
    v_accvgpr_read_b32 v61, a111
    v_mul_f32 v58, v58, v3
    v_mul_f32 v59, v59, v3
    v_mul_f32 v60, v60, v3
    v_mul_f32 v61, v61, v3
    v_accvgpr_write_b32 a108, v58
    v_accvgpr_write_b32 a109, v59
    v_accvgpr_write_b32 a110, v60
    v_accvgpr_write_b32 a111, v61
    v_accvgpr_read_b32 v58, a120
    v_accvgpr_read_b32 v59, a121
    v_accvgpr_read_b32 v60, a122
    v_accvgpr_read_b32 v61, a123
    v_mul_f32 v58, v58, v3
    v_mul_f32 v59, v59, v3
    v_mul_f32 v60, v60, v3
    v_mul_f32 v61, v61, v3
    v_accvgpr_write_b32 a120, v58
    v_accvgpr_write_b32 a121, v59
    v_accvgpr_write_b32 a122, v60
    v_accvgpr_write_b32 a123, v61
    v_accvgpr_read_b32 v58, a132
    v_accvgpr_read_b32 v59, a133
    v_accvgpr_read_b32 v60, a134
    v_accvgpr_read_b32 v61, a135
    v_mul_f32 v58, v58, v3
    v_mul_f32 v59, v59, v3
    v_mul_f32 v60, v60, v3
    v_mul_f32 v61, v61, v3
    v_accvgpr_write_b32 a132, v58
    v_accvgpr_write_b32 a133, v59
    v_accvgpr_write_b32 a134, v60
    v_accvgpr_write_b32 a135, v61
    v_max3_f32 v1, v164, v165, v166
    v_max3_f32 v1, v1, v167, v176
    v_max3_f32 v1, v1, v177, v178
    v_max3_f32 v1, v1, v179, v188
    v_max3_f32 v1, v1, v189, v190
    v_max3_f32 v1, v1, v191, v200
    v_max3_f32 v1, v1, v201, v202
    v_max_f32 v1, v1, v203
    v_mov_b32 v2, v1
    s_nop 1
    v_permlane32_swap_b32 v2, v1
    v_max_f32 v1, v1, v2
    v_mov_b32 v2, v1
    s_nop 1
    v_permlane16_swap_b32 v2, v1
    v_max_f32 v1, v1, v2
    v_max_f32 v1, 0, v1
    v_sub_f32 v3, 0, v1
    v_exp_f32 v3, v3
    s_nop 0
    v_mul_f32 v53, v53, v3
    v_sub_f32 v44, v44, v1
    v_sub_f32 v45, v45, v1
    v_sub_f32 v46, v46, v1
    v_sub_f32 v47, v47, v1
    v_sub_f32 v164, v164, v1
    v_sub_f32 v165, v165, v1
    v_sub_f32 v166, v166, v1
    v_sub_f32 v167, v167, v1
    v_sub_f32 v176, v176, v1
    v_sub_f32 v177, v177, v1
    v_sub_f32 v178, v178, v1
    v_sub_f32 v179, v179, v1
    v_sub_f32 v188, v188, v1
    v_sub_f32 v189, v189, v1
    v_sub_f32 v190, v190, v1
    v_sub_f32 v191, v191, v1
    v_sub_f32 v200, v200, v1
    v_sub_f32 v201, v201, v1
    v_sub_f32 v202, v202, v1
    v_sub_f32 v203, v203, v1
    v_accvgpr_read_b32 v58, a4
    v_accvgpr_read_b32 v59, a5
    v_accvgpr_read_b32 v60, a6
    v_accvgpr_read_b32 v61, a7
    v_mul_f32 v58, v58, v3
    v_mul_f32 v59, v59, v3
    v_mul_f32 v60, v60, v3
    v_mul_f32 v61, v61, v3
    v_accvgpr_write_b32 a4, v58
    v_accvgpr_write_b32 a5, v59
    v_accvgpr_write_b32 a6, v60
    v_accvgpr_write_b32 a7, v61
    v_accvgpr_read_b32 v58, a16
    v_accvgpr_read_b32 v59, a17
    v_accvgpr_read_b32 v60, a18
    v_accvgpr_read_b32 v61, a19
    v_mul_f32 v58, v58, v3
    v_mul_f32 v59, v59, v3
    v_mul_f32 v60, v60, v3
    v_mul_f32 v61, v61, v3
    v_accvgpr_write_b32 a16, v58
    v_accvgpr_write_b32 a17, v59
    v_accvgpr_write_b32 a18, v60
    v_accvgpr_write_b32 a19, v61
    v_accvgpr_read_b32 v58, a28
    v_accvgpr_read_b32 v59, a29
    v_accvgpr_read_b32 v60, a30
    v_accvgpr_read_b32 v61, a31
    v_mul_f32 v58, v58, v3
    v_mul_f32 v59, v59, v3
    v_mul_f32 v60, v60, v3
    v_mul_f32 v61, v61, v3
    v_accvgpr_write_b32 a28, v58
    v_accvgpr_write_b32 a29, v59
    v_accvgpr_write_b32 a30, v60
    v_accvgpr_write_b32 a31, v61
    v_accvgpr_read_b32 v58, a40
    v_accvgpr_read_b32 v59, a41
    v_accvgpr_read_b32 v60, a42
    v_accvgpr_read_b32 v61, a43
    v_mul_f32 v58, v58, v3
    v_mul_f32 v59, v59, v3
    v_mul_f32 v60, v60, v3
    v_mul_f32 v61, v61, v3
    v_accvgpr_write_b32 a40, v58
    v_accvgpr_write_b32 a41, v59
    v_accvgpr_write_b32 a42, v60
    v_accvgpr_write_b32 a43, v61
    v_accvgpr_read_b32 v58, a52
    v_accvgpr_read_b32 v59, a53
    v_accvgpr_read_b32 v60, a54
    v_accvgpr_read_b32 v61, a55
    v_mul_f32 v58, v58, v3
    v_mul_f32 v59, v59, v3
    v_mul_f32 v60, v60, v3
    v_mul_f32 v61, v61, v3
    v_accvgpr_write_b32 a52, v58
    v_accvgpr_write_b32 a53, v59
    v_accvgpr_write_b32 a54, v60
    v_accvgpr_write_b32 a55, v61
    v_accvgpr_read_b32 v58, a64
    v_accvgpr_read_b32 v59, a65
    v_accvgpr_read_b32 v60, a66
    v_accvgpr_read_b32 v61, a67
    v_mul_f32 v58, v58, v3
    v_mul_f32 v59, v59, v3
    v_mul_f32 v60, v60, v3
    v_mul_f32 v61, v61, v3
    v_accvgpr_write_b32 a64, v58
    v_accvgpr_write_b32 a65, v59
    v_accvgpr_write_b32 a66, v60
    v_accvgpr_write_b32 a67, v61
    v_accvgpr_read_b32 v58, a76
    v_accvgpr_read_b32 v59, a77
    v_accvgpr_read_b32 v60, a78
    v_accvgpr_read_b32 v61, a79
    v_mul_f32 v58, v58, v3
    v_mul_f32 v59, v59, v3
    v_mul_f32 v60, v60, v3
    v_mul_f32 v61, v61, v3
    v_accvgpr_write_b32 a76, v58
    v_accvgpr_write_b32 a77, v59
    v_accvgpr_write_b32 a78, v60
    v_accvgpr_write_b32 a79, v61
    v_accvgpr_read_b32 v58, a88
    v_accvgpr_read_b32 v59, a89
    v_accvgpr_read_b32 v60, a90
    v_accvgpr_read_b32 v61, a91
    v_mul_f32 v58, v58, v3
    v_mul_f32 v59, v59, v3
    v_mul_f32 v60, v60, v3
    v_mul_f32 v61, v61, v3
    v_accvgpr_write_b32 a88, v58
    v_accvgpr_write_b32 a89, v59
    v_accvgpr_write_b32 a90, v60
    v_accvgpr_write_b32 a91, v61
    v_accvgpr_read_b32 v58, a100
    v_accvgpr_read_b32 v59, a101
    v_accvgpr_read_b32 v60, a102
    v_accvgpr_read_b32 v61, a103
    v_mul_f32 v58, v58, v3
    v_mul_f32 v59, v59, v3
    v_mul_f32 v60, v60, v3
    v_mul_f32 v61, v61, v3
    v_accvgpr_write_b32 a100, v58
    v_accvgpr_write_b32 a101, v59
    v_accvgpr_write_b32 a102, v60
    v_accvgpr_write_b32 a103, v61
    v_accvgpr_read_b32 v58, a112
    v_accvgpr_read_b32 v59, a113
    v_accvgpr_read_b32 v60, a114
    v_accvgpr_read_b32 v61, a115
    v_mul_f32 v58, v58, v3
    v_mul_f32 v59, v59, v3
    v_mul_f32 v60, v60, v3
    v_mul_f32 v61, v61, v3
    v_accvgpr_write_b32 a112, v58
    v_accvgpr_write_b32 a113, v59
    v_accvgpr_write_b32 a114, v60
    v_accvgpr_write_b32 a115, v61
    v_accvgpr_read_b32 v58, a124
    v_accvgpr_read_b32 v59, a125
    v_accvgpr_read_b32 v60, a126
    v_accvgpr_read_b32 v61, a127
    v_mul_f32 v58, v58, v3
    v_mul_f32 v59, v59, v3
    v_mul_f32 v60, v60, v3
    v_mul_f32 v61, v61, v3
    v_accvgpr_write_b32 a124, v58
    v_accvgpr_write_b32 a125, v59
    v_accvgpr_write_b32 a126, v60
    v_accvgpr_write_b32 a127, v61
    v_accvgpr_read_b32 v58, a136
    v_accvgpr_read_b32 v59, a137
    v_accvgpr_read_b32 v60, a138
    v_accvgpr_read_b32 v61, a139
    v_mul_f32 v58, v58, v3
    v_mul_f32 v59, v59, v3
    v_mul_f32 v60, v60, v3
    v_mul_f32 v61, v61, v3
    v_accvgpr_write_b32 a136, v58
    v_accvgpr_write_b32 a137, v59
    v_accvgpr_write_b32 a138, v60
    v_accvgpr_write_b32 a139, v61
    v_max3_f32 v1, v168, v169, v170
    v_max3_f32 v1, v1, v171, v180
    v_max3_f32 v1, v1, v181, v182
    v_max3_f32 v1, v1, v183, v192
    v_max3_f32 v1, v1, v193, v194
    v_max3_f32 v1, v1, v195, v204
    v_max3_f32 v1, v1, v205, v206
    v_max_f32 v1, v1, v207
    v_mov_b32 v2, v1
    s_nop 1
    v_permlane32_swap_b32 v2, v1
    v_max_f32 v1, v1, v2
    v_mov_b32 v2, v1
    s_nop 1
    v_permlane16_swap_b32 v2, v1
    v_max_f32 v1, v1, v2
    v_max_f32 v1, 0, v1
    v_sub_f32 v3, 0, v1
    v_exp_f32 v3, v3
    s_nop 0
    v_mul_f32 v54, v54, v3
    v_sub_f32 v48, v48, v1
    v_sub_f32 v49, v49, v1
    v_sub_f32 v50, v50, v1
    v_sub_f32 v51, v51, v1
    v_sub_f32 v168, v168, v1
    v_sub_f32 v169, v169, v1
    v_sub_f32 v170, v170, v1
    v_sub_f32 v171, v171, v1
    v_sub_f32 v180, v180, v1
    v_sub_f32 v181, v181, v1
    v_sub_f32 v182, v182, v1
    v_sub_f32 v183, v183, v1
    v_sub_f32 v192, v192, v1
    v_sub_f32 v193, v193, v1
    v_sub_f32 v194, v194, v1
    v_sub_f32 v195, v195, v1
    v_sub_f32 v204, v204, v1
    v_sub_f32 v205, v205, v1
    v_sub_f32 v206, v206, v1
    v_sub_f32 v207, v207, v1
    v_accvgpr_read_b32 v58, a8
    v_accvgpr_read_b32 v59, a9
    v_accvgpr_read_b32 v60, a10
    v_accvgpr_read_b32 v61, a11
    v_mul_f32 v58, v58, v3
    v_mul_f32 v59, v59, v3
    v_mul_f32 v60, v60, v3
    v_mul_f32 v61, v61, v3
    v_accvgpr_write_b32 a8, v58
    v_accvgpr_write_b32 a9, v59
    v_accvgpr_write_b32 a10, v60
    v_accvgpr_write_b32 a11, v61
    v_accvgpr_read_b32 v58, a20
    v_accvgpr_read_b32 v59, a21
    v_accvgpr_read_b32 v60, a22
    v_accvgpr_read_b32 v61, a23
    v_mul_f32 v58, v58, v3
    v_mul_f32 v59, v59, v3
    v_mul_f32 v60, v60, v3
    v_mul_f32 v61, v61, v3
    v_accvgpr_write_b32 a20, v58
    v_accvgpr_write_b32 a21, v59
    v_accvgpr_write_b32 a22, v60
    v_accvgpr_write_b32 a23, v61
    v_accvgpr_read_b32 v58, a32
    v_accvgpr_read_b32 v59, a33
    v_accvgpr_read_b32 v60, a34
    v_accvgpr_read_b32 v61, a35
    v_mul_f32 v58, v58, v3
    v_mul_f32 v59, v59, v3
    v_mul_f32 v60, v60, v3
    v_mul_f32 v61, v61, v3
    v_accvgpr_write_b32 a32, v58
    v_accvgpr_write_b32 a33, v59
    v_accvgpr_write_b32 a34, v60
    v_accvgpr_write_b32 a35, v61
    v_accvgpr_read_b32 v58, a44
    v_accvgpr_read_b32 v59, a45
    v_accvgpr_read_b32 v60, a46
    v_accvgpr_read_b32 v61, a47
    v_mul_f32 v58, v58, v3
    v_mul_f32 v59, v59, v3
    v_mul_f32 v60, v60, v3
    v_mul_f32 v61, v61, v3
    v_accvgpr_write_b32 a44, v58
    v_accvgpr_write_b32 a45, v59
    v_accvgpr_write_b32 a46, v60
    v_accvgpr_write_b32 a47, v61
    v_accvgpr_read_b32 v58, a56
    v_accvgpr_read_b32 v59, a57
    v_accvgpr_read_b32 v60, a58
    v_accvgpr_read_b32 v61, a59
    v_mul_f32 v58, v58, v3
    v_mul_f32 v59, v59, v3
    v_mul_f32 v60, v60, v3
    v_mul_f32 v61, v61, v3
    v_accvgpr_write_b32 a56, v58
    v_accvgpr_write_b32 a57, v59
    v_accvgpr_write_b32 a58, v60
    v_accvgpr_write_b32 a59, v61
    v_accvgpr_read_b32 v58, a68
    v_accvgpr_read_b32 v59, a69
    v_accvgpr_read_b32 v60, a70
    v_accvgpr_read_b32 v61, a71
    v_mul_f32 v58, v58, v3
    v_mul_f32 v59, v59, v3
    v_mul_f32 v60, v60, v3
    v_mul_f32 v61, v61, v3
    v_accvgpr_write_b32 a68, v58
    v_accvgpr_write_b32 a69, v59
    v_accvgpr_write_b32 a70, v60
    v_accvgpr_write_b32 a71, v61
    v_accvgpr_read_b32 v58, a80
    v_accvgpr_read_b32 v59, a81
    v_accvgpr_read_b32 v60, a82
    v_accvgpr_read_b32 v61, a83
    v_mul_f32 v58, v58, v3
    v_mul_f32 v59, v59, v3
    v_mul_f32 v60, v60, v3
    v_mul_f32 v61, v61, v3
    v_accvgpr_write_b32 a80, v58
    v_accvgpr_write_b32 a81, v59
    v_accvgpr_write_b32 a82, v60
    v_accvgpr_write_b32 a83, v61
    v_accvgpr_read_b32 v58, a92
    v_accvgpr_read_b32 v59, a93
    v_accvgpr_read_b32 v60, a94
    v_accvgpr_read_b32 v61, a95
    v_mul_f32 v58, v58, v3
    v_mul_f32 v59, v59, v3
    v_mul_f32 v60, v60, v3
    v_mul_f32 v61, v61, v3
    v_accvgpr_write_b32 a92, v58
    v_accvgpr_write_b32 a93, v59
    v_accvgpr_write_b32 a94, v60
    v_accvgpr_write_b32 a95, v61
    v_accvgpr_read_b32 v58, a104
    v_accvgpr_read_b32 v59, a105
    v_accvgpr_read_b32 v60, a106
    v_accvgpr_read_b32 v61, a107
    v_mul_f32 v58, v58, v3
    v_mul_f32 v59, v59, v3
    v_mul_f32 v60, v60, v3
    v_mul_f32 v61, v61, v3
    v_accvgpr_write_b32 a104, v58
    v_accvgpr_write_b32 a105, v59
    v_accvgpr_write_b32 a106, v60
    v_accvgpr_write_b32 a107, v61
    v_accvgpr_read_b32 v58, a116
    v_accvgpr_read_b32 v59, a117
    v_accvgpr_read_b32 v60, a118
    v_accvgpr_read_b32 v61, a119
    v_mul_f32 v58, v58, v3
    v_mul_f32 v59, v59, v3
    v_mul_f32 v60, v60, v3
    v_mul_f32 v61, v61, v3
    v_accvgpr_write_b32 a116, v58
    v_accvgpr_write_b32 a117, v59
    v_accvgpr_write_b32 a118, v60
    v_accvgpr_write_b32 a119, v61
    v_accvgpr_read_b32 v58, a128
    v_accvgpr_read_b32 v59, a129
    v_accvgpr_read_b32 v60, a130
    v_accvgpr_read_b32 v61, a131
    v_mul_f32 v58, v58, v3
    v_mul_f32 v59, v59, v3
    v_mul_f32 v60, v60, v3
    v_mul_f32 v61, v61, v3
    v_accvgpr_write_b32 a128, v58
    v_accvgpr_write_b32 a129, v59
    v_accvgpr_write_b32 a130, v60
    v_accvgpr_write_b32 a131, v61
    v_accvgpr_read_b32 v58, a140
    v_accvgpr_read_b32 v59, a141
    v_accvgpr_read_b32 v60, a142
    v_accvgpr_read_b32 v61, a143
    v_mul_f32 v58, v58, v3
    v_mul_f32 v59, v59, v3
    v_mul_f32 v60, v60, v3
    v_mul_f32 v61, v61, v3
    v_accvgpr_write_b32 a140, v58
    v_accvgpr_write_b32 a141, v59
    v_accvgpr_write_b32 a142, v60
    v_accvgpr_write_b32 a143, v61
    v_exp_f32 v58, v160
    v_exp_f32 v59, v161
    v_exp_f32 v60, v162
    v_exp_f32 v61, v163
    v_add_f32 v55, v58, v59
    v_cvt_pk_bf16_f32 v208, v58, v59
    v_add_f32 v55, v55, v60
    v_add_f32 v55, v55, v61
    v_cvt_pk_bf16_f32 v209, v60, v61
    v_exp_f32 v62, v164
    v_exp_f32 v63, v165
    v_exp_f32 v38, v166
    v_exp_f32 v39, v167
    v_add_f32 v56, v62, v63
    v_cvt_pk_bf16_f32 v212, v62, v63
    v_add_f32 v56, v56, v38
    v_add_f32 v56, v56, v39
    v_cvt_pk_bf16_f32 v213, v38, v39
    v_exp_f32 v58, v168
    v_exp_f32 v59, v169
    v_exp_f32 v60, v170
    v_exp_f32 v61, v171
    v_add_f32 v57, v58, v59
    v_cvt_pk_bf16_f32 v216, v58, v59
    v_add_f32 v57, v57, v60
    v_add_f32 v57, v57, v61
    v_cvt_pk_bf16_f32 v217, v60, v61
    v_exp_f32 v62, v172
    v_exp_f32 v63, v173
    v_exp_f32 v38, v174
    v_exp_f32 v39, v175
    v_add_f32 v55, v55, v62
    v_add_f32 v55, v55, v63
    v_cvt_pk_bf16_f32 v210, v62, v63
    v_add_f32 v55, v55, v38
    v_add_f32 v55, v55, v39
    v_cvt_pk_bf16_f32 v211, v38, v39
    v_exp_f32 v58, v176
    v_exp_f32 v59, v177
    v_exp_f32 v60, v178
    v_exp_f32 v61, v179
    v_add_f32 v56, v56, v58
    v_add_f32 v56, v56, v59
    v_cvt_pk_bf16_f32 v214, v58, v59
    v_add_f32 v56, v56, v60
    v_add_f32 v56, v56, v61
    v_cvt_pk_bf16_f32 v215, v60, v61
    v_exp_f32 v62, v180
    v_exp_f32 v63, v181
    v_exp_f32 v38, v182
    v_exp_f32 v39, v183
    v_add_f32 v57, v57, v62
    v_add_f32 v57, v57, v63
    v_cvt_pk_bf16_f32 v218, v62, v63
    v_add_f32 v57, v57, v38
    v_add_f32 v57, v57, v39
    v_cvt_pk_bf16_f32 v219, v38, v39
    v_exp_f32 v58, v184
    v_exp_f32 v59, v185
    v_exp_f32 v60, v186
    v_exp_f32 v61, v187
    v_add_f32 v55, v55, v58
    v_add_f32 v55, v55, v59
    v_cvt_pk_bf16_f32 v220, v58, v59
    v_add_f32 v55, v55, v60
    v_add_f32 v55, v55, v61
    v_cvt_pk_bf16_f32 v221, v60, v61
    v_exp_f32 v62, v188
    v_exp_f32 v63, v189
    v_exp_f32 v38, v190
    v_exp_f32 v39, v191
    v_add_f32 v56, v56, v62
    v_add_f32 v56, v56, v63
    v_cvt_pk_bf16_f32 v224, v62, v63
    v_add_f32 v56, v56, v38
    v_add_f32 v56, v56, v39
    v_cvt_pk_bf16_f32 v225, v38, v39
    v_exp_f32 v58, v192
    v_exp_f32 v59, v193
    v_exp_f32 v60, v194
    v_exp_f32 v61, v195
    v_add_f32 v57, v57, v58
    v_add_f32 v57, v57, v59
    v_cvt_pk_bf16_f32 v228, v58, v59
    v_add_f32 v57, v57, v60
    v_add_f32 v57, v57, v61
    v_cvt_pk_bf16_f32 v229, v60, v61
    v_exp_f32 v62, v196
    v_exp_f32 v63, v197
    v_exp_f32 v38, v198
    v_exp_f32 v39, v199
    v_add_f32 v55, v55, v62
    v_add_f32 v55, v55, v63
    v_cvt_pk_bf16_f32 v222, v62, v63
    v_add_f32 v55, v55, v38
    v_add_f32 v55, v55, v39
    v_cvt_pk_bf16_f32 v223, v38, v39
    v_exp_f32 v58, v200
    v_exp_f32 v59, v201
    v_exp_f32 v60, v202
    v_exp_f32 v61, v203
    v_add_f32 v56, v56, v58
    v_add_f32 v56, v56, v59
    v_cvt_pk_bf16_f32 v226, v58, v59
    v_add_f32 v56, v56, v60
    v_add_f32 v56, v56, v61
    v_cvt_pk_bf16_f32 v227, v60, v61
    v_exp_f32 v62, v204
    v_exp_f32 v63, v205
    v_exp_f32 v38, v206
    v_exp_f32 v39, v207
    v_add_f32 v57, v57, v62
    v_add_f32 v57, v57, v63
    v_cvt_pk_bf16_f32 v230, v62, v63
    v_add_f32 v57, v57, v38
    v_add_f32 v57, v57, v39
    v_cvt_pk_bf16_f32 v231, v38, v39
    s_nop 7
    s_setpc_b64 s[30:31]
L_slow_1:
    s_nop 15
    v_max3_f32 v1, v160, v161, v162
    v_max3_f32 v1, v1, v163, v172
    v_max3_f32 v1, v1, v173, v174
    v_max3_f32 v1, v1, v175, v184
    v_max3_f32 v1, v1, v185, v186
    v_max3_f32 v1, v1, v187, v196
    v_max3_f32 v1, v1, v197, v198
    v_max_f32 v1, v1, v199
    v_mov_b32 v2, v1
    s_nop 1
    v_permlane32_swap_b32 v2, v1
    v_max_f32 v1, v1, v2
    v_mov_b32 v2, v1
    s_nop 1
    v_permlane16_swap_b32 v2, v1
    v_max_f32 v1, v1, v2
    v_max_f32 v1, 0, v1
    v_sub_f32 v3, 0, v1
    v_exp_f32 v3, v3
    s_nop 0
    v_mul_f32 v52, v52, v3
    v_sub_f32 v40, v40, v1
    v_sub_f32 v41, v41, v1
    v_sub_f32 v42, v42, v1
    v_sub_f32 v43, v43, v1
    v_sub_f32 v160, v160, v1
    v_sub_f32 v161, v161, v1
    v_sub_f32 v162, v162, v1
    v_sub_f32 v163, v163, v1
    v_sub_f32 v172, v172, v1
    v_sub_f32 v173, v173, v1
    v_sub_f32 v174, v174, v1
    v_sub_f32 v175, v175, v1
    v_sub_f32 v184, v184, v1
    v_sub_f32 v185, v185, v1
    v_sub_f32 v186, v186, v1
    v_sub_f32 v187, v187, v1
    v_sub_f32 v196, v196, v1
    v_sub_f32 v197, v197, v1
    v_sub_f32 v198, v198, v1
    v_sub_f32 v199, v199, v1
    v_accvgpr_read_b32 v58, a0
    v_accvgpr_read_b32 v59, a1
    v_accvgpr_read_b32 v60, a2
    v_accvgpr_read_b32 v61, a3
    v_mul_f32 v58, v58, v3
    v_mul_f32 v59, v59, v3
    v_mul_f32 v60, v60, v3
    v_mul_f32 v61, v61, v3
    v_accvgpr_write_b32 a0, v58
    v_accvgpr_write_b32 a1, v59
    v_accvgpr_write_b32 a2, v60
    v_accvgpr_write_b32 a3, v61
    v_accvgpr_read_b32 v58, a12
    v_accvgpr_read_b32 v59, a13
    v_accvgpr_read_b32 v60, a14
    v_accvgpr_read_b32 v61, a15
    v_mul_f32 v58, v58, v3
    v_mul_f32 v59, v59, v3
    v_mul_f32 v60, v60, v3
    v_mul_f32 v61, v61, v3
    v_accvgpr_write_b32 a12, v58
    v_accvgpr_write_b32 a13, v59
    v_accvgpr_write_b32 a14, v60
    v_accvgpr_write_b32 a15, v61
    v_accvgpr_read_b32 v58, a24
    v_accvgpr_read_b32 v59, a25
    v_accvgpr_read_b32 v60, a26
    v_accvgpr_read_b32 v61, a27
    v_mul_f32 v58, v58, v3
    v_mul_f32 v59, v59, v3
    v_mul_f32 v60, v60, v3
    v_mul_f32 v61, v61, v3
    v_accvgpr_write_b32 a24, v58
    v_accvgpr_write_b32 a25, v59
    v_accvgpr_write_b32 a26, v60
    v_accvgpr_write_b32 a27, v61
    v_accvgpr_read_b32 v58, a36
    v_accvgpr_read_b32 v59, a37
    v_accvgpr_read_b32 v60, a38
    v_accvgpr_read_b32 v61, a39
    v_mul_f32 v58, v58, v3
    v_mul_f32 v59, v59, v3
    v_mul_f32 v60, v60, v3
    v_mul_f32 v61, v61, v3
    v_accvgpr_write_b32 a36, v58
    v_accvgpr_write_b32 a37, v59
    v_accvgpr_write_b32 a38, v60
    v_accvgpr_write_b32 a39, v61
    v_accvgpr_read_b32 v58, a48
    v_accvgpr_read_b32 v59, a49
    v_accvgpr_read_b32 v60, a50
    v_accvgpr_read_b32 v61, a51
    v_mul_f32 v58, v58, v3
    v_mul_f32 v59, v59, v3
    v_mul_f32 v60, v60, v3
    v_mul_f32 v61, v61, v3
    v_accvgpr_write_b32 a48, v58
    v_accvgpr_write_b32 a49, v59
    v_accvgpr_write_b32 a50, v60
    v_accvgpr_write_b32 a51, v61
    v_accvgpr_read_b32 v58, a60
    v_accvgpr_read_b32 v59, a61
    v_accvgpr_read_b32 v60, a62
    v_accvgpr_read_b32 v61, a63
    v_mul_f32 v58, v58, v3
    v_mul_f32 v59, v59, v3
    v_mul_f32 v60, v60, v3
    v_mul_f32 v61, v61, v3
    v_accvgpr_write_b32 a60, v58
    v_accvgpr_write_b32 a61, v59
    v_accvgpr_write_b32 a62, v60
    v_accvgpr_write_b32 a63, v61
    v_accvgpr_read_b32 v58, a72
    v_accvgpr_read_b32 v59, a73
    v_accvgpr_read_b32 v60, a74
    v_accvgpr_read_b32 v61, a75
    v_mul_f32 v58, v58, v3
    v_mul_f32 v59, v59, v3
    v_mul_f32 v60, v60, v3
    v_mul_f32 v61, v61, v3
    v_accvgpr_write_b32 a72, v58
    v_accvgpr_write_b32 a73, v59
    v_accvgpr_write_b32 a74, v60
    v_accvgpr_write_b32 a75, v61
    v_accvgpr_read_b32 v58, a84
    v_accvgpr_read_b32 v59, a85
    v_accvgpr_read_b32 v60, a86
    v_accvgpr_read_b32 v61, a87
    v_mul_f32 v58, v58, v3
    v_mul_f32 v59, v59, v3
    v_mul_f32 v60, v60, v3
    v_mul_f32 v61, v61, v3
    v_accvgpr_write_b32 a84, v58
    v_accvgpr_write_b32 a85, v59
    v_accvgpr_write_b32 a86, v60
    v_accvgpr_write_b32 a87, v61
    v_accvgpr_read_b32 v58, a96
    v_accvgpr_read_b32 v59, a97
    v_accvgpr_read_b32 v60, a98
    v_accvgpr_read_b32 v61, a99
    v_mul_f32 v58, v58, v3
    v_mul_f32 v59, v59, v3
    v_mul_f32 v60, v60, v3
    v_mul_f32 v61, v61, v3
    v_accvgpr_write_b32 a96, v58
    v_accvgpr_write_b32 a97, v59
    v_accvgpr_write_b32 a98, v60
    v_accvgpr_write_b32 a99, v61
    v_accvgpr_read_b32 v58, a108
    v_accvgpr_read_b32 v59, a109
    v_accvgpr_read_b32 v60, a110
    v_accvgpr_read_b32 v61, a111
    v_mul_f32 v58, v58, v3
    v_mul_f32 v59, v59, v3
    v_mul_f32 v60, v60, v3
    v_mul_f32 v61, v61, v3
    v_accvgpr_write_b32 a108, v58
    v_accvgpr_write_b32 a109, v59
    v_accvgpr_write_b32 a110, v60
    v_accvgpr_write_b32 a111, v61
    v_accvgpr_read_b32 v58, a120
    v_accvgpr_read_b32 v59, a121
    v_accvgpr_read_b32 v60, a122
    v_accvgpr_read_b32 v61, a123
    v_mul_f32 v58, v58, v3
    v_mul_f32 v59, v59, v3
    v_mul_f32 v60, v60, v3
    v_mul_f32 v61, v61, v3
    v_accvgpr_write_b32 a120, v58
    v_accvgpr_write_b32 a121, v59
    v_accvgpr_write_b32 a122, v60
    v_accvgpr_write_b32 a123, v61
    v_accvgpr_read_b32 v58, a132
    v_accvgpr_read_b32 v59, a133
    v_accvgpr_read_b32 v60, a134
    v_accvgpr_read_b32 v61, a135
    v_mul_f32 v58, v58, v3
    v_mul_f32 v59, v59, v3
    v_mul_f32 v60, v60, v3
    v_mul_f32 v61, v61, v3
    v_accvgpr_write_b32 a132, v58
    v_accvgpr_write_b32 a133, v59
    v_accvgpr_write_b32 a134, v60
    v_accvgpr_write_b32 a135, v61
    v_max3_f32 v1, v164, v165, v166
    v_max3_f32 v1, v1, v167, v176
    v_max3_f32 v1, v1, v177, v178
    v_max3_f32 v1, v1, v179, v188
    v_max3_f32 v1, v1, v189, v190
    v_max3_f32 v1, v1, v191, v200
    v_max3_f32 v1, v1, v201, v202
    v_max_f32 v1, v1, v203
    v_mov_b32 v2, v1
    s_nop 1
    v_permlane32_swap_b32 v2, v1
    v_max_f32 v1, v1, v2
    v_mov_b32 v2, v1
    s_nop 1
    v_permlane16_swap_b32 v2, v1
    v_max_f32 v1, v1, v2
    v_max_f32 v1, 0, v1
    v_sub_f32 v3, 0, v1
    v_exp_f32 v3, v3
    s_nop 0
    v_mul_f32 v53, v53, v3
    v_sub_f32 v44, v44, v1
    v_sub_f32 v45, v45, v1
    v_sub_f32 v46, v46, v1
    v_sub_f32 v47, v47, v1
    v_sub_f32 v164, v164, v1
    v_sub_f32 v165, v165, v1
    v_sub_f32 v166, v166, v1
    v_sub_f32 v167, v167, v1
    v_sub_f32 v176, v176, v1
    v_sub_f32 v177, v177, v1
    v_sub_f32 v178, v178, v1
    v_sub_f32 v179, v179, v1
    v_sub_f32 v188, v188, v1
    v_sub_f32 v189, v189, v1
    v_sub_f32 v190, v190, v1
    v_sub_f32 v191, v191, v1
    v_sub_f32 v200, v200, v1
    v_sub_f32 v201, v201, v1
    v_sub_f32 v202, v202, v1
    v_sub_f32 v203, v203, v1
    v_accvgpr_read_b32 v58, a4
    v_accvgpr_read_b32 v59, a5
    v_accvgpr_read_b32 v60, a6
    v_accvgpr_read_b32 v61, a7
    v_mul_f32 v58, v58, v3
    v_mul_f32 v59, v59, v3
    v_mul_f32 v60, v60, v3
    v_mul_f32 v61, v61, v3
    v_accvgpr_write_b32 a4, v58
    v_accvgpr_write_b32 a5, v59
    v_accvgpr_write_b32 a6, v60
    v_accvgpr_write_b32 a7, v61
    v_accvgpr_read_b32 v58, a16
    v_accvgpr_read_b32 v59, a17
    v_accvgpr_read_b32 v60, a18
    v_accvgpr_read_b32 v61, a19
    v_mul_f32 v58, v58, v3
    v_mul_f32 v59, v59, v3
    v_mul_f32 v60, v60, v3
    v_mul_f32 v61, v61, v3
    v_accvgpr_write_b32 a16, v58
    v_accvgpr_write_b32 a17, v59
    v_accvgpr_write_b32 a18, v60
    v_accvgpr_write_b32 a19, v61
    v_accvgpr_read_b32 v58, a28
    v_accvgpr_read_b32 v59, a29
    v_accvgpr_read_b32 v60, a30
    v_accvgpr_read_b32 v61, a31
    v_mul_f32 v58, v58, v3
    v_mul_f32 v59, v59, v3
    v_mul_f32 v60, v60, v3
    v_mul_f32 v61, v61, v3
    v_accvgpr_write_b32 a28, v58
    v_accvgpr_write_b32 a29, v59
    v_accvgpr_write_b32 a30, v60
    v_accvgpr_write_b32 a31, v61
    v_accvgpr_read_b32 v58, a40
    v_accvgpr_read_b32 v59, a41
    v_accvgpr_read_b32 v60, a42
    v_accvgpr_read_b32 v61, a43
    v_mul_f32 v58, v58, v3
    v_mul_f32 v59, v59, v3
    v_mul_f32 v60, v60, v3
    v_mul_f32 v61, v61, v3
    v_accvgpr_write_b32 a40, v58
    v_accvgpr_write_b32 a41, v59
    v_accvgpr_write_b32 a42, v60
    v_accvgpr_write_b32 a43, v61
    v_accvgpr_read_b32 v58, a52
    v_accvgpr_read_b32 v59, a53
    v_accvgpr_read_b32 v60, a54
    v_accvgpr_read_b32 v61, a55
    v_mul_f32 v58, v58, v3
    v_mul_f32 v59, v59, v3
    v_mul_f32 v60, v60, v3
    v_mul_f32 v61, v61, v3
    v_accvgpr_write_b32 a52, v58
    v_accvgpr_write_b32 a53, v59
    v_accvgpr_write_b32 a54, v60
    v_accvgpr_write_b32 a55, v61
    v_accvgpr_read_b32 v58, a64
    v_accvgpr_read_b32 v59, a65
    v_accvgpr_read_b32 v60, a66
    v_accvgpr_read_b32 v61, a67
    v_mul_f32 v58, v58, v3
    v_mul_f32 v59, v59, v3
    v_mul_f32 v60, v60, v3
    v_mul_f32 v61, v61, v3
    v_accvgpr_write_b32 a64, v58
    v_accvgpr_write_b32 a65, v59
    v_accvgpr_write_b32 a66, v60
    v_accvgpr_write_b32 a67, v61
    v_accvgpr_read_b32 v58, a76
    v_accvgpr_read_b32 v59, a77
    v_accvgpr_read_b32 v60, a78
    v_accvgpr_read_b32 v61, a79
    v_mul_f32 v58, v58, v3
    v_mul_f32 v59, v59, v3
    v_mul_f32 v60, v60, v3
    v_mul_f32 v61, v61, v3
    v_accvgpr_write_b32 a76, v58
    v_accvgpr_write_b32 a77, v59
    v_accvgpr_write_b32 a78, v60
    v_accvgpr_write_b32 a79, v61
    v_accvgpr_read_b32 v58, a88
    v_accvgpr_read_b32 v59, a89
    v_accvgpr_read_b32 v60, a90
    v_accvgpr_read_b32 v61, a91
    v_mul_f32 v58, v58, v3
    v_mul_f32 v59, v59, v3
    v_mul_f32 v60, v60, v3
    v_mul_f32 v61, v61, v3
    v_accvgpr_write_b32 a88, v58
    v_accvgpr_write_b32 a89, v59
    v_accvgpr_write_b32 a90, v60
    v_accvgpr_write_b32 a91, v61
    v_accvgpr_read_b32 v58, a100
    v_accvgpr_read_b32 v59, a101
    v_accvgpr_read_b32 v60, a102
    v_accvgpr_read_b32 v61, a103
    v_mul_f32 v58, v58, v3
    v_mul_f32 v59, v59, v3
    v_mul_f32 v60, v60, v3
    v_mul_f32 v61, v61, v3
    v_accvgpr_write_b32 a100, v58
    v_accvgpr_write_b32 a101, v59
    v_accvgpr_write_b32 a102, v60
    v_accvgpr_write_b32 a103, v61
    v_accvgpr_read_b32 v58, a112
    v_accvgpr_read_b32 v59, a113
    v_accvgpr_read_b32 v60, a114
    v_accvgpr_read_b32 v61, a115
    v_mul_f32 v58, v58, v3
    v_mul_f32 v59, v59, v3
    v_mul_f32 v60, v60, v3
    v_mul_f32 v61, v61, v3
    v_accvgpr_write_b32 a112, v58
    v_accvgpr_write_b32 a113, v59
    v_accvgpr_write_b32 a114, v60
    v_accvgpr_write_b32 a115, v61
    v_accvgpr_read_b32 v58, a124
    v_accvgpr_read_b32 v59, a125
    v_accvgpr_read_b32 v60, a126
    v_accvgpr_read_b32 v61, a127
    v_mul_f32 v58, v58, v3
    v_mul_f32 v59, v59, v3
    v_mul_f32 v60, v60, v3
    v_mul_f32 v61, v61, v3
    v_accvgpr_write_b32 a124, v58
    v_accvgpr_write_b32 a125, v59
    v_accvgpr_write_b32 a126, v60
    v_accvgpr_write_b32 a127, v61
    v_accvgpr_read_b32 v58, a136
    v_accvgpr_read_b32 v59, a137
    v_accvgpr_read_b32 v60, a138
    v_accvgpr_read_b32 v61, a139
    v_mul_f32 v58, v58, v3
    v_mul_f32 v59, v59, v3
    v_mul_f32 v60, v60, v3
    v_mul_f32 v61, v61, v3
    v_accvgpr_write_b32 a136, v58
    v_accvgpr_write_b32 a137, v59
    v_accvgpr_write_b32 a138, v60
    v_accvgpr_write_b32 a139, v61
    v_max3_f32 v1, v168, v169, v170
    v_max3_f32 v1, v1, v171, v180
    v_max3_f32 v1, v1, v181, v182
    v_max3_f32 v1, v1, v183, v192
    v_max3_f32 v1, v1, v193, v194
    v_max3_f32 v1, v1, v195, v204
    v_max3_f32 v1, v1, v205, v206
    v_max_f32 v1, v1, v207
    v_mov_b32 v2, v1
    s_nop 1
    v_permlane32_swap_b32 v2, v1
    v_max_f32 v1, v1, v2
    v_mov_b32 v2, v1
    s_nop 1
    v_permlane16_swap_b32 v2, v1
    v_max_f32 v1, v1, v2
    v_max_f32 v1, 0, v1
    v_sub_f32 v3, 0, v1
    v_exp_f32 v3, v3
    s_nop 0
    v_mul_f32 v54, v54, v3
    v_sub_f32 v48, v48, v1
    v_sub_f32 v49, v49, v1
    v_sub_f32 v50, v50, v1
    v_sub_f32 v51, v51, v1
    v_sub_f32 v168, v168, v1
    v_sub_f32 v169, v169, v1
    v_sub_f32 v170, v170, v1
    v_sub_f32 v171, v171, v1
    v_sub_f32 v180, v180, v1
    v_sub_f32 v181, v181, v1
    v_sub_f32 v182, v182, v1
    v_sub_f32 v183, v183, v1
    v_sub_f32 v192, v192, v1
    v_sub_f32 v193, v193, v1
    v_sub_f32 v194, v194, v1
    v_sub_f32 v195, v195, v1
    v_sub_f32 v204, v204, v1
    v_sub_f32 v205, v205, v1
    v_sub_f32 v206, v206, v1
    v_sub_f32 v207, v207, v1
    v_accvgpr_read_b32 v58, a8
    v_accvgpr_read_b32 v59, a9
    v_accvgpr_read_b32 v60, a10
    v_accvgpr_read_b32 v61, a11
    v_mul_f32 v58, v58, v3
    v_mul_f32 v59, v59, v3
    v_mul_f32 v60, v60, v3
    v_mul_f32 v61, v61, v3
    v_accvgpr_write_b32 a8, v58
    v_accvgpr_write_b32 a9, v59
    v_accvgpr_write_b32 a10, v60
    v_accvgpr_write_b32 a11, v61
    v_accvgpr_read_b32 v58, a20
    v_accvgpr_read_b32 v59, a21
    v_accvgpr_read_b32 v60, a22
    v_accvgpr_read_b32 v61, a23
    v_mul_f32 v58, v58, v3
    v_mul_f32 v59, v59, v3
    v_mul_f32 v60, v60, v3
    v_mul_f32 v61, v61, v3
    v_accvgpr_write_b32 a20, v58
    v_accvgpr_write_b32 a21, v59
    v_accvgpr_write_b32 a22, v60
    v_accvgpr_write_b32 a23, v61
    v_accvgpr_read_b32 v58, a32
    v_accvgpr_read_b32 v59, a33
    v_accvgpr_read_b32 v60, a34
    v_accvgpr_read_b32 v61, a35
    v_mul_f32 v58, v58, v3
    v_mul_f32 v59, v59, v3
    v_mul_f32 v60, v60, v3
    v_mul_f32 v61, v61, v3
    v_accvgpr_write_b32 a32, v58
    v_accvgpr_write_b32 a33, v59
    v_accvgpr_write_b32 a34, v60
    v_accvgpr_write_b32 a35, v61
    v_accvgpr_read_b32 v58, a44
    v_accvgpr_read_b32 v59, a45
    v_accvgpr_read_b32 v60, a46
    v_accvgpr_read_b32 v61, a47
    v_mul_f32 v58, v58, v3
    v_mul_f32 v59, v59, v3
    v_mul_f32 v60, v60, v3
    v_mul_f32 v61, v61, v3
    v_accvgpr_write_b32 a44, v58
    v_accvgpr_write_b32 a45, v59
    v_accvgpr_write_b32 a46, v60
    v_accvgpr_write_b32 a47, v61
    v_accvgpr_read_b32 v58, a56
    v_accvgpr_read_b32 v59, a57
    v_accvgpr_read_b32 v60, a58
    v_accvgpr_read_b32 v61, a59
    v_mul_f32 v58, v58, v3
    v_mul_f32 v59, v59, v3
    v_mul_f32 v60, v60, v3
    v_mul_f32 v61, v61, v3
    v_accvgpr_write_b32 a56, v58
    v_accvgpr_write_b32 a57, v59
    v_accvgpr_write_b32 a58, v60
    v_accvgpr_write_b32 a59, v61
    v_accvgpr_read_b32 v58, a68
    v_accvgpr_read_b32 v59, a69
    v_accvgpr_read_b32 v60, a70
    v_accvgpr_read_b32 v61, a71
    v_mul_f32 v58, v58, v3
    v_mul_f32 v59, v59, v3
    v_mul_f32 v60, v60, v3
    v_mul_f32 v61, v61, v3
    v_accvgpr_write_b32 a68, v58
    v_accvgpr_write_b32 a69, v59
    v_accvgpr_write_b32 a70, v60
    v_accvgpr_write_b32 a71, v61
    v_accvgpr_read_b32 v58, a80
    v_accvgpr_read_b32 v59, a81
    v_accvgpr_read_b32 v60, a82
    v_accvgpr_read_b32 v61, a83
    v_mul_f32 v58, v58, v3
    v_mul_f32 v59, v59, v3
    v_mul_f32 v60, v60, v3
    v_mul_f32 v61, v61, v3
    v_accvgpr_write_b32 a80, v58
    v_accvgpr_write_b32 a81, v59
    v_accvgpr_write_b32 a82, v60
    v_accvgpr_write_b32 a83, v61
    v_accvgpr_read_b32 v58, a92
    v_accvgpr_read_b32 v59, a93
    v_accvgpr_read_b32 v60, a94
    v_accvgpr_read_b32 v61, a95
    v_mul_f32 v58, v58, v3
    v_mul_f32 v59, v59, v3
    v_mul_f32 v60, v60, v3
    v_mul_f32 v61, v61, v3
    v_accvgpr_write_b32 a92, v58
    v_accvgpr_write_b32 a93, v59
    v_accvgpr_write_b32 a94, v60
    v_accvgpr_write_b32 a95, v61
    v_accvgpr_read_b32 v58, a104
    v_accvgpr_read_b32 v59, a105
    v_accvgpr_read_b32 v60, a106
    v_accvgpr_read_b32 v61, a107
    v_mul_f32 v58, v58, v3
    v_mul_f32 v59, v59, v3
    v_mul_f32 v60, v60, v3
    v_mul_f32 v61, v61, v3
    v_accvgpr_write_b32 a104, v58
    v_accvgpr_write_b32 a105, v59
    v_accvgpr_write_b32 a106, v60
    v_accvgpr_write_b32 a107, v61
    v_accvgpr_read_b32 v58, a116
    v_accvgpr_read_b32 v59, a117
    v_accvgpr_read_b32 v60, a118
    v_accvgpr_read_b32 v61, a119
    v_mul_f32 v58, v58, v3
    v_mul_f32 v59, v59, v3
    v_mul_f32 v60, v60, v3
    v_mul_f32 v61, v61, v3
    v_accvgpr_write_b32 a116, v58
    v_accvgpr_write_b32 a117, v59
    v_accvgpr_write_b32 a118, v60
    v_accvgpr_write_b32 a119, v61
    v_accvgpr_read_b32 v58, a128
    v_accvgpr_read_b32 v59, a129
    v_accvgpr_read_b32 v60, a130
    v_accvgpr_read_b32 v61, a131
    v_mul_f32 v58, v58, v3
    v_mul_f32 v59, v59, v3
    v_mul_f32 v60, v60, v3
    v_mul_f32 v61, v61, v3
    v_accvgpr_write_b32 a128, v58
    v_accvgpr_write_b32 a129, v59
    v_accvgpr_write_b32 a130, v60
    v_accvgpr_write_b32 a131, v61
    v_accvgpr_read_b32 v58, a140
    v_accvgpr_read_b32 v59, a141
    v_accvgpr_read_b32 v60, a142
    v_accvgpr_read_b32 v61, a143
    v_mul_f32 v58, v58, v3
    v_mul_f32 v59, v59, v3
    v_mul_f32 v60, v60, v3
    v_mul_f32 v61, v61, v3
    v_accvgpr_write_b32 a140, v58
    v_accvgpr_write_b32 a141, v59
    v_accvgpr_write_b32 a142, v60
    v_accvgpr_write_b32 a143, v61
    v_exp_f32 v58, v160
    v_exp_f32 v59, v161
    v_exp_f32 v60, v162
    v_exp_f32 v61, v163
    v_add_f32 v55, v58, v59
    v_cvt_pk_bf16_f32 v64, v58, v59
    v_add_f32 v55, v55, v60
    v_add_f32 v55, v55, v61
    v_cvt_pk_bf16_f32 v65, v60, v61
    v_exp_f32 v62, v164
    v_exp_f32 v63, v165
    v_exp_f32 v38, v166
    v_exp_f32 v39, v167
    v_add_f32 v56, v62, v63
    v_cvt_pk_bf16_f32 v68, v62, v63
    v_add_f32 v56, v56, v38
    v_add_f32 v56, v56, v39
    v_cvt_pk_bf16_f32 v69, v38, v39
    v_exp_f32 v58, v168
    v_exp_f32 v59, v169
    v_exp_f32 v60, v170
    v_exp_f32 v61, v171
    v_add_f32 v57, v58, v59
    v_cvt_pk_bf16_f32 v72, v58, v59
    v_add_f32 v57, v57, v60
    v_add_f32 v57, v57, v61
    v_cvt_pk_bf16_f32 v73, v60, v61
    v_exp_f32 v62, v172
    v_exp_f32 v63, v173
    v_exp_f32 v38, v174
    v_exp_f32 v39, v175
    v_add_f32 v55, v55, v62
    v_add_f32 v55, v55, v63
    v_cvt_pk_bf16_f32 v66, v62, v63
    v_add_f32 v55, v55, v38
    v_add_f32 v55, v55, v39
    v_cvt_pk_bf16_f32 v67, v38, v39
    v_exp_f32 v58, v176
    v_exp_f32 v59, v177
    v_exp_f32 v60, v178
    v_exp_f32 v61, v179
    v_add_f32 v56, v56, v58
    v_add_f32 v56, v56, v59
    v_cvt_pk_bf16_f32 v70, v58, v59
    v_add_f32 v56, v56, v60
    v_add_f32 v56, v56, v61
    v_cvt_pk_bf16_f32 v71, v60, v61
    v_exp_f32 v62, v180
    v_exp_f32 v63, v181
    v_exp_f32 v38, v182
    v_exp_f32 v39, v183
    v_add_f32 v57, v57, v62
    v_add_f32 v57, v57, v63
    v_cvt_pk_bf16_f32 v74, v62, v63
    v_add_f32 v57, v57, v38
    v_add_f32 v57, v57, v39
    v_cvt_pk_bf16_f32 v75, v38, v39
    v_exp_f32 v58, v184
    v_exp_f32 v59, v185
    v_exp_f32 v60, v186
    v_exp_f32 v61, v187
    v_add_f32 v55, v55, v58
    v_add_f32 v55, v55, v59
    v_cvt_pk_bf16_f32 v76, v58, v59
    v_add_f32 v55, v55, v60
    v_add_f32 v55, v55, v61
    v_cvt_pk_bf16_f32 v77, v60, v61
    v_exp_f32 v62, v188
    v_exp_f32 v63, v189
    v_exp_f32 v38, v190
    v_exp_f32 v39, v191
    v_add_f32 v56, v56, v62
    v_add_f32 v56, v56, v63
    v_cvt_pk_bf16_f32 v80, v62, v63
    v_add_f32 v56, v56, v38
    v_add_f32 v56, v56, v39
    v_cvt_pk_bf16_f32 v81, v38, v39
    v_exp_f32 v58, v192
    v_exp_f32 v59, v193
    v_exp_f32 v60, v194
    v_exp_f32 v61, v195
    v_add_f32 v57, v57, v58
    v_add_f32 v57, v57, v59
    v_cvt_pk_bf16_f32 v84, v58, v59
    v_add_f32 v57, v57, v60
    v_add_f32 v57, v57, v61
    v_cvt_pk_bf16_f32 v85, v60, v61
    v_exp_f32 v62, v196
    v_exp_f32 v63, v197
    v_exp_f32 v38, v198
    v_exp_f32 v39, v199
    v_add_f32 v55, v55, v62
    v_add_f32 v55, v55, v63
    v_cvt_pk_bf16_f32 v78, v62, v63
    v_add_f32 v55, v55, v38
    v_add_f32 v55, v55, v39
    v_cvt_pk_bf16_f32 v79, v38, v39
    v_exp_f32 v58, v200
    v_exp_f32 v59, v201
    v_exp_f32 v60, v202
    v_exp_f32 v61, v203
    v_add_f32 v56, v56, v58
    v_add_f32 v56, v56, v59
    v_cvt_pk_bf16_f32 v82, v58, v59
    v_add_f32 v56, v56, v60
    v_add_f32 v56, v56, v61
    v_cvt_pk_bf16_f32 v83, v60, v61
    v_exp_f32 v62, v204
    v_exp_f32 v63, v205
    v_exp_f32 v38, v206
    v_exp_f32 v39, v207
    v_add_f32 v57, v57, v62
    v_add_f32 v57, v57, v63
    v_cvt_pk_bf16_f32 v86, v62, v63
    v_add_f32 v57, v57, v38
    v_add_f32 v57, v57, v39
    v_cvt_pk_bf16_f32 v87, v38, v39
    s_nop 7
    s_setpc_b64 s[30:31]
L_spin_0:
    s_mov_b32 s42, 400000
L_spin_l0:
    s_sub_u32 s42, s42, 1
    s_cbranch_scc1 L_ready_0
    s_sleep 1
    buffer_load_dword v1, v34, s[24:27], 0 offen sc1
    s_waitcnt vmcnt(0)
    v_cmp_gt_u32 vcc, 1, v1
    s_cbranch_vccnz L_spin_l0
    s_branch L_ready_0
L_spin_1:
    s_mov_b32 s42, 400000
L_spin_l1:
    s_sub_u32 s42, s42, 1
    s_cbranch_scc1 L_ready_1
    s_sleep 1
    buffer_load_dword v1, v34, s[24:27], 0 offen sc1
    s_waitcnt vmcnt(0)
    v_cmp_gt_u32 vcc, 2, v1
    s_cbranch_vccnz L_spin_l1
    s_branch L_ready_1
L_spin_2:
    s_mov_b32 s42, 400000
L_spin_l2:
    s_sub_u32 s42, s42, 1
    s_cbranch_scc1 L_ready_2
    s_sleep 1
    buffer_load_dword v1, v34, s[24:27], 0 offen sc1
    s_waitcnt vmcnt(0)
    v_cmp_gt_u32 vcc, 3, v1
    s_cbranch_vccnz L_spin_l2
    s_branch L_ready_2
L_spin_3:
    s_mov_b32 s42, 400000
L_spin_l3:
    s_sub_u32 s42, s42, 1
    s_cbranch_scc1 L_ready_3
    s_sleep 1
    buffer_load_dword v1, v34, s[24:27], 0 offen sc1
    s_waitcnt vmcnt(0)
    v_cmp_gt_u32 vcc, 4, v1
    s_cbranch_vccnz L_spin_l3
    s_branch L_ready_3
L_hs_spin:
    s_mov_b32 s42, 400000
L_hs_l:
    s_sub_u32 s42, s42, 1
    s_cbranch_scc1 L_hs_ok
    s_sleep 1
    buffer_load_dword v2, v4, s[60:63], s41 offen sc1
    s_waitcnt vmcnt(0)
    v_cmp_gt_u32 vcc, 16, v2
    s_cbranch_vccnz L_hs_l
    s_branch L_hs_ok
L_standalone__mha_block_cached__near_ridge_kernel_end:
.section .rodata,"a"
.p2align 6
.amdhsa_kernel standalone__mha_block_cached__near_ridge_kernel
  .amdhsa_next_free_vgpr 512
  .amdhsa_next_free_sgpr 102
  .amdhsa_accum_offset 256
  .amdhsa_group_segment_fixed_size 0
  .amdhsa_kernarg_size 64
  .amdhsa_user_sgpr_count 2
  .amdhsa_user_sgpr_kernarg_segment_ptr 1
  .amdhsa_system_sgpr_workgroup_id_x 1
  .amdhsa_float_denorm_mode_32 3
.end_amdhsa_kernel
```
